```python
import torch

def _softmax(x, axis=-1):
    return torch.softmax(x, dim=axis)
def _gelu(x):
    return torch.nn.functional.gelu(x, approximate="tanh")
def _silu(x):
    return torch.nn.functional.silu(x)
def _sigmoid(x):
    return torch.sigmoid(x)
def _layernorm(x, axis=-1, eps=1e-5):
    m = x.mean(dim=axis, keepdim=True)
    v = x.var(dim=axis, keepdim=True, unbiased=False)
    return (x - m) / torch.sqrt(v + eps)
def _scatter_add(tgt, idx, src, axis=0):
    return tgt.clone().index_add_(axis, idx, src)
def _segment_sum(src, seg, n):
    out = torch.zeros((n,) + src.shape[1:], dtype=src.dtype)
    return out.index_add_(0, seg, src)
def _pad(x, pw):
    flat = tuple(v for pair in reversed(pw) for v in pair)
    return torch.nn.functional.pad(x, flat)

kernel_name = 'gated_mix__compressed_kv_cla__mixer_channel_mlp__prompt'

def setup_inputs():

    _w = (lambda a: (lambda t: t.to(torch.bfloat16) if t.is_floating_point() else t)(torch.as_tensor(a)))
    def _A_setup():
        B, H, Sq, Sk, D, M = 1, 32, 2048, 2048, 128, 512
        Dc = 4 * D
        return {
            "x": _w((lambda *s: torch.randn(*s, dtype=torch.bfloat16) * 0.05)(B, Sq, M)),
            "c_kv": _w((lambda *s: torch.randn(*s, dtype=torch.bfloat16) * 0.8)(B, Sk, Dc)),
            "w_q": _w((lambda *s: torch.randn(*s, dtype=torch.bfloat16) * 6.4)(M, H, D) * (M ** -0.5)),
            "w_uk": _w((lambda *s: torch.randn(*s, dtype=torch.bfloat16) * 6.4)(Dc, H, D) * (Dc ** -0.5)),
            "w_uv": _w((lambda *s: torch.randn(*s, dtype=torch.bfloat16) * 0.8)(Dc, H, D) * (Dc ** -0.5)),
            "w_o": _w((lambda *s: torch.randn(*s, dtype=torch.bfloat16) * 0.8)(H, D, M) * ((H * D) ** -0.5)),
        }
    _A_in = _A_setup()

    def _B_setup():
        B, S, D, F = 1, 2048, 512, 1376
        return {
            "x": _w((lambda *s: torch.randn(*s, dtype=torch.bfloat16) * 0.05)(B, S, D)),
            "w1": _w((lambda *s: torch.randn(*s, dtype=torch.bfloat16) * 3.2)(D, F) * (D ** -0.5)),
            "b1": _w((lambda *s: torch.randn(*s, dtype=torch.bfloat16) * 1.6)(F)),
            "w2": _w((lambda *s: torch.randn(*s, dtype=torch.bfloat16) * 0.05)(F, D) * (F ** -0.5)),
            "b2": _w((lambda *s: torch.randn(*s, dtype=torch.bfloat16) * 0.05)(D)),
        }
    _B_in = _B_setup()

    return {
        "A_x": _A_in["x"],
        "A_c_kv": _A_in["c_kv"],
        "A_w_q": _A_in["w_q"],
        "A_w_uk": _A_in["w_uk"],
        "A_w_uv": _A_in["w_uv"],
        "A_w_o": _A_in["w_o"],
        "B_x": _B_in["x"],
        "B_w1": _B_in["w1"],
        "B_b1": _B_in["b1"],
        "B_w2": _B_in["w2"],
        "B_b2": _B_in["b2"],
        "gate_w": _w((lambda *s: torch.randn(*s, dtype=torch.bfloat16) * 0.05)(512) * 16.0),
    }

def reference(A_x, A_c_kv, A_w_q, A_w_uk, A_w_uv, A_w_o, B_x, B_w1, B_b1, B_w2, B_b2, gate_w):
    def _A_ref(x, c_kv, w_q, w_uk, w_uv, w_o):
        B, Sq, M = x.shape[0], x.shape[1], x.shape[2]
        Sk = c_kv.shape[1]
        H, D = w_q.shape[1], w_q.shape[2]
        q = torch.einsum("bqm,mhd->bhqd", x, w_q)
        k = torch.einsum("bkc,chd->bhkd", c_kv, w_uk)
        v = torch.einsum("bkc,chd->bhkd", c_kv, w_uv)
        scores = torch.einsum("bhqd,bhkd->bhqk", q, k) * (D ** -0.5)
        off = Sk - Sq
        qi = torch.arange(Sq)[:, None]
        kj = torch.arange(Sk)[None, :]
        cmask = kj <= (qi + off)
        scores = torch.where(cmask[None, None], scores, -1e9)
        p = _softmax(scores, axis=-1)
        ctx = torch.einsum("bhqk,bhkd->bhqd", p, v)
        return torch.einsum("bhqd,hdm->bqm", ctx, w_o)

    def _B_ref(x, w1, b1, w2, b2):
        y = _layernorm(x, axis=-1)
        h = _gelu(torch.einsum("bsd,df->bsf", y, w1) + b1)
        return torch.einsum("bsf,fd->bsd", h, w2) + b2

    x = A_x
    g = _sigmoid((x * gate_w).sum(-1, keepdims=True))
    a = _A_ref(x, A_c_kv, A_w_q, A_w_uk, A_w_uv, A_w_o)
    b = _B_ref(x, B_w1, B_b1, B_w2, B_b2)
    return g * a + (1 - g) * b
```

```asm
; @launch kernel=p1_kernel grid=(256,1,1) block=(256,1,1) lds=163840
; @launch kernel=p2_kernel grid=(256,1,1) block=(512,1,1) lds=163840
.amdgcn_target "amdgcn-amd-amdhsa--gfx950"
.text
    .globl p1_kernel
    .p2align 8
    .type p1_kernel,@function
p1_kernel:
    s_cmp_ge_u32 s2, 256
    s_cbranch_scc1 p1_kernel_end
    s_load_dwordx2 s[4:5], s[0:1], 112
    s_load_dwordx4 s[60:63], s[0:1], 0
    s_load_dwordx4 s[64:67], s[0:1], 16
    s_load_dwordx2 s[26:27], s[0:1], 32
    s_load_dwordx4 s[72:75], s[0:1], 56
    s_load_dwordx2 s[20:21], s[0:1], 88
    v_and_b32 v190, 63, v0
    v_lshrrev_b32 v191, 6, v0
    s_nop 0
    v_readfirstlane_b32 s35, v191
    s_getpc_b64 s[96:97]
p1_kernel_ct0:
    s_sub_u32 s96, s96, p1_kernel_ct0-p1_kernel
    s_subb_u32 s97, s97, 0
    s_lshr_b32 s98, s2, 3
    s_lshl_b32 s98, s98, 2
    s_add_u32 s98, s98, s35
    s_lshl_b32 s98, s98, 6
    v_add_u32 v193, s98, v190
    s_mov_b32 s98, (p1_kernel_end-p1_kernel)/128-1
    v_min_u32 v193, s98, v193
    v_lshlrev_b32 v193, 7, v193
    global_load_dword v192, v193, s[96:97]
    v_lshrrev_b32 v26, 6, v0
    v_and_b32 v20, 63, v0
    v_lshrrev_b32 v21, 4, v20
    v_readfirstlane_b32 s35, v26
    v_lshlrev_b32 v1, 4, v20
    s_and_b32 s68, s2, 7
    s_lshr_b32 s69, s2, 3
    s_and_b32 s36, s69, 7
    s_lshr_b32 s69, s69, 3
    s_lshl_b32 s68, s68, 2
    s_add_u32 s99, s68, s69
    v_lshrrev_b32 v26, 3, v20
    v_and_b32 v27, 7, v20
    v_lshlrev_b32 v28, 10, v26
    v_lshlrev_b32 v29, 4, v27
    v_add_u32 v28, v28, v29
    s_lshl_b32 s68, s36, 8
    s_lshl_b32 s78, s35, 6
    s_add_u32 s68, s68, s78
    s_lshl_b32 s68, s68, 10
    s_mov_b32 s14, 0x200000
    s_mov_b32 s15, 0x00020000
    s_waitcnt lgkmcnt(0)
    s_cmp_lt_u32 s99, 17
    s_cselect_b32 s12, s62, s60
    s_cselect_b32 s13, s63, s61
    s_and_b32 s13, s13, 0xffff
    s_add_u32 s37, s68, 0
    buffer_load_dwordx4 v[32:35], v28, s[12:15], s37 offen
    s_add_u32 s37, s68, 8192
    buffer_load_dwordx4 v[36:39], v28, s[12:15], s37 offen
    s_add_u32 s37, s68, 16384
    buffer_load_dwordx4 v[40:43], v28, s[12:15], s37 offen
    s_add_u32 s37, s68, 24576
    buffer_load_dwordx4 v[44:47], v28, s[12:15], s37 offen
    s_add_u32 s37, s68, 32768
    buffer_load_dwordx4 v[48:51], v28, s[12:15], s37 offen
    s_add_u32 s37, s68, 40960
    buffer_load_dwordx4 v[52:55], v28, s[12:15], s37 offen
    s_add_u32 s37, s68, 49152
    buffer_load_dwordx4 v[56:59], v28, s[12:15], s37 offen
    s_add_u32 s37, s68, 57344
    buffer_load_dwordx4 v[60:63], v28, s[12:15], s37 offen
    s_and_b32 s5, s5, 0xffff
    s_mov_b32 s6, 0x10000000
    s_mov_b32 s7, 0x00020000
    s_mov_b32 s24, s66
    s_and_b32 s25, s67, 0xffff
    s_and_b32 s27, s27, 0xffff
    s_and_b32 s21, s21, 0xffff
    s_mov_b32 s22, 1024
    s_mov_b32 s23, 0x00020000
    s_mov_b32 s16, s74
    s_and_b32 s17, s75, 0xffff
    s_mov_b32 s18, 2752
    s_mov_b32 s19, 0x00020000
    s_mov_b32 s11, 0x00020000
    s_cmp_ge_u32 s2, 80
    s_cbranch_scc1 p1_kernel_noflag
    s_cmp_lg_u32 s35, 0
    s_cbranch_scc1 p1_kernel_noflag
    v_mov_b32 v96, 0
    v_mov_b32 v97, 0
    v_mov_b32 v98, 0
    v_mov_b32 v99, 0
    v_mov_b32 v100, 0
    s_lshl_b32 s69, s2, 8
    s_add_u32 s69, s69, 0x5300000
    s_cmp_ge_u32 s2, 64
    s_cselect_b32 s78, 0xc000, 0
    s_add_u32 s69, s69, s78
    v_cmp_eq_u32 vcc, 0, v20
    s_and_saveexec_b64 s[78:79], vcc
    buffer_store_dwordx4 v[96:99], v100, s[4:7], s69 offen sc1
    s_mov_b64 exec, s[78:79]
p1_kernel_noflag:
    s_mov_b32 s98, s99
    s_cmp_lt_u32 s98, 17
    s_cbranch_scc1 p1_kernel_role_kv
    s_cmp_lt_u32 s98, 26
    s_cbranch_scc1 p1_kernel_role_q
    s_sub_u32 s98, s98, 26
    s_mul_i32 s29, s98, 3
    s_min_u32 s69, s98, 4
    s_add_u32 s29, s29, s69
    s_cmp_lt_u32 s98, 4
    s_cselect_b32 s44, 4, 3
    s_mov_b32 s45, 2
    v_lshlrev_b32 v193, 7, v20
    buffer_load_dword v192, v193, s[20:23], 0 offen
    buffer_load_dword v192, v193, s[16:19], 0 offen
    s_mov_b32 s8, s72
    s_and_b32 s9, s73, 0xffff
    s_mov_b32 s10, 1409024
    s_mov_b32 s32, 22016
    s_branch p1_kernel_role_j
p1_kernel_role_q:
    s_sub_u32 s98, s98, 17
    s_mul_i32 s29, s98, 7
    s_min_u32 s69, s98, 1
    s_add_u32 s29, s29, s69
    s_cmp_lt_u32 s98, 1
    s_cselect_b32 s44, 8, 7
    s_mov_b32 s45, 1
    s_mov_b32 s8, s64
    s_and_b32 s9, s65, 0xffff
    s_mov_b32 s10, 0x400000
    s_mov_b32 s32, 65536
    s_branch p1_kernel_role_j
p1_kernel_role_kv:
    s_mul_i32 s29, s98, 7
    s_lshr_b32 s69, s98, 2
    s_lshl_b32 s69, s69, 1
    s_add_u32 s29, s29, s69
    s_and_b32 s69, s98, 3
    s_min_u32 s78, s69, 2
    s_add_u32 s29, s29, s78
    s_cmp_lt_u32 s69, 2
    s_cselect_b32 s44, 8, 7
    s_mov_b32 s45, 0
    s_mov_b32 s8, s24
    s_mov_b32 s9, s25
    s_mov_b32 s10, 0x400000
    s_mov_b32 s32, 65536
p1_kernel_role_j:
    s_add_u32 s44, s44, s29
    s_mov_b32 s94, s10
    s_mov_b32 s95, 0x00020000
    s_mov_b32 s92, s8
    s_mov_b32 s93, s9
    s_lshr_b32 s69, s32, 3
    v_mul_lo_u32 v29, v26, s69
    v_and_b32 v30, 1, v21
    v_lshlrev_b32 v30, 1, v30
    v_xor_b32 v30, v30, v27
    v_lshlrev_b32 v30, 4, v30
    v_add_u32 v2, v29, v30
    v_xor_b32 v30, 64, v30
    v_add_u32 v3, v29, v30
    s_mov_b32 s30, s29
    s_mov_b32 s31, 0
    s_mov_b32 s57, 0
    s_cmp_eq_u32 s45, 0
    s_cbranch_scc0 p1_kernel_pf_o0
    s_cmp_lt_u32 s30, 64
    s_cselect_b32 s8, s24, s26
    s_cselect_b32 s9, s25, s27
    s_and_b32 s40, s30, 63
    s_lshl_b32 s40, s40, 7
    s_lshl_b32 s39, s31, 2
    s_add_u32 s39, s39, s35
    s_lshl_b32 s39, s39, 2
    s_mul_i32 s39, s39, s32
    s_add_u32 s40, s40, s39
    s_lshl_b32 s39, s35, 12
    s_add_u32 s39, s39, s57
    s_branch p1_kernel_pf_j0
p1_kernel_pf_o0:
    s_lshl_b32 s40, s30, 7
    s_lshl_b32 s39, s31, 2
    s_add_u32 s39, s39, s35
    s_lshl_b32 s39, s39, 2
    s_mul_i32 s39, s39, s32
    s_add_u32 s40, s40, s39
    s_lshl_b32 s39, s35, 12
    s_add_u32 s39, s39, s57
p1_kernel_pf_j0:
    s_mov_b32 m0, s39
    s_nop 0
    buffer_load_dwordx4 v2, s[8:11], s40 offen lds
    s_add_u32 m0, m0, 1024
    s_add_u32 s40, s40, s32
    buffer_load_dwordx4 v3, s[8:11], s40 offen lds
    s_add_u32 m0, m0, 1024
    s_add_u32 s40, s40, s32
    buffer_load_dwordx4 v2, s[8:11], s40 offen lds
    s_add_u32 m0, m0, 1024
    s_add_u32 s40, s40, s32
    buffer_load_dwordx4 v3, s[8:11], s40 offen lds
    s_add_u32 s57, s57, 16384
    s_and_b32 s57, s57, 0x1ffff
    s_add_u32 s31, s31, 1
    s_lshr_b32 s39, s31, 2
    s_add_u32 s30, s30, s39
    s_and_b32 s31, s31, 3
    s_add_u32 s37, s68, 128
    buffer_load_dwordx4 v[64:67], v28, s[12:15], s37 offen
    s_add_u32 s37, s68, 8320
    buffer_load_dwordx4 v[68:71], v28, s[12:15], s37 offen
    s_add_u32 s37, s68, 16512
    buffer_load_dwordx4 v[72:75], v28, s[12:15], s37 offen
    s_add_u32 s37, s68, 24704
    buffer_load_dwordx4 v[76:79], v28, s[12:15], s37 offen
    s_add_u32 s37, s68, 32896
    buffer_load_dwordx4 v[80:83], v28, s[12:15], s37 offen
    s_add_u32 s37, s68, 41088
    buffer_load_dwordx4 v[84:87], v28, s[12:15], s37 offen
    s_add_u32 s37, s68, 49280
    buffer_load_dwordx4 v[88:91], v28, s[12:15], s37 offen
    s_add_u32 s37, s68, 57472
    buffer_load_dwordx4 v[92:95], v28, s[12:15], s37 offen
    s_lshl_b32 s78, s36, 6
    s_lshl_b32 s79, s35, 4
    s_add_u32 s78, s78, s79
    v_and_b32 v26, 15, v20
    v_add_u32 v27, s78, v26
    v_mul_lo_u32 v22, v27, s69
    v_lshlrev_b32 v27, 3, v21
    v_lshrrev_b32 v29, 2, v26
    v_add_u32 v27, v27, v29
    v_lshlrev_b32 v27, 7, v27
    v_lshrrev_b32 v29, 3, v26
    v_and_b32 v30, 1, v21
    v_lshlrev_b32 v30, 1, v30
    v_or_b32 v29, v29, v30
    v_lshlrev_b32 v29, 5, v29
    v_add_u32 v27, v27, v29
    v_and_b32 v29, 3, v26
    v_lshlrev_b32 v29, 3, v29
    v_add_u32 v4, v27, v29
    v_xor_b32 v5, 32, v4
    v_xor_b32 v6, 64, v4
    v_xor_b32 v7, 96, v4
    v_mov_b32 v8, v4
    v_add_u32 v12, 0x4000, v4
    v_mov_b32 v9, v5
    v_add_u32 v13, 0x4000, v5
    v_mov_b32 v10, v6
    v_add_u32 v14, 0x4000, v6
    v_mov_b32 v11, v7
    v_add_u32 v15, 0x4000, v7
    s_mov_b32 s56, 0x4000
    v_lshlrev_b32 v24, 3, v21
    s_lshl_b32 s78, s35, 13
    s_add_u32 s78, s78, 0x20000
    v_lshrrev_b32 v27, 3, v20
    v_lshlrev_b32 v27, 7, v27
    v_and_b32 v29, 7, v20
    v_xor_b32 v29, v29, v21
    v_lshlrev_b32 v29, 4, v29
    v_add_u32 v27, v27, v29
    v_add_u32 v29, s78, v27
    v_xor_b32 v30, 64, v29
    v_lshlrev_b32 v27, 7, v26
    v_lshrrev_b32 v31, 1, v26
    v_xor_b32 v31, v31, v21
    v_lshlrev_b32 v31, 4, v31
    v_add_u32 v31, v31, v27
    v_add_u32 v31, s78, v31
    v_xor_b32 v23, 64, v31
    s_add_u32 s37, s68, 256
    buffer_load_dwordx4 v[192:195], v28, s[12:15], s37 offen
    s_add_u32 s37, s68, 8448
    buffer_load_dwordx4 v[196:199], v28, s[12:15], s37 offen
    s_add_u32 s37, s68, 16640
    buffer_load_dwordx4 v[200:203], v28, s[12:15], s37 offen
    s_add_u32 s37, s68, 24832
    buffer_load_dwordx4 v[204:207], v28, s[12:15], s37 offen
    s_add_u32 s37, s68, 33024
    buffer_load_dwordx4 v[208:211], v28, s[12:15], s37 offen
    s_add_u32 s37, s68, 41216
    buffer_load_dwordx4 v[212:215], v28, s[12:15], s37 offen
    s_add_u32 s37, s68, 49408
    buffer_load_dwordx4 v[216:219], v28, s[12:15], s37 offen
    s_add_u32 s37, s68, 57600
    buffer_load_dwordx4 v[220:223], v28, s[12:15], s37 offen
    s_waitcnt vmcnt(20)
    ds_write_b128 v29, v[32:35] offset:0
    ds_write_b128 v30, v[36:39] offset:1024
    ds_write_b128 v29, v[40:43] offset:2048
    ds_write_b128 v30, v[44:47] offset:3072
    ds_write_b128 v29, v[48:51] offset:4096
    ds_write_b128 v30, v[52:55] offset:5120
    ds_write_b128 v29, v[56:59] offset:6144
    ds_write_b128 v30, v[60:63] offset:7168
    s_waitcnt lgkmcnt(0)
    ds_read_b128 a[0:3], v31 offset:0
    ds_read_b128 a[4:7], v23 offset:0
    ds_read_b128 a[64:67], v31 offset:2048
    ds_read_b128 a[68:71], v23 offset:2048
    ds_read_b128 a[128:131], v31 offset:4096
    ds_read_b128 a[132:135], v23 offset:4096
    ds_read_b128 a[192:195], v31 offset:6144
    ds_read_b128 a[196:199], v23 offset:6144
    s_waitcnt lgkmcnt(0)
    s_add_u32 s37, s68, 384
    buffer_load_dwordx4 v[224:227], v28, s[12:15], s37 offen
    s_add_u32 s37, s68, 8576
    buffer_load_dwordx4 v[228:231], v28, s[12:15], s37 offen
    s_add_u32 s37, s68, 16768
    buffer_load_dwordx4 v[232:235], v28, s[12:15], s37 offen
    s_add_u32 s37, s68, 24960
    buffer_load_dwordx4 v[236:239], v28, s[12:15], s37 offen
    s_add_u32 s37, s68, 33152
    buffer_load_dwordx4 v[240:243], v28, s[12:15], s37 offen
    s_add_u32 s37, s68, 41344
    buffer_load_dwordx4 v[244:247], v28, s[12:15], s37 offen
    s_add_u32 s37, s68, 49536
    buffer_load_dwordx4 v[248:251], v28, s[12:15], s37 offen
    s_add_u32 s37, s68, 57728
    buffer_load_dwordx4 v[252:255], v28, s[12:15], s37 offen
    s_waitcnt vmcnt(16)
    ds_write_b128 v29, v[64:67] offset:0
    ds_write_b128 v30, v[68:71] offset:1024
    ds_write_b128 v29, v[72:75] offset:2048
    ds_write_b128 v30, v[76:79] offset:3072
    ds_write_b128 v29, v[80:83] offset:4096
    ds_write_b128 v30, v[84:87] offset:5120
    ds_write_b128 v29, v[88:91] offset:6144
    ds_write_b128 v30, v[92:95] offset:7168
    s_waitcnt lgkmcnt(0)
    ds_read_b128 a[8:11], v31 offset:0
    ds_read_b128 a[12:15], v23 offset:0
    ds_read_b128 a[72:75], v31 offset:2048
    ds_read_b128 a[76:79], v23 offset:2048
    ds_read_b128 a[136:139], v31 offset:4096
    ds_read_b128 a[140:143], v23 offset:4096
    ds_read_b128 a[200:203], v31 offset:6144
    ds_read_b128 a[204:207], v23 offset:6144
    s_waitcnt lgkmcnt(0)
    s_lshl_b32 s78, s36, 4
    s_lshl_b32 s79, s35, 2
    s_add_u32 s78, s78, s79
    s_mov_b32 s33, 0x10000000
    s_mov_b32 s58, 0x10000000
    s_cmp_eq_u32 s45, 1
    s_cbranch_scc1 p1_kernel_run_q
    s_cmp_eq_u32 s45, 2
    s_cbranch_scc1 p1_kernel_run_h
    s_lshl_b32 s47, s78, 13
    s_add_u32 s47, s47, 0x1000000
    s_mov_b32 s69, s44
    s_cmp_ge_u32 s29, 64
    s_cbranch_scc1 p1_kernel_kv_vfirst
    v_add_u32 v16, 0, v1
    v_add_u32 v17, 4096, v1
    v_add_u32 v18, 16384, v1
    v_add_u32 v19, 20480, v1
    s_waitcnt vmcnt(24)
    s_barrier
    ds_read_b64_tr_b16 v[160:161], v8 offset:0
    ds_read_b64_tr_b16 v[162:163], v8 offset:512
    ds_read_b64_tr_b16 v[164:165], v8 offset:4096
    ds_read_b64_tr_b16 v[166:167], v8 offset:4608
    ds_read_b64_tr_b16 v[168:169], v8 offset:8192
    ds_read_b64_tr_b16 v[170:171], v8 offset:8704
    ds_read_b64_tr_b16 v[172:173], v8 offset:12288
    ds_read_b64_tr_b16 v[174:175], v8 offset:12800
    s_waitcnt lgkmcnt(0)
    v_mfma_f32_16x16x32_bf16 v[96:99], v[160:163], a[0:3], 0
    ds_read_b64_tr_b16 v[176:177], v9 offset:0
    s_mov_b32 s34, s33
    s_mov_b32 s59, s58
    s_lshr_b32 s37, s29, 1
    v_mfma_f32_16x16x32_bf16 v[96:99], v[164:167], a[4:7], v[96:99]
    ds_read_b64_tr_b16 v[178:179], v9 offset:512
    s_lshl_b32 s37, s37, 20
    s_and_b32 s38, s29, 1
    s_lshl_b32 s38, s38, 11
    v_mfma_f32_16x16x32_bf16 v[96:99], v[168:171], a[8:11], v[96:99]
    ds_read_b64_tr_b16 v[180:181], v9 offset:4096
    s_add_u32 s37, s37, s38
    s_add_u32 s33, s37, s47
    s_add_u32 s58, s33, 1024
    v_mfma_f32_16x16x32_bf16 v[96:99], v[172:175], a[12:15], v[96:99]
    ds_read_b64_tr_b16 v[182:183], v9 offset:4608
    s_cmp_lt_u32 s30, 64
    s_cselect_b32 s8, s24, s26
    s_cselect_b32 s9, s25, s27
    v_mfma_f32_16x16x32_bf16 v[100:103], v[160:163], a[64:67], 0
    ds_read_b64_tr_b16 v[184:185], v9 offset:8192
    s_and_b32 s40, s30, 63
    s_lshl_b32 s40, s40, 7
    s_lshl_b32 s39, s31, 2
    v_mfma_f32_16x16x32_bf16 v[100:103], v[164:167], a[68:71], v[100:103]
    ds_read_b64_tr_b16 v[186:187], v9 offset:8704
    s_add_u32 s39, s39, s35
    s_lshl_b32 s39, s39, 2
    s_mul_i32 s39, s39, s32
    v_mfma_f32_16x16x32_bf16 v[100:103], v[168:171], a[72:75], v[100:103]
    ds_read_b64_tr_b16 v[188:189], v9 offset:12288
    s_add_u32 s40, s40, s39
    s_lshl_b32 s39, s35, 12
    s_add_u32 s39, s39, s57
    v_mfma_f32_16x16x32_bf16 v[100:103], v[172:175], a[76:79], v[100:103]
    ds_read_b64_tr_b16 v[190:191], v9 offset:12800
    s_waitcnt vmcnt(8)
    s_mov_b32 m0, s39
    s_nop 0
    v_mfma_f32_16x16x32_bf16 v[104:107], v[160:163], a[128:131], 0
    ds_write_b128 v29, v[192:195] offset:0
    buffer_load_dwordx4 v2, s[8:11], s40 offen lds
    s_add_u32 s42, s68, 512
    buffer_load_dwordx4 v[32:35], v28, s[12:15], s42 offen
    v_mfma_f32_16x16x32_bf16 v[104:107], v[164:167], a[132:135], v[104:107]
    ds_write_b128 v30, v[196:199] offset:1024
    s_add_u32 m0, m0, 1024
    s_add_u32 s40, s40, s32
    v_mfma_f32_16x16x32_bf16 v[104:107], v[168:171], a[136:139], v[104:107]
    ds_write_b128 v29, v[200:203] offset:2048
    buffer_load_dwordx4 v3, s[8:11], s40 offen lds
    s_add_u32 s42, s68, 8704
    buffer_load_dwordx4 v[36:39], v28, s[12:15], s42 offen
    v_mfma_f32_16x16x32_bf16 v[104:107], v[172:175], a[140:143], v[104:107]
    ds_write_b128 v30, v[204:207] offset:3072
    s_add_u32 m0, m0, 1024
    s_add_u32 s40, s40, s32
    v_mfma_f32_16x16x32_bf16 v[108:111], v[160:163], a[192:195], 0
    ds_write_b128 v29, v[208:211] offset:4096
    buffer_load_dwordx4 v2, s[8:11], s40 offen lds
    s_add_u32 s42, s68, 16896
    buffer_load_dwordx4 v[40:43], v28, s[12:15], s42 offen
    v_mfma_f32_16x16x32_bf16 v[108:111], v[164:167], a[196:199], v[108:111]
    ds_write_b128 v30, v[212:215] offset:5120
    s_add_u32 m0, m0, 1024
    s_add_u32 s40, s40, s32
    v_mfma_f32_16x16x32_bf16 v[108:111], v[168:171], a[200:203], v[108:111]
    ds_write_b128 v29, v[216:219] offset:6144
    buffer_load_dwordx4 v3, s[8:11], s40 offen lds
    s_add_u32 s42, s68, 25088
    buffer_load_dwordx4 v[44:47], v28, s[12:15], s42 offen
    v_mfma_f32_16x16x32_bf16 v[108:111], v[172:175], a[204:207], v[108:111]
    ds_write_b128 v30, v[220:223] offset:7168
    s_add_u32 s57, s57, 16384
    s_and_b32 s57, s57, 0x1ffff
    s_add_u32 s31, s31, 1
    s_waitcnt lgkmcnt(0)
    v_mfma_f32_16x16x32_bf16 v[112:115], v[176:179], a[0:3], 0
    ds_read_b64_tr_b16 v[160:161], v10 offset:0
    s_lshr_b32 s39, s31, 2
    s_add_u32 s30, s30, s39
    s_and_b32 s31, s31, 3
    v_mfma_f32_16x16x32_bf16 v[112:115], v[180:183], a[4:7], v[112:115]
    ds_read_b64_tr_b16 v[162:163], v10 offset:512
    s_cmp_lt_u32 s30, 64
    s_cselect_b32 s8, s24, s26
    s_cselect_b32 s9, s25, s27
    v_mfma_f32_16x16x32_bf16 v[112:115], v[184:187], a[8:11], v[112:115]
    ds_read_b64_tr_b16 v[164:165], v10 offset:4096
    s_and_b32 s40, s30, 63
    s_lshl_b32 s40, s40, 7
    s_lshl_b32 s39, s31, 2
    v_mfma_f32_16x16x32_bf16 v[112:115], v[188:191], a[12:15], v[112:115]
    ds_read_b64_tr_b16 v[166:167], v10 offset:4608
    s_add_u32 s39, s39, s35
    s_lshl_b32 s39, s39, 2
    s_mul_i32 s39, s39, s32
    v_mfma_f32_16x16x32_bf16 v[116:119], v[176:179], a[64:67], 0
    ds_read_b64_tr_b16 v[168:169], v10 offset:8192
    s_add_u32 s40, s40, s39
    s_lshl_b32 s39, s35, 12
    s_add_u32 s39, s39, s57
    v_mfma_f32_16x16x32_bf16 v[116:119], v[180:183], a[68:71], v[116:119]
    ds_read_b64_tr_b16 v[170:171], v10 offset:8704
    s_mov_b32 m0, s39
    s_nop 0
    v_mfma_f32_16x16x32_bf16 v[116:119], v[184:187], a[72:75], v[116:119]
    ds_read_b64_tr_b16 v[172:173], v10 offset:12288
    buffer_load_dwordx4 v2, s[8:11], s40 offen lds
    s_add_u32 s42, s68, 33280
    buffer_load_dwordx4 v[48:51], v28, s[12:15], s42 offen
    v_mfma_f32_16x16x32_bf16 v[116:119], v[188:191], a[76:79], v[116:119]
    ds_read_b64_tr_b16 v[174:175], v10 offset:12800
    s_add_u32 m0, m0, 1024
    s_add_u32 s40, s40, s32
    v_mfma_f32_16x16x32_bf16 v[120:123], v[176:179], a[128:131], 0
    ds_read_b128 a[16:19], v31 offset:0
    buffer_load_dwordx4 v3, s[8:11], s40 offen lds
    s_add_u32 s42, s68, 41472
    buffer_load_dwordx4 v[52:55], v28, s[12:15], s42 offen
    v_mfma_f32_16x16x32_bf16 v[120:123], v[180:183], a[132:135], v[120:123]
    ds_read_b128 a[20:23], v23 offset:0
    s_add_u32 m0, m0, 1024
    s_add_u32 s40, s40, s32
    v_mfma_f32_16x16x32_bf16 v[120:123], v[184:187], a[136:139], v[120:123]
    ds_read_b128 a[80:83], v31 offset:2048
    buffer_load_dwordx4 v2, s[8:11], s40 offen lds
    s_add_u32 s42, s68, 49664
    buffer_load_dwordx4 v[56:59], v28, s[12:15], s42 offen
    v_mfma_f32_16x16x32_bf16 v[120:123], v[188:191], a[140:143], v[120:123]
    ds_read_b128 a[84:87], v23 offset:2048
    s_add_u32 m0, m0, 1024
    s_add_u32 s40, s40, s32
    v_mfma_f32_16x16x32_bf16 v[124:127], v[176:179], a[192:195], 0
    ds_read_b128 a[144:147], v31 offset:4096
    buffer_load_dwordx4 v3, s[8:11], s40 offen lds
    s_add_u32 s42, s68, 57856
    buffer_load_dwordx4 v[60:63], v28, s[12:15], s42 offen
    v_mfma_f32_16x16x32_bf16 v[124:127], v[180:183], a[196:199], v[124:127]
    ds_read_b128 a[148:151], v23 offset:4096
    s_add_u32 s57, s57, 16384
    s_and_b32 s57, s57, 0x1ffff
    s_add_u32 s31, s31, 1
    v_mfma_f32_16x16x32_bf16 v[124:127], v[184:187], a[200:203], v[124:127]
    ds_read_b128 a[208:211], v31 offset:6144
    s_lshr_b32 s39, s31, 2
    s_add_u32 s30, s30, s39
    s_and_b32 s31, s31, 3
    v_mfma_f32_16x16x32_bf16 v[124:127], v[188:191], a[204:207], v[124:127]
    ds_read_b128 a[212:215], v23 offset:6144
    s_cmp_lt_u32 s30, 64
    s_cselect_b32 s8, s24, s26
    s_cselect_b32 s9, s25, s27
    s_waitcnt lgkmcnt(0)
    v_mfma_f32_16x16x32_bf16 v[128:131], v[160:163], a[0:3], 0
    ds_read_b64_tr_b16 v[176:177], v11 offset:0
    s_and_b32 s40, s30, 63
    s_lshl_b32 s40, s40, 7
    s_lshl_b32 s39, s31, 2
    v_mfma_f32_16x16x32_bf16 v[128:131], v[164:167], a[4:7], v[128:131]
    ds_read_b64_tr_b16 v[178:179], v11 offset:512
    s_add_u32 s39, s39, s35
    s_lshl_b32 s39, s39, 2
    s_mul_i32 s39, s39, s32
    v_mfma_f32_16x16x32_bf16 v[128:131], v[168:171], a[8:11], v[128:131]
    ds_read_b64_tr_b16 v[180:181], v11 offset:4096
    s_add_u32 s40, s40, s39
    s_lshl_b32 s39, s35, 12
    s_add_u32 s39, s39, s57
    v_mfma_f32_16x16x32_bf16 v[128:131], v[172:175], a[12:15], v[128:131]
    ds_read_b64_tr_b16 v[182:183], v11 offset:4608
    s_mov_b32 m0, s39
    s_nop 0
    v_mfma_f32_16x16x32_bf16 v[132:135], v[160:163], a[64:67], 0
    ds_read_b64_tr_b16 v[184:185], v11 offset:8192
    buffer_load_dwordx4 v2, s[8:11], s40 offen lds
    s_add_u32 s42, s68, 640
    buffer_load_dwordx4 v[64:67], v28, s[12:15], s42 offen
    v_mfma_f32_16x16x32_bf16 v[132:135], v[164:167], a[68:71], v[132:135]
    ds_read_b64_tr_b16 v[186:187], v11 offset:8704
    s_add_u32 m0, m0, 1024
    s_add_u32 s40, s40, s32
    v_mfma_f32_16x16x32_bf16 v[132:135], v[168:171], a[72:75], v[132:135]
    ds_read_b64_tr_b16 v[188:189], v11 offset:12288
    buffer_load_dwordx4 v3, s[8:11], s40 offen lds
    s_add_u32 s42, s68, 8832
    buffer_load_dwordx4 v[68:71], v28, s[12:15], s42 offen
    v_mfma_f32_16x16x32_bf16 v[132:135], v[172:175], a[76:79], v[132:135]
    ds_read_b64_tr_b16 v[190:191], v11 offset:12800
    s_waitcnt vmcnt(20)
    s_add_u32 m0, m0, 1024
    s_add_u32 s40, s40, s32
    v_mfma_f32_16x16x32_bf16 v[136:139], v[160:163], a[128:131], 0
    ds_write_b128 v29, v[224:227] offset:0
    buffer_load_dwordx4 v2, s[8:11], s40 offen lds
    s_add_u32 s42, s68, 17024
    buffer_load_dwordx4 v[72:75], v28, s[12:15], s42 offen
    v_mfma_f32_16x16x32_bf16 v[136:139], v[164:167], a[132:135], v[136:139]
    ds_write_b128 v30, v[228:231] offset:1024
    s_add_u32 m0, m0, 1024
    s_add_u32 s40, s40, s32
    v_mfma_f32_16x16x32_bf16 v[136:139], v[168:171], a[136:139], v[136:139]
    ds_write_b128 v29, v[232:235] offset:2048
    buffer_load_dwordx4 v3, s[8:11], s40 offen lds
    s_add_u32 s42, s68, 25216
    buffer_load_dwordx4 v[76:79], v28, s[12:15], s42 offen
    v_mfma_f32_16x16x32_bf16 v[136:139], v[172:175], a[140:143], v[136:139]
    ds_write_b128 v30, v[236:239] offset:3072
    s_add_u32 s57, s57, 16384
    s_and_b32 s57, s57, 0x1ffff
    s_add_u32 s31, s31, 1
    v_mfma_f32_16x16x32_bf16 v[140:143], v[160:163], a[192:195], 0
    ds_write_b128 v29, v[240:243] offset:4096
    s_lshr_b32 s39, s31, 2
    s_add_u32 s30, s30, s39
    s_and_b32 s31, s31, 3
    v_mfma_f32_16x16x32_bf16 v[140:143], v[164:167], a[196:199], v[140:143]
    ds_write_b128 v30, v[244:247] offset:5120
    s_add_u32 s42, s68, 33408
    buffer_load_dwordx4 v[80:83], v28, s[12:15], s42 offen
    v_mfma_f32_16x16x32_bf16 v[140:143], v[168:171], a[200:203], v[140:143]
    ds_write_b128 v29, v[248:251] offset:6144
    v_mfma_f32_16x16x32_bf16 v[140:143], v[172:175], a[204:207], v[140:143]
    ds_write_b128 v30, v[252:255] offset:7168
    s_waitcnt vmcnt(18)
    s_barrier
    s_waitcnt lgkmcnt(0)
    v_mfma_f32_16x16x32_bf16 v[144:147], v[176:179], a[0:3], 0
    ds_read_b64_tr_b16 v[160:161], v12 offset:0
    v_mfma_f32_16x16x32_bf16 v[144:147], v[180:183], a[4:7], v[144:147]
    ds_read_b64_tr_b16 v[162:163], v12 offset:512
    s_add_u32 s42, s68, 41600
    buffer_load_dwordx4 v[84:87], v28, s[12:15], s42 offen
    v_mfma_f32_16x16x32_bf16 v[144:147], v[184:187], a[8:11], v[144:147]
    ds_read_b64_tr_b16 v[164:165], v12 offset:4096
    v_mfma_f32_16x16x32_bf16 v[144:147], v[188:191], a[12:15], v[144:147]
    ds_read_b64_tr_b16 v[166:167], v12 offset:4608
    v_mfma_f32_16x16x32_bf16 v[148:151], v[176:179], a[64:67], 0
    ds_read_b64_tr_b16 v[168:169], v12 offset:8192
    s_add_u32 s42, s68, 49792
    buffer_load_dwordx4 v[88:91], v28, s[12:15], s42 offen
    v_mfma_f32_16x16x32_bf16 v[148:151], v[180:183], a[68:71], v[148:151]
    ds_read_b64_tr_b16 v[170:171], v12 offset:8704
    v_mfma_f32_16x16x32_bf16 v[148:151], v[184:187], a[72:75], v[148:151]
    ds_read_b64_tr_b16 v[172:173], v12 offset:12288
    v_mfma_f32_16x16x32_bf16 v[148:151], v[188:191], a[76:79], v[148:151]
    ds_read_b64_tr_b16 v[174:175], v12 offset:12800
    v_mfma_f32_16x16x32_bf16 v[152:155], v[176:179], a[128:131], 0
    ds_read_b128 a[24:27], v31 offset:0
    s_add_u32 s42, s68, 57984
    buffer_load_dwordx4 v[92:95], v28, s[12:15], s42 offen
    s_add_u32 s56, s56, 16384
    v_mfma_f32_16x16x32_bf16 v[152:155], v[180:183], a[132:135], v[152:155]
    ds_read_b128 a[28:31], v23 offset:0
    s_and_b32 s56, s56, 0x1ffff
    v_mov_b32 v8, v12
    v_mov_b32 v9, v13
    v_mfma_f32_16x16x32_bf16 v[152:155], v[184:187], a[136:139], v[152:155]
    ds_read_b128 a[88:91], v31 offset:2048
    v_mov_b32 v10, v14
    v_mov_b32 v11, v15
    v_add_u32 v12, s56, v4
    v_mfma_f32_16x16x32_bf16 v[152:155], v[188:191], a[140:143], v[152:155]
    ds_read_b128 a[92:95], v23 offset:2048
    v_add_u32 v13, s56, v5
    v_add_u32 v14, s56, v6
    v_add_u32 v15, s56, v7
    v_mfma_f32_16x16x32_bf16 v[156:159], v[176:179], a[192:195], 0
    ds_read_b128 a[152:155], v31 offset:4096
    v_mfma_f32_16x16x32_bf16 v[156:159], v[180:183], a[196:199], v[156:159]
    ds_read_b128 a[156:159], v23 offset:4096
    v_mfma_f32_16x16x32_bf16 v[156:159], v[184:187], a[200:203], v[156:159]
    ds_read_b128 a[216:219], v31 offset:6144
    v_mfma_f32_16x16x32_bf16 v[156:159], v[188:191], a[204:207], v[156:159]
    ds_read_b128 a[220:223], v23 offset:6144
    s_waitcnt lgkmcnt(0)
    v_mfma_f32_16x16x32_bf16 v[96:99], v[160:163], a[16:19], v[96:99]
    ds_read_b64_tr_b16 v[176:177], v9 offset:0
    s_cmp_lt_u32 s30, 64
    s_cselect_b32 s8, s24, s26
    s_cselect_b32 s9, s25, s27
    v_mfma_f32_16x16x32_bf16 v[96:99], v[164:167], a[20:23], v[96:99]
    ds_read_b64_tr_b16 v[178:179], v9 offset:512
    s_and_b32 s40, s30, 63
    s_lshl_b32 s40, s40, 7
    s_lshl_b32 s39, s31, 2
    v_mfma_f32_16x16x32_bf16 v[96:99], v[168:171], a[24:27], v[96:99]
    ds_read_b64_tr_b16 v[180:181], v9 offset:4096
    s_add_u32 s39, s39, s35
    s_lshl_b32 s39, s39, 2
    s_mul_i32 s39, s39, s32
    v_mfma_f32_16x16x32_bf16 v[96:99], v[172:175], a[28:31], v[96:99]
    ds_read_b64_tr_b16 v[182:183], v9 offset:4608
    s_add_u32 s40, s40, s39
    s_lshl_b32 s39, s35, 12
    s_add_u32 s39, s39, s57
    v_mfma_f32_16x16x32_bf16 v[100:103], v[160:163], a[80:83], v[100:103]
    ds_read_b64_tr_b16 v[184:185], v9 offset:8192
    s_mov_b32 m0, s39
    s_nop 0
    v_mfma_f32_16x16x32_bf16 v[100:103], v[164:167], a[84:87], v[100:103]
    ds_read_b64_tr_b16 v[186:187], v9 offset:8704
    buffer_load_dwordx4 v2, s[8:11], s40 offen lds
    s_add_u32 s42, s68, 768
    buffer_load_dwordx4 v[192:195], v28, s[12:15], s42 offen
    v_mfma_f32_16x16x32_bf16 v[100:103], v[168:171], a[88:91], v[100:103]
    ds_read_b64_tr_b16 v[188:189], v9 offset:12288
    s_add_u32 s42, s68, 8960
    buffer_load_dwordx4 v[196:199], v28, s[12:15], s42 offen
    v_mfma_f32_16x16x32_bf16 v[100:103], v[172:175], a[92:95], v[100:103]
    ds_read_b64_tr_b16 v[190:191], v9 offset:12800
    s_waitcnt vmcnt(15)
    v_mfma_f32_16x16x32_bf16 v[104:107], v[160:163], a[144:147], v[104:107]
    ds_write_b128 v29, v[32:35] offset:0
    v_mfma_f32_16x16x32_bf16 v[104:107], v[164:167], a[148:151], v[104:107]
    ds_write_b128 v30, v[36:39] offset:1024
    s_add_u32 s42, s68, 17152
    buffer_load_dwordx4 v[200:203], v28, s[12:15], s42 offen
    v_mfma_f32_16x16x32_bf16 v[104:107], v[168:171], a[152:155], v[104:107]
    ds_write_b128 v29, v[40:43] offset:2048
    v_mfma_f32_16x16x32_bf16 v[104:107], v[172:175], a[156:159], v[104:107]
    ds_write_b128 v30, v[44:47] offset:3072
    v_mfma_f32_16x16x32_bf16 v[108:111], v[160:163], a[208:211], v[108:111]
    ds_write_b128 v29, v[48:51] offset:4096
    s_add_u32 m0, m0, 1024
    s_add_u32 s40, s40, s32
    v_mfma_f32_16x16x32_bf16 v[108:111], v[164:167], a[212:215], v[108:111]
    ds_write_b128 v30, v[52:55] offset:5120
    buffer_load_dwordx4 v3, s[8:11], s40 offen lds
    s_add_u32 s42, s68, 25344
    buffer_load_dwordx4 v[204:207], v28, s[12:15], s42 offen
    v_mfma_f32_16x16x32_bf16 v[108:111], v[168:171], a[216:219], v[108:111]
    ds_write_b128 v29, v[56:59] offset:6144
    v_mfma_f32_16x16x32_bf16 v[108:111], v[172:175], a[220:223], v[108:111]
    ds_write_b128 v30, v[60:63] offset:7168
    s_waitcnt lgkmcnt(0)
    v_mfma_f32_16x16x32_bf16 v[112:115], v[176:179], a[16:19], v[112:115]
    ds_read_b64_tr_b16 v[160:161], v10 offset:0
    s_add_u32 s42, s68, 33536
    buffer_load_dwordx4 v[208:211], v28, s[12:15], s42 offen
    v_mfma_f32_16x16x32_bf16 v[112:115], v[180:183], a[20:23], v[112:115]
    ds_read_b64_tr_b16 v[162:163], v10 offset:512
    v_mfma_f32_16x16x32_bf16 v[112:115], v[184:187], a[24:27], v[112:115]
    ds_read_b64_tr_b16 v[164:165], v10 offset:4096
    v_mfma_f32_16x16x32_bf16 v[112:115], v[188:191], a[28:31], v[112:115]
    ds_read_b64_tr_b16 v[166:167], v10 offset:4608
    v_mfma_f32_16x16x32_bf16 v[116:119], v[176:179], a[80:83], v[116:119]
    ds_read_b64_tr_b16 v[168:169], v10 offset:8192
    s_add_u32 m0, m0, 1024
    s_add_u32 s40, s40, s32
    v_mfma_f32_16x16x32_bf16 v[116:119], v[180:183], a[84:87], v[116:119]
    ds_read_b64_tr_b16 v[170:171], v10 offset:8704
    buffer_load_dwordx4 v2, s[8:11], s40 offen lds
    s_add_u32 s42, s68, 41728
    buffer_load_dwordx4 v[212:215], v28, s[12:15], s42 offen
    v_mfma_f32_16x16x32_bf16 v[116:119], v[184:187], a[88:91], v[116:119]
    ds_read_b64_tr_b16 v[172:173], v10 offset:12288
    v_mfma_f32_16x16x32_bf16 v[116:119], v[188:191], a[92:95], v[116:119]
    ds_read_b64_tr_b16 v[174:175], v10 offset:12800
    s_add_u32 s42, s68, 49920
    buffer_load_dwordx4 v[216:219], v28, s[12:15], s42 offen
    v_mfma_f32_16x16x32_bf16 v[120:123], v[176:179], a[144:147], v[120:123]
    ds_read_b128 a[32:35], v31 offset:0
    v_mfma_f32_16x16x32_bf16 v[120:123], v[180:183], a[148:151], v[120:123]
    ds_read_b128 a[36:39], v23 offset:0
    v_mfma_f32_16x16x32_bf16 v[120:123], v[184:187], a[152:155], v[120:123]
    ds_read_b128 a[96:99], v31 offset:2048
    v_mfma_f32_16x16x32_bf16 v[120:123], v[188:191], a[156:159], v[120:123]
    ds_read_b128 a[100:103], v23 offset:2048
    s_add_u32 s42, s68, 58112
    buffer_load_dwordx4 v[220:223], v28, s[12:15], s42 offen
    v_mfma_f32_16x16x32_bf16 v[124:127], v[176:179], a[208:211], v[124:127]
    ds_read_b128 a[160:163], v31 offset:4096
    s_add_u32 m0, m0, 1024
    s_add_u32 s40, s40, s32
    v_mfma_f32_16x16x32_bf16 v[124:127], v[180:183], a[212:215], v[124:127]
    ds_read_b128 a[164:167], v23 offset:4096
    buffer_load_dwordx4 v3, s[8:11], s40 offen lds
    v_mfma_f32_16x16x32_bf16 v[124:127], v[184:187], a[216:219], v[124:127]
    ds_read_b128 a[224:227], v31 offset:6144
    s_add_u32 s57, s57, 16384
    s_and_b32 s57, s57, 0x1ffff
    s_add_u32 s31, s31, 1
    v_mfma_f32_16x16x32_bf16 v[124:127], v[188:191], a[220:223], v[124:127]
    ds_read_b128 a[228:231], v23 offset:6144
    s_lshr_b32 s39, s31, 2
    s_add_u32 s30, s30, s39
    s_and_b32 s31, s31, 3
    s_waitcnt lgkmcnt(0)
    v_mfma_f32_16x16x32_bf16 v[128:131], v[160:163], a[16:19], v[128:131]
    ds_read_b64_tr_b16 v[176:177], v11 offset:0
    s_cmp_lt_u32 s30, 64
    s_cselect_b32 s8, s24, s26
    s_cselect_b32 s9, s25, s27
    v_mfma_f32_16x16x32_bf16 v[128:131], v[164:167], a[20:23], v[128:131]
    ds_read_b64_tr_b16 v[178:179], v11 offset:512
    s_and_b32 s40, s30, 63
    s_lshl_b32 s40, s40, 7
    s_lshl_b32 s39, s31, 2
    v_mfma_f32_16x16x32_bf16 v[128:131], v[168:171], a[24:27], v[128:131]
    ds_read_b64_tr_b16 v[180:181], v11 offset:4096
    s_add_u32 s39, s39, s35
    s_lshl_b32 s39, s39, 2
    s_mul_i32 s39, s39, s32
    v_mfma_f32_16x16x32_bf16 v[128:131], v[172:175], a[28:31], v[128:131]
    ds_read_b64_tr_b16 v[182:183], v11 offset:4608
    s_add_u32 s40, s40, s39
    s_lshl_b32 s39, s35, 12
    s_add_u32 s39, s39, s57
    v_mfma_f32_16x16x32_bf16 v[132:135], v[160:163], a[80:83], v[132:135]
    ds_read_b64_tr_b16 v[184:185], v11 offset:8192
    s_mov_b32 m0, s39
    s_nop 0
    v_mfma_f32_16x16x32_bf16 v[132:135], v[164:167], a[84:87], v[132:135]
    ds_read_b64_tr_b16 v[186:187], v11 offset:8704
    buffer_load_dwordx4 v2, s[8:11], s40 offen lds
    s_add_u32 s42, s68, 896
    buffer_load_dwordx4 v[224:227], v28, s[12:15], s42 offen
    v_mfma_f32_16x16x32_bf16 v[132:135], v[168:171], a[88:91], v[132:135]
    ds_read_b64_tr_b16 v[188:189], v11 offset:12288
    s_add_u32 s42, s68, 9088
    buffer_load_dwordx4 v[228:231], v28, s[12:15], s42 offen
    v_mfma_f32_16x16x32_bf16 v[132:135], v[172:175], a[92:95], v[132:135]
    ds_read_b64_tr_b16 v[190:191], v11 offset:12800
    s_waitcnt vmcnt(15)
    s_add_u32 s42, s68, 17280
    buffer_load_dwordx4 v[232:235], v28, s[12:15], s42 offen
    v_mfma_f32_16x16x32_bf16 v[136:139], v[160:163], a[144:147], v[136:139]
    ds_write_b128 v29, v[64:67] offset:0
    v_mfma_f32_16x16x32_bf16 v[136:139], v[164:167], a[148:151], v[136:139]
    ds_write_b128 v30, v[68:71] offset:1024
    s_add_u32 s42, s68, 25472
    buffer_load_dwordx4 v[236:239], v28, s[12:15], s42 offen
    v_mfma_f32_16x16x32_bf16 v[136:139], v[168:171], a[152:155], v[136:139]
    ds_write_b128 v29, v[72:75] offset:2048
    v_mfma_f32_16x16x32_bf16 v[136:139], v[172:175], a[156:159], v[136:139]
    ds_write_b128 v30, v[76:79] offset:3072
    v_mfma_f32_16x16x32_bf16 v[140:143], v[160:163], a[208:211], v[140:143]
    ds_write_b128 v29, v[80:83] offset:4096
    s_add_u32 m0, m0, 1024
    s_add_u32 s40, s40, s32
    v_mfma_f32_16x16x32_bf16 v[140:143], v[164:167], a[212:215], v[140:143]
    ds_write_b128 v30, v[84:87] offset:5120
    buffer_load_dwordx4 v3, s[8:11], s40 offen lds
    s_add_u32 s42, s68, 33664
    buffer_load_dwordx4 v[240:243], v28, s[12:15], s42 offen
    v_mfma_f32_16x16x32_bf16 v[140:143], v[168:171], a[216:219], v[140:143]
    ds_write_b128 v29, v[88:91] offset:6144
    v_mfma_f32_16x16x32_bf16 v[140:143], v[172:175], a[220:223], v[140:143]
    ds_write_b128 v30, v[92:95] offset:7168
    s_waitcnt vmcnt(32)
    s_barrier
    s_waitcnt lgkmcnt(0)
    v_mfma_f32_16x16x32_bf16 v[144:147], v[176:179], a[16:19], v[144:147]
    ds_read_b64_tr_b16 v[160:161], v12 offset:0
    v_mfma_f32_16x16x32_bf16 v[144:147], v[180:183], a[20:23], v[144:147]
    ds_read_b64_tr_b16 v[162:163], v12 offset:512
    s_add_u32 s42, s68, 41856
    buffer_load_dwordx4 v[244:247], v28, s[12:15], s42 offen
    v_mfma_f32_16x16x32_bf16 v[144:147], v[184:187], a[24:27], v[144:147]
    ds_read_b64_tr_b16 v[164:165], v12 offset:4096
    v_mfma_f32_16x16x32_bf16 v[144:147], v[188:191], a[28:31], v[144:147]
    ds_read_b64_tr_b16 v[166:167], v12 offset:4608
    v_mfma_f32_16x16x32_bf16 v[148:151], v[176:179], a[80:83], v[148:151]
    ds_read_b64_tr_b16 v[168:169], v12 offset:8192
    s_add_u32 m0, m0, 1024
    s_add_u32 s40, s40, s32
    v_mfma_f32_16x16x32_bf16 v[148:151], v[180:183], a[84:87], v[148:151]
    ds_read_b64_tr_b16 v[170:171], v12 offset:8704
    buffer_load_dwordx4 v2, s[8:11], s40 offen lds
    s_add_u32 s42, s68, 50048
    buffer_load_dwordx4 v[248:251], v28, s[12:15], s42 offen
    v_mfma_f32_16x16x32_bf16 v[148:151], v[184:187], a[88:91], v[148:151]
    ds_read_b64_tr_b16 v[172:173], v12 offset:12288
    v_mfma_f32_16x16x32_bf16 v[148:151], v[188:191], a[92:95], v[148:151]
    ds_read_b64_tr_b16 v[174:175], v12 offset:12800
    v_mfma_f32_16x16x32_bf16 v[152:155], v[176:179], a[144:147], v[152:155]
    ds_read_b128 a[40:43], v31 offset:0
    s_add_u32 s42, s68, 58240
    buffer_load_dwordx4 v[252:255], v28, s[12:15], s42 offen
    s_add_u32 s56, s56, 16384
    v_mfma_f32_16x16x32_bf16 v[152:155], v[180:183], a[148:151], v[152:155]
    ds_read_b128 a[44:47], v23 offset:0
    s_and_b32 s56, s56, 0x1ffff
    v_mov_b32 v8, v12
    v_mov_b32 v9, v13
    v_mfma_f32_16x16x32_bf16 v[152:155], v[184:187], a[152:155], v[152:155]
    ds_read_b128 a[104:107], v31 offset:2048
    v_mov_b32 v10, v14
    v_mov_b32 v11, v15
    v_add_u32 v12, s56, v4
    v_mfma_f32_16x16x32_bf16 v[152:155], v[188:191], a[156:159], v[152:155]
    ds_read_b128 a[108:111], v23 offset:2048
    v_add_u32 v13, s56, v5
    v_add_u32 v14, s56, v6
    v_add_u32 v15, s56, v7
    v_mfma_f32_16x16x32_bf16 v[156:159], v[176:179], a[208:211], v[156:159]
    ds_read_b128 a[168:171], v31 offset:4096
    s_add_u32 m0, m0, 1024
    s_add_u32 s40, s40, s32
    v_mfma_f32_16x16x32_bf16 v[156:159], v[180:183], a[212:215], v[156:159]
    ds_read_b128 a[172:175], v23 offset:4096
    buffer_load_dwordx4 v3, s[8:11], s40 offen lds
    v_mfma_f32_16x16x32_bf16 v[156:159], v[184:187], a[216:219], v[156:159]
    ds_read_b128 a[232:235], v31 offset:6144
    s_add_u32 s57, s57, 16384
    s_and_b32 s57, s57, 0x1ffff
    s_add_u32 s31, s31, 1
    v_mfma_f32_16x16x32_bf16 v[156:159], v[188:191], a[220:223], v[156:159]
    ds_read_b128 a[236:239], v23 offset:6144
    s_lshr_b32 s39, s31, 2
    s_add_u32 s30, s30, s39
    s_and_b32 s31, s31, 3
    s_waitcnt lgkmcnt(0)
    v_mfma_f32_16x16x32_bf16 v[96:99], v[160:163], a[32:35], v[96:99]
    ds_read_b64_tr_b16 v[176:177], v9 offset:0
    s_cmp_lt_u32 s30, 64
    s_cselect_b32 s8, s24, s26
    s_cselect_b32 s9, s25, s27
    v_mfma_f32_16x16x32_bf16 v[96:99], v[164:167], a[36:39], v[96:99]
    ds_read_b64_tr_b16 v[178:179], v9 offset:512
    s_and_b32 s40, s30, 63
    s_lshl_b32 s40, s40, 7
    s_lshl_b32 s39, s31, 2
    v_mfma_f32_16x16x32_bf16 v[96:99], v[168:171], a[40:43], v[96:99]
    ds_read_b64_tr_b16 v[180:181], v9 offset:4096
    s_add_u32 s39, s39, s35
    s_lshl_b32 s39, s39, 2
    s_mul_i32 s39, s39, s32
    v_mfma_f32_16x16x32_bf16 v[96:99], v[172:175], a[44:47], v[96:99]
    ds_read_b64_tr_b16 v[182:183], v9 offset:4608
    s_add_u32 s40, s40, s39
    s_lshl_b32 s39, s35, 12
    s_add_u32 s39, s39, s57
    v_mfma_f32_16x16x32_bf16 v[100:103], v[160:163], a[96:99], v[100:103]
    ds_read_b64_tr_b16 v[184:185], v9 offset:8192
    s_mov_b32 m0, s39
    s_nop 0
    v_mfma_f32_16x16x32_bf16 v[100:103], v[164:167], a[100:103], v[100:103]
    ds_read_b64_tr_b16 v[186:187], v9 offset:8704
    buffer_load_dwordx4 v2, s[8:11], s40 offen lds
    v_mfma_f32_16x16x32_bf16 v[100:103], v[168:171], a[104:107], v[100:103]
    ds_read_b64_tr_b16 v[188:189], v9 offset:12288
    v_mfma_f32_16x16x32_bf16 v[100:103], v[172:175], a[108:111], v[100:103]
    ds_read_b64_tr_b16 v[190:191], v9 offset:12800
    s_waitcnt vmcnt(14)
    v_mfma_f32_16x16x32_bf16 v[104:107], v[160:163], a[160:163], v[104:107]
    ds_write_b128 v29, v[192:195] offset:0
    v_mfma_f32_16x16x32_bf16 v[104:107], v[164:167], a[164:167], v[104:107]
    ds_write_b128 v30, v[196:199] offset:1024
    v_mfma_f32_16x16x32_bf16 v[104:107], v[168:171], a[168:171], v[104:107]
    ds_write_b128 v29, v[200:203] offset:2048
    v_mfma_f32_16x16x32_bf16 v[104:107], v[172:175], a[172:175], v[104:107]
    ds_write_b128 v30, v[204:207] offset:3072
    v_mfma_f32_16x16x32_bf16 v[108:111], v[160:163], a[224:227], v[108:111]
    ds_write_b128 v29, v[208:211] offset:4096
    s_add_u32 m0, m0, 1024
    s_add_u32 s40, s40, s32
    v_mfma_f32_16x16x32_bf16 v[108:111], v[164:167], a[228:231], v[108:111]
    ds_write_b128 v30, v[212:215] offset:5120
    buffer_load_dwordx4 v3, s[8:11], s40 offen lds
    v_mfma_f32_16x16x32_bf16 v[108:111], v[168:171], a[232:235], v[108:111]
    ds_write_b128 v29, v[216:219] offset:6144
    v_mfma_f32_16x16x32_bf16 v[108:111], v[172:175], a[236:239], v[108:111]
    ds_write_b128 v30, v[220:223] offset:7168
    s_waitcnt lgkmcnt(0)
    v_mfma_f32_16x16x32_bf16 v[112:115], v[176:179], a[32:35], v[112:115]
    ds_read_b64_tr_b16 v[160:161], v10 offset:0
    v_mfma_f32_16x16x32_bf16 v[112:115], v[180:183], a[36:39], v[112:115]
    ds_read_b64_tr_b16 v[162:163], v10 offset:512
    v_mfma_f32_16x16x32_bf16 v[112:115], v[184:187], a[40:43], v[112:115]
    ds_read_b64_tr_b16 v[164:165], v10 offset:4096
    v_mfma_f32_16x16x32_bf16 v[112:115], v[188:191], a[44:47], v[112:115]
    ds_read_b64_tr_b16 v[166:167], v10 offset:4608
    v_mfma_f32_16x16x32_bf16 v[116:119], v[176:179], a[96:99], v[116:119]
    ds_read_b64_tr_b16 v[168:169], v10 offset:8192
    s_add_u32 m0, m0, 1024
    s_add_u32 s40, s40, s32
    v_mfma_f32_16x16x32_bf16 v[116:119], v[180:183], a[100:103], v[116:119]
    ds_read_b64_tr_b16 v[170:171], v10 offset:8704
    buffer_load_dwordx4 v2, s[8:11], s40 offen lds
    v_mfma_f32_16x16x32_bf16 v[116:119], v[184:187], a[104:107], v[116:119]
    ds_read_b64_tr_b16 v[172:173], v10 offset:12288
    v_mfma_f32_16x16x32_bf16 v[116:119], v[188:191], a[108:111], v[116:119]
    ds_read_b64_tr_b16 v[174:175], v10 offset:12800
    v_mfma_f32_16x16x32_bf16 v[120:123], v[176:179], a[160:163], v[120:123]
    ds_read_b128 a[48:51], v31 offset:0
    v_mfma_f32_16x16x32_bf16 v[120:123], v[180:183], a[164:167], v[120:123]
    ds_read_b128 a[52:55], v23 offset:0
    v_mfma_f32_16x16x32_bf16 v[120:123], v[184:187], a[168:171], v[120:123]
    ds_read_b128 a[112:115], v31 offset:2048
    v_mfma_f32_16x16x32_bf16 v[120:123], v[188:191], a[172:175], v[120:123]
    ds_read_b128 a[116:119], v23 offset:2048
    v_mfma_f32_16x16x32_bf16 v[124:127], v[176:179], a[224:227], v[124:127]
    ds_read_b128 a[176:179], v31 offset:4096
    s_add_u32 m0, m0, 1024
    s_add_u32 s40, s40, s32
    v_mfma_f32_16x16x32_bf16 v[124:127], v[180:183], a[228:231], v[124:127]
    ds_read_b128 a[180:183], v23 offset:4096
    buffer_load_dwordx4 v3, s[8:11], s40 offen lds
    v_mfma_f32_16x16x32_bf16 v[124:127], v[184:187], a[232:235], v[124:127]
    ds_read_b128 a[240:243], v31 offset:6144
    s_add_u32 s57, s57, 16384
    s_and_b32 s57, s57, 0x1ffff
    s_add_u32 s31, s31, 1
    v_mfma_f32_16x16x32_bf16 v[124:127], v[188:191], a[236:239], v[124:127]
    ds_read_b128 a[244:247], v23 offset:6144
    s_lshr_b32 s39, s31, 2
    s_add_u32 s30, s30, s39
    s_and_b32 s31, s31, 3
    s_waitcnt lgkmcnt(0)
    v_mfma_f32_16x16x32_bf16 v[128:131], v[160:163], a[32:35], v[128:131]
    ds_read_b64_tr_b16 v[176:177], v11 offset:0
    s_cmp_lt_u32 s30, 64
    s_cselect_b32 s8, s24, s26
    s_cselect_b32 s9, s25, s27
    v_mfma_f32_16x16x32_bf16 v[128:131], v[164:167], a[36:39], v[128:131]
    ds_read_b64_tr_b16 v[178:179], v11 offset:512
    s_and_b32 s40, s30, 63
    s_lshl_b32 s40, s40, 7
    s_lshl_b32 s39, s31, 2
    v_mfma_f32_16x16x32_bf16 v[128:131], v[168:171], a[40:43], v[128:131]
    ds_read_b64_tr_b16 v[180:181], v11 offset:4096
    s_add_u32 s39, s39, s35
    s_lshl_b32 s39, s39, 2
    s_mul_i32 s39, s39, s32
    v_mfma_f32_16x16x32_bf16 v[128:131], v[172:175], a[44:47], v[128:131]
    ds_read_b64_tr_b16 v[182:183], v11 offset:4608
    s_add_u32 s40, s40, s39
    s_lshl_b32 s39, s35, 12
    s_add_u32 s39, s39, s57
    v_mfma_f32_16x16x32_bf16 v[132:135], v[160:163], a[96:99], v[132:135]
    ds_read_b64_tr_b16 v[184:185], v11 offset:8192
    s_mov_b32 m0, s39
    s_nop 0
    v_mfma_f32_16x16x32_bf16 v[132:135], v[164:167], a[100:103], v[132:135]
    ds_read_b64_tr_b16 v[186:187], v11 offset:8704
    buffer_load_dwordx4 v2, s[8:11], s40 offen lds
    v_mfma_f32_16x16x32_bf16 v[132:135], v[168:171], a[104:107], v[132:135]
    ds_read_b64_tr_b16 v[188:189], v11 offset:12288
    v_mfma_f32_16x16x32_bf16 v[132:135], v[172:175], a[108:111], v[132:135]
    ds_read_b64_tr_b16 v[190:191], v11 offset:12800
    s_waitcnt vmcnt(6)
    v_mfma_f32_16x16x32_bf16 v[136:139], v[160:163], a[160:163], v[136:139]
    ds_write_b128 v29, v[224:227] offset:0
    v_mfma_f32_16x16x32_bf16 v[136:139], v[164:167], a[164:167], v[136:139]
    ds_write_b128 v30, v[228:231] offset:1024
    v_mfma_f32_16x16x32_bf16 v[136:139], v[168:171], a[168:171], v[136:139]
    ds_write_b128 v29, v[232:235] offset:2048
    v_mfma_f32_16x16x32_bf16 v[136:139], v[172:175], a[172:175], v[136:139]
    ds_write_b128 v30, v[236:239] offset:3072
    v_mfma_f32_16x16x32_bf16 v[140:143], v[160:163], a[224:227], v[140:143]
    ds_write_b128 v29, v[240:243] offset:4096
    s_add_u32 m0, m0, 1024
    s_add_u32 s40, s40, s32
    v_mfma_f32_16x16x32_bf16 v[140:143], v[164:167], a[228:231], v[140:143]
    ds_write_b128 v30, v[244:247] offset:5120
    buffer_load_dwordx4 v3, s[8:11], s40 offen lds
    v_mfma_f32_16x16x32_bf16 v[140:143], v[168:171], a[232:235], v[140:143]
    ds_write_b128 v29, v[248:251] offset:6144
    v_mfma_f32_16x16x32_bf16 v[140:143], v[172:175], a[236:239], v[140:143]
    ds_write_b128 v30, v[252:255] offset:7168
    s_waitcnt vmcnt(35)
    s_barrier
    s_waitcnt lgkmcnt(0)
    v_mfma_f32_16x16x32_bf16 v[144:147], v[176:179], a[32:35], v[144:147]
    ds_read_b64_tr_b16 v[160:161], v12 offset:0
    v_mfma_f32_16x16x32_bf16 v[144:147], v[180:183], a[36:39], v[144:147]
    ds_read_b64_tr_b16 v[162:163], v12 offset:512
    v_mfma_f32_16x16x32_bf16 v[144:147], v[184:187], a[40:43], v[144:147]
    ds_read_b64_tr_b16 v[164:165], v12 offset:4096
    v_mfma_f32_16x16x32_bf16 v[144:147], v[188:191], a[44:47], v[144:147]
    ds_read_b64_tr_b16 v[166:167], v12 offset:4608
    v_mfma_f32_16x16x32_bf16 v[148:151], v[176:179], a[96:99], v[148:151]
    ds_read_b64_tr_b16 v[168:169], v12 offset:8192
    s_add_u32 m0, m0, 1024
    s_add_u32 s40, s40, s32
    v_mfma_f32_16x16x32_bf16 v[148:151], v[180:183], a[100:103], v[148:151]
    ds_read_b64_tr_b16 v[170:171], v12 offset:8704
    buffer_load_dwordx4 v2, s[8:11], s40 offen lds
    v_mfma_f32_16x16x32_bf16 v[148:151], v[184:187], a[104:107], v[148:151]
    ds_read_b64_tr_b16 v[172:173], v12 offset:12288
    v_mfma_f32_16x16x32_bf16 v[148:151], v[188:191], a[108:111], v[148:151]
    ds_read_b64_tr_b16 v[174:175], v12 offset:12800
    v_mfma_f32_16x16x32_bf16 v[152:155], v[176:179], a[160:163], v[152:155]
    ds_read_b128 a[56:59], v31 offset:0
    s_add_u32 s79, s29, 3
    s_cmp_lt_u32 s79, 64
    s_cselect_b32 s92, s24, s26
    v_mfma_f32_16x16x32_bf16 v[152:155], v[180:183], a[164:167], v[152:155]
    ds_read_b128 a[60:63], v23 offset:0
    s_cselect_b32 s93, s25, s27
    s_and_b32 s79, s79, 63
    s_lshl_b32 s79, s79, 7
    v_mfma_f32_16x16x32_bf16 v[152:155], v[184:187], a[168:171], v[152:155]
    ds_read_b128 a[120:123], v31 offset:2048
    buffer_load_dword v27, v22, s[92:95], s79 offen
    s_add_u32 s56, s56, 16384
    s_and_b32 s56, s56, 0x1ffff
    v_mfma_f32_16x16x32_bf16 v[152:155], v[188:191], a[172:175], v[152:155]
    ds_read_b128 a[124:127], v23 offset:2048
    v_mov_b32 v8, v12
    v_mov_b32 v9, v13
    v_mov_b32 v10, v14
    v_mfma_f32_16x16x32_bf16 v[156:159], v[176:179], a[224:227], v[156:159]
    ds_read_b128 a[184:187], v31 offset:4096
    s_add_u32 m0, m0, 1024
    s_add_u32 s40, s40, s32
    v_mov_b32 v11, v15
    v_mfma_f32_16x16x32_bf16 v[156:159], v[180:183], a[228:231], v[156:159]
    ds_read_b128 a[188:191], v23 offset:4096
    buffer_load_dwordx4 v3, s[8:11], s40 offen lds
    v_add_u32 v12, s56, v4
    v_add_u32 v13, s56, v5
    v_mfma_f32_16x16x32_bf16 v[156:159], v[184:187], a[232:235], v[156:159]
    ds_read_b128 a[248:251], v31 offset:6144
    s_add_u32 s57, s57, 16384
    s_and_b32 s57, s57, 0x1ffff
    s_add_u32 s31, s31, 1
    v_mfma_f32_16x16x32_bf16 v[156:159], v[188:191], a[236:239], v[156:159]
    ds_read_b128 a[252:255], v23 offset:6144
    s_lshr_b32 s39, s31, 2
    s_add_u32 s30, s30, s39
    s_and_b32 s31, s31, 3
    v_add_u32 v14, s56, v6
    v_add_u32 v15, s56, v7
    s_waitcnt lgkmcnt(0)
    v_mfma_f32_16x16x32_bf16 v[96:99], v[160:163], a[48:51], v[96:99]
    ds_read_b64_tr_b16 v[176:177], v9 offset:0
    s_cmp_lt_u32 s30, 64
    s_cselect_b32 s8, s24, s26
    s_cselect_b32 s9, s25, s27
    v_mfma_f32_16x16x32_bf16 v[96:99], v[164:167], a[52:55], v[96:99]
    ds_read_b64_tr_b16 v[178:179], v9 offset:512
    s_and_b32 s40, s30, 63
    s_lshl_b32 s40, s40, 7
    s_lshl_b32 s39, s31, 2
    v_mfma_f32_16x16x32_bf16 v[96:99], v[168:171], a[56:59], v[96:99]
    ds_read_b64_tr_b16 v[180:181], v9 offset:4096
    s_add_u32 s39, s39, s35
    s_lshl_b32 s39, s39, 2
    s_mul_i32 s39, s39, s32
    v_mfma_f32_16x16x32_bf16 v[96:99], v[172:175], a[60:63], v[96:99]
    ds_read_b64_tr_b16 v[182:183], v9 offset:4608
    s_add_u32 s40, s40, s39
    s_lshl_b32 s39, s35, 12
    s_add_u32 s39, s39, s57
    v_mfma_f32_16x16x32_bf16 v[100:103], v[160:163], a[112:115], v[100:103]
    ds_read_b64_tr_b16 v[184:185], v9 offset:8192
    s_mov_b32 m0, s39
    s_nop 0
    v_mfma_f32_16x16x32_bf16 v[100:103], v[164:167], a[116:119], v[100:103]
    ds_read_b64_tr_b16 v[186:187], v9 offset:8704
    buffer_load_dwordx4 v2, s[8:11], s40 offen lds
    v_mfma_f32_16x16x32_bf16 v[100:103], v[168:171], a[120:123], v[100:103]
    ds_read_b64_tr_b16 v[188:189], v9 offset:12288
    v_mfma_f32_16x16x32_bf16 v[100:103], v[172:175], a[124:127], v[100:103]
    ds_read_b64_tr_b16 v[190:191], v9 offset:12800
    v_mfma_f32_16x16x32_bf16 v[104:107], v[160:163], a[176:179], v[104:107]
    v_mfma_f32_16x16x32_bf16 v[104:107], v[164:167], a[180:183], v[104:107]
    v_mfma_f32_16x16x32_bf16 v[104:107], v[168:171], a[184:187], v[104:107]
    v_mfma_f32_16x16x32_bf16 v[104:107], v[172:175], a[188:191], v[104:107]
    v_mfma_f32_16x16x32_bf16 v[108:111], v[160:163], a[240:243], v[108:111]
    s_add_u32 m0, m0, 1024
    s_add_u32 s40, s40, s32
    v_mfma_f32_16x16x32_bf16 v[108:111], v[164:167], a[244:247], v[108:111]
    buffer_load_dwordx4 v3, s[8:11], s40 offen lds
    v_mfma_f32_16x16x32_bf16 v[108:111], v[168:171], a[248:251], v[108:111]
    v_mfma_f32_16x16x32_bf16 v[108:111], v[172:175], a[252:255], v[108:111]
    s_waitcnt lgkmcnt(0)
    v_mfma_f32_16x16x32_bf16 v[112:115], v[176:179], a[48:51], v[112:115]
    ds_read_b64_tr_b16 v[160:161], v10 offset:0
    v_mfma_f32_16x16x32_bf16 v[112:115], v[180:183], a[52:55], v[112:115]
    ds_read_b64_tr_b16 v[162:163], v10 offset:512
    v_mfma_f32_16x16x32_bf16 v[112:115], v[184:187], a[56:59], v[112:115]
    ds_read_b64_tr_b16 v[164:165], v10 offset:4096
    v_mfma_f32_16x16x32_bf16 v[112:115], v[188:191], a[60:63], v[112:115]
    ds_read_b64_tr_b16 v[166:167], v10 offset:4608
    v_cvt_pk_bf16_f32 v192, v96, v97
    v_mfma_f32_16x16x32_bf16 v[116:119], v[176:179], a[112:115], v[116:119]
    ds_read_b64_tr_b16 v[168:169], v10 offset:8192
    s_add_u32 m0, m0, 1024
    s_add_u32 s40, s40, s32
    v_mfma_f32_16x16x32_bf16 v[116:119], v[180:183], a[116:119], v[116:119]
    ds_read_b64_tr_b16 v[170:171], v10 offset:8704
    buffer_load_dwordx4 v2, s[8:11], s40 offen lds
    v_mfma_f32_16x16x32_bf16 v[116:119], v[184:187], a[120:123], v[116:119]
    ds_read_b64_tr_b16 v[172:173], v10 offset:12288
    v_cvt_pk_bf16_f32 v193, v98, v99
    v_mfma_f32_16x16x32_bf16 v[116:119], v[188:191], a[124:127], v[116:119]
    ds_read_b64_tr_b16 v[174:175], v10 offset:12800
    v_mfma_f32_16x16x32_bf16 v[120:123], v[176:179], a[176:179], v[120:123]
    v_mfma_f32_16x16x32_bf16 v[120:123], v[180:183], a[180:183], v[120:123]
    v_mfma_f32_16x16x32_bf16 v[120:123], v[184:187], a[184:187], v[120:123]
    v_cvt_pk_bf16_f32 v196, v100, v101
    v_mfma_f32_16x16x32_bf16 v[120:123], v[188:191], a[188:191], v[120:123]
    v_mfma_f32_16x16x32_bf16 v[124:127], v[176:179], a[240:243], v[124:127]
    s_add_u32 m0, m0, 1024
    s_add_u32 s40, s40, s32
    v_mfma_f32_16x16x32_bf16 v[124:127], v[180:183], a[244:247], v[124:127]
    buffer_load_dwordx4 v3, s[8:11], s40 offen lds
    v_cvt_pk_bf16_f32 v197, v102, v103
    v_mfma_f32_16x16x32_bf16 v[124:127], v[184:187], a[248:251], v[124:127]
    s_add_u32 s57, s57, 16384
    s_and_b32 s57, s57, 0x1ffff
    s_add_u32 s31, s31, 1
    s_lshr_b32 s39, s31, 2
    v_mfma_f32_16x16x32_bf16 v[124:127], v[188:191], a[252:255], v[124:127]
    s_add_u32 s30, s30, s39
    s_and_b32 s31, s31, 3
    s_waitcnt lgkmcnt(0)
    v_mfma_f32_16x16x32_bf16 v[128:131], v[160:163], a[48:51], v[128:131]
    ds_read_b64_tr_b16 v[176:177], v11 offset:0
    s_cmp_lt_u32 s30, 64
    s_cselect_b32 s8, s24, s26
    s_cselect_b32 s9, s25, s27
    v_mfma_f32_16x16x32_bf16 v[128:131], v[164:167], a[52:55], v[128:131]
    ds_read_b64_tr_b16 v[178:179], v11 offset:512
    s_and_b32 s40, s30, 63
    s_lshl_b32 s40, s40, 7
    s_lshl_b32 s39, s31, 2
    v_mfma_f32_16x16x32_bf16 v[128:131], v[168:171], a[56:59], v[128:131]
    ds_read_b64_tr_b16 v[180:181], v11 offset:4096
    s_add_u32 s39, s39, s35
    s_lshl_b32 s39, s39, 2
    s_mul_i32 s39, s39, s32
    v_mfma_f32_16x16x32_bf16 v[128:131], v[172:175], a[60:63], v[128:131]
    ds_read_b64_tr_b16 v[182:183], v11 offset:4608
    s_add_u32 s40, s40, s39
    s_lshl_b32 s39, s35, 12
    s_add_u32 s39, s39, s57
    v_mfma_f32_16x16x32_bf16 v[132:135], v[160:163], a[112:115], v[132:135]
    ds_read_b64_tr_b16 v[184:185], v11 offset:8192
    s_mov_b32 m0, s39
    s_nop 0
    v_cvt_pk_bf16_f32 v200, v104, v105
    v_mfma_f32_16x16x32_bf16 v[132:135], v[164:167], a[116:119], v[132:135]
    ds_read_b64_tr_b16 v[186:187], v11 offset:8704
    buffer_load_dwordx4 v2, s[8:11], s40 offen lds
    v_cvt_pk_bf16_f32 v201, v106, v107
    v_cvt_pk_bf16_f32 v194, v112, v113
    v_mfma_f32_16x16x32_bf16 v[132:135], v[168:171], a[120:123], v[132:135]
    ds_read_b64_tr_b16 v[188:189], v11 offset:12288
    v_cvt_pk_bf16_f32 v195, v114, v115
    v_mfma_f32_16x16x32_bf16 v[132:135], v[172:175], a[124:127], v[132:135]
    ds_read_b64_tr_b16 v[190:191], v11 offset:12800
    v_mfma_f32_16x16x32_bf16 v[136:139], v[160:163], a[176:179], v[136:139]
    v_cvt_pk_bf16_f32 v204, v108, v109
    v_mfma_f32_16x16x32_bf16 v[136:139], v[164:167], a[180:183], v[136:139]
    v_mfma_f32_16x16x32_bf16 v[136:139], v[168:171], a[184:187], v[136:139]
    v_cvt_pk_bf16_f32 v198, v116, v117
    v_mfma_f32_16x16x32_bf16 v[136:139], v[172:175], a[188:191], v[136:139]
    v_mfma_f32_16x16x32_bf16 v[140:143], v[160:163], a[240:243], v[140:143]
    s_add_u32 m0, m0, 1024
    s_add_u32 s40, s40, s32
    v_cvt_pk_bf16_f32 v205, v110, v111
    v_mfma_f32_16x16x32_bf16 v[140:143], v[164:167], a[244:247], v[140:143]
    buffer_load_dwordx4 v3, s[8:11], s40 offen lds
    v_cvt_pk_bf16_f32 v199, v118, v119
    v_mfma_f32_16x16x32_bf16 v[140:143], v[168:171], a[248:251], v[140:143]
    v_mfma_f32_16x16x32_bf16 v[140:143], v[172:175], a[252:255], v[140:143]
    s_waitcnt vmcnt(27)
    s_barrier
    s_waitcnt lgkmcnt(0)
    v_mfma_f32_16x16x32_bf16 v[144:147], v[176:179], a[48:51], v[144:147]
    ds_read_b64_tr_b16 v[160:161], v12 offset:0
    v_mfma_f32_16x16x32_bf16 v[144:147], v[180:183], a[52:55], v[144:147]
    ds_read_b64_tr_b16 v[162:163], v12 offset:512
    v_cvt_pk_bf16_f32 v202, v120, v121
    v_mfma_f32_16x16x32_bf16 v[144:147], v[184:187], a[56:59], v[144:147]
    ds_read_b64_tr_b16 v[164:165], v12 offset:4096
    v_mfma_f32_16x16x32_bf16 v[144:147], v[188:191], a[60:63], v[144:147]
    ds_read_b64_tr_b16 v[166:167], v12 offset:4608
    v_cvt_pk_bf16_f32 v208, v128, v129
    v_mfma_f32_16x16x32_bf16 v[148:151], v[176:179], a[112:115], v[148:151]
    ds_read_b64_tr_b16 v[168:169], v12 offset:8192
    s_add_u32 m0, m0, 1024
    s_add_u32 s40, s40, s32
    v_cvt_pk_bf16_f32 v209, v130, v131
    v_mfma_f32_16x16x32_bf16 v[148:151], v[180:183], a[116:119], v[148:151]
    ds_read_b64_tr_b16 v[170:171], v12 offset:8704
    buffer_load_dwordx4 v2, s[8:11], s40 offen lds
    v_cvt_pk_bf16_f32 v203, v122, v123
    v_mfma_f32_16x16x32_bf16 v[148:151], v[184:187], a[120:123], v[148:151]
    ds_read_b64_tr_b16 v[172:173], v12 offset:12288
    v_cvt_pk_bf16_f32 v212, v132, v133
    v_mfma_f32_16x16x32_bf16 v[148:151], v[188:191], a[124:127], v[148:151]
    ds_read_b64_tr_b16 v[174:175], v12 offset:12800
    v_cvt_pk_bf16_f32 v213, v134, v135
    v_mfma_f32_16x16x32_bf16 v[152:155], v[176:179], a[176:179], v[152:155]
    v_cvt_pk_bf16_f32 v206, v124, v125
    s_add_u32 s56, s56, 16384
    s_and_b32 s56, s56, 0x1ffff
    v_mov_b32 v8, v12
    v_mfma_f32_16x16x32_bf16 v[152:155], v[180:183], a[180:183], v[152:155]
    v_cvt_pk_bf16_f32 v216, v136, v137
    v_mov_b32 v9, v13
    v_mov_b32 v10, v14
    v_mov_b32 v11, v15
    v_mfma_f32_16x16x32_bf16 v[152:155], v[184:187], a[184:187], v[152:155]
    v_add_u32 v12, s56, v4
    v_add_u32 v13, s56, v5
    v_add_u32 v14, s56, v6
    v_add_u32 v15, s56, v7
    v_mfma_f32_16x16x32_bf16 v[152:155], v[188:191], a[188:191], v[152:155]
    v_cvt_pk_bf16_f32 v217, v138, v139
    s_add_u32 s29, s29, 1
    v_mfma_f32_16x16x32_bf16 v[156:159], v[176:179], a[240:243], v[156:159]
    s_add_u32 m0, m0, 1024
    s_add_u32 s40, s40, s32
    v_cvt_pk_bf16_f32 v207, v126, v127
    v_cvt_pk_bf16_f32 v220, v140, v141
    v_mfma_f32_16x16x32_bf16 v[156:159], v[180:183], a[244:247], v[156:159]
    buffer_load_dwordx4 v3, s[8:11], s40 offen lds
    v_mfma_f32_16x16x32_bf16 v[156:159], v[184:187], a[248:251], v[156:159]
    s_add_u32 s57, s57, 16384
    s_and_b32 s57, s57, 0x1ffff
    s_add_u32 s31, s31, 1
    s_lshr_b32 s39, s31, 2
    v_mfma_f32_16x16x32_bf16 v[156:159], v[188:191], a[252:255], v[156:159]
    s_add_u32 s30, s30, s39
    s_and_b32 s31, s31, 3
    v_cvt_pk_bf16_f32 v221, v142, v143
    s_cmp_lt_u32 s29, s44
    s_waitcnt vmcnt(13)
    s_min_u32 s44, s44, 64
    s_cmp_ge_u32 s29, s44
    s_cbranch_scc1 p1_kernel_segk_skip
p1_kernel_segk_loop:
    s_waitcnt vmcnt(16)
    s_barrier
    s_waitcnt lgkmcnt(0)
    v_mfma_f32_16x16x32_bf16 v[96:99], v[160:163], a[0:3], 0
    ds_read_b64_tr_b16 v[176:177], v9 offset:0
    s_mov_b32 s34, s33
    v_mfma_f32_16x16x32_bf16 v[96:99], v[164:167], a[4:7], v[96:99]
    ds_read_b64_tr_b16 v[178:179], v9 offset:512
    s_mov_b32 s59, s58
    v_mfma_f32_16x16x32_bf16 v[96:99], v[168:171], a[8:11], v[96:99]
    ds_read_b64_tr_b16 v[180:181], v9 offset:4096
    s_lshr_b32 s37, s29, 1
    v_mfma_f32_16x16x32_bf16 v[96:99], v[172:175], a[12:15], v[96:99]
    ds_read_b64_tr_b16 v[182:183], v9 offset:4608
    s_lshl_b32 s37, s37, 20
    v_mfma_f32_16x16x32_bf16 v[100:103], v[160:163], a[64:67], 0
    ds_read_b64_tr_b16 v[184:185], v9 offset:8192
    s_and_b32 s38, s29, 1
    v_mfma_f32_16x16x32_bf16 v[100:103], v[164:167], a[68:71], v[100:103]
    ds_read_b64_tr_b16 v[186:187], v9 offset:8704
    s_lshl_b32 s38, s38, 11
    v_mfma_f32_16x16x32_bf16 v[100:103], v[168:171], a[72:75], v[100:103]
    ds_read_b64_tr_b16 v[188:189], v9 offset:12288
    s_add_u32 s37, s37, s38
    v_mfma_f32_16x16x32_bf16 v[100:103], v[172:175], a[76:79], v[100:103]
    ds_read_b64_tr_b16 v[190:191], v9 offset:12800
    s_add_u32 s33, s37, s47
    v_mfma_f32_16x16x32_bf16 v[104:107], v[160:163], a[128:131], 0
    s_add_u32 s58, s33, 1024
    s_cmp_lt_u32 s30, 64
    v_mfma_f32_16x16x32_bf16 v[104:107], v[164:167], a[132:135], v[104:107]
    s_cselect_b32 s8, s24, s26
    s_cselect_b32 s9, s25, s27
    v_mfma_f32_16x16x32_bf16 v[104:107], v[168:171], a[136:139], v[104:107]
    s_and_b32 s40, s30, 63
    s_lshl_b32 s40, s40, 7
    v_mfma_f32_16x16x32_bf16 v[104:107], v[172:175], a[140:143], v[104:107]
    s_lshl_b32 s39, s31, 2
    s_add_u32 s39, s39, s35
    v_mfma_f32_16x16x32_bf16 v[108:111], v[160:163], a[192:195], 0
    s_lshl_b32 s39, s39, 2
    s_mul_i32 s39, s39, s32
    v_mfma_f32_16x16x32_bf16 v[108:111], v[164:167], a[196:199], v[108:111]
    s_add_u32 s40, s40, s39
    s_lshl_b32 s39, s35, 12
    v_mfma_f32_16x16x32_bf16 v[108:111], v[168:171], a[200:203], v[108:111]
    s_add_u32 s39, s39, s57
    v_cvt_pk_bf16_f32 v210, v144, v145
    v_mfma_f32_16x16x32_bf16 v[108:111], v[172:175], a[204:207], v[108:111]
    s_mov_b32 m0, s39
    s_nop 0
    s_waitcnt lgkmcnt(0)
    v_mfma_f32_16x16x32_bf16 v[112:115], v[176:179], a[0:3], 0
    ds_read_b64_tr_b16 v[160:161], v10 offset:0
    buffer_load_dwordx4 v2, s[8:11], s40 offen lds
    v_mfma_f32_16x16x32_bf16 v[112:115], v[180:183], a[4:7], v[112:115]
    ds_read_b64_tr_b16 v[162:163], v10 offset:512
    v_cvt_pk_bf16_f32 v211, v146, v147
    v_mfma_f32_16x16x32_bf16 v[112:115], v[184:187], a[8:11], v[112:115]
    ds_read_b64_tr_b16 v[164:165], v10 offset:4096
    v_cvt_pk_bf16_f32 v214, v148, v149
    v_mfma_f32_16x16x32_bf16 v[112:115], v[188:191], a[12:15], v[112:115]
    ds_read_b64_tr_b16 v[166:167], v10 offset:4608
    v_cvt_pk_bf16_f32 v215, v150, v151
    v_mfma_f32_16x16x32_bf16 v[116:119], v[176:179], a[64:67], 0
    ds_read_b64_tr_b16 v[168:169], v10 offset:8192
    v_mfma_f32_16x16x32_bf16 v[116:119], v[180:183], a[68:71], v[116:119]
    ds_read_b64_tr_b16 v[170:171], v10 offset:8704
    v_mfma_f32_16x16x32_bf16 v[116:119], v[184:187], a[72:75], v[116:119]
    ds_read_b64_tr_b16 v[172:173], v10 offset:12288
    v_mfma_f32_16x16x32_bf16 v[116:119], v[188:191], a[76:79], v[116:119]
    ds_read_b64_tr_b16 v[174:175], v10 offset:12800
    v_mfma_f32_16x16x32_bf16 v[120:123], v[176:179], a[128:131], 0
    buffer_store_dwordx4 v[192:195], v16, s[4:7], s34 offen offset:0 sc1
    v_cvt_pk_bf16_f32 v218, v152, v153
    v_mfma_f32_16x16x32_bf16 v[120:123], v[180:183], a[132:135], v[120:123]
    v_mfma_f32_16x16x32_bf16 v[120:123], v[184:187], a[136:139], v[120:123]
    s_add_u32 m0, m0, 1024
    s_add_u32 s40, s40, s32
    v_mfma_f32_16x16x32_bf16 v[120:123], v[188:191], a[140:143], v[120:123]
    buffer_load_dwordx4 v3, s[8:11], s40 offen lds
    v_mfma_f32_16x16x32_bf16 v[124:127], v[176:179], a[192:195], 0
    v_mfma_f32_16x16x32_bf16 v[124:127], v[180:183], a[196:199], v[124:127]
    v_cvt_pk_bf16_f32 v219, v154, v155
    v_mfma_f32_16x16x32_bf16 v[124:127], v[184:187], a[200:203], v[124:127]
    v_mfma_f32_16x16x32_bf16 v[124:127], v[188:191], a[204:207], v[124:127]
    s_waitcnt lgkmcnt(0)
    v_mfma_f32_16x16x32_bf16 v[128:131], v[160:163], a[0:3], 0
    ds_read_b64_tr_b16 v[176:177], v11 offset:0
    v_mfma_f32_16x16x32_bf16 v[128:131], v[164:167], a[4:7], v[128:131]
    ds_read_b64_tr_b16 v[178:179], v11 offset:512
    v_mfma_f32_16x16x32_bf16 v[128:131], v[168:171], a[8:11], v[128:131]
    ds_read_b64_tr_b16 v[180:181], v11 offset:4096
    v_mfma_f32_16x16x32_bf16 v[128:131], v[172:175], a[12:15], v[128:131]
    ds_read_b64_tr_b16 v[182:183], v11 offset:4608
    v_cvt_pk_bf16_f32 v222, v156, v157
    v_mfma_f32_16x16x32_bf16 v[132:135], v[160:163], a[64:67], 0
    ds_read_b64_tr_b16 v[184:185], v11 offset:8192
    v_mfma_f32_16x16x32_bf16 v[132:135], v[164:167], a[68:71], v[132:135]
    ds_read_b64_tr_b16 v[186:187], v11 offset:8704
    v_mfma_f32_16x16x32_bf16 v[132:135], v[168:171], a[72:75], v[132:135]
    ds_read_b64_tr_b16 v[188:189], v11 offset:12288
    v_mfma_f32_16x16x32_bf16 v[132:135], v[172:175], a[76:79], v[132:135]
    ds_read_b64_tr_b16 v[190:191], v11 offset:12800
    v_mfma_f32_16x16x32_bf16 v[136:139], v[160:163], a[128:131], 0
    v_cvt_pk_bf16_f32 v223, v158, v159
    v_mfma_f32_16x16x32_bf16 v[136:139], v[164:167], a[132:135], v[136:139]
    buffer_store_dwordx4 v[196:199], v17, s[4:7], s34 offen offset:0 sc1
    v_mfma_f32_16x16x32_bf16 v[136:139], v[168:171], a[136:139], v[136:139]
    s_add_u32 m0, m0, 1024
    s_add_u32 s40, s40, s32
    v_mfma_f32_16x16x32_bf16 v[136:139], v[172:175], a[140:143], v[136:139]
    buffer_load_dwordx4 v2, s[8:11], s40 offen lds
    v_mfma_f32_16x16x32_bf16 v[140:143], v[160:163], a[192:195], 0
    v_mfma_f32_16x16x32_bf16 v[140:143], v[164:167], a[196:199], v[140:143]
    v_mfma_f32_16x16x32_bf16 v[140:143], v[168:171], a[200:203], v[140:143]
    v_mfma_f32_16x16x32_bf16 v[140:143], v[172:175], a[204:207], v[140:143]
    s_waitcnt lgkmcnt(0)
    v_mfma_f32_16x16x32_bf16 v[144:147], v[176:179], a[0:3], 0
    ds_read_b64_tr_b16 v[160:161], v12 offset:0
    v_mfma_f32_16x16x32_bf16 v[144:147], v[180:183], a[4:7], v[144:147]
    ds_read_b64_tr_b16 v[162:163], v12 offset:512
    v_mfma_f32_16x16x32_bf16 v[144:147], v[184:187], a[8:11], v[144:147]
    ds_read_b64_tr_b16 v[164:165], v12 offset:4096
    v_mfma_f32_16x16x32_bf16 v[144:147], v[188:191], a[12:15], v[144:147]
    ds_read_b64_tr_b16 v[166:167], v12 offset:4608
    v_mfma_f32_16x16x32_bf16 v[148:151], v[176:179], a[64:67], 0
    ds_read_b64_tr_b16 v[168:169], v12 offset:8192
    v_mfma_f32_16x16x32_bf16 v[148:151], v[180:183], a[68:71], v[148:151]
    ds_read_b64_tr_b16 v[170:171], v12 offset:8704
    v_mfma_f32_16x16x32_bf16 v[148:151], v[184:187], a[72:75], v[148:151]
    ds_read_b64_tr_b16 v[172:173], v12 offset:12288
    v_mfma_f32_16x16x32_bf16 v[148:151], v[188:191], a[76:79], v[148:151]
    ds_read_b64_tr_b16 v[174:175], v12 offset:12800
    v_mfma_f32_16x16x32_bf16 v[152:155], v[176:179], a[128:131], 0
    s_add_u32 s56, s56, 16384
    s_and_b32 s56, s56, 0x1ffff
    v_mfma_f32_16x16x32_bf16 v[152:155], v[180:183], a[132:135], v[152:155]
    v_mov_b32 v8, v12
    v_mov_b32 v9, v13
    v_mfma_f32_16x16x32_bf16 v[152:155], v[184:187], a[136:139], v[152:155]
    s_add_u32 m0, m0, 1024
    s_add_u32 s40, s40, s32
    v_mfma_f32_16x16x32_bf16 v[152:155], v[188:191], a[140:143], v[152:155]
    buffer_load_dwordx4 v3, s[8:11], s40 offen lds
    v_mov_b32 v10, v14
    v_mfma_f32_16x16x32_bf16 v[156:159], v[176:179], a[192:195], 0
    s_add_u32 s57, s57, 16384
    s_and_b32 s57, s57, 0x1ffff
    v_mfma_f32_16x16x32_bf16 v[156:159], v[180:183], a[196:199], v[156:159]
    s_add_u32 s31, s31, 1
    s_lshr_b32 s39, s31, 2
    v_mfma_f32_16x16x32_bf16 v[156:159], v[184:187], a[200:203], v[156:159]
    s_add_u32 s30, s30, s39
    s_and_b32 s31, s31, 3
    v_mfma_f32_16x16x32_bf16 v[156:159], v[188:191], a[204:207], v[156:159]
    v_mov_b32 v11, v15
    v_add_u32 v12, s56, v4
    v_add_u32 v13, s56, v5
    v_add_u32 v14, s56, v6
    v_add_u32 v15, s56, v7
    s_waitcnt lgkmcnt(0)
    v_mfma_f32_16x16x32_bf16 v[96:99], v[160:163], a[16:19], v[96:99]
    ds_read_b64_tr_b16 v[176:177], v9 offset:0
    s_cmp_lt_u32 s30, 64
    v_mfma_f32_16x16x32_bf16 v[96:99], v[164:167], a[20:23], v[96:99]
    ds_read_b64_tr_b16 v[178:179], v9 offset:512
    s_cselect_b32 s8, s24, s26
    v_mfma_f32_16x16x32_bf16 v[96:99], v[168:171], a[24:27], v[96:99]
    ds_read_b64_tr_b16 v[180:181], v9 offset:4096
    s_cselect_b32 s9, s25, s27
    v_mfma_f32_16x16x32_bf16 v[96:99], v[172:175], a[28:31], v[96:99]
    ds_read_b64_tr_b16 v[182:183], v9 offset:4608
    s_and_b32 s40, s30, 63
    v_mfma_f32_16x16x32_bf16 v[100:103], v[160:163], a[80:83], v[100:103]
    ds_read_b64_tr_b16 v[184:185], v9 offset:8192
    s_lshl_b32 s40, s40, 7
    v_mfma_f32_16x16x32_bf16 v[100:103], v[164:167], a[84:87], v[100:103]
    ds_read_b64_tr_b16 v[186:187], v9 offset:8704
    s_lshl_b32 s39, s31, 2
    v_mfma_f32_16x16x32_bf16 v[100:103], v[168:171], a[88:91], v[100:103]
    ds_read_b64_tr_b16 v[188:189], v9 offset:12288
    s_add_u32 s39, s39, s35
    v_mfma_f32_16x16x32_bf16 v[100:103], v[172:175], a[92:95], v[100:103]
    ds_read_b64_tr_b16 v[190:191], v9 offset:12800
    s_lshl_b32 s39, s39, 2
    v_mfma_f32_16x16x32_bf16 v[104:107], v[160:163], a[144:147], v[104:107]
    s_mul_i32 s39, s39, s32
    s_add_u32 s40, s40, s39
    v_mfma_f32_16x16x32_bf16 v[104:107], v[164:167], a[148:151], v[104:107]
    s_lshl_b32 s39, s35, 12
    s_add_u32 s39, s39, s57
    v_mfma_f32_16x16x32_bf16 v[104:107], v[168:171], a[152:155], v[104:107]
    s_mov_b32 m0, s39
    s_nop 0
    v_mfma_f32_16x16x32_bf16 v[104:107], v[172:175], a[156:159], v[104:107]
    buffer_load_dwordx4 v2, s[8:11], s40 offen lds
    buffer_store_dwordx4 v[200:203], v18, s[4:7], s34 offen offset:0 sc1
    v_mfma_f32_16x16x32_bf16 v[108:111], v[160:163], a[208:211], v[108:111]
    v_mfma_f32_16x16x32_bf16 v[108:111], v[164:167], a[212:215], v[108:111]
    v_mfma_f32_16x16x32_bf16 v[108:111], v[168:171], a[216:219], v[108:111]
    v_mfma_f32_16x16x32_bf16 v[108:111], v[172:175], a[220:223], v[108:111]
    s_waitcnt lgkmcnt(0)
    v_mfma_f32_16x16x32_bf16 v[112:115], v[176:179], a[16:19], v[112:115]
    ds_read_b64_tr_b16 v[160:161], v10 offset:0
    v_mfma_f32_16x16x32_bf16 v[112:115], v[180:183], a[20:23], v[112:115]
    ds_read_b64_tr_b16 v[162:163], v10 offset:512
    v_mfma_f32_16x16x32_bf16 v[112:115], v[184:187], a[24:27], v[112:115]
    ds_read_b64_tr_b16 v[164:165], v10 offset:4096
    v_mfma_f32_16x16x32_bf16 v[112:115], v[188:191], a[28:31], v[112:115]
    ds_read_b64_tr_b16 v[166:167], v10 offset:4608
    v_mfma_f32_16x16x32_bf16 v[116:119], v[176:179], a[80:83], v[116:119]
    ds_read_b64_tr_b16 v[168:169], v10 offset:8192
    v_mfma_f32_16x16x32_bf16 v[116:119], v[180:183], a[84:87], v[116:119]
    ds_read_b64_tr_b16 v[170:171], v10 offset:8704
    v_mfma_f32_16x16x32_bf16 v[116:119], v[184:187], a[88:91], v[116:119]
    ds_read_b64_tr_b16 v[172:173], v10 offset:12288
    v_mfma_f32_16x16x32_bf16 v[116:119], v[188:191], a[92:95], v[116:119]
    ds_read_b64_tr_b16 v[174:175], v10 offset:12800
    buffer_store_dwordx4 v[204:207], v19, s[4:7], s34 offen offset:0 sc1
    v_mfma_f32_16x16x32_bf16 v[120:123], v[176:179], a[144:147], v[120:123]
    v_mfma_f32_16x16x32_bf16 v[120:123], v[180:183], a[148:151], v[120:123]
    v_mfma_f32_16x16x32_bf16 v[120:123], v[184:187], a[152:155], v[120:123]
    s_add_u32 m0, m0, 1024
    s_add_u32 s40, s40, s32
    v_mfma_f32_16x16x32_bf16 v[120:123], v[188:191], a[156:159], v[120:123]
    buffer_load_dwordx4 v3, s[8:11], s40 offen lds
    v_mfma_f32_16x16x32_bf16 v[124:127], v[176:179], a[208:211], v[124:127]
    v_mfma_f32_16x16x32_bf16 v[124:127], v[180:183], a[212:215], v[124:127]
    v_mfma_f32_16x16x32_bf16 v[124:127], v[184:187], a[216:219], v[124:127]
    v_mfma_f32_16x16x32_bf16 v[124:127], v[188:191], a[220:223], v[124:127]
    s_waitcnt lgkmcnt(0)
    v_mfma_f32_16x16x32_bf16 v[128:131], v[160:163], a[16:19], v[128:131]
    ds_read_b64_tr_b16 v[176:177], v11 offset:0
    v_mfma_f32_16x16x32_bf16 v[128:131], v[164:167], a[20:23], v[128:131]
    ds_read_b64_tr_b16 v[178:179], v11 offset:512
    v_mfma_f32_16x16x32_bf16 v[128:131], v[168:171], a[24:27], v[128:131]
    ds_read_b64_tr_b16 v[180:181], v11 offset:4096
    v_mfma_f32_16x16x32_bf16 v[128:131], v[172:175], a[28:31], v[128:131]
    ds_read_b64_tr_b16 v[182:183], v11 offset:4608
    v_mfma_f32_16x16x32_bf16 v[132:135], v[160:163], a[80:83], v[132:135]
    ds_read_b64_tr_b16 v[184:185], v11 offset:8192
    v_mfma_f32_16x16x32_bf16 v[132:135], v[164:167], a[84:87], v[132:135]
    ds_read_b64_tr_b16 v[186:187], v11 offset:8704
    v_mfma_f32_16x16x32_bf16 v[132:135], v[168:171], a[88:91], v[132:135]
    ds_read_b64_tr_b16 v[188:189], v11 offset:12288
    v_mfma_f32_16x16x32_bf16 v[132:135], v[172:175], a[92:95], v[132:135]
    ds_read_b64_tr_b16 v[190:191], v11 offset:12800
    v_mfma_f32_16x16x32_bf16 v[136:139], v[160:163], a[144:147], v[136:139]
    buffer_store_dwordx4 v[208:211], v16, s[4:7], s59 offen offset:0 sc1
    v_mfma_f32_16x16x32_bf16 v[136:139], v[164:167], a[148:151], v[136:139]
    v_mfma_f32_16x16x32_bf16 v[136:139], v[168:171], a[152:155], v[136:139]
    s_add_u32 m0, m0, 1024
    s_add_u32 s40, s40, s32
    v_mfma_f32_16x16x32_bf16 v[136:139], v[172:175], a[156:159], v[136:139]
    buffer_load_dwordx4 v2, s[8:11], s40 offen lds
    v_mfma_f32_16x16x32_bf16 v[140:143], v[160:163], a[208:211], v[140:143]
    v_mfma_f32_16x16x32_bf16 v[140:143], v[164:167], a[212:215], v[140:143]
    v_mfma_f32_16x16x32_bf16 v[140:143], v[168:171], a[216:219], v[140:143]
    v_mfma_f32_16x16x32_bf16 v[140:143], v[172:175], a[220:223], v[140:143]
    s_waitcnt lgkmcnt(0)
    v_mfma_f32_16x16x32_bf16 v[144:147], v[176:179], a[16:19], v[144:147]
    ds_read_b64_tr_b16 v[160:161], v12 offset:0
    v_mfma_f32_16x16x32_bf16 v[144:147], v[180:183], a[20:23], v[144:147]
    ds_read_b64_tr_b16 v[162:163], v12 offset:512
    v_mfma_f32_16x16x32_bf16 v[144:147], v[184:187], a[24:27], v[144:147]
    ds_read_b64_tr_b16 v[164:165], v12 offset:4096
    v_mfma_f32_16x16x32_bf16 v[144:147], v[188:191], a[28:31], v[144:147]
    ds_read_b64_tr_b16 v[166:167], v12 offset:4608
    v_mfma_f32_16x16x32_bf16 v[148:151], v[176:179], a[80:83], v[148:151]
    ds_read_b64_tr_b16 v[168:169], v12 offset:8192
    v_mfma_f32_16x16x32_bf16 v[148:151], v[180:183], a[84:87], v[148:151]
    ds_read_b64_tr_b16 v[170:171], v12 offset:8704
    v_mfma_f32_16x16x32_bf16 v[148:151], v[184:187], a[88:91], v[148:151]
    ds_read_b64_tr_b16 v[172:173], v12 offset:12288
    v_mfma_f32_16x16x32_bf16 v[148:151], v[188:191], a[92:95], v[148:151]
    ds_read_b64_tr_b16 v[174:175], v12 offset:12800
    v_mfma_f32_16x16x32_bf16 v[152:155], v[176:179], a[144:147], v[152:155]
    s_add_u32 s56, s56, 16384
    s_and_b32 s56, s56, 0x1ffff
    v_mfma_f32_16x16x32_bf16 v[152:155], v[180:183], a[148:151], v[152:155]
    v_mov_b32 v8, v12
    v_mov_b32 v9, v13
    v_mfma_f32_16x16x32_bf16 v[152:155], v[184:187], a[152:155], v[152:155]
    s_add_u32 m0, m0, 1024
    s_add_u32 s40, s40, s32
    v_mfma_f32_16x16x32_bf16 v[152:155], v[188:191], a[156:159], v[152:155]
    buffer_load_dwordx4 v3, s[8:11], s40 offen lds
    v_mov_b32 v10, v14
    v_mfma_f32_16x16x32_bf16 v[156:159], v[176:179], a[208:211], v[156:159]
    s_add_u32 s57, s57, 16384
    s_and_b32 s57, s57, 0x1ffff
    v_mfma_f32_16x16x32_bf16 v[156:159], v[180:183], a[212:215], v[156:159]
    s_add_u32 s31, s31, 1
    s_lshr_b32 s39, s31, 2
    v_mfma_f32_16x16x32_bf16 v[156:159], v[184:187], a[216:219], v[156:159]
    s_add_u32 s30, s30, s39
    s_and_b32 s31, s31, 3
    v_mfma_f32_16x16x32_bf16 v[156:159], v[188:191], a[220:223], v[156:159]
    v_mov_b32 v11, v15
    v_add_u32 v12, s56, v4
    v_add_u32 v13, s56, v5
    v_add_u32 v14, s56, v6
    v_add_u32 v15, s56, v7
    s_waitcnt vmcnt(15)
    s_barrier
    s_waitcnt lgkmcnt(0)
    v_mfma_f32_16x16x32_bf16 v[96:99], v[160:163], a[32:35], v[96:99]
    ds_read_b64_tr_b16 v[176:177], v9 offset:0
    s_cmp_lt_u32 s30, 64
    v_mfma_f32_16x16x32_bf16 v[96:99], v[164:167], a[36:39], v[96:99]
    ds_read_b64_tr_b16 v[178:179], v9 offset:512
    s_cselect_b32 s8, s24, s26
    v_mfma_f32_16x16x32_bf16 v[96:99], v[168:171], a[40:43], v[96:99]
    ds_read_b64_tr_b16 v[180:181], v9 offset:4096
    s_cselect_b32 s9, s25, s27
    v_mfma_f32_16x16x32_bf16 v[96:99], v[172:175], a[44:47], v[96:99]
    ds_read_b64_tr_b16 v[182:183], v9 offset:4608
    s_and_b32 s40, s30, 63
    v_mfma_f32_16x16x32_bf16 v[100:103], v[160:163], a[96:99], v[100:103]
    ds_read_b64_tr_b16 v[184:185], v9 offset:8192
    s_lshl_b32 s40, s40, 7
    v_mfma_f32_16x16x32_bf16 v[100:103], v[164:167], a[100:103], v[100:103]
    ds_read_b64_tr_b16 v[186:187], v9 offset:8704
    s_lshl_b32 s39, s31, 2
    v_mfma_f32_16x16x32_bf16 v[100:103], v[168:171], a[104:107], v[100:103]
    ds_read_b64_tr_b16 v[188:189], v9 offset:12288
    s_add_u32 s39, s39, s35
    v_mfma_f32_16x16x32_bf16 v[100:103], v[172:175], a[108:111], v[100:103]
    ds_read_b64_tr_b16 v[190:191], v9 offset:12800
    s_lshl_b32 s39, s39, 2
    v_mfma_f32_16x16x32_bf16 v[104:107], v[160:163], a[160:163], v[104:107]
    s_mul_i32 s39, s39, s32
    s_add_u32 s40, s40, s39
    v_mfma_f32_16x16x32_bf16 v[104:107], v[164:167], a[164:167], v[104:107]
    s_lshl_b32 s39, s35, 12
    s_add_u32 s39, s39, s57
    v_mfma_f32_16x16x32_bf16 v[104:107], v[168:171], a[168:171], v[104:107]
    s_mov_b32 m0, s39
    s_nop 0
    v_mfma_f32_16x16x32_bf16 v[104:107], v[172:175], a[172:175], v[104:107]
    buffer_load_dwordx4 v2, s[8:11], s40 offen lds
    buffer_store_dwordx4 v[212:215], v17, s[4:7], s59 offen offset:0 sc1
    v_mfma_f32_16x16x32_bf16 v[108:111], v[160:163], a[224:227], v[108:111]
    v_mfma_f32_16x16x32_bf16 v[108:111], v[164:167], a[228:231], v[108:111]
    v_mfma_f32_16x16x32_bf16 v[108:111], v[168:171], a[232:235], v[108:111]
    v_mfma_f32_16x16x32_bf16 v[108:111], v[172:175], a[236:239], v[108:111]
    s_waitcnt lgkmcnt(0)
    v_mfma_f32_16x16x32_bf16 v[112:115], v[176:179], a[32:35], v[112:115]
    ds_read_b64_tr_b16 v[160:161], v10 offset:0
    v_mfma_f32_16x16x32_bf16 v[112:115], v[180:183], a[36:39], v[112:115]
    ds_read_b64_tr_b16 v[162:163], v10 offset:512
    v_mfma_f32_16x16x32_bf16 v[112:115], v[184:187], a[40:43], v[112:115]
    ds_read_b64_tr_b16 v[164:165], v10 offset:4096
    v_mfma_f32_16x16x32_bf16 v[112:115], v[188:191], a[44:47], v[112:115]
    ds_read_b64_tr_b16 v[166:167], v10 offset:4608
    v_mfma_f32_16x16x32_bf16 v[116:119], v[176:179], a[96:99], v[116:119]
    ds_read_b64_tr_b16 v[168:169], v10 offset:8192
    v_mfma_f32_16x16x32_bf16 v[116:119], v[180:183], a[100:103], v[116:119]
    ds_read_b64_tr_b16 v[170:171], v10 offset:8704
    v_mfma_f32_16x16x32_bf16 v[116:119], v[184:187], a[104:107], v[116:119]
    ds_read_b64_tr_b16 v[172:173], v10 offset:12288
    v_mfma_f32_16x16x32_bf16 v[116:119], v[188:191], a[108:111], v[116:119]
    ds_read_b64_tr_b16 v[174:175], v10 offset:12800
    buffer_store_dwordx4 v[216:219], v18, s[4:7], s59 offen offset:0 sc1
    v_mfma_f32_16x16x32_bf16 v[120:123], v[176:179], a[160:163], v[120:123]
    v_mfma_f32_16x16x32_bf16 v[120:123], v[180:183], a[164:167], v[120:123]
    v_mfma_f32_16x16x32_bf16 v[120:123], v[184:187], a[168:171], v[120:123]
    s_add_u32 m0, m0, 1024
    s_add_u32 s40, s40, s32
    v_mfma_f32_16x16x32_bf16 v[120:123], v[188:191], a[172:175], v[120:123]
    buffer_load_dwordx4 v3, s[8:11], s40 offen lds
    v_mfma_f32_16x16x32_bf16 v[124:127], v[176:179], a[224:227], v[124:127]
    v_mfma_f32_16x16x32_bf16 v[124:127], v[180:183], a[228:231], v[124:127]
    v_mfma_f32_16x16x32_bf16 v[124:127], v[184:187], a[232:235], v[124:127]
    v_mfma_f32_16x16x32_bf16 v[124:127], v[188:191], a[236:239], v[124:127]
    s_waitcnt lgkmcnt(0)
    v_mfma_f32_16x16x32_bf16 v[128:131], v[160:163], a[32:35], v[128:131]
    ds_read_b64_tr_b16 v[176:177], v11 offset:0
    v_mfma_f32_16x16x32_bf16 v[128:131], v[164:167], a[36:39], v[128:131]
    ds_read_b64_tr_b16 v[178:179], v11 offset:512
    v_mfma_f32_16x16x32_bf16 v[128:131], v[168:171], a[40:43], v[128:131]
    ds_read_b64_tr_b16 v[180:181], v11 offset:4096
    v_mfma_f32_16x16x32_bf16 v[128:131], v[172:175], a[44:47], v[128:131]
    ds_read_b64_tr_b16 v[182:183], v11 offset:4608
    v_mfma_f32_16x16x32_bf16 v[132:135], v[160:163], a[96:99], v[132:135]
    ds_read_b64_tr_b16 v[184:185], v11 offset:8192
    v_mfma_f32_16x16x32_bf16 v[132:135], v[164:167], a[100:103], v[132:135]
    ds_read_b64_tr_b16 v[186:187], v11 offset:8704
    v_mfma_f32_16x16x32_bf16 v[132:135], v[168:171], a[104:107], v[132:135]
    ds_read_b64_tr_b16 v[188:189], v11 offset:12288
    v_mfma_f32_16x16x32_bf16 v[132:135], v[172:175], a[108:111], v[132:135]
    ds_read_b64_tr_b16 v[190:191], v11 offset:12800
    v_mfma_f32_16x16x32_bf16 v[136:139], v[160:163], a[160:163], v[136:139]
    buffer_store_dwordx4 v[220:223], v19, s[4:7], s59 offen offset:0 sc1
    v_mfma_f32_16x16x32_bf16 v[136:139], v[164:167], a[164:167], v[136:139]
    v_mfma_f32_16x16x32_bf16 v[136:139], v[168:171], a[168:171], v[136:139]
    s_add_u32 m0, m0, 1024
    s_add_u32 s40, s40, s32
    v_mfma_f32_16x16x32_bf16 v[136:139], v[172:175], a[172:175], v[136:139]
    buffer_load_dwordx4 v2, s[8:11], s40 offen lds
    v_mfma_f32_16x16x32_bf16 v[140:143], v[160:163], a[224:227], v[140:143]
    v_mfma_f32_16x16x32_bf16 v[140:143], v[164:167], a[228:231], v[140:143]
    v_mfma_f32_16x16x32_bf16 v[140:143], v[168:171], a[232:235], v[140:143]
    v_mfma_f32_16x16x32_bf16 v[140:143], v[172:175], a[236:239], v[140:143]
    s_waitcnt lgkmcnt(0)
    v_mfma_f32_16x16x32_bf16 v[144:147], v[176:179], a[32:35], v[144:147]
    ds_read_b64_tr_b16 v[160:161], v12 offset:0
    v_mfma_f32_16x16x32_bf16 v[144:147], v[180:183], a[36:39], v[144:147]
    ds_read_b64_tr_b16 v[162:163], v12 offset:512
    v_mfma_f32_16x16x32_bf16 v[144:147], v[184:187], a[40:43], v[144:147]
    ds_read_b64_tr_b16 v[164:165], v12 offset:4096
    v_mfma_f32_16x16x32_bf16 v[144:147], v[188:191], a[44:47], v[144:147]
    ds_read_b64_tr_b16 v[166:167], v12 offset:4608
    v_mfma_f32_16x16x32_bf16 v[148:151], v[176:179], a[96:99], v[148:151]
    ds_read_b64_tr_b16 v[168:169], v12 offset:8192
    v_mfma_f32_16x16x32_bf16 v[148:151], v[180:183], a[100:103], v[148:151]
    ds_read_b64_tr_b16 v[170:171], v12 offset:8704
    v_mfma_f32_16x16x32_bf16 v[148:151], v[184:187], a[104:107], v[148:151]
    ds_read_b64_tr_b16 v[172:173], v12 offset:12288
    v_mfma_f32_16x16x32_bf16 v[148:151], v[188:191], a[108:111], v[148:151]
    ds_read_b64_tr_b16 v[174:175], v12 offset:12800
    v_mfma_f32_16x16x32_bf16 v[152:155], v[176:179], a[160:163], v[152:155]
    s_add_u32 s79, s29, 3
    s_cmp_lt_u32 s79, 64
    v_mfma_f32_16x16x32_bf16 v[152:155], v[180:183], a[164:167], v[152:155]
    s_cselect_b32 s92, s24, s26
    s_cselect_b32 s93, s25, s27
    v_mfma_f32_16x16x32_bf16 v[152:155], v[184:187], a[168:171], v[152:155]
    s_add_u32 m0, m0, 1024
    s_add_u32 s40, s40, s32
    v_mfma_f32_16x16x32_bf16 v[152:155], v[188:191], a[172:175], v[152:155]
    buffer_load_dwordx4 v3, s[8:11], s40 offen lds
    s_and_b32 s79, s79, 63
    v_mfma_f32_16x16x32_bf16 v[156:159], v[176:179], a[224:227], v[156:159]
    s_add_u32 s57, s57, 16384
    s_and_b32 s57, s57, 0x1ffff
    v_mfma_f32_16x16x32_bf16 v[156:159], v[180:183], a[228:231], v[156:159]
    s_add_u32 s31, s31, 1
    s_lshr_b32 s39, s31, 2
    v_mfma_f32_16x16x32_bf16 v[156:159], v[184:187], a[232:235], v[156:159]
    s_add_u32 s30, s30, s39
    s_and_b32 s31, s31, 3
    v_mfma_f32_16x16x32_bf16 v[156:159], v[188:191], a[236:239], v[156:159]
    s_lshl_b32 s79, s79, 7
    buffer_load_dword v27, v22, s[92:95], s79 offen
    s_add_u32 s56, s56, 16384
    s_and_b32 s56, s56, 0x1ffff
    v_mov_b32 v8, v12
    v_mov_b32 v9, v13
    v_mov_b32 v10, v14
    v_mov_b32 v11, v15
    v_add_u32 v12, s56, v4
    v_add_u32 v13, s56, v5
    v_add_u32 v14, s56, v6
    v_add_u32 v15, s56, v7
    s_waitcnt lgkmcnt(0)
    v_mfma_f32_16x16x32_bf16 v[96:99], v[160:163], a[48:51], v[96:99]
    ds_read_b64_tr_b16 v[176:177], v9 offset:0
    s_cmp_lt_u32 s30, 64
    v_mfma_f32_16x16x32_bf16 v[96:99], v[164:167], a[52:55], v[96:99]
    ds_read_b64_tr_b16 v[178:179], v9 offset:512
    s_cselect_b32 s8, s24, s26
    v_mfma_f32_16x16x32_bf16 v[96:99], v[168:171], a[56:59], v[96:99]
    ds_read_b64_tr_b16 v[180:181], v9 offset:4096
    s_cselect_b32 s9, s25, s27
    v_mfma_f32_16x16x32_bf16 v[96:99], v[172:175], a[60:63], v[96:99]
    ds_read_b64_tr_b16 v[182:183], v9 offset:4608
    s_and_b32 s40, s30, 63
    v_mfma_f32_16x16x32_bf16 v[100:103], v[160:163], a[112:115], v[100:103]
    ds_read_b64_tr_b16 v[184:185], v9 offset:8192
    s_lshl_b32 s40, s40, 7
    v_mfma_f32_16x16x32_bf16 v[100:103], v[164:167], a[116:119], v[100:103]
    ds_read_b64_tr_b16 v[186:187], v9 offset:8704
    s_lshl_b32 s39, s31, 2
    v_mfma_f32_16x16x32_bf16 v[100:103], v[168:171], a[120:123], v[100:103]
    ds_read_b64_tr_b16 v[188:189], v9 offset:12288
    s_add_u32 s39, s39, s35
    v_mfma_f32_16x16x32_bf16 v[100:103], v[172:175], a[124:127], v[100:103]
    ds_read_b64_tr_b16 v[190:191], v9 offset:12800
    s_lshl_b32 s39, s39, 2
    v_mfma_f32_16x16x32_bf16 v[104:107], v[160:163], a[176:179], v[104:107]
    s_mul_i32 s39, s39, s32
    s_add_u32 s40, s40, s39
    v_mfma_f32_16x16x32_bf16 v[104:107], v[164:167], a[180:183], v[104:107]
    s_lshl_b32 s39, s35, 12
    s_add_u32 s39, s39, s57
    v_mfma_f32_16x16x32_bf16 v[104:107], v[168:171], a[184:187], v[104:107]
    s_mov_b32 m0, s39
    s_nop 0
    v_mfma_f32_16x16x32_bf16 v[104:107], v[172:175], a[188:191], v[104:107]
    buffer_load_dwordx4 v2, s[8:11], s40 offen lds
    v_mfma_f32_16x16x32_bf16 v[108:111], v[160:163], a[240:243], v[108:111]
    v_mfma_f32_16x16x32_bf16 v[108:111], v[164:167], a[244:247], v[108:111]
    v_mfma_f32_16x16x32_bf16 v[108:111], v[168:171], a[248:251], v[108:111]
    v_mfma_f32_16x16x32_bf16 v[108:111], v[172:175], a[252:255], v[108:111]
    s_waitcnt lgkmcnt(0)
    v_mfma_f32_16x16x32_bf16 v[112:115], v[176:179], a[48:51], v[112:115]
    ds_read_b64_tr_b16 v[160:161], v10 offset:0
    v_mfma_f32_16x16x32_bf16 v[112:115], v[180:183], a[52:55], v[112:115]
    ds_read_b64_tr_b16 v[162:163], v10 offset:512
    v_mfma_f32_16x16x32_bf16 v[112:115], v[184:187], a[56:59], v[112:115]
    ds_read_b64_tr_b16 v[164:165], v10 offset:4096
    v_mfma_f32_16x16x32_bf16 v[112:115], v[188:191], a[60:63], v[112:115]
    ds_read_b64_tr_b16 v[166:167], v10 offset:4608
    v_cvt_pk_bf16_f32 v192, v96, v97
    v_mfma_f32_16x16x32_bf16 v[116:119], v[176:179], a[112:115], v[116:119]
    ds_read_b64_tr_b16 v[168:169], v10 offset:8192
    v_mfma_f32_16x16x32_bf16 v[116:119], v[180:183], a[116:119], v[116:119]
    ds_read_b64_tr_b16 v[170:171], v10 offset:8704
    v_mfma_f32_16x16x32_bf16 v[116:119], v[184:187], a[120:123], v[116:119]
    ds_read_b64_tr_b16 v[172:173], v10 offset:12288
    v_cvt_pk_bf16_f32 v193, v98, v99
    v_mfma_f32_16x16x32_bf16 v[116:119], v[188:191], a[124:127], v[116:119]
    ds_read_b64_tr_b16 v[174:175], v10 offset:12800
    v_mfma_f32_16x16x32_bf16 v[120:123], v[176:179], a[176:179], v[120:123]
    v_mfma_f32_16x16x32_bf16 v[120:123], v[180:183], a[180:183], v[120:123]
    v_mfma_f32_16x16x32_bf16 v[120:123], v[184:187], a[184:187], v[120:123]
    s_add_u32 m0, m0, 1024
    s_add_u32 s40, s40, s32
    v_mfma_f32_16x16x32_bf16 v[120:123], v[188:191], a[188:191], v[120:123]
    buffer_load_dwordx4 v3, s[8:11], s40 offen lds
    v_cvt_pk_bf16_f32 v196, v100, v101
    v_mfma_f32_16x16x32_bf16 v[124:127], v[176:179], a[240:243], v[124:127]
    v_mfma_f32_16x16x32_bf16 v[124:127], v[180:183], a[244:247], v[124:127]
    v_cvt_pk_bf16_f32 v197, v102, v103
    v_mfma_f32_16x16x32_bf16 v[124:127], v[184:187], a[248:251], v[124:127]
    v_mfma_f32_16x16x32_bf16 v[124:127], v[188:191], a[252:255], v[124:127]
    s_waitcnt lgkmcnt(0)
    v_mfma_f32_16x16x32_bf16 v[128:131], v[160:163], a[48:51], v[128:131]
    ds_read_b64_tr_b16 v[176:177], v11 offset:0
    v_mfma_f32_16x16x32_bf16 v[128:131], v[164:167], a[52:55], v[128:131]
    ds_read_b64_tr_b16 v[178:179], v11 offset:512
    v_cvt_pk_bf16_f32 v200, v104, v105
    v_mfma_f32_16x16x32_bf16 v[128:131], v[168:171], a[56:59], v[128:131]
    ds_read_b64_tr_b16 v[180:181], v11 offset:4096
    v_mfma_f32_16x16x32_bf16 v[128:131], v[172:175], a[60:63], v[128:131]
    ds_read_b64_tr_b16 v[182:183], v11 offset:4608
    v_cvt_pk_bf16_f32 v194, v112, v113
    v_mfma_f32_16x16x32_bf16 v[132:135], v[160:163], a[112:115], v[132:135]
    ds_read_b64_tr_b16 v[184:185], v11 offset:8192
    v_mfma_f32_16x16x32_bf16 v[132:135], v[164:167], a[116:119], v[132:135]
    ds_read_b64_tr_b16 v[186:187], v11 offset:8704
    v_cvt_pk_bf16_f32 v201, v106, v107
    v_mfma_f32_16x16x32_bf16 v[132:135], v[168:171], a[120:123], v[132:135]
    ds_read_b64_tr_b16 v[188:189], v11 offset:12288
    v_cvt_pk_bf16_f32 v195, v114, v115
    v_mfma_f32_16x16x32_bf16 v[132:135], v[172:175], a[124:127], v[132:135]
    ds_read_b64_tr_b16 v[190:191], v11 offset:12800
    v_mfma_f32_16x16x32_bf16 v[136:139], v[160:163], a[176:179], v[136:139]
    v_cvt_pk_bf16_f32 v204, v108, v109
    v_mfma_f32_16x16x32_bf16 v[136:139], v[164:167], a[180:183], v[136:139]
    v_mfma_f32_16x16x32_bf16 v[136:139], v[168:171], a[184:187], v[136:139]
    s_add_u32 m0, m0, 1024
    s_add_u32 s40, s40, s32
    v_mfma_f32_16x16x32_bf16 v[136:139], v[172:175], a[188:191], v[136:139]
    buffer_load_dwordx4 v2, s[8:11], s40 offen lds
    v_cvt_pk_bf16_f32 v198, v116, v117
    v_mfma_f32_16x16x32_bf16 v[140:143], v[160:163], a[240:243], v[140:143]
    v_cvt_pk_bf16_f32 v205, v110, v111
    v_mfma_f32_16x16x32_bf16 v[140:143], v[164:167], a[244:247], v[140:143]
    v_cvt_pk_bf16_f32 v199, v118, v119
    v_mfma_f32_16x16x32_bf16 v[140:143], v[168:171], a[248:251], v[140:143]
    v_mfma_f32_16x16x32_bf16 v[140:143], v[172:175], a[252:255], v[140:143]
    s_waitcnt lgkmcnt(0)
    v_mfma_f32_16x16x32_bf16 v[144:147], v[176:179], a[48:51], v[144:147]
    ds_read_b64_tr_b16 v[160:161], v12 offset:0
    v_mfma_f32_16x16x32_bf16 v[144:147], v[180:183], a[52:55], v[144:147]
    ds_read_b64_tr_b16 v[162:163], v12 offset:512
    v_cvt_pk_bf16_f32 v202, v120, v121
    v_mfma_f32_16x16x32_bf16 v[144:147], v[184:187], a[56:59], v[144:147]
    ds_read_b64_tr_b16 v[164:165], v12 offset:4096
    v_mfma_f32_16x16x32_bf16 v[144:147], v[188:191], a[60:63], v[144:147]
    ds_read_b64_tr_b16 v[166:167], v12 offset:4608
    v_cvt_pk_bf16_f32 v208, v128, v129
    v_mfma_f32_16x16x32_bf16 v[148:151], v[176:179], a[112:115], v[148:151]
    ds_read_b64_tr_b16 v[168:169], v12 offset:8192
    v_cvt_pk_bf16_f32 v209, v130, v131
    v_mfma_f32_16x16x32_bf16 v[148:151], v[180:183], a[116:119], v[148:151]
    ds_read_b64_tr_b16 v[170:171], v12 offset:8704
    v_cvt_pk_bf16_f32 v203, v122, v123
    v_mfma_f32_16x16x32_bf16 v[148:151], v[184:187], a[120:123], v[148:151]
    ds_read_b64_tr_b16 v[172:173], v12 offset:12288
    v_cvt_pk_bf16_f32 v212, v132, v133
    v_mfma_f32_16x16x32_bf16 v[148:151], v[188:191], a[124:127], v[148:151]
    ds_read_b64_tr_b16 v[174:175], v12 offset:12800
    v_cvt_pk_bf16_f32 v213, v134, v135
    v_mfma_f32_16x16x32_bf16 v[152:155], v[176:179], a[176:179], v[152:155]
    v_cvt_pk_bf16_f32 v206, v124, v125
    s_add_u32 s56, s56, 16384
    v_mfma_f32_16x16x32_bf16 v[152:155], v[180:183], a[180:183], v[152:155]
    v_cvt_pk_bf16_f32 v216, v136, v137
    s_and_b32 s56, s56, 0x1ffff
    v_mfma_f32_16x16x32_bf16 v[152:155], v[184:187], a[184:187], v[152:155]
    s_add_u32 m0, m0, 1024
    s_add_u32 s40, s40, s32
    v_mfma_f32_16x16x32_bf16 v[152:155], v[188:191], a[188:191], v[152:155]
    buffer_load_dwordx4 v3, s[8:11], s40 offen lds
    v_cvt_pk_bf16_f32 v217, v138, v139
    v_mfma_f32_16x16x32_bf16 v[156:159], v[176:179], a[240:243], v[156:159]
    s_add_u32 s57, s57, 16384
    s_and_b32 s57, s57, 0x1ffff
    v_mfma_f32_16x16x32_bf16 v[156:159], v[180:183], a[244:247], v[156:159]
    s_add_u32 s31, s31, 1
    s_lshr_b32 s39, s31, 2
    v_mfma_f32_16x16x32_bf16 v[156:159], v[184:187], a[248:251], v[156:159]
    s_add_u32 s30, s30, s39
    s_and_b32 s31, s31, 3
    v_mfma_f32_16x16x32_bf16 v[156:159], v[188:191], a[252:255], v[156:159]
    v_cvt_pk_bf16_f32 v207, v126, v127
    v_cvt_pk_bf16_f32 v220, v140, v141
    v_cvt_pk_bf16_f32 v221, v142, v143
    v_mov_b32 v8, v12
    v_mov_b32 v9, v13
    v_mov_b32 v10, v14
    v_mov_b32 v11, v15
    v_add_u32 v12, s56, v4
    v_add_u32 v13, s56, v5
    v_add_u32 v14, s56, v6
    v_add_u32 v15, s56, v7
    s_add_u32 s29, s29, 1
    s_cmp_lt_u32 s29, s44
    s_cbranch_scc1 p1_kernel_segk_loop
p1_kernel_segk_skip:
    s_mov_b32 s34, s33
    s_mov_b32 s59, s58
    s_nop 7
    v_cvt_pk_bf16_f32 v210, v144, v145
    v_cvt_pk_bf16_f32 v211, v146, v147
    v_cvt_pk_bf16_f32 v214, v148, v149
    v_cvt_pk_bf16_f32 v215, v150, v151
    v_cvt_pk_bf16_f32 v218, v152, v153
    v_cvt_pk_bf16_f32 v219, v154, v155
    v_cvt_pk_bf16_f32 v222, v156, v157
    v_cvt_pk_bf16_f32 v223, v158, v159
    s_nop 1
    buffer_store_dwordx4 v[192:195], v16, s[4:7], s34 offen offset:0 sc1
    buffer_store_dwordx4 v[196:199], v17, s[4:7], s34 offen offset:0 sc1
    buffer_store_dwordx4 v[200:203], v18, s[4:7], s34 offen offset:0 sc1
    buffer_store_dwordx4 v[204:207], v19, s[4:7], s34 offen offset:0 sc1
    buffer_store_dwordx4 v[208:211], v16, s[4:7], s59 offen offset:0 sc1
    buffer_store_dwordx4 v[212:215], v17, s[4:7], s59 offen offset:0 sc1
    buffer_store_dwordx4 v[216:219], v18, s[4:7], s59 offen offset:0 sc1
    buffer_store_dwordx4 v[220:223], v19, s[4:7], s59 offen offset:0 sc1
    s_mov_b32 s44, s69
    s_mov_b32 s33, 0x10000000
    s_mov_b32 s58, 0x10000000
    v_add_u32 v16, 0, v1
    v_add_u32 v17, 16384, v1
    s_cmp_ge_u32 s29, s44
    s_cbranch_scc1 p1_kernel_done
    s_branch p1_kernel_kv_vseg
p1_kernel_kv_vfirst:
    v_add_u32 v16, 0, v1
    v_add_u32 v17, 16384, v1
    s_waitcnt vmcnt(24)
    s_barrier
    ds_read_b64_tr_b16 v[160:161], v8 offset:0
    ds_read_b64_tr_b16 v[162:163], v8 offset:512
    ds_read_b64_tr_b16 v[164:165], v8 offset:4096
    ds_read_b64_tr_b16 v[166:167], v8 offset:4608
    ds_read_b64_tr_b16 v[168:169], v8 offset:8192
    ds_read_b64_tr_b16 v[170:171], v8 offset:8704
    ds_read_b64_tr_b16 v[172:173], v8 offset:12288
    ds_read_b64_tr_b16 v[174:175], v8 offset:12800
    s_waitcnt lgkmcnt(0)
    v_mfma_f32_16x16x32_bf16 v[96:99], a[0:3], v[160:163], 0
    ds_read_b64_tr_b16 v[176:177], v9 offset:0
    s_mov_b32 s34, s33
    s_mov_b32 s59, s58
    s_lshr_b32 s37, s29, 1
    v_mfma_f32_16x16x32_bf16 v[96:99], a[4:7], v[164:167], v[96:99]
    ds_read_b64_tr_b16 v[178:179], v9 offset:512
    s_and_b32 s37, s37, 31
    s_lshl_b32 s37, s37, 20
    s_and_b32 s38, s29, 1
    v_mfma_f32_16x16x32_bf16 v[96:99], a[8:11], v[168:171], v[96:99]
    ds_read_b64_tr_b16 v[180:181], v9 offset:4096
    s_lshl_b32 s38, s38, 12
    s_add_u32 s38, s38, 8192
    s_add_u32 s37, s37, s38
    v_mfma_f32_16x16x32_bf16 v[96:99], a[12:15], v[172:175], v[96:99]
    ds_read_b64_tr_b16 v[182:183], v9 offset:4608
    s_add_u32 s33, s37, s47
    s_add_u32 s58, s33, 1024
    s_cmp_lt_u32 s30, 64
    v_mfma_f32_16x16x32_bf16 v[100:103], a[64:67], v[160:163], 0
    ds_read_b64_tr_b16 v[184:185], v9 offset:8192
    s_cselect_b32 s8, s24, s26
    s_cselect_b32 s9, s25, s27
    s_and_b32 s40, s30, 63
    v_mfma_f32_16x16x32_bf16 v[100:103], a[68:71], v[164:167], v[100:103]
    ds_read_b64_tr_b16 v[186:187], v9 offset:8704
    s_lshl_b32 s40, s40, 7
    s_lshl_b32 s39, s31, 2
    s_add_u32 s39, s39, s35
    v_mfma_f32_16x16x32_bf16 v[100:103], a[72:75], v[168:171], v[100:103]
    ds_read_b64_tr_b16 v[188:189], v9 offset:12288
    s_lshl_b32 s39, s39, 2
    s_mul_i32 s39, s39, s32
    s_add_u32 s40, s40, s39
    v_mfma_f32_16x16x32_bf16 v[100:103], a[76:79], v[172:175], v[100:103]
    ds_read_b64_tr_b16 v[190:191], v9 offset:12800
    s_waitcnt vmcnt(8)
    s_lshl_b32 s39, s35, 12
    s_add_u32 s39, s39, s57
    v_mfma_f32_16x16x32_bf16 v[104:107], a[128:131], v[160:163], 0
    ds_write_b128 v29, v[192:195] offset:0
    s_mov_b32 m0, s39
    s_nop 0
    v_mfma_f32_16x16x32_bf16 v[104:107], a[132:135], v[164:167], v[104:107]
    ds_write_b128 v30, v[196:199] offset:1024
    buffer_load_dwordx4 v2, s[8:11], s40 offen lds
    s_add_u32 s42, s68, 512
    buffer_load_dwordx4 v[32:35], v28, s[12:15], s42 offen
    v_mfma_f32_16x16x32_bf16 v[104:107], a[136:139], v[168:171], v[104:107]
    ds_write_b128 v29, v[200:203] offset:2048
    s_add_u32 m0, m0, 1024
    s_add_u32 s40, s40, s32
    v_mfma_f32_16x16x32_bf16 v[104:107], a[140:143], v[172:175], v[104:107]
    ds_write_b128 v30, v[204:207] offset:3072
    buffer_load_dwordx4 v3, s[8:11], s40 offen lds
    s_add_u32 s42, s68, 8704
    buffer_load_dwordx4 v[36:39], v28, s[12:15], s42 offen
    v_mfma_f32_16x16x32_bf16 v[108:111], a[192:195], v[160:163], 0
    ds_write_b128 v29, v[208:211] offset:4096
    s_add_u32 m0, m0, 1024
    s_add_u32 s40, s40, s32
    v_mfma_f32_16x16x32_bf16 v[108:111], a[196:199], v[164:167], v[108:111]
    ds_write_b128 v30, v[212:215] offset:5120
    buffer_load_dwordx4 v2, s[8:11], s40 offen lds
    s_add_u32 s42, s68, 16896
    buffer_load_dwordx4 v[40:43], v28, s[12:15], s42 offen
    v_mfma_f32_16x16x32_bf16 v[108:111], a[200:203], v[168:171], v[108:111]
    ds_write_b128 v29, v[216:219] offset:6144
    s_add_u32 m0, m0, 1024
    s_add_u32 s40, s40, s32
    v_mfma_f32_16x16x32_bf16 v[108:111], a[204:207], v[172:175], v[108:111]
    ds_write_b128 v30, v[220:223] offset:7168
    buffer_load_dwordx4 v3, s[8:11], s40 offen lds
    s_add_u32 s42, s68, 25088
    buffer_load_dwordx4 v[44:47], v28, s[12:15], s42 offen
    s_waitcnt lgkmcnt(0)
    v_mfma_f32_16x16x32_bf16 v[112:115], a[0:3], v[176:179], 0
    ds_read_b64_tr_b16 v[160:161], v10 offset:0
    s_add_u32 s57, s57, 16384
    s_and_b32 s57, s57, 0x1ffff
    s_add_u32 s31, s31, 1
    v_mfma_f32_16x16x32_bf16 v[112:115], a[4:7], v[180:183], v[112:115]
    ds_read_b64_tr_b16 v[162:163], v10 offset:512
    s_lshr_b32 s39, s31, 2
    s_add_u32 s30, s30, s39
    s_and_b32 s31, s31, 3
    v_mfma_f32_16x16x32_bf16 v[112:115], a[8:11], v[184:187], v[112:115]
    ds_read_b64_tr_b16 v[164:165], v10 offset:4096
    s_cmp_lt_u32 s30, 64
    s_cselect_b32 s8, s24, s26
    s_cselect_b32 s9, s25, s27
    v_mfma_f32_16x16x32_bf16 v[112:115], a[12:15], v[188:191], v[112:115]
    ds_read_b64_tr_b16 v[166:167], v10 offset:4608
    s_and_b32 s40, s30, 63
    s_lshl_b32 s40, s40, 7
    s_lshl_b32 s39, s31, 2
    v_mfma_f32_16x16x32_bf16 v[116:119], a[64:67], v[176:179], 0
    ds_read_b64_tr_b16 v[168:169], v10 offset:8192
    s_add_u32 s39, s39, s35
    s_lshl_b32 s39, s39, 2
    s_mul_i32 s39, s39, s32
    v_mfma_f32_16x16x32_bf16 v[116:119], a[68:71], v[180:183], v[116:119]
    ds_read_b64_tr_b16 v[170:171], v10 offset:8704
    s_add_u32 s40, s40, s39
    s_lshl_b32 s39, s35, 12
    s_add_u32 s39, s39, s57
    v_mfma_f32_16x16x32_bf16 v[116:119], a[72:75], v[184:187], v[116:119]
    ds_read_b64_tr_b16 v[172:173], v10 offset:12288
    s_mov_b32 m0, s39
    s_nop 0
    v_mfma_f32_16x16x32_bf16 v[116:119], a[76:79], v[188:191], v[116:119]
    ds_read_b64_tr_b16 v[174:175], v10 offset:12800
    buffer_load_dwordx4 v2, s[8:11], s40 offen lds
    s_add_u32 s42, s68, 33280
    buffer_load_dwordx4 v[48:51], v28, s[12:15], s42 offen
    v_mfma_f32_16x16x32_bf16 v[120:123], a[128:131], v[176:179], 0
    ds_read_b128 a[16:19], v31 offset:0
    s_add_u32 m0, m0, 1024
    s_add_u32 s40, s40, s32
    v_mfma_f32_16x16x32_bf16 v[120:123], a[132:135], v[180:183], v[120:123]
    ds_read_b128 a[20:23], v23 offset:0
    buffer_load_dwordx4 v3, s[8:11], s40 offen lds
    s_add_u32 s42, s68, 41472
    buffer_load_dwordx4 v[52:55], v28, s[12:15], s42 offen
    v_mfma_f32_16x16x32_bf16 v[120:123], a[136:139], v[184:187], v[120:123]
    ds_read_b128 a[80:83], v31 offset:2048
    s_add_u32 m0, m0, 1024
    s_add_u32 s40, s40, s32
    v_mfma_f32_16x16x32_bf16 v[120:123], a[140:143], v[188:191], v[120:123]
    ds_read_b128 a[84:87], v23 offset:2048
    buffer_load_dwordx4 v2, s[8:11], s40 offen lds
    s_add_u32 s42, s68, 49664
    buffer_load_dwordx4 v[56:59], v28, s[12:15], s42 offen
    v_mfma_f32_16x16x32_bf16 v[124:127], a[192:195], v[176:179], 0
    ds_read_b128 a[144:147], v31 offset:4096
    s_add_u32 m0, m0, 1024
    s_add_u32 s40, s40, s32
    v_mfma_f32_16x16x32_bf16 v[124:127], a[196:199], v[180:183], v[124:127]
    ds_read_b128 a[148:151], v23 offset:4096
    buffer_load_dwordx4 v3, s[8:11], s40 offen lds
    s_add_u32 s42, s68, 57856
    buffer_load_dwordx4 v[60:63], v28, s[12:15], s42 offen
    v_mfma_f32_16x16x32_bf16 v[124:127], a[200:203], v[184:187], v[124:127]
    ds_read_b128 a[208:211], v31 offset:6144
    s_add_u32 s57, s57, 16384
    s_and_b32 s57, s57, 0x1ffff
    s_add_u32 s31, s31, 1
    v_mfma_f32_16x16x32_bf16 v[124:127], a[204:207], v[188:191], v[124:127]
    ds_read_b128 a[212:215], v23 offset:6144
    s_lshr_b32 s39, s31, 2
    s_add_u32 s30, s30, s39
    s_and_b32 s31, s31, 3
    s_waitcnt lgkmcnt(0)
    v_mfma_f32_16x16x32_bf16 v[128:131], a[0:3], v[160:163], 0
    ds_read_b64_tr_b16 v[176:177], v11 offset:0
    s_cmp_lt_u32 s30, 64
    s_cselect_b32 s8, s24, s26
    s_cselect_b32 s9, s25, s27
    v_mfma_f32_16x16x32_bf16 v[128:131], a[4:7], v[164:167], v[128:131]
    ds_read_b64_tr_b16 v[178:179], v11 offset:512
    s_and_b32 s40, s30, 63
    s_lshl_b32 s40, s40, 7
    s_lshl_b32 s39, s31, 2
    v_mfma_f32_16x16x32_bf16 v[128:131], a[8:11], v[168:171], v[128:131]
    ds_read_b64_tr_b16 v[180:181], v11 offset:4096
    s_add_u32 s39, s39, s35
    s_lshl_b32 s39, s39, 2
    s_mul_i32 s39, s39, s32
    v_mfma_f32_16x16x32_bf16 v[128:131], a[12:15], v[172:175], v[128:131]
    ds_read_b64_tr_b16 v[182:183], v11 offset:4608
    s_add_u32 s40, s40, s39
    s_lshl_b32 s39, s35, 12
    s_add_u32 s39, s39, s57
    v_mfma_f32_16x16x32_bf16 v[132:135], a[64:67], v[160:163], 0
    ds_read_b64_tr_b16 v[184:185], v11 offset:8192
    s_mov_b32 m0, s39
    s_nop 0
    v_mfma_f32_16x16x32_bf16 v[132:135], a[68:71], v[164:167], v[132:135]
    ds_read_b64_tr_b16 v[186:187], v11 offset:8704
    buffer_load_dwordx4 v2, s[8:11], s40 offen lds
    s_add_u32 s42, s68, 640
    buffer_load_dwordx4 v[64:67], v28, s[12:15], s42 offen
    v_mfma_f32_16x16x32_bf16 v[132:135], a[72:75], v[168:171], v[132:135]
    ds_read_b64_tr_b16 v[188:189], v11 offset:12288
    s_add_u32 m0, m0, 1024
    s_add_u32 s40, s40, s32
    v_mfma_f32_16x16x32_bf16 v[132:135], a[76:79], v[172:175], v[132:135]
    ds_read_b64_tr_b16 v[190:191], v11 offset:12800
    s_waitcnt vmcnt(18)
    buffer_load_dwordx4 v3, s[8:11], s40 offen lds
    v_mfma_f32_16x16x32_bf16 v[136:139], a[128:131], v[160:163], 0
    ds_write_b128 v29, v[224:227] offset:0
    s_add_u32 m0, m0, 1024
    s_add_u32 s40, s40, s32
    v_mfma_f32_16x16x32_bf16 v[136:139], a[132:135], v[164:167], v[136:139]
    ds_write_b128 v30, v[228:231] offset:1024
    buffer_load_dwordx4 v2, s[8:11], s40 offen lds
    s_add_u32 s42, s68, 8832
    buffer_load_dwordx4 v[68:71], v28, s[12:15], s42 offen
    v_mfma_f32_16x16x32_bf16 v[136:139], a[136:139], v[168:171], v[136:139]
    ds_write_b128 v29, v[232:235] offset:2048
    s_add_u32 m0, m0, 1024
    s_add_u32 s40, s40, s32
    v_mfma_f32_16x16x32_bf16 v[136:139], a[140:143], v[172:175], v[136:139]
    ds_write_b128 v30, v[236:239] offset:3072
    buffer_load_dwordx4 v3, s[8:11], s40 offen lds
    s_add_u32 s42, s68, 17024
    buffer_load_dwordx4 v[72:75], v28, s[12:15], s42 offen
    v_mfma_f32_16x16x32_bf16 v[140:143], a[192:195], v[160:163], 0
    ds_write_b128 v29, v[240:243] offset:4096
    s_add_u32 s57, s57, 16384
    s_and_b32 s57, s57, 0x1ffff
    s_add_u32 s31, s31, 1
    v_mfma_f32_16x16x32_bf16 v[140:143], a[196:199], v[164:167], v[140:143]
    ds_write_b128 v30, v[244:247] offset:5120
    s_lshr_b32 s39, s31, 2
    s_add_u32 s30, s30, s39
    s_and_b32 s31, s31, 3
    v_mfma_f32_16x16x32_bf16 v[140:143], a[200:203], v[168:171], v[140:143]
    ds_write_b128 v29, v[248:251] offset:6144
    s_add_u32 s42, s68, 25216
    buffer_load_dwordx4 v[76:79], v28, s[12:15], s42 offen
    v_mfma_f32_16x16x32_bf16 v[140:143], a[204:207], v[172:175], v[140:143]
    ds_write_b128 v30, v[252:255] offset:7168
    s_add_u32 s42, s68, 33408
    buffer_load_dwordx4 v[80:83], v28, s[12:15], s42 offen
    s_waitcnt vmcnt(18)
    s_barrier
    s_waitcnt lgkmcnt(0)
    v_mfma_f32_16x16x32_bf16 v[144:147], a[0:3], v[176:179], 0
    ds_read_b64_tr_b16 v[160:161], v12 offset:0
    v_mfma_f32_16x16x32_bf16 v[144:147], a[4:7], v[180:183], v[144:147]
    ds_read_b64_tr_b16 v[162:163], v12 offset:512
    s_add_u32 s42, s68, 41600
    buffer_load_dwordx4 v[84:87], v28, s[12:15], s42 offen
    v_mfma_f32_16x16x32_bf16 v[144:147], a[8:11], v[184:187], v[144:147]
    ds_read_b64_tr_b16 v[164:165], v12 offset:4096
    v_mfma_f32_16x16x32_bf16 v[144:147], a[12:15], v[188:191], v[144:147]
    ds_read_b64_tr_b16 v[166:167], v12 offset:4608
    v_mfma_f32_16x16x32_bf16 v[148:151], a[64:67], v[176:179], 0
    ds_read_b64_tr_b16 v[168:169], v12 offset:8192
    s_add_u32 s42, s68, 49792
    buffer_load_dwordx4 v[88:91], v28, s[12:15], s42 offen
    v_mfma_f32_16x16x32_bf16 v[148:151], a[68:71], v[180:183], v[148:151]
    ds_read_b64_tr_b16 v[170:171], v12 offset:8704
    v_mfma_f32_16x16x32_bf16 v[148:151], a[72:75], v[184:187], v[148:151]
    ds_read_b64_tr_b16 v[172:173], v12 offset:12288
    v_mfma_f32_16x16x32_bf16 v[148:151], a[76:79], v[188:191], v[148:151]
    ds_read_b64_tr_b16 v[174:175], v12 offset:12800
    v_mfma_f32_16x16x32_bf16 v[152:155], a[128:131], v[176:179], 0
    ds_read_b128 a[24:27], v31 offset:0
    s_add_u32 s42, s68, 57984
    buffer_load_dwordx4 v[92:95], v28, s[12:15], s42 offen
    s_add_u32 s56, s56, 16384
    v_mfma_f32_16x16x32_bf16 v[152:155], a[132:135], v[180:183], v[152:155]
    ds_read_b128 a[28:31], v23 offset:0
    s_and_b32 s56, s56, 0x1ffff
    v_mov_b32 v8, v12
    v_mov_b32 v9, v13
    v_mfma_f32_16x16x32_bf16 v[152:155], a[136:139], v[184:187], v[152:155]
    ds_read_b128 a[88:91], v31 offset:2048
    v_mov_b32 v10, v14
    v_mov_b32 v11, v15
    v_add_u32 v12, s56, v4
    v_mfma_f32_16x16x32_bf16 v[152:155], a[140:143], v[188:191], v[152:155]
    ds_read_b128 a[92:95], v23 offset:2048
    v_add_u32 v13, s56, v5
    v_add_u32 v14, s56, v6
    v_add_u32 v15, s56, v7
    v_mfma_f32_16x16x32_bf16 v[156:159], a[192:195], v[176:179], 0
    ds_read_b128 a[152:155], v31 offset:4096
    v_mfma_f32_16x16x32_bf16 v[156:159], a[196:199], v[180:183], v[156:159]
    ds_read_b128 a[156:159], v23 offset:4096
    v_mfma_f32_16x16x32_bf16 v[156:159], a[200:203], v[184:187], v[156:159]
    ds_read_b128 a[216:219], v31 offset:6144
    v_mfma_f32_16x16x32_bf16 v[156:159], a[204:207], v[188:191], v[156:159]
    ds_read_b128 a[220:223], v23 offset:6144
    s_waitcnt lgkmcnt(0)
    v_mfma_f32_16x16x32_bf16 v[96:99], a[16:19], v[160:163], v[96:99]
    ds_read_b64_tr_b16 v[176:177], v9 offset:0
    s_cmp_lt_u32 s30, 64
    s_cselect_b32 s8, s24, s26
    s_cselect_b32 s9, s25, s27
    v_mfma_f32_16x16x32_bf16 v[96:99], a[20:23], v[164:167], v[96:99]
    ds_read_b64_tr_b16 v[178:179], v9 offset:512
    s_and_b32 s40, s30, 63
    s_lshl_b32 s40, s40, 7
    s_lshl_b32 s39, s31, 2
    v_mfma_f32_16x16x32_bf16 v[96:99], a[24:27], v[168:171], v[96:99]
    ds_read_b64_tr_b16 v[180:181], v9 offset:4096
    s_add_u32 s39, s39, s35
    s_lshl_b32 s39, s39, 2
    s_mul_i32 s39, s39, s32
    v_mfma_f32_16x16x32_bf16 v[96:99], a[28:31], v[172:175], v[96:99]
    ds_read_b64_tr_b16 v[182:183], v9 offset:4608
    s_add_u32 s40, s40, s39
    s_lshl_b32 s39, s35, 12
    s_add_u32 s39, s39, s57
    v_mfma_f32_16x16x32_bf16 v[100:103], a[80:83], v[160:163], v[100:103]
    ds_read_b64_tr_b16 v[184:185], v9 offset:8192
    s_mov_b32 m0, s39
    s_nop 0
    v_mfma_f32_16x16x32_bf16 v[100:103], a[84:87], v[164:167], v[100:103]
    ds_read_b64_tr_b16 v[186:187], v9 offset:8704
    buffer_load_dwordx4 v2, s[8:11], s40 offen lds
    s_add_u32 s42, s68, 768
    buffer_load_dwordx4 v[192:195], v28, s[12:15], s42 offen
    v_mfma_f32_16x16x32_bf16 v[100:103], a[88:91], v[168:171], v[100:103]
    ds_read_b64_tr_b16 v[188:189], v9 offset:12288
    s_add_u32 s42, s68, 8960
    buffer_load_dwordx4 v[196:199], v28, s[12:15], s42 offen
    v_mfma_f32_16x16x32_bf16 v[100:103], a[92:95], v[172:175], v[100:103]
    ds_read_b64_tr_b16 v[190:191], v9 offset:12800
    s_waitcnt vmcnt(15)
    v_mfma_f32_16x16x32_bf16 v[104:107], a[144:147], v[160:163], v[104:107]
    ds_write_b128 v29, v[32:35] offset:0
    v_mfma_f32_16x16x32_bf16 v[104:107], a[148:151], v[164:167], v[104:107]
    ds_write_b128 v30, v[36:39] offset:1024
    s_add_u32 s42, s68, 17152
    buffer_load_dwordx4 v[200:203], v28, s[12:15], s42 offen
    v_mfma_f32_16x16x32_bf16 v[104:107], a[152:155], v[168:171], v[104:107]
    ds_write_b128 v29, v[40:43] offset:2048
    v_mfma_f32_16x16x32_bf16 v[104:107], a[156:159], v[172:175], v[104:107]
    ds_write_b128 v30, v[44:47] offset:3072
    v_mfma_f32_16x16x32_bf16 v[108:111], a[208:211], v[160:163], v[108:111]
    ds_write_b128 v29, v[48:51] offset:4096
    s_add_u32 m0, m0, 1024
    s_add_u32 s40, s40, s32
    v_mfma_f32_16x16x32_bf16 v[108:111], a[212:215], v[164:167], v[108:111]
    ds_write_b128 v30, v[52:55] offset:5120
    buffer_load_dwordx4 v3, s[8:11], s40 offen lds
    s_add_u32 s42, s68, 25344
    buffer_load_dwordx4 v[204:207], v28, s[12:15], s42 offen
    v_mfma_f32_16x16x32_bf16 v[108:111], a[216:219], v[168:171], v[108:111]
    ds_write_b128 v29, v[56:59] offset:6144
    v_mfma_f32_16x16x32_bf16 v[108:111], a[220:223], v[172:175], v[108:111]
    ds_write_b128 v30, v[60:63] offset:7168
    s_waitcnt lgkmcnt(0)
    v_mfma_f32_16x16x32_bf16 v[112:115], a[16:19], v[176:179], v[112:115]
    ds_read_b64_tr_b16 v[160:161], v10 offset:0
    s_add_u32 s42, s68, 33536
    buffer_load_dwordx4 v[208:211], v28, s[12:15], s42 offen
    v_mfma_f32_16x16x32_bf16 v[112:115], a[20:23], v[180:183], v[112:115]
    ds_read_b64_tr_b16 v[162:163], v10 offset:512
    v_mfma_f32_16x16x32_bf16 v[112:115], a[24:27], v[184:187], v[112:115]
    ds_read_b64_tr_b16 v[164:165], v10 offset:4096
    v_mfma_f32_16x16x32_bf16 v[112:115], a[28:31], v[188:191], v[112:115]
    ds_read_b64_tr_b16 v[166:167], v10 offset:4608
    v_mfma_f32_16x16x32_bf16 v[116:119], a[80:83], v[176:179], v[116:119]
    ds_read_b64_tr_b16 v[168:169], v10 offset:8192
    s_add_u32 m0, m0, 1024
    s_add_u32 s40, s40, s32
    v_mfma_f32_16x16x32_bf16 v[116:119], a[84:87], v[180:183], v[116:119]
    ds_read_b64_tr_b16 v[170:171], v10 offset:8704
    buffer_load_dwordx4 v2, s[8:11], s40 offen lds
    s_add_u32 s42, s68, 41728
    buffer_load_dwordx4 v[212:215], v28, s[12:15], s42 offen
    v_mfma_f32_16x16x32_bf16 v[116:119], a[88:91], v[184:187], v[116:119]
    ds_read_b64_tr_b16 v[172:173], v10 offset:12288
    v_mfma_f32_16x16x32_bf16 v[116:119], a[92:95], v[188:191], v[116:119]
    ds_read_b64_tr_b16 v[174:175], v10 offset:12800
    s_add_u32 s42, s68, 49920
    buffer_load_dwordx4 v[216:219], v28, s[12:15], s42 offen
    v_mfma_f32_16x16x32_bf16 v[120:123], a[144:147], v[176:179], v[120:123]
    ds_read_b128 a[32:35], v31 offset:0
    v_mfma_f32_16x16x32_bf16 v[120:123], a[148:151], v[180:183], v[120:123]
    ds_read_b128 a[36:39], v23 offset:0
    v_mfma_f32_16x16x32_bf16 v[120:123], a[152:155], v[184:187], v[120:123]
    ds_read_b128 a[96:99], v31 offset:2048
    v_mfma_f32_16x16x32_bf16 v[120:123], a[156:159], v[188:191], v[120:123]
    ds_read_b128 a[100:103], v23 offset:2048
    s_add_u32 s42, s68, 58112
    buffer_load_dwordx4 v[220:223], v28, s[12:15], s42 offen
    v_mfma_f32_16x16x32_bf16 v[124:127], a[208:211], v[176:179], v[124:127]
    ds_read_b128 a[160:163], v31 offset:4096
    s_add_u32 m0, m0, 1024
    s_add_u32 s40, s40, s32
    v_mfma_f32_16x16x32_bf16 v[124:127], a[212:215], v[180:183], v[124:127]
    ds_read_b128 a[164:167], v23 offset:4096
    buffer_load_dwordx4 v3, s[8:11], s40 offen lds
    v_mfma_f32_16x16x32_bf16 v[124:127], a[216:219], v[184:187], v[124:127]
    ds_read_b128 a[224:227], v31 offset:6144
    s_add_u32 s57, s57, 16384
    s_and_b32 s57, s57, 0x1ffff
    s_add_u32 s31, s31, 1
    v_mfma_f32_16x16x32_bf16 v[124:127], a[220:223], v[188:191], v[124:127]
    ds_read_b128 a[228:231], v23 offset:6144
    s_lshr_b32 s39, s31, 2
    s_add_u32 s30, s30, s39
    s_and_b32 s31, s31, 3
    s_waitcnt lgkmcnt(0)
    v_mfma_f32_16x16x32_bf16 v[128:131], a[16:19], v[160:163], v[128:131]
    ds_read_b64_tr_b16 v[176:177], v11 offset:0
    s_cmp_lt_u32 s30, 64
    s_cselect_b32 s8, s24, s26
    s_cselect_b32 s9, s25, s27
    v_mfma_f32_16x16x32_bf16 v[128:131], a[20:23], v[164:167], v[128:131]
    ds_read_b64_tr_b16 v[178:179], v11 offset:512
    s_and_b32 s40, s30, 63
    s_lshl_b32 s40, s40, 7
    s_lshl_b32 s39, s31, 2
    v_mfma_f32_16x16x32_bf16 v[128:131], a[24:27], v[168:171], v[128:131]
    ds_read_b64_tr_b16 v[180:181], v11 offset:4096
    s_add_u32 s39, s39, s35
    s_lshl_b32 s39, s39, 2
    s_mul_i32 s39, s39, s32
    v_mfma_f32_16x16x32_bf16 v[128:131], a[28:31], v[172:175], v[128:131]
    ds_read_b64_tr_b16 v[182:183], v11 offset:4608
    s_add_u32 s40, s40, s39
    s_lshl_b32 s39, s35, 12
    s_add_u32 s39, s39, s57
    v_mfma_f32_16x16x32_bf16 v[132:135], a[80:83], v[160:163], v[132:135]
    ds_read_b64_tr_b16 v[184:185], v11 offset:8192
    s_mov_b32 m0, s39
    s_nop 0
    v_mfma_f32_16x16x32_bf16 v[132:135], a[84:87], v[164:167], v[132:135]
    ds_read_b64_tr_b16 v[186:187], v11 offset:8704
    buffer_load_dwordx4 v2, s[8:11], s40 offen lds
    s_add_u32 s42, s68, 896
    buffer_load_dwordx4 v[224:227], v28, s[12:15], s42 offen
    v_mfma_f32_16x16x32_bf16 v[132:135], a[88:91], v[168:171], v[132:135]
    ds_read_b64_tr_b16 v[188:189], v11 offset:12288
    s_add_u32 s42, s68, 9088
    buffer_load_dwordx4 v[228:231], v28, s[12:15], s42 offen
    v_mfma_f32_16x16x32_bf16 v[132:135], a[92:95], v[172:175], v[132:135]
    ds_read_b64_tr_b16 v[190:191], v11 offset:12800
    s_waitcnt vmcnt(15)
    s_add_u32 s42, s68, 17280
    buffer_load_dwordx4 v[232:235], v28, s[12:15], s42 offen
    v_mfma_f32_16x16x32_bf16 v[136:139], a[144:147], v[160:163], v[136:139]
    ds_write_b128 v29, v[64:67] offset:0
    v_mfma_f32_16x16x32_bf16 v[136:139], a[148:151], v[164:167], v[136:139]
    ds_write_b128 v30, v[68:71] offset:1024
    s_add_u32 s42, s68, 25472
    buffer_load_dwordx4 v[236:239], v28, s[12:15], s42 offen
    v_mfma_f32_16x16x32_bf16 v[136:139], a[152:155], v[168:171], v[136:139]
    ds_write_b128 v29, v[72:75] offset:2048
    v_mfma_f32_16x16x32_bf16 v[136:139], a[156:159], v[172:175], v[136:139]
    ds_write_b128 v30, v[76:79] offset:3072
    v_mfma_f32_16x16x32_bf16 v[140:143], a[208:211], v[160:163], v[140:143]
    ds_write_b128 v29, v[80:83] offset:4096
    s_add_u32 m0, m0, 1024
    s_add_u32 s40, s40, s32
    v_mfma_f32_16x16x32_bf16 v[140:143], a[212:215], v[164:167], v[140:143]
    ds_write_b128 v30, v[84:87] offset:5120
    buffer_load_dwordx4 v3, s[8:11], s40 offen lds
    s_add_u32 s42, s68, 33664
    buffer_load_dwordx4 v[240:243], v28, s[12:15], s42 offen
    v_mfma_f32_16x16x32_bf16 v[140:143], a[216:219], v[168:171], v[140:143]
    ds_write_b128 v29, v[88:91] offset:6144
    v_mfma_f32_16x16x32_bf16 v[140:143], a[220:223], v[172:175], v[140:143]
    ds_write_b128 v30, v[92:95] offset:7168
    s_waitcnt vmcnt(32)
    s_barrier
    s_waitcnt lgkmcnt(0)
    v_mfma_f32_16x16x32_bf16 v[144:147], a[16:19], v[176:179], v[144:147]
    ds_read_b64_tr_b16 v[160:161], v12 offset:0
    v_mfma_f32_16x16x32_bf16 v[144:147], a[20:23], v[180:183], v[144:147]
    ds_read_b64_tr_b16 v[162:163], v12 offset:512
    s_add_u32 s42, s68, 41856
    buffer_load_dwordx4 v[244:247], v28, s[12:15], s42 offen
    v_mfma_f32_16x16x32_bf16 v[144:147], a[24:27], v[184:187], v[144:147]
    ds_read_b64_tr_b16 v[164:165], v12 offset:4096
    v_mfma_f32_16x16x32_bf16 v[144:147], a[28:31], v[188:191], v[144:147]
    ds_read_b64_tr_b16 v[166:167], v12 offset:4608
    v_mfma_f32_16x16x32_bf16 v[148:151], a[80:83], v[176:179], v[148:151]
    ds_read_b64_tr_b16 v[168:169], v12 offset:8192
    s_add_u32 m0, m0, 1024
    s_add_u32 s40, s40, s32
    v_mfma_f32_16x16x32_bf16 v[148:151], a[84:87], v[180:183], v[148:151]
    ds_read_b64_tr_b16 v[170:171], v12 offset:8704
    buffer_load_dwordx4 v2, s[8:11], s40 offen lds
    s_add_u32 s42, s68, 50048
    buffer_load_dwordx4 v[248:251], v28, s[12:15], s42 offen
    v_mfma_f32_16x16x32_bf16 v[148:151], a[88:91], v[184:187], v[148:151]
    ds_read_b64_tr_b16 v[172:173], v12 offset:12288
    v_mfma_f32_16x16x32_bf16 v[148:151], a[92:95], v[188:191], v[148:151]
    ds_read_b64_tr_b16 v[174:175], v12 offset:12800
    v_mfma_f32_16x16x32_bf16 v[152:155], a[144:147], v[176:179], v[152:155]
    ds_read_b128 a[40:43], v31 offset:0
    s_add_u32 s42, s68, 58240
    buffer_load_dwordx4 v[252:255], v28, s[12:15], s42 offen
    s_add_u32 s56, s56, 16384
    v_mfma_f32_16x16x32_bf16 v[152:155], a[148:151], v[180:183], v[152:155]
    ds_read_b128 a[44:47], v23 offset:0
    s_and_b32 s56, s56, 0x1ffff
    v_mov_b32 v8, v12
    v_mov_b32 v9, v13
    v_mfma_f32_16x16x32_bf16 v[152:155], a[152:155], v[184:187], v[152:155]
    ds_read_b128 a[104:107], v31 offset:2048
    v_mov_b32 v10, v14
    v_mov_b32 v11, v15
    v_add_u32 v12, s56, v4
    v_mfma_f32_16x16x32_bf16 v[152:155], a[156:159], v[188:191], v[152:155]
    ds_read_b128 a[108:111], v23 offset:2048
    v_add_u32 v13, s56, v5
    v_add_u32 v14, s56, v6
    v_add_u32 v15, s56, v7
    v_mfma_f32_16x16x32_bf16 v[156:159], a[208:211], v[176:179], v[156:159]
    ds_read_b128 a[168:171], v31 offset:4096
    s_add_u32 m0, m0, 1024
    s_add_u32 s40, s40, s32
    v_mfma_f32_16x16x32_bf16 v[156:159], a[212:215], v[180:183], v[156:159]
    ds_read_b128 a[172:175], v23 offset:4096
    buffer_load_dwordx4 v3, s[8:11], s40 offen lds
    v_mfma_f32_16x16x32_bf16 v[156:159], a[216:219], v[184:187], v[156:159]
    ds_read_b128 a[232:235], v31 offset:6144
    s_add_u32 s57, s57, 16384
    s_and_b32 s57, s57, 0x1ffff
    s_add_u32 s31, s31, 1
    v_mfma_f32_16x16x32_bf16 v[156:159], a[220:223], v[188:191], v[156:159]
    ds_read_b128 a[236:239], v23 offset:6144
    s_lshr_b32 s39, s31, 2
    s_add_u32 s30, s30, s39
    s_and_b32 s31, s31, 3
    s_waitcnt lgkmcnt(0)
    v_mfma_f32_16x16x32_bf16 v[96:99], a[32:35], v[160:163], v[96:99]
    ds_read_b64_tr_b16 v[176:177], v9 offset:0
    s_cmp_lt_u32 s30, 64
    s_cselect_b32 s8, s24, s26
    s_cselect_b32 s9, s25, s27
    v_mfma_f32_16x16x32_bf16 v[96:99], a[36:39], v[164:167], v[96:99]
    ds_read_b64_tr_b16 v[178:179], v9 offset:512
    s_and_b32 s40, s30, 63
    s_lshl_b32 s40, s40, 7
    s_lshl_b32 s39, s31, 2
    v_mfma_f32_16x16x32_bf16 v[96:99], a[40:43], v[168:171], v[96:99]
    ds_read_b64_tr_b16 v[180:181], v9 offset:4096
    s_add_u32 s39, s39, s35
    s_lshl_b32 s39, s39, 2
    s_mul_i32 s39, s39, s32
    v_mfma_f32_16x16x32_bf16 v[96:99], a[44:47], v[172:175], v[96:99]
    ds_read_b64_tr_b16 v[182:183], v9 offset:4608
    s_add_u32 s40, s40, s39
    s_lshl_b32 s39, s35, 12
    s_add_u32 s39, s39, s57
    v_mfma_f32_16x16x32_bf16 v[100:103], a[96:99], v[160:163], v[100:103]
    ds_read_b64_tr_b16 v[184:185], v9 offset:8192
    s_mov_b32 m0, s39
    s_nop 0
    v_mfma_f32_16x16x32_bf16 v[100:103], a[100:103], v[164:167], v[100:103]
    ds_read_b64_tr_b16 v[186:187], v9 offset:8704
    buffer_load_dwordx4 v2, s[8:11], s40 offen lds
    v_mfma_f32_16x16x32_bf16 v[100:103], a[104:107], v[168:171], v[100:103]
    ds_read_b64_tr_b16 v[188:189], v9 offset:12288
    v_mfma_f32_16x16x32_bf16 v[100:103], a[108:111], v[172:175], v[100:103]
    ds_read_b64_tr_b16 v[190:191], v9 offset:12800
    s_waitcnt vmcnt(14)
    v_mfma_f32_16x16x32_bf16 v[104:107], a[160:163], v[160:163], v[104:107]
    ds_write_b128 v29, v[192:195] offset:0
    v_mfma_f32_16x16x32_bf16 v[104:107], a[164:167], v[164:167], v[104:107]
    ds_write_b128 v30, v[196:199] offset:1024
    v_mfma_f32_16x16x32_bf16 v[104:107], a[168:171], v[168:171], v[104:107]
    ds_write_b128 v29, v[200:203] offset:2048
    v_mfma_f32_16x16x32_bf16 v[104:107], a[172:175], v[172:175], v[104:107]
    ds_write_b128 v30, v[204:207] offset:3072
    v_mfma_f32_16x16x32_bf16 v[108:111], a[224:227], v[160:163], v[108:111]
    ds_write_b128 v29, v[208:211] offset:4096
    s_add_u32 m0, m0, 1024
    s_add_u32 s40, s40, s32
    v_mfma_f32_16x16x32_bf16 v[108:111], a[228:231], v[164:167], v[108:111]
    ds_write_b128 v30, v[212:215] offset:5120
    buffer_load_dwordx4 v3, s[8:11], s40 offen lds
    v_mfma_f32_16x16x32_bf16 v[108:111], a[232:235], v[168:171], v[108:111]
    ds_write_b128 v29, v[216:219] offset:6144
    v_mfma_f32_16x16x32_bf16 v[108:111], a[236:239], v[172:175], v[108:111]
    ds_write_b128 v30, v[220:223] offset:7168
    s_waitcnt lgkmcnt(0)
    v_mfma_f32_16x16x32_bf16 v[112:115], a[32:35], v[176:179], v[112:115]
    ds_read_b64_tr_b16 v[160:161], v10 offset:0
    v_mfma_f32_16x16x32_bf16 v[112:115], a[36:39], v[180:183], v[112:115]
    ds_read_b64_tr_b16 v[162:163], v10 offset:512
    v_mfma_f32_16x16x32_bf16 v[112:115], a[40:43], v[184:187], v[112:115]
    ds_read_b64_tr_b16 v[164:165], v10 offset:4096
    v_mfma_f32_16x16x32_bf16 v[112:115], a[44:47], v[188:191], v[112:115]
    ds_read_b64_tr_b16 v[166:167], v10 offset:4608
    v_mfma_f32_16x16x32_bf16 v[116:119], a[96:99], v[176:179], v[116:119]
    ds_read_b64_tr_b16 v[168:169], v10 offset:8192
    s_add_u32 m0, m0, 1024
    s_add_u32 s40, s40, s32
    v_mfma_f32_16x16x32_bf16 v[116:119], a[100:103], v[180:183], v[116:119]
    ds_read_b64_tr_b16 v[170:171], v10 offset:8704
    buffer_load_dwordx4 v2, s[8:11], s40 offen lds
    v_mfma_f32_16x16x32_bf16 v[116:119], a[104:107], v[184:187], v[116:119]
    ds_read_b64_tr_b16 v[172:173], v10 offset:12288
    v_mfma_f32_16x16x32_bf16 v[116:119], a[108:111], v[188:191], v[116:119]
    ds_read_b64_tr_b16 v[174:175], v10 offset:12800
    v_mfma_f32_16x16x32_bf16 v[120:123], a[160:163], v[176:179], v[120:123]
    ds_read_b128 a[48:51], v31 offset:0
    v_mfma_f32_16x16x32_bf16 v[120:123], a[164:167], v[180:183], v[120:123]
    ds_read_b128 a[52:55], v23 offset:0
    v_mfma_f32_16x16x32_bf16 v[120:123], a[168:171], v[184:187], v[120:123]
    ds_read_b128 a[112:115], v31 offset:2048
    v_mfma_f32_16x16x32_bf16 v[120:123], a[172:175], v[188:191], v[120:123]
    ds_read_b128 a[116:119], v23 offset:2048
    v_mfma_f32_16x16x32_bf16 v[124:127], a[224:227], v[176:179], v[124:127]
    ds_read_b128 a[176:179], v31 offset:4096
    s_add_u32 m0, m0, 1024
    s_add_u32 s40, s40, s32
    v_mfma_f32_16x16x32_bf16 v[124:127], a[228:231], v[180:183], v[124:127]
    ds_read_b128 a[180:183], v23 offset:4096
    buffer_load_dwordx4 v3, s[8:11], s40 offen lds
    v_mfma_f32_16x16x32_bf16 v[124:127], a[232:235], v[184:187], v[124:127]
    ds_read_b128 a[240:243], v31 offset:6144
    s_add_u32 s57, s57, 16384
    s_and_b32 s57, s57, 0x1ffff
    s_add_u32 s31, s31, 1
    v_mfma_f32_16x16x32_bf16 v[124:127], a[236:239], v[188:191], v[124:127]
    ds_read_b128 a[244:247], v23 offset:6144
    s_lshr_b32 s39, s31, 2
    s_add_u32 s30, s30, s39
    s_and_b32 s31, s31, 3
    s_waitcnt lgkmcnt(0)
    v_mfma_f32_16x16x32_bf16 v[128:131], a[32:35], v[160:163], v[128:131]
    ds_read_b64_tr_b16 v[176:177], v11 offset:0
    s_cmp_lt_u32 s30, 64
    s_cselect_b32 s8, s24, s26
    s_cselect_b32 s9, s25, s27
    v_mfma_f32_16x16x32_bf16 v[128:131], a[36:39], v[164:167], v[128:131]
    ds_read_b64_tr_b16 v[178:179], v11 offset:512
    s_and_b32 s40, s30, 63
    s_lshl_b32 s40, s40, 7
    s_lshl_b32 s39, s31, 2
    v_mfma_f32_16x16x32_bf16 v[128:131], a[40:43], v[168:171], v[128:131]
    ds_read_b64_tr_b16 v[180:181], v11 offset:4096
    s_add_u32 s39, s39, s35
    s_lshl_b32 s39, s39, 2
    s_mul_i32 s39, s39, s32
    v_mfma_f32_16x16x32_bf16 v[128:131], a[44:47], v[172:175], v[128:131]
    ds_read_b64_tr_b16 v[182:183], v11 offset:4608
    s_add_u32 s40, s40, s39
    s_lshl_b32 s39, s35, 12
    s_add_u32 s39, s39, s57
    v_mfma_f32_16x16x32_bf16 v[132:135], a[96:99], v[160:163], v[132:135]
    ds_read_b64_tr_b16 v[184:185], v11 offset:8192
    s_mov_b32 m0, s39
    s_nop 0
    v_mfma_f32_16x16x32_bf16 v[132:135], a[100:103], v[164:167], v[132:135]
    ds_read_b64_tr_b16 v[186:187], v11 offset:8704
    buffer_load_dwordx4 v2, s[8:11], s40 offen lds
    v_mfma_f32_16x16x32_bf16 v[132:135], a[104:107], v[168:171], v[132:135]
    ds_read_b64_tr_b16 v[188:189], v11 offset:12288
    v_mfma_f32_16x16x32_bf16 v[132:135], a[108:111], v[172:175], v[132:135]
    ds_read_b64_tr_b16 v[190:191], v11 offset:12800
    s_waitcnt vmcnt(6)
    v_mfma_f32_16x16x32_bf16 v[136:139], a[160:163], v[160:163], v[136:139]
    ds_write_b128 v29, v[224:227] offset:0
    v_mfma_f32_16x16x32_bf16 v[136:139], a[164:167], v[164:167], v[136:139]
    ds_write_b128 v30, v[228:231] offset:1024
    v_mfma_f32_16x16x32_bf16 v[136:139], a[168:171], v[168:171], v[136:139]
    ds_write_b128 v29, v[232:235] offset:2048
    v_mfma_f32_16x16x32_bf16 v[136:139], a[172:175], v[172:175], v[136:139]
    ds_write_b128 v30, v[236:239] offset:3072
    v_mfma_f32_16x16x32_bf16 v[140:143], a[224:227], v[160:163], v[140:143]
    ds_write_b128 v29, v[240:243] offset:4096
    s_add_u32 m0, m0, 1024
    s_add_u32 s40, s40, s32
    v_mfma_f32_16x16x32_bf16 v[140:143], a[228:231], v[164:167], v[140:143]
    ds_write_b128 v30, v[244:247] offset:5120
    buffer_load_dwordx4 v3, s[8:11], s40 offen lds
    v_mfma_f32_16x16x32_bf16 v[140:143], a[232:235], v[168:171], v[140:143]
    ds_write_b128 v29, v[248:251] offset:6144
    v_mfma_f32_16x16x32_bf16 v[140:143], a[236:239], v[172:175], v[140:143]
    ds_write_b128 v30, v[252:255] offset:7168
    s_waitcnt vmcnt(36)
    s_barrier
    s_waitcnt lgkmcnt(0)
    v_mfma_f32_16x16x32_bf16 v[144:147], a[32:35], v[176:179], v[144:147]
    ds_read_b64_tr_b16 v[160:161], v12 offset:0
    v_mfma_f32_16x16x32_bf16 v[144:147], a[36:39], v[180:183], v[144:147]
    ds_read_b64_tr_b16 v[162:163], v12 offset:512
    v_mfma_f32_16x16x32_bf16 v[144:147], a[40:43], v[184:187], v[144:147]
    ds_read_b64_tr_b16 v[164:165], v12 offset:4096
    v_mfma_f32_16x16x32_bf16 v[144:147], a[44:47], v[188:191], v[144:147]
    ds_read_b64_tr_b16 v[166:167], v12 offset:4608
    v_mfma_f32_16x16x32_bf16 v[148:151], a[96:99], v[176:179], v[148:151]
    ds_read_b64_tr_b16 v[168:169], v12 offset:8192
    s_add_u32 m0, m0, 1024
    s_add_u32 s40, s40, s32
    v_mfma_f32_16x16x32_bf16 v[148:151], a[100:103], v[180:183], v[148:151]
    ds_read_b64_tr_b16 v[170:171], v12 offset:8704
    buffer_load_dwordx4 v2, s[8:11], s40 offen lds
    v_mfma_f32_16x16x32_bf16 v[148:151], a[104:107], v[184:187], v[148:151]
    ds_read_b64_tr_b16 v[172:173], v12 offset:12288
    v_mfma_f32_16x16x32_bf16 v[148:151], a[108:111], v[188:191], v[148:151]
    ds_read_b64_tr_b16 v[174:175], v12 offset:12800
    v_mfma_f32_16x16x32_bf16 v[152:155], a[160:163], v[176:179], v[152:155]
    ds_read_b128 a[56:59], v31 offset:0
    s_add_u32 s79, s29, 3
    s_cmp_lt_u32 s79, 64
    s_cselect_b32 s92, s24, s26
    v_mfma_f32_16x16x32_bf16 v[152:155], a[164:167], v[180:183], v[152:155]
    ds_read_b128 a[60:63], v23 offset:0
    s_cselect_b32 s93, s25, s27
    s_and_b32 s79, s79, 63
    s_lshl_b32 s79, s79, 7
    v_mfma_f32_16x16x32_bf16 v[152:155], a[168:171], v[184:187], v[152:155]
    ds_read_b128 a[120:123], v31 offset:2048
    buffer_load_dword v27, v22, s[92:95], s79 offen
    s_add_u32 s56, s56, 16384
    s_and_b32 s56, s56, 0x1ffff
    v_mfma_f32_16x16x32_bf16 v[152:155], a[172:175], v[188:191], v[152:155]
    ds_read_b128 a[124:127], v23 offset:2048
    v_mov_b32 v8, v12
    v_mov_b32 v9, v13
    v_mov_b32 v10, v14
    v_mfma_f32_16x16x32_bf16 v[156:159], a[224:227], v[176:179], v[156:159]
    ds_read_b128 a[184:187], v31 offset:4096
    s_add_u32 m0, m0, 1024
    s_add_u32 s40, s40, s32
    v_mov_b32 v11, v15
    v_mfma_f32_16x16x32_bf16 v[156:159], a[228:231], v[180:183], v[156:159]
    ds_read_b128 a[188:191], v23 offset:4096
    buffer_load_dwordx4 v3, s[8:11], s40 offen lds
    v_add_u32 v12, s56, v4
    v_add_u32 v13, s56, v5
    v_mfma_f32_16x16x32_bf16 v[156:159], a[232:235], v[184:187], v[156:159]
    ds_read_b128 a[248:251], v31 offset:6144
    s_add_u32 s57, s57, 16384
    s_and_b32 s57, s57, 0x1ffff
    s_add_u32 s31, s31, 1
    v_mfma_f32_16x16x32_bf16 v[156:159], a[236:239], v[188:191], v[156:159]
    ds_read_b128 a[252:255], v23 offset:6144
    s_lshr_b32 s39, s31, 2
    s_add_u32 s30, s30, s39
    s_and_b32 s31, s31, 3
    v_add_u32 v14, s56, v6
    v_add_u32 v15, s56, v7
    s_waitcnt lgkmcnt(0)
    v_mfma_f32_16x16x32_bf16 v[96:99], a[48:51], v[160:163], v[96:99]
    ds_read_b64_tr_b16 v[176:177], v9 offset:0
    s_cmp_lt_u32 s30, 64
    s_cselect_b32 s8, s24, s26
    s_cselect_b32 s9, s25, s27
    v_mfma_f32_16x16x32_bf16 v[96:99], a[52:55], v[164:167], v[96:99]
    ds_read_b64_tr_b16 v[178:179], v9 offset:512
    s_and_b32 s40, s30, 63
    s_lshl_b32 s40, s40, 7
    s_lshl_b32 s39, s31, 2
    v_mfma_f32_16x16x32_bf16 v[96:99], a[56:59], v[168:171], v[96:99]
    ds_read_b64_tr_b16 v[180:181], v9 offset:4096
    s_add_u32 s39, s39, s35
    s_lshl_b32 s39, s39, 2
    s_mul_i32 s39, s39, s32
    v_mfma_f32_16x16x32_bf16 v[96:99], a[60:63], v[172:175], v[96:99]
    ds_read_b64_tr_b16 v[182:183], v9 offset:4608
    s_add_u32 s40, s40, s39
    s_lshl_b32 s39, s35, 12
    s_add_u32 s39, s39, s57
    v_mfma_f32_16x16x32_bf16 v[100:103], a[112:115], v[160:163], v[100:103]
    ds_read_b64_tr_b16 v[184:185], v9 offset:8192
    s_mov_b32 m0, s39
    s_nop 0
    v_mfma_f32_16x16x32_bf16 v[100:103], a[116:119], v[164:167], v[100:103]
    ds_read_b64_tr_b16 v[186:187], v9 offset:8704
    buffer_load_dwordx4 v2, s[8:11], s40 offen lds
    v_mfma_f32_16x16x32_bf16 v[100:103], a[120:123], v[168:171], v[100:103]
    ds_read_b64_tr_b16 v[188:189], v9 offset:12288
    v_mfma_f32_16x16x32_bf16 v[100:103], a[124:127], v[172:175], v[100:103]
    ds_read_b64_tr_b16 v[190:191], v9 offset:12800
    v_mfma_f32_16x16x32_bf16 v[104:107], a[176:179], v[160:163], v[104:107]
    v_mfma_f32_16x16x32_bf16 v[104:107], a[180:183], v[164:167], v[104:107]
    v_mfma_f32_16x16x32_bf16 v[104:107], a[184:187], v[168:171], v[104:107]
    v_mfma_f32_16x16x32_bf16 v[104:107], a[188:191], v[172:175], v[104:107]
    v_mfma_f32_16x16x32_bf16 v[108:111], a[240:243], v[160:163], v[108:111]
    s_add_u32 m0, m0, 1024
    s_add_u32 s40, s40, s32
    v_mfma_f32_16x16x32_bf16 v[108:111], a[244:247], v[164:167], v[108:111]
    buffer_load_dwordx4 v3, s[8:11], s40 offen lds
    v_mfma_f32_16x16x32_bf16 v[108:111], a[248:251], v[168:171], v[108:111]
    v_mfma_f32_16x16x32_bf16 v[108:111], a[252:255], v[172:175], v[108:111]
    s_waitcnt lgkmcnt(0)
    v_mfma_f32_16x16x32_bf16 v[112:115], a[48:51], v[176:179], v[112:115]
    ds_read_b64_tr_b16 v[160:161], v10 offset:0
    v_mfma_f32_16x16x32_bf16 v[112:115], a[52:55], v[180:183], v[112:115]
    ds_read_b64_tr_b16 v[162:163], v10 offset:512
    v_mfma_f32_16x16x32_bf16 v[112:115], a[56:59], v[184:187], v[112:115]
    ds_read_b64_tr_b16 v[164:165], v10 offset:4096
    v_mfma_f32_16x16x32_bf16 v[112:115], a[60:63], v[188:191], v[112:115]
    ds_read_b64_tr_b16 v[166:167], v10 offset:4608
    v_cvt_pk_bf16_f32 v192, v96, v97
    v_mfma_f32_16x16x32_bf16 v[116:119], a[112:115], v[176:179], v[116:119]
    ds_read_b64_tr_b16 v[168:169], v10 offset:8192
    s_add_u32 m0, m0, 1024
    s_add_u32 s40, s40, s32
    v_cvt_pk_bf16_f32 v193, v98, v99
    v_mfma_f32_16x16x32_bf16 v[116:119], a[116:119], v[180:183], v[116:119]
    ds_read_b64_tr_b16 v[170:171], v10 offset:8704
    buffer_load_dwordx4 v2, s[8:11], s40 offen lds
    v_mfma_f32_16x16x32_bf16 v[116:119], a[120:123], v[184:187], v[116:119]
    ds_read_b64_tr_b16 v[172:173], v10 offset:12288
    v_cvt_pk_bf16_f32 v194, v100, v101
    v_mfma_f32_16x16x32_bf16 v[116:119], a[124:127], v[188:191], v[116:119]
    ds_read_b64_tr_b16 v[174:175], v10 offset:12800
    v_cvt_pk_bf16_f32 v195, v102, v103
    v_mfma_f32_16x16x32_bf16 v[120:123], a[176:179], v[176:179], v[120:123]
    v_mfma_f32_16x16x32_bf16 v[120:123], a[180:183], v[180:183], v[120:123]
    v_cvt_pk_bf16_f32 v196, v104, v105
    v_mfma_f32_16x16x32_bf16 v[120:123], a[184:187], v[184:187], v[120:123]
    v_mfma_f32_16x16x32_bf16 v[120:123], a[188:191], v[188:191], v[120:123]
    v_cvt_pk_bf16_f32 v197, v106, v107
    v_mfma_f32_16x16x32_bf16 v[124:127], a[240:243], v[176:179], v[124:127]
    s_add_u32 m0, m0, 1024
    s_add_u32 s40, s40, s32
    v_cvt_pk_bf16_f32 v198, v108, v109
    v_mfma_f32_16x16x32_bf16 v[124:127], a[244:247], v[180:183], v[124:127]
    buffer_load_dwordx4 v3, s[8:11], s40 offen lds
    v_mfma_f32_16x16x32_bf16 v[124:127], a[248:251], v[184:187], v[124:127]
    s_add_u32 s57, s57, 16384
    s_and_b32 s57, s57, 0x1ffff
    s_add_u32 s31, s31, 1
    s_lshr_b32 s39, s31, 2
    v_mfma_f32_16x16x32_bf16 v[124:127], a[252:255], v[188:191], v[124:127]
    s_add_u32 s30, s30, s39
    s_and_b32 s31, s31, 3
    v_cvt_pk_bf16_f32 v199, v110, v111
    s_waitcnt lgkmcnt(0)
    v_mfma_f32_16x16x32_bf16 v[128:131], a[48:51], v[160:163], v[128:131]
    ds_read_b64_tr_b16 v[176:177], v11 offset:0
    s_cmp_lt_u32 s30, 64
    s_cselect_b32 s8, s24, s26
    s_cselect_b32 s9, s25, s27
    v_mfma_f32_16x16x32_bf16 v[128:131], a[52:55], v[164:167], v[128:131]
    ds_read_b64_tr_b16 v[178:179], v11 offset:512
    s_and_b32 s40, s30, 63
    s_lshl_b32 s40, s40, 7
    s_lshl_b32 s39, s31, 2
    v_mfma_f32_16x16x32_bf16 v[128:131], a[56:59], v[168:171], v[128:131]
    ds_read_b64_tr_b16 v[180:181], v11 offset:4096
    s_add_u32 s39, s39, s35
    s_lshl_b32 s39, s39, 2
    s_mul_i32 s39, s39, s32
    v_mfma_f32_16x16x32_bf16 v[128:131], a[60:63], v[172:175], v[128:131]
    ds_read_b64_tr_b16 v[182:183], v11 offset:4608
    s_add_u32 s40, s40, s39
    s_lshl_b32 s39, s35, 12
    s_add_u32 s39, s39, s57
    v_mfma_f32_16x16x32_bf16 v[132:135], a[112:115], v[160:163], v[132:135]
    ds_read_b64_tr_b16 v[184:185], v11 offset:8192
    s_mov_b32 m0, s39
    s_nop 0
    v_cvt_pk_bf16_f32 v200, v112, v113
    v_mfma_f32_16x16x32_bf16 v[132:135], a[116:119], v[164:167], v[132:135]
    ds_read_b64_tr_b16 v[186:187], v11 offset:8704
    buffer_load_dwordx4 v2, s[8:11], s40 offen lds
    v_cvt_pk_bf16_f32 v201, v114, v115
    v_mfma_f32_16x16x32_bf16 v[132:135], a[120:123], v[168:171], v[132:135]
    ds_read_b64_tr_b16 v[188:189], v11 offset:12288
    v_cvt_pk_bf16_f32 v202, v116, v117
    v_mfma_f32_16x16x32_bf16 v[132:135], a[124:127], v[172:175], v[132:135]
    ds_read_b64_tr_b16 v[190:191], v11 offset:12800
    v_cvt_pk_bf16_f32 v203, v118, v119
    v_mfma_f32_16x16x32_bf16 v[136:139], a[176:179], v[160:163], v[136:139]
    v_mfma_f32_16x16x32_bf16 v[136:139], a[180:183], v[164:167], v[136:139]
    v_cvt_pk_bf16_f32 v204, v120, v121
    v_mfma_f32_16x16x32_bf16 v[136:139], a[184:187], v[168:171], v[136:139]
    v_mfma_f32_16x16x32_bf16 v[136:139], a[188:191], v[172:175], v[136:139]
    v_cvt_pk_bf16_f32 v205, v122, v123
    v_mfma_f32_16x16x32_bf16 v[140:143], a[240:243], v[160:163], v[140:143]
    s_add_u32 m0, m0, 1024
    s_add_u32 s40, s40, s32
    v_cvt_pk_bf16_f32 v206, v124, v125
    v_mfma_f32_16x16x32_bf16 v[140:143], a[244:247], v[164:167], v[140:143]
    buffer_load_dwordx4 v3, s[8:11], s40 offen lds
    v_mfma_f32_16x16x32_bf16 v[140:143], a[248:251], v[168:171], v[140:143]
    v_cvt_pk_bf16_f32 v207, v126, v127
    v_mfma_f32_16x16x32_bf16 v[140:143], a[252:255], v[172:175], v[140:143]
    s_waitcnt vmcnt(27)
    s_barrier
    s_waitcnt lgkmcnt(0)
    v_mfma_f32_16x16x32_bf16 v[144:147], a[48:51], v[176:179], v[144:147]
    ds_read_b64_tr_b16 v[160:161], v12 offset:0
    v_mfma_f32_16x16x32_bf16 v[144:147], a[52:55], v[180:183], v[144:147]
    ds_read_b64_tr_b16 v[162:163], v12 offset:512
    v_mfma_f32_16x16x32_bf16 v[144:147], a[56:59], v[184:187], v[144:147]
    ds_read_b64_tr_b16 v[164:165], v12 offset:4096
    v_mfma_f32_16x16x32_bf16 v[144:147], a[60:63], v[188:191], v[144:147]
    ds_read_b64_tr_b16 v[166:167], v12 offset:4608
    v_cvt_pk_bf16_f32 v208, v128, v129
    v_mfma_f32_16x16x32_bf16 v[148:151], a[112:115], v[176:179], v[148:151]
    ds_read_b64_tr_b16 v[168:169], v12 offset:8192
    s_add_u32 m0, m0, 1024
    s_add_u32 s40, s40, s32
    v_cvt_pk_bf16_f32 v209, v130, v131
    v_mfma_f32_16x16x32_bf16 v[148:151], a[116:119], v[180:183], v[148:151]
    ds_read_b64_tr_b16 v[170:171], v12 offset:8704
    buffer_load_dwordx4 v2, s[8:11], s40 offen lds
    v_mfma_f32_16x16x32_bf16 v[148:151], a[120:123], v[184:187], v[148:151]
    ds_read_b64_tr_b16 v[172:173], v12 offset:12288
    v_cvt_pk_bf16_f32 v210, v132, v133
    v_mfma_f32_16x16x32_bf16 v[148:151], a[124:127], v[188:191], v[148:151]
    ds_read_b64_tr_b16 v[174:175], v12 offset:12800
    v_cvt_pk_bf16_f32 v211, v134, v135
    v_mfma_f32_16x16x32_bf16 v[152:155], a[176:179], v[176:179], v[152:155]
    s_add_u32 s56, s56, 16384
    s_and_b32 s56, s56, 0x1ffff
    v_mov_b32 v8, v12
    v_mov_b32 v9, v13
    v_mfma_f32_16x16x32_bf16 v[152:155], a[180:183], v[180:183], v[152:155]
    v_cvt_pk_bf16_f32 v212, v136, v137
    v_mov_b32 v10, v14
    v_mov_b32 v11, v15
    v_add_u32 v12, s56, v4
    v_mfma_f32_16x16x32_bf16 v[152:155], a[184:187], v[184:187], v[152:155]
    v_add_u32 v13, s56, v5
    v_add_u32 v14, s56, v6
    v_add_u32 v15, s56, v7
    s_add_u32 s29, s29, 1
    v_mfma_f32_16x16x32_bf16 v[152:155], a[188:191], v[188:191], v[152:155]
    v_cvt_pk_bf16_f32 v213, v138, v139
    v_mfma_f32_16x16x32_bf16 v[156:159], a[240:243], v[176:179], v[156:159]
    s_add_u32 m0, m0, 1024
    s_add_u32 s40, s40, s32
    v_cvt_pk_bf16_f32 v214, v140, v141
    v_mfma_f32_16x16x32_bf16 v[156:159], a[244:247], v[180:183], v[156:159]
    buffer_load_dwordx4 v3, s[8:11], s40 offen lds
    v_mfma_f32_16x16x32_bf16 v[156:159], a[248:251], v[184:187], v[156:159]
    s_add_u32 s57, s57, 16384
    s_and_b32 s57, s57, 0x1ffff
    s_add_u32 s31, s31, 1
    s_lshr_b32 s39, s31, 2
    v_mfma_f32_16x16x32_bf16 v[156:159], a[252:255], v[188:191], v[156:159]
    s_add_u32 s30, s30, s39
    s_and_b32 s31, s31, 3
    v_cvt_pk_bf16_f32 v215, v142, v143
    s_cmp_lt_u32 s29, s44
    s_waitcnt vmcnt(13)
p1_kernel_kv_vseg:
    s_cmp_ge_u32 s29, s44
    s_cbranch_scc1 p1_kernel_segv_skip
p1_kernel_segv_loop:
    s_waitcnt vmcnt(16)
    s_barrier
    s_waitcnt lgkmcnt(0)
    v_mfma_f32_16x16x32_bf16 v[96:99], a[0:3], v[160:163], 0
    ds_read_b64_tr_b16 v[176:177], v9 offset:0
    s_mov_b32 s34, s33
    v_mfma_f32_16x16x32_bf16 v[96:99], a[4:7], v[164:167], v[96:99]
    ds_read_b64_tr_b16 v[178:179], v9 offset:512
    s_mov_b32 s59, s58
    v_mfma_f32_16x16x32_bf16 v[96:99], a[8:11], v[168:171], v[96:99]
    ds_read_b64_tr_b16 v[180:181], v9 offset:4096
    s_lshr_b32 s37, s29, 1
    v_mfma_f32_16x16x32_bf16 v[96:99], a[12:15], v[172:175], v[96:99]
    ds_read_b64_tr_b16 v[182:183], v9 offset:4608
    s_and_b32 s37, s37, 31
    v_mfma_f32_16x16x32_bf16 v[100:103], a[64:67], v[160:163], 0
    ds_read_b64_tr_b16 v[184:185], v9 offset:8192
    s_lshl_b32 s37, s37, 20
    v_mfma_f32_16x16x32_bf16 v[100:103], a[68:71], v[164:167], v[100:103]
    ds_read_b64_tr_b16 v[186:187], v9 offset:8704
    s_and_b32 s38, s29, 1
    v_mfma_f32_16x16x32_bf16 v[100:103], a[72:75], v[168:171], v[100:103]
    ds_read_b64_tr_b16 v[188:189], v9 offset:12288
    s_lshl_b32 s38, s38, 12
    v_mfma_f32_16x16x32_bf16 v[100:103], a[76:79], v[172:175], v[100:103]
    ds_read_b64_tr_b16 v[190:191], v9 offset:12800
    s_add_u32 s38, s38, 8192
    v_mfma_f32_16x16x32_bf16 v[104:107], a[128:131], v[160:163], 0
    s_add_u32 s37, s37, s38
    s_add_u32 s33, s37, s47
    v_mfma_f32_16x16x32_bf16 v[104:107], a[132:135], v[164:167], v[104:107]
    s_add_u32 s58, s33, 1024
    s_cmp_lt_u32 s30, 64
    v_mfma_f32_16x16x32_bf16 v[104:107], a[136:139], v[168:171], v[104:107]
    s_cselect_b32 s8, s24, s26
    s_cselect_b32 s9, s25, s27
    v_mfma_f32_16x16x32_bf16 v[104:107], a[140:143], v[172:175], v[104:107]
    s_and_b32 s40, s30, 63
    s_lshl_b32 s40, s40, 7
    v_mfma_f32_16x16x32_bf16 v[108:111], a[192:195], v[160:163], 0
    s_lshl_b32 s39, s31, 2
    s_add_u32 s39, s39, s35
    v_mfma_f32_16x16x32_bf16 v[108:111], a[196:199], v[164:167], v[108:111]
    s_lshl_b32 s39, s39, 2
    s_mul_i32 s39, s39, s32
    v_mfma_f32_16x16x32_bf16 v[108:111], a[200:203], v[168:171], v[108:111]
    s_add_u32 s40, s40, s39
    s_lshl_b32 s39, s35, 12
    v_mfma_f32_16x16x32_bf16 v[108:111], a[204:207], v[172:175], v[108:111]
    s_add_u32 s39, s39, s57
    v_cvt_pk_bf16_f32 v216, v144, v145
    s_waitcnt lgkmcnt(0)
    v_mfma_f32_16x16x32_bf16 v[112:115], a[0:3], v[176:179], 0
    ds_read_b64_tr_b16 v[160:161], v10 offset:0
    v_cvt_pk_bf16_f32 v217, v146, v147
    v_mfma_f32_16x16x32_bf16 v[112:115], a[4:7], v[180:183], v[112:115]
    ds_read_b64_tr_b16 v[162:163], v10 offset:512
    v_cvt_pk_bf16_f32 v218, v148, v149
    v_mfma_f32_16x16x32_bf16 v[112:115], a[8:11], v[184:187], v[112:115]
    ds_read_b64_tr_b16 v[164:165], v10 offset:4096
    v_mfma_f32_16x16x32_bf16 v[112:115], a[12:15], v[188:191], v[112:115]
    ds_read_b64_tr_b16 v[166:167], v10 offset:4608
    v_cvt_pk_bf16_f32 v219, v150, v151
    v_mfma_f32_16x16x32_bf16 v[116:119], a[64:67], v[176:179], 0
    ds_read_b64_tr_b16 v[168:169], v10 offset:8192
    v_mfma_f32_16x16x32_bf16 v[116:119], a[68:71], v[180:183], v[116:119]
    ds_read_b64_tr_b16 v[170:171], v10 offset:8704
    v_mfma_f32_16x16x32_bf16 v[116:119], a[72:75], v[184:187], v[116:119]
    ds_read_b64_tr_b16 v[172:173], v10 offset:12288
    v_mfma_f32_16x16x32_bf16 v[116:119], a[76:79], v[188:191], v[116:119]
    ds_read_b64_tr_b16 v[174:175], v10 offset:12800
    v_mfma_f32_16x16x32_bf16 v[120:123], a[128:131], v[176:179], 0
    s_mov_b32 m0, s39
    s_nop 0
    v_mfma_f32_16x16x32_bf16 v[120:123], a[132:135], v[180:183], v[120:123]
    buffer_load_dwordx4 v2, s[8:11], s40 offen lds
    buffer_store_dwordx4 v[192:195], v16, s[4:7], s34 offen offset:0 sc1
    v_mfma_f32_16x16x32_bf16 v[120:123], a[136:139], v[184:187], v[120:123]
    s_add_u32 m0, m0, 1024
    s_add_u32 s40, s40, s32
    v_mfma_f32_16x16x32_bf16 v[120:123], a[140:143], v[188:191], v[120:123]
    buffer_load_dwordx4 v3, s[8:11], s40 offen lds
    v_cvt_pk_bf16_f32 v220, v152, v153
    v_mfma_f32_16x16x32_bf16 v[124:127], a[192:195], v[176:179], 0
    v_mfma_f32_16x16x32_bf16 v[124:127], a[196:199], v[180:183], v[124:127]
    v_cvt_pk_bf16_f32 v221, v154, v155
    v_mfma_f32_16x16x32_bf16 v[124:127], a[200:203], v[184:187], v[124:127]
    v_mfma_f32_16x16x32_bf16 v[124:127], a[204:207], v[188:191], v[124:127]
    s_waitcnt lgkmcnt(0)
    v_mfma_f32_16x16x32_bf16 v[128:131], a[0:3], v[160:163], 0
    ds_read_b64_tr_b16 v[176:177], v11 offset:0
    v_mfma_f32_16x16x32_bf16 v[128:131], a[4:7], v[164:167], v[128:131]
    ds_read_b64_tr_b16 v[178:179], v11 offset:512
    v_mfma_f32_16x16x32_bf16 v[128:131], a[8:11], v[168:171], v[128:131]
    ds_read_b64_tr_b16 v[180:181], v11 offset:4096
    v_mfma_f32_16x16x32_bf16 v[128:131], a[12:15], v[172:175], v[128:131]
    ds_read_b64_tr_b16 v[182:183], v11 offset:4608
    v_cvt_pk_bf16_f32 v222, v156, v157
    v_mfma_f32_16x16x32_bf16 v[132:135], a[64:67], v[160:163], 0
    ds_read_b64_tr_b16 v[184:185], v11 offset:8192
    v_mfma_f32_16x16x32_bf16 v[132:135], a[68:71], v[164:167], v[132:135]
    ds_read_b64_tr_b16 v[186:187], v11 offset:8704
    v_mfma_f32_16x16x32_bf16 v[132:135], a[72:75], v[168:171], v[132:135]
    ds_read_b64_tr_b16 v[188:189], v11 offset:12288
    v_mfma_f32_16x16x32_bf16 v[132:135], a[76:79], v[172:175], v[132:135]
    ds_read_b64_tr_b16 v[190:191], v11 offset:12800
    v_mfma_f32_16x16x32_bf16 v[136:139], a[128:131], v[160:163], 0
    v_cvt_pk_bf16_f32 v223, v158, v159
    v_mfma_f32_16x16x32_bf16 v[136:139], a[132:135], v[164:167], v[136:139]
    buffer_store_dwordx4 v[196:199], v17, s[4:7], s34 offen offset:0 sc1
    v_mfma_f32_16x16x32_bf16 v[136:139], a[136:139], v[168:171], v[136:139]
    s_add_u32 m0, m0, 1024
    s_add_u32 s40, s40, s32
    v_mfma_f32_16x16x32_bf16 v[136:139], a[140:143], v[172:175], v[136:139]
    buffer_load_dwordx4 v2, s[8:11], s40 offen lds
    v_mfma_f32_16x16x32_bf16 v[140:143], a[192:195], v[160:163], 0
    v_mfma_f32_16x16x32_bf16 v[140:143], a[196:199], v[164:167], v[140:143]
    v_mfma_f32_16x16x32_bf16 v[140:143], a[200:203], v[168:171], v[140:143]
    v_mfma_f32_16x16x32_bf16 v[140:143], a[204:207], v[172:175], v[140:143]
    s_waitcnt lgkmcnt(0)
    v_mfma_f32_16x16x32_bf16 v[144:147], a[0:3], v[176:179], 0
    ds_read_b64_tr_b16 v[160:161], v12 offset:0
    v_mfma_f32_16x16x32_bf16 v[144:147], a[4:7], v[180:183], v[144:147]
    ds_read_b64_tr_b16 v[162:163], v12 offset:512
    v_mfma_f32_16x16x32_bf16 v[144:147], a[8:11], v[184:187], v[144:147]
    ds_read_b64_tr_b16 v[164:165], v12 offset:4096
    v_mfma_f32_16x16x32_bf16 v[144:147], a[12:15], v[188:191], v[144:147]
    ds_read_b64_tr_b16 v[166:167], v12 offset:4608
    v_mfma_f32_16x16x32_bf16 v[148:151], a[64:67], v[176:179], 0
    ds_read_b64_tr_b16 v[168:169], v12 offset:8192
    v_mfma_f32_16x16x32_bf16 v[148:151], a[68:71], v[180:183], v[148:151]
    ds_read_b64_tr_b16 v[170:171], v12 offset:8704
    v_mfma_f32_16x16x32_bf16 v[148:151], a[72:75], v[184:187], v[148:151]
    ds_read_b64_tr_b16 v[172:173], v12 offset:12288
    v_mfma_f32_16x16x32_bf16 v[148:151], a[76:79], v[188:191], v[148:151]
    ds_read_b64_tr_b16 v[174:175], v12 offset:12800
    v_mfma_f32_16x16x32_bf16 v[152:155], a[128:131], v[176:179], 0
    s_add_u32 s56, s56, 16384
    s_and_b32 s56, s56, 0x1ffff
    v_mfma_f32_16x16x32_bf16 v[152:155], a[132:135], v[180:183], v[152:155]
    v_mov_b32 v8, v12
    v_mov_b32 v9, v13
    v_mfma_f32_16x16x32_bf16 v[152:155], a[136:139], v[184:187], v[152:155]
    s_add_u32 m0, m0, 1024
    s_add_u32 s40, s40, s32
    v_mfma_f32_16x16x32_bf16 v[152:155], a[140:143], v[188:191], v[152:155]
    buffer_load_dwordx4 v3, s[8:11], s40 offen lds
    v_mov_b32 v10, v14
    v_mfma_f32_16x16x32_bf16 v[156:159], a[192:195], v[176:179], 0
    s_add_u32 s57, s57, 16384
    s_and_b32 s57, s57, 0x1ffff
    v_mfma_f32_16x16x32_bf16 v[156:159], a[196:199], v[180:183], v[156:159]
    s_add_u32 s31, s31, 1
    s_lshr_b32 s39, s31, 2
    v_mfma_f32_16x16x32_bf16 v[156:159], a[200:203], v[184:187], v[156:159]
    s_add_u32 s30, s30, s39
    s_and_b32 s31, s31, 3
    v_mfma_f32_16x16x32_bf16 v[156:159], a[204:207], v[188:191], v[156:159]
    v_mov_b32 v11, v15
    v_add_u32 v12, s56, v4
    v_add_u32 v13, s56, v5
    v_add_u32 v14, s56, v6
    v_add_u32 v15, s56, v7
    s_waitcnt lgkmcnt(0)
    v_mfma_f32_16x16x32_bf16 v[96:99], a[16:19], v[160:163], v[96:99]
    ds_read_b64_tr_b16 v[176:177], v9 offset:0
    s_cmp_lt_u32 s30, 64
    v_mfma_f32_16x16x32_bf16 v[96:99], a[20:23], v[164:167], v[96:99]
    ds_read_b64_tr_b16 v[178:179], v9 offset:512
    s_cselect_b32 s8, s24, s26
    v_mfma_f32_16x16x32_bf16 v[96:99], a[24:27], v[168:171], v[96:99]
    ds_read_b64_tr_b16 v[180:181], v9 offset:4096
    s_cselect_b32 s9, s25, s27
    v_mfma_f32_16x16x32_bf16 v[96:99], a[28:31], v[172:175], v[96:99]
    ds_read_b64_tr_b16 v[182:183], v9 offset:4608
    s_and_b32 s40, s30, 63
    v_mfma_f32_16x16x32_bf16 v[100:103], a[80:83], v[160:163], v[100:103]
    ds_read_b64_tr_b16 v[184:185], v9 offset:8192
    s_lshl_b32 s40, s40, 7
    v_mfma_f32_16x16x32_bf16 v[100:103], a[84:87], v[164:167], v[100:103]
    ds_read_b64_tr_b16 v[186:187], v9 offset:8704
    s_lshl_b32 s39, s31, 2
    v_mfma_f32_16x16x32_bf16 v[100:103], a[88:91], v[168:171], v[100:103]
    ds_read_b64_tr_b16 v[188:189], v9 offset:12288
    s_add_u32 s39, s39, s35
    v_mfma_f32_16x16x32_bf16 v[100:103], a[92:95], v[172:175], v[100:103]
    ds_read_b64_tr_b16 v[190:191], v9 offset:12800
    s_lshl_b32 s39, s39, 2
    v_mfma_f32_16x16x32_bf16 v[104:107], a[144:147], v[160:163], v[104:107]
    s_mul_i32 s39, s39, s32
    s_add_u32 s40, s40, s39
    v_mfma_f32_16x16x32_bf16 v[104:107], a[148:151], v[164:167], v[104:107]
    s_lshl_b32 s39, s35, 12
    s_add_u32 s39, s39, s57
    v_mfma_f32_16x16x32_bf16 v[104:107], a[152:155], v[168:171], v[104:107]
    s_mov_b32 m0, s39
    s_nop 0
    v_mfma_f32_16x16x32_bf16 v[104:107], a[156:159], v[172:175], v[104:107]
    buffer_load_dwordx4 v2, s[8:11], s40 offen lds
    buffer_store_dwordx4 v[200:203], v16, s[4:7], s34 offen offset:1024 sc1
    v_mfma_f32_16x16x32_bf16 v[108:111], a[208:211], v[160:163], v[108:111]
    v_mfma_f32_16x16x32_bf16 v[108:111], a[212:215], v[164:167], v[108:111]
    v_mfma_f32_16x16x32_bf16 v[108:111], a[216:219], v[168:171], v[108:111]
    v_mfma_f32_16x16x32_bf16 v[108:111], a[220:223], v[172:175], v[108:111]
    s_waitcnt lgkmcnt(0)
    v_mfma_f32_16x16x32_bf16 v[112:115], a[16:19], v[176:179], v[112:115]
    ds_read_b64_tr_b16 v[160:161], v10 offset:0
    v_mfma_f32_16x16x32_bf16 v[112:115], a[20:23], v[180:183], v[112:115]
    ds_read_b64_tr_b16 v[162:163], v10 offset:512
    v_mfma_f32_16x16x32_bf16 v[112:115], a[24:27], v[184:187], v[112:115]
    ds_read_b64_tr_b16 v[164:165], v10 offset:4096
    v_mfma_f32_16x16x32_bf16 v[112:115], a[28:31], v[188:191], v[112:115]
    ds_read_b64_tr_b16 v[166:167], v10 offset:4608
    v_mfma_f32_16x16x32_bf16 v[116:119], a[80:83], v[176:179], v[116:119]
    ds_read_b64_tr_b16 v[168:169], v10 offset:8192
    v_mfma_f32_16x16x32_bf16 v[116:119], a[84:87], v[180:183], v[116:119]
    ds_read_b64_tr_b16 v[170:171], v10 offset:8704
    v_mfma_f32_16x16x32_bf16 v[116:119], a[88:91], v[184:187], v[116:119]
    ds_read_b64_tr_b16 v[172:173], v10 offset:12288
    v_mfma_f32_16x16x32_bf16 v[116:119], a[92:95], v[188:191], v[116:119]
    ds_read_b64_tr_b16 v[174:175], v10 offset:12800
    buffer_store_dwordx4 v[204:207], v17, s[4:7], s34 offen offset:1024 sc1
    v_mfma_f32_16x16x32_bf16 v[120:123], a[144:147], v[176:179], v[120:123]
    v_mfma_f32_16x16x32_bf16 v[120:123], a[148:151], v[180:183], v[120:123]
    v_mfma_f32_16x16x32_bf16 v[120:123], a[152:155], v[184:187], v[120:123]
    s_add_u32 m0, m0, 1024
    s_add_u32 s40, s40, s32
    v_mfma_f32_16x16x32_bf16 v[120:123], a[156:159], v[188:191], v[120:123]
    buffer_load_dwordx4 v3, s[8:11], s40 offen lds
    v_mfma_f32_16x16x32_bf16 v[124:127], a[208:211], v[176:179], v[124:127]
    v_mfma_f32_16x16x32_bf16 v[124:127], a[212:215], v[180:183], v[124:127]
    v_mfma_f32_16x16x32_bf16 v[124:127], a[216:219], v[184:187], v[124:127]
    v_mfma_f32_16x16x32_bf16 v[124:127], a[220:223], v[188:191], v[124:127]
    s_waitcnt lgkmcnt(0)
    v_mfma_f32_16x16x32_bf16 v[128:131], a[16:19], v[160:163], v[128:131]
    ds_read_b64_tr_b16 v[176:177], v11 offset:0
    v_mfma_f32_16x16x32_bf16 v[128:131], a[20:23], v[164:167], v[128:131]
    ds_read_b64_tr_b16 v[178:179], v11 offset:512
    v_mfma_f32_16x16x32_bf16 v[128:131], a[24:27], v[168:171], v[128:131]
    ds_read_b64_tr_b16 v[180:181], v11 offset:4096
    v_mfma_f32_16x16x32_bf16 v[128:131], a[28:31], v[172:175], v[128:131]
    ds_read_b64_tr_b16 v[182:183], v11 offset:4608
    v_mfma_f32_16x16x32_bf16 v[132:135], a[80:83], v[160:163], v[132:135]
    ds_read_b64_tr_b16 v[184:185], v11 offset:8192
    v_mfma_f32_16x16x32_bf16 v[132:135], a[84:87], v[164:167], v[132:135]
    ds_read_b64_tr_b16 v[186:187], v11 offset:8704
    v_mfma_f32_16x16x32_bf16 v[132:135], a[88:91], v[168:171], v[132:135]
    ds_read_b64_tr_b16 v[188:189], v11 offset:12288
    v_mfma_f32_16x16x32_bf16 v[132:135], a[92:95], v[172:175], v[132:135]
    ds_read_b64_tr_b16 v[190:191], v11 offset:12800
    v_mfma_f32_16x16x32_bf16 v[136:139], a[144:147], v[160:163], v[136:139]
    buffer_store_dwordx4 v[208:211], v16, s[4:7], s34 offen offset:2048 sc1
    v_mfma_f32_16x16x32_bf16 v[136:139], a[148:151], v[164:167], v[136:139]
    v_mfma_f32_16x16x32_bf16 v[136:139], a[152:155], v[168:171], v[136:139]
    s_add_u32 m0, m0, 1024
    s_add_u32 s40, s40, s32
    v_mfma_f32_16x16x32_bf16 v[136:139], a[156:159], v[172:175], v[136:139]
    buffer_load_dwordx4 v2, s[8:11], s40 offen lds
    v_mfma_f32_16x16x32_bf16 v[140:143], a[208:211], v[160:163], v[140:143]
    v_mfma_f32_16x16x32_bf16 v[140:143], a[212:215], v[164:167], v[140:143]
    v_mfma_f32_16x16x32_bf16 v[140:143], a[216:219], v[168:171], v[140:143]
    v_mfma_f32_16x16x32_bf16 v[140:143], a[220:223], v[172:175], v[140:143]
    s_waitcnt lgkmcnt(0)
    v_mfma_f32_16x16x32_bf16 v[144:147], a[16:19], v[176:179], v[144:147]
    ds_read_b64_tr_b16 v[160:161], v12 offset:0
    v_mfma_f32_16x16x32_bf16 v[144:147], a[20:23], v[180:183], v[144:147]
    ds_read_b64_tr_b16 v[162:163], v12 offset:512
    v_mfma_f32_16x16x32_bf16 v[144:147], a[24:27], v[184:187], v[144:147]
    ds_read_b64_tr_b16 v[164:165], v12 offset:4096
    v_mfma_f32_16x16x32_bf16 v[144:147], a[28:31], v[188:191], v[144:147]
    ds_read_b64_tr_b16 v[166:167], v12 offset:4608
    v_mfma_f32_16x16x32_bf16 v[148:151], a[80:83], v[176:179], v[148:151]
    ds_read_b64_tr_b16 v[168:169], v12 offset:8192
    v_mfma_f32_16x16x32_bf16 v[148:151], a[84:87], v[180:183], v[148:151]
    ds_read_b64_tr_b16 v[170:171], v12 offset:8704
    v_mfma_f32_16x16x32_bf16 v[148:151], a[88:91], v[184:187], v[148:151]
    ds_read_b64_tr_b16 v[172:173], v12 offset:12288
    v_mfma_f32_16x16x32_bf16 v[148:151], a[92:95], v[188:191], v[148:151]
    ds_read_b64_tr_b16 v[174:175], v12 offset:12800
    v_mfma_f32_16x16x32_bf16 v[152:155], a[144:147], v[176:179], v[152:155]
    s_add_u32 s56, s56, 16384
    s_and_b32 s56, s56, 0x1ffff
    v_mfma_f32_16x16x32_bf16 v[152:155], a[148:151], v[180:183], v[152:155]
    v_mov_b32 v8, v12
    v_mov_b32 v9, v13
    v_mfma_f32_16x16x32_bf16 v[152:155], a[152:155], v[184:187], v[152:155]
    s_add_u32 m0, m0, 1024
    s_add_u32 s40, s40, s32
    v_mfma_f32_16x16x32_bf16 v[152:155], a[156:159], v[188:191], v[152:155]
    buffer_load_dwordx4 v3, s[8:11], s40 offen lds
    v_mov_b32 v10, v14
    v_mfma_f32_16x16x32_bf16 v[156:159], a[208:211], v[176:179], v[156:159]
    s_add_u32 s57, s57, 16384
    s_and_b32 s57, s57, 0x1ffff
    v_mfma_f32_16x16x32_bf16 v[156:159], a[212:215], v[180:183], v[156:159]
    s_add_u32 s31, s31, 1
    s_lshr_b32 s39, s31, 2
    v_mfma_f32_16x16x32_bf16 v[156:159], a[216:219], v[184:187], v[156:159]
    s_add_u32 s30, s30, s39
    s_and_b32 s31, s31, 3
    v_mfma_f32_16x16x32_bf16 v[156:159], a[220:223], v[188:191], v[156:159]
    v_mov_b32 v11, v15
    v_add_u32 v12, s56, v4
    v_add_u32 v13, s56, v5
    v_add_u32 v14, s56, v6
    v_add_u32 v15, s56, v7
    s_waitcnt vmcnt(15)
    s_barrier
    s_waitcnt lgkmcnt(0)
    v_mfma_f32_16x16x32_bf16 v[96:99], a[32:35], v[160:163], v[96:99]
    ds_read_b64_tr_b16 v[176:177], v9 offset:0
    s_cmp_lt_u32 s30, 64
    v_mfma_f32_16x16x32_bf16 v[96:99], a[36:39], v[164:167], v[96:99]
    ds_read_b64_tr_b16 v[178:179], v9 offset:512
    s_cselect_b32 s8, s24, s26
    v_mfma_f32_16x16x32_bf16 v[96:99], a[40:43], v[168:171], v[96:99]
    ds_read_b64_tr_b16 v[180:181], v9 offset:4096
    s_cselect_b32 s9, s25, s27
    v_mfma_f32_16x16x32_bf16 v[96:99], a[44:47], v[172:175], v[96:99]
    ds_read_b64_tr_b16 v[182:183], v9 offset:4608
    s_and_b32 s40, s30, 63
    v_mfma_f32_16x16x32_bf16 v[100:103], a[96:99], v[160:163], v[100:103]
    ds_read_b64_tr_b16 v[184:185], v9 offset:8192
    s_lshl_b32 s40, s40, 7
    v_mfma_f32_16x16x32_bf16 v[100:103], a[100:103], v[164:167], v[100:103]
    ds_read_b64_tr_b16 v[186:187], v9 offset:8704
    s_lshl_b32 s39, s31, 2
    v_mfma_f32_16x16x32_bf16 v[100:103], a[104:107], v[168:171], v[100:103]
    ds_read_b64_tr_b16 v[188:189], v9 offset:12288
    s_add_u32 s39, s39, s35
    v_mfma_f32_16x16x32_bf16 v[100:103], a[108:111], v[172:175], v[100:103]
    ds_read_b64_tr_b16 v[190:191], v9 offset:12800
    s_lshl_b32 s39, s39, 2
    v_mfma_f32_16x16x32_bf16 v[104:107], a[160:163], v[160:163], v[104:107]
    s_mul_i32 s39, s39, s32
    s_add_u32 s40, s40, s39
    v_mfma_f32_16x16x32_bf16 v[104:107], a[164:167], v[164:167], v[104:107]
    s_lshl_b32 s39, s35, 12
    s_add_u32 s39, s39, s57
    v_mfma_f32_16x16x32_bf16 v[104:107], a[168:171], v[168:171], v[104:107]
    s_mov_b32 m0, s39
    s_nop 0
    v_mfma_f32_16x16x32_bf16 v[104:107], a[172:175], v[172:175], v[104:107]
    buffer_load_dwordx4 v2, s[8:11], s40 offen lds
    buffer_store_dwordx4 v[212:215], v17, s[4:7], s34 offen offset:2048 sc1
    v_mfma_f32_16x16x32_bf16 v[108:111], a[224:227], v[160:163], v[108:111]
    v_mfma_f32_16x16x32_bf16 v[108:111], a[228:231], v[164:167], v[108:111]
    v_mfma_f32_16x16x32_bf16 v[108:111], a[232:235], v[168:171], v[108:111]
    v_mfma_f32_16x16x32_bf16 v[108:111], a[236:239], v[172:175], v[108:111]
    s_waitcnt lgkmcnt(0)
    v_mfma_f32_16x16x32_bf16 v[112:115], a[32:35], v[176:179], v[112:115]
    ds_read_b64_tr_b16 v[160:161], v10 offset:0
    v_mfma_f32_16x16x32_bf16 v[112:115], a[36:39], v[180:183], v[112:115]
    ds_read_b64_tr_b16 v[162:163], v10 offset:512
    v_mfma_f32_16x16x32_bf16 v[112:115], a[40:43], v[184:187], v[112:115]
    ds_read_b64_tr_b16 v[164:165], v10 offset:4096
    v_mfma_f32_16x16x32_bf16 v[112:115], a[44:47], v[188:191], v[112:115]
    ds_read_b64_tr_b16 v[166:167], v10 offset:4608
    v_mfma_f32_16x16x32_bf16 v[116:119], a[96:99], v[176:179], v[116:119]
    ds_read_b64_tr_b16 v[168:169], v10 offset:8192
    v_mfma_f32_16x16x32_bf16 v[116:119], a[100:103], v[180:183], v[116:119]
    ds_read_b64_tr_b16 v[170:171], v10 offset:8704
    v_mfma_f32_16x16x32_bf16 v[116:119], a[104:107], v[184:187], v[116:119]
    ds_read_b64_tr_b16 v[172:173], v10 offset:12288
    v_mfma_f32_16x16x32_bf16 v[116:119], a[108:111], v[188:191], v[116:119]
    ds_read_b64_tr_b16 v[174:175], v10 offset:12800
    buffer_store_dwordx4 v[216:219], v16, s[4:7], s34 offen offset:3072 sc1
    v_mfma_f32_16x16x32_bf16 v[120:123], a[160:163], v[176:179], v[120:123]
    v_mfma_f32_16x16x32_bf16 v[120:123], a[164:167], v[180:183], v[120:123]
    v_mfma_f32_16x16x32_bf16 v[120:123], a[168:171], v[184:187], v[120:123]
    s_add_u32 m0, m0, 1024
    s_add_u32 s40, s40, s32
    v_mfma_f32_16x16x32_bf16 v[120:123], a[172:175], v[188:191], v[120:123]
    buffer_load_dwordx4 v3, s[8:11], s40 offen lds
    v_mfma_f32_16x16x32_bf16 v[124:127], a[224:227], v[176:179], v[124:127]
    v_mfma_f32_16x16x32_bf16 v[124:127], a[228:231], v[180:183], v[124:127]
    v_mfma_f32_16x16x32_bf16 v[124:127], a[232:235], v[184:187], v[124:127]
    v_mfma_f32_16x16x32_bf16 v[124:127], a[236:239], v[188:191], v[124:127]
    s_waitcnt lgkmcnt(0)
    v_mfma_f32_16x16x32_bf16 v[128:131], a[32:35], v[160:163], v[128:131]
    ds_read_b64_tr_b16 v[176:177], v11 offset:0
    v_mfma_f32_16x16x32_bf16 v[128:131], a[36:39], v[164:167], v[128:131]
    ds_read_b64_tr_b16 v[178:179], v11 offset:512
    v_mfma_f32_16x16x32_bf16 v[128:131], a[40:43], v[168:171], v[128:131]
    ds_read_b64_tr_b16 v[180:181], v11 offset:4096
    v_mfma_f32_16x16x32_bf16 v[128:131], a[44:47], v[172:175], v[128:131]
    ds_read_b64_tr_b16 v[182:183], v11 offset:4608
    v_mfma_f32_16x16x32_bf16 v[132:135], a[96:99], v[160:163], v[132:135]
    ds_read_b64_tr_b16 v[184:185], v11 offset:8192
    v_mfma_f32_16x16x32_bf16 v[132:135], a[100:103], v[164:167], v[132:135]
    ds_read_b64_tr_b16 v[186:187], v11 offset:8704
    v_mfma_f32_16x16x32_bf16 v[132:135], a[104:107], v[168:171], v[132:135]
    ds_read_b64_tr_b16 v[188:189], v11 offset:12288
    v_mfma_f32_16x16x32_bf16 v[132:135], a[108:111], v[172:175], v[132:135]
    ds_read_b64_tr_b16 v[190:191], v11 offset:12800
    v_mfma_f32_16x16x32_bf16 v[136:139], a[160:163], v[160:163], v[136:139]
    buffer_store_dwordx4 v[220:223], v17, s[4:7], s34 offen offset:3072 sc1
    v_mfma_f32_16x16x32_bf16 v[136:139], a[164:167], v[164:167], v[136:139]
    v_mfma_f32_16x16x32_bf16 v[136:139], a[168:171], v[168:171], v[136:139]
    s_add_u32 m0, m0, 1024
    s_add_u32 s40, s40, s32
    v_mfma_f32_16x16x32_bf16 v[136:139], a[172:175], v[172:175], v[136:139]
    buffer_load_dwordx4 v2, s[8:11], s40 offen lds
    v_mfma_f32_16x16x32_bf16 v[140:143], a[224:227], v[160:163], v[140:143]
    v_mfma_f32_16x16x32_bf16 v[140:143], a[228:231], v[164:167], v[140:143]
    v_mfma_f32_16x16x32_bf16 v[140:143], a[232:235], v[168:171], v[140:143]
    v_mfma_f32_16x16x32_bf16 v[140:143], a[236:239], v[172:175], v[140:143]
    s_waitcnt lgkmcnt(0)
    v_mfma_f32_16x16x32_bf16 v[144:147], a[32:35], v[176:179], v[144:147]
    ds_read_b64_tr_b16 v[160:161], v12 offset:0
    v_mfma_f32_16x16x32_bf16 v[144:147], a[36:39], v[180:183], v[144:147]
    ds_read_b64_tr_b16 v[162:163], v12 offset:512
    v_mfma_f32_16x16x32_bf16 v[144:147], a[40:43], v[184:187], v[144:147]
    ds_read_b64_tr_b16 v[164:165], v12 offset:4096
    v_mfma_f32_16x16x32_bf16 v[144:147], a[44:47], v[188:191], v[144:147]
    ds_read_b64_tr_b16 v[166:167], v12 offset:4608
    v_mfma_f32_16x16x32_bf16 v[148:151], a[96:99], v[176:179], v[148:151]
    ds_read_b64_tr_b16 v[168:169], v12 offset:8192
    v_mfma_f32_16x16x32_bf16 v[148:151], a[100:103], v[180:183], v[148:151]
    ds_read_b64_tr_b16 v[170:171], v12 offset:8704
    v_mfma_f32_16x16x32_bf16 v[148:151], a[104:107], v[184:187], v[148:151]
    ds_read_b64_tr_b16 v[172:173], v12 offset:12288
    v_mfma_f32_16x16x32_bf16 v[148:151], a[108:111], v[188:191], v[148:151]
    ds_read_b64_tr_b16 v[174:175], v12 offset:12800
    v_mfma_f32_16x16x32_bf16 v[152:155], a[160:163], v[176:179], v[152:155]
    s_add_u32 s79, s29, 3
    s_cmp_lt_u32 s79, 64
    v_mfma_f32_16x16x32_bf16 v[152:155], a[164:167], v[180:183], v[152:155]
    s_cselect_b32 s92, s24, s26
    s_cselect_b32 s93, s25, s27
    v_mfma_f32_16x16x32_bf16 v[152:155], a[168:171], v[184:187], v[152:155]
    s_add_u32 m0, m0, 1024
    s_add_u32 s40, s40, s32
    v_mfma_f32_16x16x32_bf16 v[152:155], a[172:175], v[188:191], v[152:155]
    buffer_load_dwordx4 v3, s[8:11], s40 offen lds
    s_and_b32 s79, s79, 63
    v_mfma_f32_16x16x32_bf16 v[156:159], a[224:227], v[176:179], v[156:159]
    s_add_u32 s57, s57, 16384
    s_and_b32 s57, s57, 0x1ffff
    v_mfma_f32_16x16x32_bf16 v[156:159], a[228:231], v[180:183], v[156:159]
    s_add_u32 s31, s31, 1
    s_lshr_b32 s39, s31, 2
    v_mfma_f32_16x16x32_bf16 v[156:159], a[232:235], v[184:187], v[156:159]
    s_add_u32 s30, s30, s39
    s_and_b32 s31, s31, 3
    v_mfma_f32_16x16x32_bf16 v[156:159], a[236:239], v[188:191], v[156:159]
    s_lshl_b32 s79, s79, 7
    buffer_load_dword v27, v22, s[92:95], s79 offen
    s_add_u32 s56, s56, 16384
    s_and_b32 s56, s56, 0x1ffff
    v_mov_b32 v8, v12
    v_mov_b32 v9, v13
    v_mov_b32 v10, v14
    v_mov_b32 v11, v15
    v_add_u32 v12, s56, v4
    v_add_u32 v13, s56, v5
    v_add_u32 v14, s56, v6
    v_add_u32 v15, s56, v7
    s_waitcnt lgkmcnt(0)
    v_mfma_f32_16x16x32_bf16 v[96:99], a[48:51], v[160:163], v[96:99]
    ds_read_b64_tr_b16 v[176:177], v9 offset:0
    s_cmp_lt_u32 s30, 64
    v_mfma_f32_16x16x32_bf16 v[96:99], a[52:55], v[164:167], v[96:99]
    ds_read_b64_tr_b16 v[178:179], v9 offset:512
    s_cselect_b32 s8, s24, s26
    v_mfma_f32_16x16x32_bf16 v[96:99], a[56:59], v[168:171], v[96:99]
    ds_read_b64_tr_b16 v[180:181], v9 offset:4096
    s_cselect_b32 s9, s25, s27
    v_mfma_f32_16x16x32_bf16 v[96:99], a[60:63], v[172:175], v[96:99]
    ds_read_b64_tr_b16 v[182:183], v9 offset:4608
    s_and_b32 s40, s30, 63
    v_mfma_f32_16x16x32_bf16 v[100:103], a[112:115], v[160:163], v[100:103]
    ds_read_b64_tr_b16 v[184:185], v9 offset:8192
    s_lshl_b32 s40, s40, 7
    v_mfma_f32_16x16x32_bf16 v[100:103], a[116:119], v[164:167], v[100:103]
    ds_read_b64_tr_b16 v[186:187], v9 offset:8704
    s_lshl_b32 s39, s31, 2
    v_mfma_f32_16x16x32_bf16 v[100:103], a[120:123], v[168:171], v[100:103]
    ds_read_b64_tr_b16 v[188:189], v9 offset:12288
    s_add_u32 s39, s39, s35
    v_mfma_f32_16x16x32_bf16 v[100:103], a[124:127], v[172:175], v[100:103]
    ds_read_b64_tr_b16 v[190:191], v9 offset:12800
    s_lshl_b32 s39, s39, 2
    v_mfma_f32_16x16x32_bf16 v[104:107], a[176:179], v[160:163], v[104:107]
    s_mul_i32 s39, s39, s32
    s_add_u32 s40, s40, s39
    v_mfma_f32_16x16x32_bf16 v[104:107], a[180:183], v[164:167], v[104:107]
    s_lshl_b32 s39, s35, 12
    s_add_u32 s39, s39, s57
    v_mfma_f32_16x16x32_bf16 v[104:107], a[184:187], v[168:171], v[104:107]
    s_mov_b32 m0, s39
    s_nop 0
    v_mfma_f32_16x16x32_bf16 v[104:107], a[188:191], v[172:175], v[104:107]
    buffer_load_dwordx4 v2, s[8:11], s40 offen lds
    v_mfma_f32_16x16x32_bf16 v[108:111], a[240:243], v[160:163], v[108:111]
    v_mfma_f32_16x16x32_bf16 v[108:111], a[244:247], v[164:167], v[108:111]
    v_mfma_f32_16x16x32_bf16 v[108:111], a[248:251], v[168:171], v[108:111]
    v_mfma_f32_16x16x32_bf16 v[108:111], a[252:255], v[172:175], v[108:111]
    s_waitcnt lgkmcnt(0)
    v_mfma_f32_16x16x32_bf16 v[112:115], a[48:51], v[176:179], v[112:115]
    ds_read_b64_tr_b16 v[160:161], v10 offset:0
    v_mfma_f32_16x16x32_bf16 v[112:115], a[52:55], v[180:183], v[112:115]
    ds_read_b64_tr_b16 v[162:163], v10 offset:512
    v_mfma_f32_16x16x32_bf16 v[112:115], a[56:59], v[184:187], v[112:115]
    ds_read_b64_tr_b16 v[164:165], v10 offset:4096
    v_mfma_f32_16x16x32_bf16 v[112:115], a[60:63], v[188:191], v[112:115]
    ds_read_b64_tr_b16 v[166:167], v10 offset:4608
    v_cvt_pk_bf16_f32 v192, v96, v97
    v_mfma_f32_16x16x32_bf16 v[116:119], a[112:115], v[176:179], v[116:119]
    ds_read_b64_tr_b16 v[168:169], v10 offset:8192
    v_cvt_pk_bf16_f32 v193, v98, v99
    v_mfma_f32_16x16x32_bf16 v[116:119], a[116:119], v[180:183], v[116:119]
    ds_read_b64_tr_b16 v[170:171], v10 offset:8704
    v_mfma_f32_16x16x32_bf16 v[116:119], a[120:123], v[184:187], v[116:119]
    ds_read_b64_tr_b16 v[172:173], v10 offset:12288
    v_cvt_pk_bf16_f32 v194, v100, v101
    v_mfma_f32_16x16x32_bf16 v[116:119], a[124:127], v[188:191], v[116:119]
    ds_read_b64_tr_b16 v[174:175], v10 offset:12800
    v_cvt_pk_bf16_f32 v195, v102, v103
    v_mfma_f32_16x16x32_bf16 v[120:123], a[176:179], v[176:179], v[120:123]
    v_mfma_f32_16x16x32_bf16 v[120:123], a[180:183], v[180:183], v[120:123]
    v_cvt_pk_bf16_f32 v196, v104, v105
    v_mfma_f32_16x16x32_bf16 v[120:123], a[184:187], v[184:187], v[120:123]
    s_add_u32 m0, m0, 1024
    s_add_u32 s40, s40, s32
    v_mfma_f32_16x16x32_bf16 v[120:123], a[188:191], v[188:191], v[120:123]
    buffer_load_dwordx4 v3, s[8:11], s40 offen lds
    v_cvt_pk_bf16_f32 v197, v106, v107
    v_mfma_f32_16x16x32_bf16 v[124:127], a[240:243], v[176:179], v[124:127]
    v_cvt_pk_bf16_f32 v198, v108, v109
    v_mfma_f32_16x16x32_bf16 v[124:127], a[244:247], v[180:183], v[124:127]
    v_mfma_f32_16x16x32_bf16 v[124:127], a[248:251], v[184:187], v[124:127]
    v_cvt_pk_bf16_f32 v199, v110, v111
    v_mfma_f32_16x16x32_bf16 v[124:127], a[252:255], v[188:191], v[124:127]
    s_waitcnt lgkmcnt(0)
    v_mfma_f32_16x16x32_bf16 v[128:131], a[48:51], v[160:163], v[128:131]
    ds_read_b64_tr_b16 v[176:177], v11 offset:0
    v_mfma_f32_16x16x32_bf16 v[128:131], a[52:55], v[164:167], v[128:131]
    ds_read_b64_tr_b16 v[178:179], v11 offset:512
    v_mfma_f32_16x16x32_bf16 v[128:131], a[56:59], v[168:171], v[128:131]
    ds_read_b64_tr_b16 v[180:181], v11 offset:4096
    v_mfma_f32_16x16x32_bf16 v[128:131], a[60:63], v[172:175], v[128:131]
    ds_read_b64_tr_b16 v[182:183], v11 offset:4608
    v_cvt_pk_bf16_f32 v200, v112, v113
    v_mfma_f32_16x16x32_bf16 v[132:135], a[112:115], v[160:163], v[132:135]
    ds_read_b64_tr_b16 v[184:185], v11 offset:8192
    v_cvt_pk_bf16_f32 v201, v114, v115
    v_mfma_f32_16x16x32_bf16 v[132:135], a[116:119], v[164:167], v[132:135]
    ds_read_b64_tr_b16 v[186:187], v11 offset:8704
    v_mfma_f32_16x16x32_bf16 v[132:135], a[120:123], v[168:171], v[132:135]
    ds_read_b64_tr_b16 v[188:189], v11 offset:12288
    v_cvt_pk_bf16_f32 v202, v116, v117
    v_mfma_f32_16x16x32_bf16 v[132:135], a[124:127], v[172:175], v[132:135]
    ds_read_b64_tr_b16 v[190:191], v11 offset:12800
    v_cvt_pk_bf16_f32 v203, v118, v119
    v_mfma_f32_16x16x32_bf16 v[136:139], a[176:179], v[160:163], v[136:139]
    v_mfma_f32_16x16x32_bf16 v[136:139], a[180:183], v[164:167], v[136:139]
    v_cvt_pk_bf16_f32 v204, v120, v121
    v_mfma_f32_16x16x32_bf16 v[136:139], a[184:187], v[168:171], v[136:139]
    s_add_u32 m0, m0, 1024
    s_add_u32 s40, s40, s32
    v_mfma_f32_16x16x32_bf16 v[136:139], a[188:191], v[172:175], v[136:139]
    buffer_load_dwordx4 v2, s[8:11], s40 offen lds
    v_cvt_pk_bf16_f32 v205, v122, v123
    v_mfma_f32_16x16x32_bf16 v[140:143], a[240:243], v[160:163], v[140:143]
    v_cvt_pk_bf16_f32 v206, v124, v125
    v_mfma_f32_16x16x32_bf16 v[140:143], a[244:247], v[164:167], v[140:143]
    v_mfma_f32_16x16x32_bf16 v[140:143], a[248:251], v[168:171], v[140:143]
    v_cvt_pk_bf16_f32 v207, v126, v127
    v_mfma_f32_16x16x32_bf16 v[140:143], a[252:255], v[172:175], v[140:143]
    s_waitcnt lgkmcnt(0)
    v_mfma_f32_16x16x32_bf16 v[144:147], a[48:51], v[176:179], v[144:147]
    ds_read_b64_tr_b16 v[160:161], v12 offset:0
    v_mfma_f32_16x16x32_bf16 v[144:147], a[52:55], v[180:183], v[144:147]
    ds_read_b64_tr_b16 v[162:163], v12 offset:512
    v_mfma_f32_16x16x32_bf16 v[144:147], a[56:59], v[184:187], v[144:147]
    ds_read_b64_tr_b16 v[164:165], v12 offset:4096
    v_mfma_f32_16x16x32_bf16 v[144:147], a[60:63], v[188:191], v[144:147]
    ds_read_b64_tr_b16 v[166:167], v12 offset:4608
    v_cvt_pk_bf16_f32 v208, v128, v129
    v_mfma_f32_16x16x32_bf16 v[148:151], a[112:115], v[176:179], v[148:151]
    ds_read_b64_tr_b16 v[168:169], v12 offset:8192
    v_cvt_pk_bf16_f32 v209, v130, v131
    v_mfma_f32_16x16x32_bf16 v[148:151], a[116:119], v[180:183], v[148:151]
    ds_read_b64_tr_b16 v[170:171], v12 offset:8704
    v_mfma_f32_16x16x32_bf16 v[148:151], a[120:123], v[184:187], v[148:151]
    ds_read_b64_tr_b16 v[172:173], v12 offset:12288
    v_cvt_pk_bf16_f32 v210, v132, v133
    v_mfma_f32_16x16x32_bf16 v[148:151], a[124:127], v[188:191], v[148:151]
    ds_read_b64_tr_b16 v[174:175], v12 offset:12800
    v_cvt_pk_bf16_f32 v211, v134, v135
    v_mfma_f32_16x16x32_bf16 v[152:155], a[176:179], v[176:179], v[152:155]
    s_add_u32 s56, s56, 16384
    s_and_b32 s56, s56, 0x1ffff
    v_mfma_f32_16x16x32_bf16 v[152:155], a[180:183], v[180:183], v[152:155]
    v_cvt_pk_bf16_f32 v212, v136, v137
    v_mov_b32 v8, v12
    v_mfma_f32_16x16x32_bf16 v[152:155], a[184:187], v[184:187], v[152:155]
    s_add_u32 m0, m0, 1024
    s_add_u32 s40, s40, s32
    v_mfma_f32_16x16x32_bf16 v[152:155], a[188:191], v[188:191], v[152:155]
    buffer_load_dwordx4 v3, s[8:11], s40 offen lds
    v_cvt_pk_bf16_f32 v213, v138, v139
    v_mfma_f32_16x16x32_bf16 v[156:159], a[240:243], v[176:179], v[156:159]
    s_add_u32 s57, s57, 16384
    s_and_b32 s57, s57, 0x1ffff
    v_mfma_f32_16x16x32_bf16 v[156:159], a[244:247], v[180:183], v[156:159]
    s_add_u32 s31, s31, 1
    s_lshr_b32 s39, s31, 2
    v_mfma_f32_16x16x32_bf16 v[156:159], a[248:251], v[184:187], v[156:159]
    s_add_u32 s30, s30, s39
    s_and_b32 s31, s31, 3
    v_mfma_f32_16x16x32_bf16 v[156:159], a[252:255], v[188:191], v[156:159]
    v_cvt_pk_bf16_f32 v214, v140, v141
    v_cvt_pk_bf16_f32 v215, v142, v143
    v_mov_b32 v9, v13
    v_mov_b32 v10, v14
    v_mov_b32 v11, v15
    v_add_u32 v12, s56, v4
    v_add_u32 v13, s56, v5
    v_add_u32 v14, s56, v6
    v_add_u32 v15, s56, v7
    s_add_u32 s29, s29, 1
    s_cmp_lt_u32 s29, s44
    s_cbranch_scc1 p1_kernel_segv_loop
p1_kernel_segv_skip:
    s_mov_b32 s34, s33
    s_mov_b32 s59, s58
    s_nop 7
    v_cvt_pk_bf16_f32 v216, v144, v145
    v_cvt_pk_bf16_f32 v217, v146, v147
    v_cvt_pk_bf16_f32 v218, v148, v149
    v_cvt_pk_bf16_f32 v219, v150, v151
    v_cvt_pk_bf16_f32 v220, v152, v153
    v_cvt_pk_bf16_f32 v221, v154, v155
    v_cvt_pk_bf16_f32 v222, v156, v157
    v_cvt_pk_bf16_f32 v223, v158, v159
    s_nop 1
    buffer_store_dwordx4 v[192:195], v16, s[4:7], s34 offen offset:0 sc1
    buffer_store_dwordx4 v[196:199], v17, s[4:7], s34 offen offset:0 sc1
    buffer_store_dwordx4 v[200:203], v16, s[4:7], s34 offen offset:1024 sc1
    buffer_store_dwordx4 v[204:207], v17, s[4:7], s34 offen offset:1024 sc1
    buffer_store_dwordx4 v[208:211], v16, s[4:7], s34 offen offset:2048 sc1
    buffer_store_dwordx4 v[212:215], v17, s[4:7], s34 offen offset:2048 sc1
    buffer_store_dwordx4 v[216:219], v16, s[4:7], s34 offen offset:3072 sc1
    buffer_store_dwordx4 v[220:223], v17, s[4:7], s34 offen offset:3072 sc1
    s_branch p1_kernel_done
p1_kernel_run_q:
    s_lshl_b32 s47, s78, 12
    s_mov_b32 s41, 0x3e0293ee
    v_add_u32 v16, 0, v1
    v_add_u32 v17, 4096, v1
    v_add_u32 v18, 8192, v1
    v_add_u32 v19, 12288, v1
    s_waitcnt vmcnt(24)
    s_barrier
    ds_read_b64_tr_b16 v[160:161], v8 offset:0
    ds_read_b64_tr_b16 v[162:163], v8 offset:512
    ds_read_b64_tr_b16 v[164:165], v8 offset:4096
    ds_read_b64_tr_b16 v[166:167], v8 offset:4608
    ds_read_b64_tr_b16 v[168:169], v8 offset:8192
    ds_read_b64_tr_b16 v[170:171], v8 offset:8704
    ds_read_b64_tr_b16 v[172:173], v8 offset:12288
    ds_read_b64_tr_b16 v[174:175], v8 offset:12800
    s_waitcnt lgkmcnt(0)
    v_mfma_f32_16x16x32_bf16 v[96:99], v[160:163], a[0:3], 0
    ds_read_b64_tr_b16 v[176:177], v9 offset:0
    s_mov_b32 s34, s33
    s_mov_b32 s59, s58
    s_lshr_b32 s37, s29, 1
    v_mfma_f32_16x16x32_bf16 v[96:99], v[164:167], a[4:7], v[96:99]
    ds_read_b64_tr_b16 v[178:179], v9 offset:512
    s_lshl_b32 s37, s37, 19
    s_and_b32 s38, s29, 1
    s_lshl_b32 s38, s38, 11
    v_mfma_f32_16x16x32_bf16 v[96:99], v[168:171], a[8:11], v[96:99]
    ds_read_b64_tr_b16 v[180:181], v9 offset:4096
    s_add_u32 s37, s37, s38
    s_add_u32 s33, s37, s47
    s_add_u32 s58, s33, 1024
    v_mfma_f32_16x16x32_bf16 v[96:99], v[172:175], a[12:15], v[96:99]
    ds_read_b64_tr_b16 v[182:183], v9 offset:4608
    s_lshl_b32 s40, s30, 7
    s_lshl_b32 s39, s31, 2
    s_add_u32 s39, s39, s35
    v_mfma_f32_16x16x32_bf16 v[100:103], v[160:163], a[64:67], 0
    ds_read_b64_tr_b16 v[184:185], v9 offset:8192
    s_lshl_b32 s39, s39, 2
    s_mul_i32 s39, s39, s32
    s_add_u32 s40, s40, s39
    v_mfma_f32_16x16x32_bf16 v[100:103], v[164:167], a[68:71], v[100:103]
    ds_read_b64_tr_b16 v[186:187], v9 offset:8704
    s_lshl_b32 s39, s35, 12
    s_add_u32 s39, s39, s57
    v_mfma_f32_16x16x32_bf16 v[100:103], v[168:171], a[72:75], v[100:103]
    ds_read_b64_tr_b16 v[188:189], v9 offset:12288
    s_mov_b32 m0, s39
    s_nop 0
    v_mfma_f32_16x16x32_bf16 v[100:103], v[172:175], a[76:79], v[100:103]
    ds_read_b64_tr_b16 v[190:191], v9 offset:12800
    s_waitcnt vmcnt(8)
    buffer_load_dwordx4 v2, s[8:11], s40 offen lds
    v_mfma_f32_16x16x32_bf16 v[104:107], v[160:163], a[128:131], 0
    ds_write_b128 v29, v[192:195] offset:0
    s_add_u32 m0, m0, 1024
    s_add_u32 s40, s40, s32
    v_mfma_f32_16x16x32_bf16 v[104:107], v[164:167], a[132:135], v[104:107]
    ds_write_b128 v30, v[196:199] offset:1024
    buffer_load_dwordx4 v3, s[8:11], s40 offen lds
    s_add_u32 s42, s68, 512
    buffer_load_dwordx4 v[32:35], v28, s[12:15], s42 offen
    v_mfma_f32_16x16x32_bf16 v[104:107], v[168:171], a[136:139], v[104:107]
    ds_write_b128 v29, v[200:203] offset:2048
    s_add_u32 m0, m0, 1024
    s_add_u32 s40, s40, s32
    v_mfma_f32_16x16x32_bf16 v[104:107], v[172:175], a[140:143], v[104:107]
    ds_write_b128 v30, v[204:207] offset:3072
    buffer_load_dwordx4 v2, s[8:11], s40 offen lds
    s_add_u32 s42, s68, 8704
    buffer_load_dwordx4 v[36:39], v28, s[12:15], s42 offen
    v_mfma_f32_16x16x32_bf16 v[108:111], v[160:163], a[192:195], 0
    ds_write_b128 v29, v[208:211] offset:4096
    s_add_u32 m0, m0, 1024
    s_add_u32 s40, s40, s32
    v_mfma_f32_16x16x32_bf16 v[108:111], v[164:167], a[196:199], v[108:111]
    ds_write_b128 v30, v[212:215] offset:5120
    buffer_load_dwordx4 v3, s[8:11], s40 offen lds
    s_add_u32 s42, s68, 16896
    buffer_load_dwordx4 v[40:43], v28, s[12:15], s42 offen
    v_mfma_f32_16x16x32_bf16 v[108:111], v[168:171], a[200:203], v[108:111]
    ds_write_b128 v29, v[216:219] offset:6144
    s_add_u32 s57, s57, 16384
    s_and_b32 s57, s57, 0x1ffff
    s_add_u32 s31, s31, 1
    v_mfma_f32_16x16x32_bf16 v[108:111], v[172:175], a[204:207], v[108:111]
    ds_write_b128 v30, v[220:223] offset:7168
    s_lshr_b32 s39, s31, 2
    s_add_u32 s30, s30, s39
    s_and_b32 s31, s31, 3
    s_waitcnt lgkmcnt(0)
    v_mfma_f32_16x16x32_bf16 v[112:115], v[176:179], a[0:3], 0
    ds_read_b64_tr_b16 v[160:161], v10 offset:0
    s_lshl_b32 s40, s30, 7
    s_lshl_b32 s39, s31, 2
    s_add_u32 s39, s39, s35
    v_mfma_f32_16x16x32_bf16 v[112:115], v[180:183], a[4:7], v[112:115]
    ds_read_b64_tr_b16 v[162:163], v10 offset:512
    s_lshl_b32 s39, s39, 2
    s_mul_i32 s39, s39, s32
    s_add_u32 s40, s40, s39
    v_mfma_f32_16x16x32_bf16 v[112:115], v[184:187], a[8:11], v[112:115]
    ds_read_b64_tr_b16 v[164:165], v10 offset:4096
    s_lshl_b32 s39, s35, 12
    s_add_u32 s39, s39, s57
    v_mfma_f32_16x16x32_bf16 v[112:115], v[188:191], a[12:15], v[112:115]
    ds_read_b64_tr_b16 v[166:167], v10 offset:4608
    s_mov_b32 m0, s39
    s_nop 0
    v_mfma_f32_16x16x32_bf16 v[116:119], v[176:179], a[64:67], 0
    ds_read_b64_tr_b16 v[168:169], v10 offset:8192
    buffer_load_dwordx4 v2, s[8:11], s40 offen lds
    s_add_u32 s42, s68, 25088
    buffer_load_dwordx4 v[44:47], v28, s[12:15], s42 offen
    v_mfma_f32_16x16x32_bf16 v[116:119], v[180:183], a[68:71], v[116:119]
    ds_read_b64_tr_b16 v[170:171], v10 offset:8704
    s_add_u32 m0, m0, 1024
    s_add_u32 s40, s40, s32
    v_mfma_f32_16x16x32_bf16 v[116:119], v[184:187], a[72:75], v[116:119]
    ds_read_b64_tr_b16 v[172:173], v10 offset:12288
    buffer_load_dwordx4 v3, s[8:11], s40 offen lds
    s_add_u32 s42, s68, 33280
    buffer_load_dwordx4 v[48:51], v28, s[12:15], s42 offen
    v_mfma_f32_16x16x32_bf16 v[116:119], v[188:191], a[76:79], v[116:119]
    ds_read_b64_tr_b16 v[174:175], v10 offset:12800
    s_add_u32 m0, m0, 1024
    s_add_u32 s40, s40, s32
    v_mfma_f32_16x16x32_bf16 v[120:123], v[176:179], a[128:131], 0
    ds_read_b128 a[16:19], v31 offset:0
    buffer_load_dwordx4 v2, s[8:11], s40 offen lds
    s_add_u32 s42, s68, 41472
    buffer_load_dwordx4 v[52:55], v28, s[12:15], s42 offen
    v_mfma_f32_16x16x32_bf16 v[120:123], v[180:183], a[132:135], v[120:123]
    ds_read_b128 a[20:23], v23 offset:0
    s_add_u32 m0, m0, 1024
    s_add_u32 s40, s40, s32
    v_mfma_f32_16x16x32_bf16 v[120:123], v[184:187], a[136:139], v[120:123]
    ds_read_b128 a[80:83], v31 offset:2048
    buffer_load_dwordx4 v3, s[8:11], s40 offen lds
    s_add_u32 s42, s68, 49664
    buffer_load_dwordx4 v[56:59], v28, s[12:15], s42 offen
    v_mfma_f32_16x16x32_bf16 v[120:123], v[188:191], a[140:143], v[120:123]
    ds_read_b128 a[84:87], v23 offset:2048
    s_add_u32 s57, s57, 16384
    s_and_b32 s57, s57, 0x1ffff
    s_add_u32 s31, s31, 1
    v_mfma_f32_16x16x32_bf16 v[124:127], v[176:179], a[192:195], 0
    ds_read_b128 a[144:147], v31 offset:4096
    s_lshr_b32 s39, s31, 2
    s_add_u32 s30, s30, s39
    s_and_b32 s31, s31, 3
    v_mfma_f32_16x16x32_bf16 v[124:127], v[180:183], a[196:199], v[124:127]
    ds_read_b128 a[148:151], v23 offset:4096
    s_lshl_b32 s40, s30, 7
    s_lshl_b32 s39, s31, 2
    s_add_u32 s39, s39, s35
    v_mfma_f32_16x16x32_bf16 v[124:127], v[184:187], a[200:203], v[124:127]
    ds_read_b128 a[208:211], v31 offset:6144
    s_lshl_b32 s39, s39, 2
    s_mul_i32 s39, s39, s32
    s_add_u32 s40, s40, s39
    v_mfma_f32_16x16x32_bf16 v[124:127], v[188:191], a[204:207], v[124:127]
    ds_read_b128 a[212:215], v23 offset:6144
    s_lshl_b32 s39, s35, 12
    s_add_u32 s39, s39, s57
    s_waitcnt lgkmcnt(0)
    v_mfma_f32_16x16x32_bf16 v[128:131], v[160:163], a[0:3], 0
    ds_read_b64_tr_b16 v[176:177], v11 offset:0
    s_mov_b32 m0, s39
    s_nop 0
    v_mfma_f32_16x16x32_bf16 v[128:131], v[164:167], a[4:7], v[128:131]
    ds_read_b64_tr_b16 v[178:179], v11 offset:512
    buffer_load_dwordx4 v2, s[8:11], s40 offen lds
    s_add_u32 s42, s68, 57856
    buffer_load_dwordx4 v[60:63], v28, s[12:15], s42 offen
    v_mfma_f32_16x16x32_bf16 v[128:131], v[168:171], a[8:11], v[128:131]
    ds_read_b64_tr_b16 v[180:181], v11 offset:4096
    s_add_u32 m0, m0, 1024
    s_add_u32 s40, s40, s32
    v_mfma_f32_16x16x32_bf16 v[128:131], v[172:175], a[12:15], v[128:131]
    ds_read_b64_tr_b16 v[182:183], v11 offset:4608
    buffer_load_dwordx4 v3, s[8:11], s40 offen lds
    s_add_u32 s42, s68, 640
    buffer_load_dwordx4 v[64:67], v28, s[12:15], s42 offen
    v_mfma_f32_16x16x32_bf16 v[132:135], v[160:163], a[64:67], 0
    ds_read_b64_tr_b16 v[184:185], v11 offset:8192
    s_add_u32 m0, m0, 1024
    s_add_u32 s40, s40, s32
    v_mfma_f32_16x16x32_bf16 v[132:135], v[164:167], a[68:71], v[132:135]
    ds_read_b64_tr_b16 v[186:187], v11 offset:8704
    buffer_load_dwordx4 v2, s[8:11], s40 offen lds
    s_add_u32 s42, s68, 8832
    buffer_load_dwordx4 v[68:71], v28, s[12:15], s42 offen
    v_mfma_f32_16x16x32_bf16 v[132:135], v[168:171], a[72:75], v[132:135]
    ds_read_b64_tr_b16 v[188:189], v11 offset:12288
    s_add_u32 m0, m0, 1024
    s_add_u32 s40, s40, s32
    v_mfma_f32_16x16x32_bf16 v[132:135], v[172:175], a[76:79], v[132:135]
    ds_read_b64_tr_b16 v[190:191], v11 offset:12800
    s_waitcnt vmcnt(21)
    buffer_load_dwordx4 v3, s[8:11], s40 offen lds
    v_mfma_f32_16x16x32_bf16 v[136:139], v[160:163], a[128:131], 0
    ds_write_b128 v29, v[224:227] offset:0
    s_add_u32 s57, s57, 16384
    s_and_b32 s57, s57, 0x1ffff
    s_add_u32 s31, s31, 1
    v_mfma_f32_16x16x32_bf16 v[136:139], v[164:167], a[132:135], v[136:139]
    ds_write_b128 v30, v[228:231] offset:1024
    s_lshr_b32 s39, s31, 2
    s_add_u32 s30, s30, s39
    s_and_b32 s31, s31, 3
    v_mfma_f32_16x16x32_bf16 v[136:139], v[168:171], a[136:139], v[136:139]
    ds_write_b128 v29, v[232:235] offset:2048
    s_add_u32 s42, s68, 17024
    buffer_load_dwordx4 v[72:75], v28, s[12:15], s42 offen
    v_mfma_f32_16x16x32_bf16 v[136:139], v[172:175], a[140:143], v[136:139]
    ds_write_b128 v30, v[236:239] offset:3072
    s_add_u32 s42, s68, 25216
    buffer_load_dwordx4 v[76:79], v28, s[12:15], s42 offen
    v_mfma_f32_16x16x32_bf16 v[140:143], v[160:163], a[192:195], 0
    ds_write_b128 v29, v[240:243] offset:4096
    v_mfma_f32_16x16x32_bf16 v[140:143], v[164:167], a[196:199], v[140:143]
    ds_write_b128 v30, v[244:247] offset:5120
    s_add_u32 s42, s68, 33408
    buffer_load_dwordx4 v[80:83], v28, s[12:15], s42 offen
    v_mfma_f32_16x16x32_bf16 v[140:143], v[168:171], a[200:203], v[140:143]
    ds_write_b128 v29, v[248:251] offset:6144
    v_mfma_f32_16x16x32_bf16 v[140:143], v[172:175], a[204:207], v[140:143]
    ds_write_b128 v30, v[252:255] offset:7168
    s_waitcnt vmcnt(19)
    s_barrier
    s_waitcnt lgkmcnt(0)
    v_mfma_f32_16x16x32_bf16 v[144:147], v[176:179], a[0:3], 0
    ds_read_b64_tr_b16 v[160:161], v12 offset:0
    v_mfma_f32_16x16x32_bf16 v[144:147], v[180:183], a[4:7], v[144:147]
    ds_read_b64_tr_b16 v[162:163], v12 offset:512
    s_add_u32 s42, s68, 41600
    buffer_load_dwordx4 v[84:87], v28, s[12:15], s42 offen
    v_mfma_f32_16x16x32_bf16 v[144:147], v[184:187], a[8:11], v[144:147]
    ds_read_b64_tr_b16 v[164:165], v12 offset:4096
    v_mfma_f32_16x16x32_bf16 v[144:147], v[188:191], a[12:15], v[144:147]
    ds_read_b64_tr_b16 v[166:167], v12 offset:4608
    v_mfma_f32_16x16x32_bf16 v[148:151], v[176:179], a[64:67], 0
    ds_read_b64_tr_b16 v[168:169], v12 offset:8192
    s_add_u32 s42, s68, 49792
    buffer_load_dwordx4 v[88:91], v28, s[12:15], s42 offen
    v_mfma_f32_16x16x32_bf16 v[148:151], v[180:183], a[68:71], v[148:151]
    ds_read_b64_tr_b16 v[170:171], v12 offset:8704
    v_mfma_f32_16x16x32_bf16 v[148:151], v[184:187], a[72:75], v[148:151]
    ds_read_b64_tr_b16 v[172:173], v12 offset:12288
    v_mfma_f32_16x16x32_bf16 v[148:151], v[188:191], a[76:79], v[148:151]
    ds_read_b64_tr_b16 v[174:175], v12 offset:12800
    v_mfma_f32_16x16x32_bf16 v[152:155], v[176:179], a[128:131], 0
    ds_read_b128 a[24:27], v31 offset:0
    s_add_u32 s42, s68, 57984
    buffer_load_dwordx4 v[92:95], v28, s[12:15], s42 offen
    s_add_u32 s56, s56, 16384
    v_mfma_f32_16x16x32_bf16 v[152:155], v[180:183], a[132:135], v[152:155]
    ds_read_b128 a[28:31], v23 offset:0
    s_and_b32 s56, s56, 0x1ffff
    v_mov_b32 v8, v12
    v_mov_b32 v9, v13
    v_mfma_f32_16x16x32_bf16 v[152:155], v[184:187], a[136:139], v[152:155]
    ds_read_b128 a[88:91], v31 offset:2048
    v_mov_b32 v10, v14
    v_mov_b32 v11, v15
    v_add_u32 v12, s56, v4
    v_mfma_f32_16x16x32_bf16 v[152:155], v[188:191], a[140:143], v[152:155]
    ds_read_b128 a[92:95], v23 offset:2048
    v_add_u32 v13, s56, v5
    v_add_u32 v14, s56, v6
    v_add_u32 v15, s56, v7
    v_mfma_f32_16x16x32_bf16 v[156:159], v[176:179], a[192:195], 0
    ds_read_b128 a[152:155], v31 offset:4096
    v_mfma_f32_16x16x32_bf16 v[156:159], v[180:183], a[196:199], v[156:159]
    ds_read_b128 a[156:159], v23 offset:4096
    v_mfma_f32_16x16x32_bf16 v[156:159], v[184:187], a[200:203], v[156:159]
    ds_read_b128 a[216:219], v31 offset:6144
    v_mfma_f32_16x16x32_bf16 v[156:159], v[188:191], a[204:207], v[156:159]
    ds_read_b128 a[220:223], v23 offset:6144
    s_waitcnt lgkmcnt(0)
    v_mfma_f32_16x16x32_bf16 v[96:99], v[160:163], a[16:19], v[96:99]
    ds_read_b64_tr_b16 v[176:177], v9 offset:0
    s_lshl_b32 s40, s30, 7
    s_lshl_b32 s39, s31, 2
    s_add_u32 s39, s39, s35
    v_mfma_f32_16x16x32_bf16 v[96:99], v[164:167], a[20:23], v[96:99]
    ds_read_b64_tr_b16 v[178:179], v9 offset:512
    s_lshl_b32 s39, s39, 2
    s_mul_i32 s39, s39, s32
    s_add_u32 s40, s40, s39
    v_mfma_f32_16x16x32_bf16 v[96:99], v[168:171], a[24:27], v[96:99]
    ds_read_b64_tr_b16 v[180:181], v9 offset:4096
    s_lshl_b32 s39, s35, 12
    s_add_u32 s39, s39, s57
    v_mfma_f32_16x16x32_bf16 v[96:99], v[172:175], a[28:31], v[96:99]
    ds_read_b64_tr_b16 v[182:183], v9 offset:4608
    s_add_u32 s42, s68, 768
    buffer_load_dwordx4 v[192:195], v28, s[12:15], s42 offen
    v_mfma_f32_16x16x32_bf16 v[100:103], v[160:163], a[80:83], v[100:103]
    ds_read_b64_tr_b16 v[184:185], v9 offset:8192
    s_mov_b32 m0, s39
    s_nop 0
    v_mfma_f32_16x16x32_bf16 v[100:103], v[164:167], a[84:87], v[100:103]
    ds_read_b64_tr_b16 v[186:187], v9 offset:8704
    buffer_load_dwordx4 v2, s[8:11], s40 offen lds
    s_add_u32 s42, s68, 8960
    buffer_load_dwordx4 v[196:199], v28, s[12:15], s42 offen
    v_mfma_f32_16x16x32_bf16 v[100:103], v[168:171], a[88:91], v[100:103]
    ds_read_b64_tr_b16 v[188:189], v9 offset:12288
    v_mfma_f32_16x16x32_bf16 v[100:103], v[172:175], a[92:95], v[100:103]
    ds_read_b64_tr_b16 v[190:191], v9 offset:12800
    s_waitcnt vmcnt(14)
    v_mfma_f32_16x16x32_bf16 v[104:107], v[160:163], a[144:147], v[104:107]
    ds_write_b128 v29, v[32:35] offset:0
    v_mfma_f32_16x16x32_bf16 v[104:107], v[164:167], a[148:151], v[104:107]
    ds_write_b128 v30, v[36:39] offset:1024
    s_add_u32 s42, s68, 17152
    buffer_load_dwordx4 v[200:203], v28, s[12:15], s42 offen
    v_mfma_f32_16x16x32_bf16 v[104:107], v[168:171], a[152:155], v[104:107]
    ds_write_b128 v29, v[40:43] offset:2048
    v_mfma_f32_16x16x32_bf16 v[104:107], v[172:175], a[156:159], v[104:107]
    ds_write_b128 v30, v[44:47] offset:3072
    v_mfma_f32_16x16x32_bf16 v[108:111], v[160:163], a[208:211], v[108:111]
    ds_write_b128 v29, v[48:51] offset:4096
    s_add_u32 m0, m0, 1024
    s_add_u32 s40, s40, s32
    v_mfma_f32_16x16x32_bf16 v[108:111], v[164:167], a[212:215], v[108:111]
    ds_write_b128 v30, v[52:55] offset:5120
    buffer_load_dwordx4 v3, s[8:11], s40 offen lds
    s_add_u32 s42, s68, 25344
    buffer_load_dwordx4 v[204:207], v28, s[12:15], s42 offen
    v_mfma_f32_16x16x32_bf16 v[108:111], v[168:171], a[216:219], v[108:111]
    ds_write_b128 v29, v[56:59] offset:6144
    v_mfma_f32_16x16x32_bf16 v[108:111], v[172:175], a[220:223], v[108:111]
    ds_write_b128 v30, v[60:63] offset:7168
    s_waitcnt lgkmcnt(0)
    v_mfma_f32_16x16x32_bf16 v[112:115], v[176:179], a[16:19], v[112:115]
    ds_read_b64_tr_b16 v[160:161], v10 offset:0
    s_add_u32 s42, s68, 33536
    buffer_load_dwordx4 v[208:211], v28, s[12:15], s42 offen
    v_mfma_f32_16x16x32_bf16 v[112:115], v[180:183], a[20:23], v[112:115]
    ds_read_b64_tr_b16 v[162:163], v10 offset:512
    v_mfma_f32_16x16x32_bf16 v[112:115], v[184:187], a[24:27], v[112:115]
    ds_read_b64_tr_b16 v[164:165], v10 offset:4096
    v_mfma_f32_16x16x32_bf16 v[112:115], v[188:191], a[28:31], v[112:115]
    ds_read_b64_tr_b16 v[166:167], v10 offset:4608
    v_mfma_f32_16x16x32_bf16 v[116:119], v[176:179], a[80:83], v[116:119]
    ds_read_b64_tr_b16 v[168:169], v10 offset:8192
    s_add_u32 m0, m0, 1024
    s_add_u32 s40, s40, s32
    v_mfma_f32_16x16x32_bf16 v[116:119], v[180:183], a[84:87], v[116:119]
    ds_read_b64_tr_b16 v[170:171], v10 offset:8704
    buffer_load_dwordx4 v2, s[8:11], s40 offen lds
    s_add_u32 s42, s68, 41728
    buffer_load_dwordx4 v[212:215], v28, s[12:15], s42 offen
    v_mfma_f32_16x16x32_bf16 v[116:119], v[184:187], a[88:91], v[116:119]
    ds_read_b64_tr_b16 v[172:173], v10 offset:12288
    v_mfma_f32_16x16x32_bf16 v[116:119], v[188:191], a[92:95], v[116:119]
    ds_read_b64_tr_b16 v[174:175], v10 offset:12800
    s_add_u32 s42, s68, 49920
    buffer_load_dwordx4 v[216:219], v28, s[12:15], s42 offen
    v_mfma_f32_16x16x32_bf16 v[120:123], v[176:179], a[144:147], v[120:123]
    ds_read_b128 a[32:35], v31 offset:0
    v_mfma_f32_16x16x32_bf16 v[120:123], v[180:183], a[148:151], v[120:123]
    ds_read_b128 a[36:39], v23 offset:0
    v_mfma_f32_16x16x32_bf16 v[120:123], v[184:187], a[152:155], v[120:123]
    ds_read_b128 a[96:99], v31 offset:2048
    v_mfma_f32_16x16x32_bf16 v[120:123], v[188:191], a[156:159], v[120:123]
    ds_read_b128 a[100:103], v23 offset:2048
    s_add_u32 s42, s68, 58112
    buffer_load_dwordx4 v[220:223], v28, s[12:15], s42 offen
    v_mfma_f32_16x16x32_bf16 v[124:127], v[176:179], a[208:211], v[124:127]
    ds_read_b128 a[160:163], v31 offset:4096
    s_add_u32 m0, m0, 1024
    s_add_u32 s40, s40, s32
    v_mfma_f32_16x16x32_bf16 v[124:127], v[180:183], a[212:215], v[124:127]
    ds_read_b128 a[164:167], v23 offset:4096
    buffer_load_dwordx4 v3, s[8:11], s40 offen lds
    v_mfma_f32_16x16x32_bf16 v[124:127], v[184:187], a[216:219], v[124:127]
    ds_read_b128 a[224:227], v31 offset:6144
    s_add_u32 s57, s57, 16384
    s_and_b32 s57, s57, 0x1ffff
    s_add_u32 s31, s31, 1
    v_mfma_f32_16x16x32_bf16 v[124:127], v[188:191], a[220:223], v[124:127]
    ds_read_b128 a[228:231], v23 offset:6144
    s_lshr_b32 s39, s31, 2
    s_add_u32 s30, s30, s39
    s_and_b32 s31, s31, 3
    s_waitcnt lgkmcnt(0)
    v_mfma_f32_16x16x32_bf16 v[128:131], v[160:163], a[16:19], v[128:131]
    ds_read_b64_tr_b16 v[176:177], v11 offset:0
    s_lshl_b32 s40, s30, 7
    s_lshl_b32 s39, s31, 2
    s_add_u32 s39, s39, s35
    v_mfma_f32_16x16x32_bf16 v[128:131], v[164:167], a[20:23], v[128:131]
    ds_read_b64_tr_b16 v[178:179], v11 offset:512
    s_lshl_b32 s39, s39, 2
    s_mul_i32 s39, s39, s32
    s_add_u32 s40, s40, s39
    v_mfma_f32_16x16x32_bf16 v[128:131], v[168:171], a[24:27], v[128:131]
    ds_read_b64_tr_b16 v[180:181], v11 offset:4096
    s_lshl_b32 s39, s35, 12
    s_add_u32 s39, s39, s57
    v_mfma_f32_16x16x32_bf16 v[128:131], v[172:175], a[28:31], v[128:131]
    ds_read_b64_tr_b16 v[182:183], v11 offset:4608
    s_add_u32 s42, s68, 896
    buffer_load_dwordx4 v[224:227], v28, s[12:15], s42 offen
    v_mfma_f32_16x16x32_bf16 v[132:135], v[160:163], a[80:83], v[132:135]
    ds_read_b64_tr_b16 v[184:185], v11 offset:8192
    s_mov_b32 m0, s39
    s_nop 0
    v_mfma_f32_16x16x32_bf16 v[132:135], v[164:167], a[84:87], v[132:135]
    ds_read_b64_tr_b16 v[186:187], v11 offset:8704
    buffer_load_dwordx4 v2, s[8:11], s40 offen lds
    s_add_u32 s42, s68, 9088
    buffer_load_dwordx4 v[228:231], v28, s[12:15], s42 offen
    v_mfma_f32_16x16x32_bf16 v[132:135], v[168:171], a[88:91], v[132:135]
    ds_read_b64_tr_b16 v[188:189], v11 offset:12288
    s_add_u32 s42, s68, 17280
    buffer_load_dwordx4 v[232:235], v28, s[12:15], s42 offen
    v_mfma_f32_16x16x32_bf16 v[132:135], v[172:175], a[92:95], v[132:135]
    ds_read_b64_tr_b16 v[190:191], v11 offset:12800
    s_waitcnt vmcnt(16)
    v_mfma_f32_16x16x32_bf16 v[136:139], v[160:163], a[144:147], v[136:139]
    ds_write_b128 v29, v[64:67] offset:0
    v_mfma_f32_16x16x32_bf16 v[136:139], v[164:167], a[148:151], v[136:139]
    ds_write_b128 v30, v[68:71] offset:1024
    s_add_u32 s42, s68, 25472
    buffer_load_dwordx4 v[236:239], v28, s[12:15], s42 offen
    v_mfma_f32_16x16x32_bf16 v[136:139], v[168:171], a[152:155], v[136:139]
    ds_write_b128 v29, v[72:75] offset:2048
    v_mfma_f32_16x16x32_bf16 v[136:139], v[172:175], a[156:159], v[136:139]
    ds_write_b128 v30, v[76:79] offset:3072
    v_mfma_f32_16x16x32_bf16 v[140:143], v[160:163], a[208:211], v[140:143]
    ds_write_b128 v29, v[80:83] offset:4096
    s_add_u32 m0, m0, 1024
    s_add_u32 s40, s40, s32
    v_mfma_f32_16x16x32_bf16 v[140:143], v[164:167], a[212:215], v[140:143]
    ds_write_b128 v30, v[84:87] offset:5120
    buffer_load_dwordx4 v3, s[8:11], s40 offen lds
    s_add_u32 s42, s68, 33664
    buffer_load_dwordx4 v[240:243], v28, s[12:15], s42 offen
    v_mfma_f32_16x16x32_bf16 v[140:143], v[168:171], a[216:219], v[140:143]
    ds_write_b128 v29, v[88:91] offset:6144
    v_mfma_f32_16x16x32_bf16 v[140:143], v[172:175], a[220:223], v[140:143]
    ds_write_b128 v30, v[92:95] offset:7168
    s_waitcnt vmcnt(33)
    s_barrier
    s_waitcnt lgkmcnt(0)
    v_mfma_f32_16x16x32_bf16 v[144:147], v[176:179], a[16:19], v[144:147]
    ds_read_b64_tr_b16 v[160:161], v12 offset:0
    v_mfma_f32_16x16x32_bf16 v[144:147], v[180:183], a[20:23], v[144:147]
    ds_read_b64_tr_b16 v[162:163], v12 offset:512
    s_add_u32 s42, s68, 41856
    buffer_load_dwordx4 v[244:247], v28, s[12:15], s42 offen
    v_mfma_f32_16x16x32_bf16 v[144:147], v[184:187], a[24:27], v[144:147]
    ds_read_b64_tr_b16 v[164:165], v12 offset:4096
    v_mfma_f32_16x16x32_bf16 v[144:147], v[188:191], a[28:31], v[144:147]
    ds_read_b64_tr_b16 v[166:167], v12 offset:4608
    v_mfma_f32_16x16x32_bf16 v[148:151], v[176:179], a[80:83], v[148:151]
    ds_read_b64_tr_b16 v[168:169], v12 offset:8192
    s_add_u32 m0, m0, 1024
    s_add_u32 s40, s40, s32
    v_mfma_f32_16x16x32_bf16 v[148:151], v[180:183], a[84:87], v[148:151]
    ds_read_b64_tr_b16 v[170:171], v12 offset:8704
    buffer_load_dwordx4 v2, s[8:11], s40 offen lds
    s_add_u32 s42, s68, 50048
    buffer_load_dwordx4 v[248:251], v28, s[12:15], s42 offen
    v_mfma_f32_16x16x32_bf16 v[148:151], v[184:187], a[88:91], v[148:151]
    ds_read_b64_tr_b16 v[172:173], v12 offset:12288
    v_mfma_f32_16x16x32_bf16 v[148:151], v[188:191], a[92:95], v[148:151]
    ds_read_b64_tr_b16 v[174:175], v12 offset:12800
    v_mfma_f32_16x16x32_bf16 v[152:155], v[176:179], a[144:147], v[152:155]
    ds_read_b128 a[40:43], v31 offset:0
    s_add_u32 s42, s68, 58240
    buffer_load_dwordx4 v[252:255], v28, s[12:15], s42 offen
    s_add_u32 s56, s56, 16384
    v_mfma_f32_16x16x32_bf16 v[152:155], v[180:183], a[148:151], v[152:155]
    ds_read_b128 a[44:47], v23 offset:0
    s_and_b32 s56, s56, 0x1ffff
    v_mov_b32 v8, v12
    v_mov_b32 v9, v13
    v_mfma_f32_16x16x32_bf16 v[152:155], v[184:187], a[152:155], v[152:155]
    ds_read_b128 a[104:107], v31 offset:2048
    v_mov_b32 v10, v14
    v_mov_b32 v11, v15
    v_add_u32 v12, s56, v4
    v_mfma_f32_16x16x32_bf16 v[152:155], v[188:191], a[156:159], v[152:155]
    ds_read_b128 a[108:111], v23 offset:2048
    v_add_u32 v13, s56, v5
    v_add_u32 v14, s56, v6
    v_add_u32 v15, s56, v7
    v_mfma_f32_16x16x32_bf16 v[156:159], v[176:179], a[208:211], v[156:159]
    ds_read_b128 a[168:171], v31 offset:4096
    s_add_u32 m0, m0, 1024
    s_add_u32 s40, s40, s32
    v_mfma_f32_16x16x32_bf16 v[156:159], v[180:183], a[212:215], v[156:159]
    ds_read_b128 a[172:175], v23 offset:4096
    buffer_load_dwordx4 v3, s[8:11], s40 offen lds
    v_mfma_f32_16x16x32_bf16 v[156:159], v[184:187], a[216:219], v[156:159]
    ds_read_b128 a[232:235], v31 offset:6144
    s_add_u32 s57, s57, 16384
    s_and_b32 s57, s57, 0x1ffff
    s_add_u32 s31, s31, 1
    v_mfma_f32_16x16x32_bf16 v[156:159], v[188:191], a[220:223], v[156:159]
    ds_read_b128 a[236:239], v23 offset:6144
    s_lshr_b32 s39, s31, 2
    s_add_u32 s30, s30, s39
    s_and_b32 s31, s31, 3
    s_waitcnt lgkmcnt(0)
    v_mfma_f32_16x16x32_bf16 v[96:99], v[160:163], a[32:35], v[96:99]
    ds_read_b64_tr_b16 v[176:177], v9 offset:0
    s_lshl_b32 s40, s30, 7
    s_lshl_b32 s39, s31, 2
    s_add_u32 s39, s39, s35
    v_mfma_f32_16x16x32_bf16 v[96:99], v[164:167], a[36:39], v[96:99]
    ds_read_b64_tr_b16 v[178:179], v9 offset:512
    s_lshl_b32 s39, s39, 2
    s_mul_i32 s39, s39, s32
    s_add_u32 s40, s40, s39
    v_mfma_f32_16x16x32_bf16 v[96:99], v[168:171], a[40:43], v[96:99]
    ds_read_b64_tr_b16 v[180:181], v9 offset:4096
    s_lshl_b32 s39, s35, 12
    s_add_u32 s39, s39, s57
    v_mfma_f32_16x16x32_bf16 v[96:99], v[172:175], a[44:47], v[96:99]
    ds_read_b64_tr_b16 v[182:183], v9 offset:4608
    v_mfma_f32_16x16x32_bf16 v[100:103], v[160:163], a[96:99], v[100:103]
    ds_read_b64_tr_b16 v[184:185], v9 offset:8192
    s_mov_b32 m0, s39
    s_nop 0
    v_mfma_f32_16x16x32_bf16 v[100:103], v[164:167], a[100:103], v[100:103]
    ds_read_b64_tr_b16 v[186:187], v9 offset:8704
    buffer_load_dwordx4 v2, s[8:11], s40 offen lds
    v_mfma_f32_16x16x32_bf16 v[100:103], v[168:171], a[104:107], v[100:103]
    ds_read_b64_tr_b16 v[188:189], v9 offset:12288
    v_mfma_f32_16x16x32_bf16 v[100:103], v[172:175], a[108:111], v[100:103]
    ds_read_b64_tr_b16 v[190:191], v9 offset:12800
    s_waitcnt vmcnt(14)
    v_mfma_f32_16x16x32_bf16 v[104:107], v[160:163], a[160:163], v[104:107]
    ds_write_b128 v29, v[192:195] offset:0
    v_mfma_f32_16x16x32_bf16 v[104:107], v[164:167], a[164:167], v[104:107]
    ds_write_b128 v30, v[196:199] offset:1024
    v_mfma_f32_16x16x32_bf16 v[104:107], v[168:171], a[168:171], v[104:107]
    ds_write_b128 v29, v[200:203] offset:2048
    v_mfma_f32_16x16x32_bf16 v[104:107], v[172:175], a[172:175], v[104:107]
    ds_write_b128 v30, v[204:207] offset:3072
    v_mfma_f32_16x16x32_bf16 v[108:111], v[160:163], a[224:227], v[108:111]
    ds_write_b128 v29, v[208:211] offset:4096
    s_add_u32 m0, m0, 1024
    s_add_u32 s40, s40, s32
    v_mfma_f32_16x16x32_bf16 v[108:111], v[164:167], a[228:231], v[108:111]
    ds_write_b128 v30, v[212:215] offset:5120
    buffer_load_dwordx4 v3, s[8:11], s40 offen lds
    v_mfma_f32_16x16x32_bf16 v[108:111], v[168:171], a[232:235], v[108:111]
    ds_write_b128 v29, v[216:219] offset:6144
    v_mfma_f32_16x16x32_bf16 v[108:111], v[172:175], a[236:239], v[108:111]
    ds_write_b128 v30, v[220:223] offset:7168
    s_waitcnt lgkmcnt(0)
    v_mfma_f32_16x16x32_bf16 v[112:115], v[176:179], a[32:35], v[112:115]
    ds_read_b64_tr_b16 v[160:161], v10 offset:0
    v_mfma_f32_16x16x32_bf16 v[112:115], v[180:183], a[36:39], v[112:115]
    ds_read_b64_tr_b16 v[162:163], v10 offset:512
    v_mfma_f32_16x16x32_bf16 v[112:115], v[184:187], a[40:43], v[112:115]
    ds_read_b64_tr_b16 v[164:165], v10 offset:4096
    v_mfma_f32_16x16x32_bf16 v[112:115], v[188:191], a[44:47], v[112:115]
    ds_read_b64_tr_b16 v[166:167], v10 offset:4608
    v_mfma_f32_16x16x32_bf16 v[116:119], v[176:179], a[96:99], v[116:119]
    ds_read_b64_tr_b16 v[168:169], v10 offset:8192
    s_add_u32 m0, m0, 1024
    s_add_u32 s40, s40, s32
    v_mfma_f32_16x16x32_bf16 v[116:119], v[180:183], a[100:103], v[116:119]
    ds_read_b64_tr_b16 v[170:171], v10 offset:8704
    buffer_load_dwordx4 v2, s[8:11], s40 offen lds
    v_mfma_f32_16x16x32_bf16 v[116:119], v[184:187], a[104:107], v[116:119]
    ds_read_b64_tr_b16 v[172:173], v10 offset:12288
    v_mfma_f32_16x16x32_bf16 v[116:119], v[188:191], a[108:111], v[116:119]
    ds_read_b64_tr_b16 v[174:175], v10 offset:12800
    v_mfma_f32_16x16x32_bf16 v[120:123], v[176:179], a[160:163], v[120:123]
    ds_read_b128 a[48:51], v31 offset:0
    v_mfma_f32_16x16x32_bf16 v[120:123], v[180:183], a[164:167], v[120:123]
    ds_read_b128 a[52:55], v23 offset:0
    v_mfma_f32_16x16x32_bf16 v[120:123], v[184:187], a[168:171], v[120:123]
    ds_read_b128 a[112:115], v31 offset:2048
    v_mfma_f32_16x16x32_bf16 v[120:123], v[188:191], a[172:175], v[120:123]
    ds_read_b128 a[116:119], v23 offset:2048
    v_mfma_f32_16x16x32_bf16 v[124:127], v[176:179], a[224:227], v[124:127]
    ds_read_b128 a[176:179], v31 offset:4096
    s_add_u32 m0, m0, 1024
    s_add_u32 s40, s40, s32
    v_mfma_f32_16x16x32_bf16 v[124:127], v[180:183], a[228:231], v[124:127]
    ds_read_b128 a[180:183], v23 offset:4096
    buffer_load_dwordx4 v3, s[8:11], s40 offen lds
    v_mfma_f32_16x16x32_bf16 v[124:127], v[184:187], a[232:235], v[124:127]
    ds_read_b128 a[240:243], v31 offset:6144
    s_add_u32 s57, s57, 16384
    s_and_b32 s57, s57, 0x1ffff
    s_add_u32 s31, s31, 1
    v_mfma_f32_16x16x32_bf16 v[124:127], v[188:191], a[236:239], v[124:127]
    ds_read_b128 a[244:247], v23 offset:6144
    s_lshr_b32 s39, s31, 2
    s_add_u32 s30, s30, s39
    s_and_b32 s31, s31, 3
    s_waitcnt lgkmcnt(0)
    v_mfma_f32_16x16x32_bf16 v[128:131], v[160:163], a[32:35], v[128:131]
    ds_read_b64_tr_b16 v[176:177], v11 offset:0
    s_lshl_b32 s40, s30, 7
    s_lshl_b32 s39, s31, 2
    s_add_u32 s39, s39, s35
    v_mfma_f32_16x16x32_bf16 v[128:131], v[164:167], a[36:39], v[128:131]
    ds_read_b64_tr_b16 v[178:179], v11 offset:512
    s_lshl_b32 s39, s39, 2
    s_mul_i32 s39, s39, s32
    s_add_u32 s40, s40, s39
    v_mfma_f32_16x16x32_bf16 v[128:131], v[168:171], a[40:43], v[128:131]
    ds_read_b64_tr_b16 v[180:181], v11 offset:4096
    s_lshl_b32 s39, s35, 12
    s_add_u32 s39, s39, s57
    v_mfma_f32_16x16x32_bf16 v[128:131], v[172:175], a[44:47], v[128:131]
    ds_read_b64_tr_b16 v[182:183], v11 offset:4608
    v_mfma_f32_16x16x32_bf16 v[132:135], v[160:163], a[96:99], v[132:135]
    ds_read_b64_tr_b16 v[184:185], v11 offset:8192
    s_mov_b32 m0, s39
    s_nop 0
    v_mfma_f32_16x16x32_bf16 v[132:135], v[164:167], a[100:103], v[132:135]
    ds_read_b64_tr_b16 v[186:187], v11 offset:8704
    buffer_load_dwordx4 v2, s[8:11], s40 offen lds
    v_mfma_f32_16x16x32_bf16 v[132:135], v[168:171], a[104:107], v[132:135]
    ds_read_b64_tr_b16 v[188:189], v11 offset:12288
    v_mfma_f32_16x16x32_bf16 v[132:135], v[172:175], a[108:111], v[132:135]
    ds_read_b64_tr_b16 v[190:191], v11 offset:12800
    s_waitcnt vmcnt(6)
    v_mfma_f32_16x16x32_bf16 v[136:139], v[160:163], a[160:163], v[136:139]
    ds_write_b128 v29, v[224:227] offset:0
    v_mfma_f32_16x16x32_bf16 v[136:139], v[164:167], a[164:167], v[136:139]
    ds_write_b128 v30, v[228:231] offset:1024
    v_mfma_f32_16x16x32_bf16 v[136:139], v[168:171], a[168:171], v[136:139]
    ds_write_b128 v29, v[232:235] offset:2048
    v_mfma_f32_16x16x32_bf16 v[136:139], v[172:175], a[172:175], v[136:139]
    ds_write_b128 v30, v[236:239] offset:3072
    v_mfma_f32_16x16x32_bf16 v[140:143], v[160:163], a[224:227], v[140:143]
    ds_write_b128 v29, v[240:243] offset:4096
    s_add_u32 m0, m0, 1024
    s_add_u32 s40, s40, s32
    v_mfma_f32_16x16x32_bf16 v[140:143], v[164:167], a[228:231], v[140:143]
    ds_write_b128 v30, v[244:247] offset:5120
    buffer_load_dwordx4 v3, s[8:11], s40 offen lds
    v_mfma_f32_16x16x32_bf16 v[140:143], v[168:171], a[232:235], v[140:143]
    ds_write_b128 v29, v[248:251] offset:6144
    v_mfma_f32_16x16x32_bf16 v[140:143], v[172:175], a[236:239], v[140:143]
    ds_write_b128 v30, v[252:255] offset:7168
    s_waitcnt vmcnt(36)
    s_barrier
    s_waitcnt lgkmcnt(0)
    v_mfma_f32_16x16x32_bf16 v[144:147], v[176:179], a[32:35], v[144:147]
    ds_read_b64_tr_b16 v[160:161], v12 offset:0
    v_mfma_f32_16x16x32_bf16 v[144:147], v[180:183], a[36:39], v[144:147]
    ds_read_b64_tr_b16 v[162:163], v12 offset:512
    v_mfma_f32_16x16x32_bf16 v[144:147], v[184:187], a[40:43], v[144:147]
    ds_read_b64_tr_b16 v[164:165], v12 offset:4096
    v_mfma_f32_16x16x32_bf16 v[144:147], v[188:191], a[44:47], v[144:147]
    ds_read_b64_tr_b16 v[166:167], v12 offset:4608
    v_mfma_f32_16x16x32_bf16 v[148:151], v[176:179], a[96:99], v[148:151]
    ds_read_b64_tr_b16 v[168:169], v12 offset:8192
    s_add_u32 m0, m0, 1024
    s_add_u32 s40, s40, s32
    v_mfma_f32_16x16x32_bf16 v[148:151], v[180:183], a[100:103], v[148:151]
    ds_read_b64_tr_b16 v[170:171], v12 offset:8704
    buffer_load_dwordx4 v2, s[8:11], s40 offen lds
    v_mfma_f32_16x16x32_bf16 v[148:151], v[184:187], a[104:107], v[148:151]
    ds_read_b64_tr_b16 v[172:173], v12 offset:12288
    v_mfma_f32_16x16x32_bf16 v[148:151], v[188:191], a[108:111], v[148:151]
    ds_read_b64_tr_b16 v[174:175], v12 offset:12800
    v_mfma_f32_16x16x32_bf16 v[152:155], v[176:179], a[160:163], v[152:155]
    ds_read_b128 a[56:59], v31 offset:0
    s_add_u32 s79, s29, 3
    s_lshl_b32 s79, s79, 7
    buffer_load_dword v27, v22, s[8:11], s79 offen
    v_mfma_f32_16x16x32_bf16 v[152:155], v[180:183], a[164:167], v[152:155]
    ds_read_b128 a[60:63], v23 offset:0
    s_add_u32 s56, s56, 16384
    s_and_b32 s56, s56, 0x1ffff
    v_mov_b32 v8, v12
    v_mfma_f32_16x16x32_bf16 v[152:155], v[184:187], a[168:171], v[152:155]
    ds_read_b128 a[120:123], v31 offset:2048
    v_mov_b32 v9, v13
    v_mov_b32 v10, v14
    v_mov_b32 v11, v15
    v_mfma_f32_16x16x32_bf16 v[152:155], v[188:191], a[172:175], v[152:155]
    ds_read_b128 a[124:127], v23 offset:2048
    v_add_u32 v12, s56, v4
    v_add_u32 v13, s56, v5
    v_add_u32 v14, s56, v6
    v_mfma_f32_16x16x32_bf16 v[156:159], v[176:179], a[224:227], v[156:159]
    ds_read_b128 a[184:187], v31 offset:4096
    s_add_u32 m0, m0, 1024
    s_add_u32 s40, s40, s32
    v_add_u32 v15, s56, v7
    v_mfma_f32_16x16x32_bf16 v[156:159], v[180:183], a[228:231], v[156:159]
    ds_read_b128 a[188:191], v23 offset:4096
    buffer_load_dwordx4 v3, s[8:11], s40 offen lds
    v_mfma_f32_16x16x32_bf16 v[156:159], v[184:187], a[232:235], v[156:159]
    ds_read_b128 a[248:251], v31 offset:6144
    s_add_u32 s57, s57, 16384
    s_and_b32 s57, s57, 0x1ffff
    s_add_u32 s31, s31, 1
    v_mfma_f32_16x16x32_bf16 v[156:159], v[188:191], a[236:239], v[156:159]
    ds_read_b128 a[252:255], v23 offset:6144
    s_lshr_b32 s39, s31, 2
    s_add_u32 s30, s30, s39
    s_and_b32 s31, s31, 3
    s_waitcnt lgkmcnt(0)
    v_mfma_f32_16x16x32_bf16 v[96:99], v[160:163], a[48:51], v[96:99]
    ds_read_b64_tr_b16 v[176:177], v9 offset:0
    s_lshl_b32 s40, s30, 7
    s_lshl_b32 s39, s31, 2
    s_add_u32 s39, s39, s35
    v_mfma_f32_16x16x32_bf16 v[96:99], v[164:167], a[52:55], v[96:99]
    ds_read_b64_tr_b16 v[178:179], v9 offset:512
    s_lshl_b32 s39, s39, 2
    s_mul_i32 s39, s39, s32
    s_add_u32 s40, s40, s39
    v_mfma_f32_16x16x32_bf16 v[96:99], v[168:171], a[56:59], v[96:99]
    ds_read_b64_tr_b16 v[180:181], v9 offset:4096
    s_lshl_b32 s39, s35, 12
    s_add_u32 s39, s39, s57
    v_mfma_f32_16x16x32_bf16 v[96:99], v[172:175], a[60:63], v[96:99]
    ds_read_b64_tr_b16 v[182:183], v9 offset:4608
    v_mfma_f32_16x16x32_bf16 v[100:103], v[160:163], a[112:115], v[100:103]
    ds_read_b64_tr_b16 v[184:185], v9 offset:8192
    s_mov_b32 m0, s39
    s_nop 0
    v_mfma_f32_16x16x32_bf16 v[100:103], v[164:167], a[116:119], v[100:103]
    ds_read_b64_tr_b16 v[186:187], v9 offset:8704
    buffer_load_dwordx4 v2, s[8:11], s40 offen lds
    v_mfma_f32_16x16x32_bf16 v[100:103], v[168:171], a[120:123], v[100:103]
    ds_read_b64_tr_b16 v[188:189], v9 offset:12288
    v_mfma_f32_16x16x32_bf16 v[100:103], v[172:175], a[124:127], v[100:103]
    ds_read_b64_tr_b16 v[190:191], v9 offset:12800
    v_mfma_f32_16x16x32_bf16 v[104:107], v[160:163], a[176:179], v[104:107]
    v_mfma_f32_16x16x32_bf16 v[104:107], v[164:167], a[180:183], v[104:107]
    v_mfma_f32_16x16x32_bf16 v[104:107], v[168:171], a[184:187], v[104:107]
    v_mfma_f32_16x16x32_bf16 v[104:107], v[172:175], a[188:191], v[104:107]
    v_mfma_f32_16x16x32_bf16 v[108:111], v[160:163], a[240:243], v[108:111]
    s_add_u32 m0, m0, 1024
    s_add_u32 s40, s40, s32
    v_mfma_f32_16x16x32_bf16 v[108:111], v[164:167], a[244:247], v[108:111]
    buffer_load_dwordx4 v3, s[8:11], s40 offen lds
    v_mfma_f32_16x16x32_bf16 v[108:111], v[168:171], a[248:251], v[108:111]
    v_mfma_f32_16x16x32_bf16 v[108:111], v[172:175], a[252:255], v[108:111]
    s_waitcnt lgkmcnt(0)
    v_mfma_f32_16x16x32_bf16 v[112:115], v[176:179], a[48:51], v[112:115]
    ds_read_b64_tr_b16 v[160:161], v10 offset:0
    v_mfma_f32_16x16x32_bf16 v[112:115], v[180:183], a[52:55], v[112:115]
    ds_read_b64_tr_b16 v[162:163], v10 offset:512
    v_mfma_f32_16x16x32_bf16 v[112:115], v[184:187], a[56:59], v[112:115]
    ds_read_b64_tr_b16 v[164:165], v10 offset:4096
    v_mfma_f32_16x16x32_bf16 v[112:115], v[188:191], a[60:63], v[112:115]
    ds_read_b64_tr_b16 v[166:167], v10 offset:4608
    v_mul_f32 v96, s41, v96
    v_mfma_f32_16x16x32_bf16 v[116:119], v[176:179], a[112:115], v[116:119]
    ds_read_b64_tr_b16 v[168:169], v10 offset:8192
    s_add_u32 m0, m0, 1024
    s_add_u32 s40, s40, s32
    v_mul_f32 v97, s41, v97
    v_mfma_f32_16x16x32_bf16 v[116:119], v[180:183], a[116:119], v[116:119]
    ds_read_b64_tr_b16 v[170:171], v10 offset:8704
    buffer_load_dwordx4 v2, s[8:11], s40 offen lds
    v_mul_f32 v98, s41, v98
    v_mfma_f32_16x16x32_bf16 v[116:119], v[184:187], a[120:123], v[116:119]
    ds_read_b64_tr_b16 v[172:173], v10 offset:12288
    v_mul_f32 v99, s41, v99
    v_mfma_f32_16x16x32_bf16 v[116:119], v[188:191], a[124:127], v[116:119]
    ds_read_b64_tr_b16 v[174:175], v10 offset:12800
    v_cvt_pk_bf16_f32 v192, v96, v97
    v_mfma_f32_16x16x32_bf16 v[120:123], v[176:179], a[176:179], v[120:123]
    v_mfma_f32_16x16x32_bf16 v[120:123], v[180:183], a[180:183], v[120:123]
    v_cvt_pk_bf16_f32 v193, v98, v99
    v_mfma_f32_16x16x32_bf16 v[120:123], v[184:187], a[184:187], v[120:123]
    v_mul_f32 v100, s41, v100
    v_mfma_f32_16x16x32_bf16 v[120:123], v[188:191], a[188:191], v[120:123]
    v_mul_f32 v101, s41, v101
    v_mfma_f32_16x16x32_bf16 v[124:127], v[176:179], a[240:243], v[124:127]
    s_add_u32 m0, m0, 1024
    s_add_u32 s40, s40, s32
    v_mul_f32 v102, s41, v102
    v_mfma_f32_16x16x32_bf16 v[124:127], v[180:183], a[244:247], v[124:127]
    buffer_load_dwordx4 v3, s[8:11], s40 offen lds
    v_mul_f32 v103, s41, v103
    v_mfma_f32_16x16x32_bf16 v[124:127], v[184:187], a[248:251], v[124:127]
    s_add_u32 s57, s57, 16384
    s_and_b32 s57, s57, 0x1ffff
    s_add_u32 s31, s31, 1
    s_lshr_b32 s39, s31, 2
    v_mfma_f32_16x16x32_bf16 v[124:127], v[188:191], a[252:255], v[124:127]
    s_add_u32 s30, s30, s39
    s_and_b32 s31, s31, 3
    v_cvt_pk_bf16_f32 v196, v100, v101
    s_waitcnt lgkmcnt(0)
    v_mfma_f32_16x16x32_bf16 v[128:131], v[160:163], a[48:51], v[128:131]
    ds_read_b64_tr_b16 v[176:177], v11 offset:0
    s_lshl_b32 s40, s30, 7
    s_lshl_b32 s39, s31, 2
    s_add_u32 s39, s39, s35
    v_mfma_f32_16x16x32_bf16 v[128:131], v[164:167], a[52:55], v[128:131]
    ds_read_b64_tr_b16 v[178:179], v11 offset:512
    s_lshl_b32 s39, s39, 2
    s_mul_i32 s39, s39, s32
    s_add_u32 s40, s40, s39
    v_mfma_f32_16x16x32_bf16 v[128:131], v[168:171], a[56:59], v[128:131]
    ds_read_b64_tr_b16 v[180:181], v11 offset:4096
    s_lshl_b32 s39, s35, 12
    s_add_u32 s39, s39, s57
    v_cvt_pk_bf16_f32 v197, v102, v103
    v_mfma_f32_16x16x32_bf16 v[128:131], v[172:175], a[60:63], v[128:131]
    ds_read_b64_tr_b16 v[182:183], v11 offset:4608
    v_mul_f32 v104, s41, v104
    v_mul_f32 v105, s41, v105
    v_mul_f32 v106, s41, v106
    v_mfma_f32_16x16x32_bf16 v[132:135], v[160:163], a[112:115], v[132:135]
    ds_read_b64_tr_b16 v[184:185], v11 offset:8192
    s_mov_b32 m0, s39
    s_nop 0
    v_mul_f32 v112, s41, v112
    v_mfma_f32_16x16x32_bf16 v[132:135], v[164:167], a[116:119], v[132:135]
    ds_read_b64_tr_b16 v[186:187], v11 offset:8704
    buffer_load_dwordx4 v2, s[8:11], s40 offen lds
    v_mul_f32 v107, s41, v107
    v_mul_f32 v113, s41, v113
    v_mfma_f32_16x16x32_bf16 v[132:135], v[168:171], a[120:123], v[132:135]
    ds_read_b64_tr_b16 v[188:189], v11 offset:12288
    v_cvt_pk_bf16_f32 v200, v104, v105
    v_mul_f32 v114, s41, v114
    v_mul_f32 v115, s41, v115
    v_mfma_f32_16x16x32_bf16 v[132:135], v[172:175], a[124:127], v[132:135]
    ds_read_b64_tr_b16 v[190:191], v11 offset:12800
    v_cvt_pk_bf16_f32 v201, v106, v107
    v_cvt_pk_bf16_f32 v194, v112, v113
    v_mfma_f32_16x16x32_bf16 v[136:139], v[160:163], a[176:179], v[136:139]
    v_mul_f32 v108, s41, v108
    v_mfma_f32_16x16x32_bf16 v[136:139], v[164:167], a[180:183], v[136:139]
    v_mul_f32 v109, s41, v109
    v_cvt_pk_bf16_f32 v195, v114, v115
    v_mfma_f32_16x16x32_bf16 v[136:139], v[168:171], a[184:187], v[136:139]
    v_mul_f32 v116, s41, v116
    v_mfma_f32_16x16x32_bf16 v[136:139], v[172:175], a[188:191], v[136:139]
    v_mul_f32 v110, s41, v110
    v_mul_f32 v117, s41, v117
    v_mfma_f32_16x16x32_bf16 v[140:143], v[160:163], a[240:243], v[140:143]
    s_add_u32 m0, m0, 1024
    s_add_u32 s40, s40, s32
    v_mul_f32 v111, s41, v111
    v_mul_f32 v118, s41, v118
    v_mfma_f32_16x16x32_bf16 v[140:143], v[164:167], a[244:247], v[140:143]
    buffer_load_dwordx4 v3, s[8:11], s40 offen lds
    v_cvt_pk_bf16_f32 v204, v108, v109
    v_mul_f32 v119, s41, v119
    v_mfma_f32_16x16x32_bf16 v[140:143], v[168:171], a[248:251], v[140:143]
    v_cvt_pk_bf16_f32 v205, v110, v111
    v_mfma_f32_16x16x32_bf16 v[140:143], v[172:175], a[252:255], v[140:143]
    v_cvt_pk_bf16_f32 v198, v116, v117
    s_waitcnt vmcnt(27)
    s_barrier
    s_waitcnt lgkmcnt(0)
    v_mfma_f32_16x16x32_bf16 v[144:147], v[176:179], a[48:51], v[144:147]
    ds_read_b64_tr_b16 v[160:161], v12 offset:0
    v_cvt_pk_bf16_f32 v199, v118, v119
    v_mfma_f32_16x16x32_bf16 v[144:147], v[180:183], a[52:55], v[144:147]
    ds_read_b64_tr_b16 v[162:163], v12 offset:512
    v_mul_f32 v120, s41, v120
    v_mfma_f32_16x16x32_bf16 v[144:147], v[184:187], a[56:59], v[144:147]
    ds_read_b64_tr_b16 v[164:165], v12 offset:4096
    v_mul_f32 v121, s41, v121
    v_mfma_f32_16x16x32_bf16 v[144:147], v[188:191], a[60:63], v[144:147]
    ds_read_b64_tr_b16 v[166:167], v12 offset:4608
    v_mul_f32 v122, s41, v122
    v_mul_f32 v128, s41, v128
    v_mul_f32 v129, s41, v129
    v_mfma_f32_16x16x32_bf16 v[148:151], v[176:179], a[112:115], v[148:151]
    ds_read_b64_tr_b16 v[168:169], v12 offset:8192
    s_add_u32 m0, m0, 1024
    s_add_u32 s40, s40, s32
    v_mul_f32 v130, s41, v130
    v_mfma_f32_16x16x32_bf16 v[148:151], v[180:183], a[116:119], v[148:151]
    ds_read_b64_tr_b16 v[170:171], v12 offset:8704
    buffer_load_dwordx4 v2, s[8:11], s40 offen lds
    v_mul_f32 v123, s41, v123
    v_mul_f32 v131, s41, v131
    v_mfma_f32_16x16x32_bf16 v[148:151], v[184:187], a[120:123], v[148:151]
    ds_read_b64_tr_b16 v[172:173], v12 offset:12288
    v_cvt_pk_bf16_f32 v202, v120, v121
    v_cvt_pk_bf16_f32 v208, v128, v129
    v_cvt_pk_bf16_f32 v209, v130, v131
    v_mfma_f32_16x16x32_bf16 v[148:151], v[188:191], a[124:127], v[148:151]
    ds_read_b64_tr_b16 v[174:175], v12 offset:12800
    v_cvt_pk_bf16_f32 v203, v122, v123
    v_mul_f32 v132, s41, v132
    v_mul_f32 v133, s41, v133
    v_mfma_f32_16x16x32_bf16 v[152:155], v[176:179], a[176:179], v[152:155]
    v_mul_f32 v124, s41, v124
    v_mul_f32 v134, s41, v134
    v_mul_f32 v135, s41, v135
    v_cvt_pk_bf16_f32 v212, v132, v133
    v_mfma_f32_16x16x32_bf16 v[152:155], v[180:183], a[180:183], v[152:155]
    v_mul_f32 v125, s41, v125
    v_cvt_pk_bf16_f32 v213, v134, v135
    v_mul_f32 v136, s41, v136
    s_add_u32 s56, s56, 16384
    v_mfma_f32_16x16x32_bf16 v[152:155], v[184:187], a[184:187], v[152:155]
    v_mul_f32 v137, s41, v137
    v_mul_f32 v138, s41, v138
    s_and_b32 s56, s56, 0x1ffff
    v_mov_b32 v8, v12
    v_mfma_f32_16x16x32_bf16 v[152:155], v[188:191], a[188:191], v[152:155]
    v_mul_f32 v126, s41, v126
    v_mul_f32 v139, s41, v139
    v_cvt_pk_bf16_f32 v216, v136, v137
    v_mov_b32 v9, v13
    v_mfma_f32_16x16x32_bf16 v[156:159], v[176:179], a[240:243], v[156:159]
    s_add_u32 m0, m0, 1024
    s_add_u32 s40, s40, s32
    v_mul_f32 v127, s41, v127
    v_cvt_pk_bf16_f32 v217, v138, v139
    v_mfma_f32_16x16x32_bf16 v[156:159], v[180:183], a[244:247], v[156:159]
    buffer_load_dwordx4 v3, s[8:11], s40 offen lds
    v_cvt_pk_bf16_f32 v206, v124, v125
    v_mul_f32 v140, s41, v140
    v_mul_f32 v141, s41, v141
    v_mfma_f32_16x16x32_bf16 v[156:159], v[184:187], a[248:251], v[156:159]
    s_add_u32 s57, s57, 16384
    s_and_b32 s57, s57, 0x1ffff
    s_add_u32 s31, s31, 1
    s_lshr_b32 s39, s31, 2
    v_mfma_f32_16x16x32_bf16 v[156:159], v[188:191], a[252:255], v[156:159]
    s_add_u32 s30, s30, s39
    s_and_b32 s31, s31, 3
    v_cvt_pk_bf16_f32 v207, v126, v127
    v_mul_f32 v142, s41, v142
    v_mul_f32 v143, s41, v143
    v_cvt_pk_bf16_f32 v220, v140, v141
    v_cvt_pk_bf16_f32 v221, v142, v143
    v_mov_b32 v10, v14
    v_mov_b32 v11, v15
    v_add_u32 v12, s56, v4
    v_add_u32 v13, s56, v5
    v_add_u32 v14, s56, v6
    v_add_u32 v15, s56, v7
    s_add_u32 s29, s29, 1
    s_cmp_lt_u32 s29, s44
    s_waitcnt vmcnt(13)
    s_cmp_ge_u32 s29, s44
    s_cbranch_scc1 p1_kernel_segq_skip
p1_kernel_segq_loop:
    s_waitcnt vmcnt(16)
    s_barrier
    s_waitcnt lgkmcnt(0)
    v_mfma_f32_16x16x32_bf16 v[96:99], v[160:163], a[0:3], 0
    ds_read_b64_tr_b16 v[176:177], v9 offset:0
    s_mov_b32 s34, s33
    v_mfma_f32_16x16x32_bf16 v[96:99], v[164:167], a[4:7], v[96:99]
    ds_read_b64_tr_b16 v[178:179], v9 offset:512
    s_mov_b32 s59, s58
    v_mfma_f32_16x16x32_bf16 v[96:99], v[168:171], a[8:11], v[96:99]
    ds_read_b64_tr_b16 v[180:181], v9 offset:4096
    s_lshr_b32 s37, s29, 1
    v_mfma_f32_16x16x32_bf16 v[96:99], v[172:175], a[12:15], v[96:99]
    ds_read_b64_tr_b16 v[182:183], v9 offset:4608
    s_lshl_b32 s37, s37, 19
    v_mfma_f32_16x16x32_bf16 v[100:103], v[160:163], a[64:67], 0
    ds_read_b64_tr_b16 v[184:185], v9 offset:8192
    s_and_b32 s38, s29, 1
    v_mfma_f32_16x16x32_bf16 v[100:103], v[164:167], a[68:71], v[100:103]
    ds_read_b64_tr_b16 v[186:187], v9 offset:8704
    s_lshl_b32 s38, s38, 11
    v_mfma_f32_16x16x32_bf16 v[100:103], v[168:171], a[72:75], v[100:103]
    ds_read_b64_tr_b16 v[188:189], v9 offset:12288
    s_add_u32 s37, s37, s38
    v_mfma_f32_16x16x32_bf16 v[100:103], v[172:175], a[76:79], v[100:103]
    ds_read_b64_tr_b16 v[190:191], v9 offset:12800
    s_add_u32 s33, s37, s47
    v_mfma_f32_16x16x32_bf16 v[104:107], v[160:163], a[128:131], 0
    s_add_u32 s58, s33, 1024
    s_lshl_b32 s40, s30, 7
    v_mfma_f32_16x16x32_bf16 v[104:107], v[164:167], a[132:135], v[104:107]
    s_lshl_b32 s39, s31, 2
    s_add_u32 s39, s39, s35
    v_mfma_f32_16x16x32_bf16 v[104:107], v[168:171], a[136:139], v[104:107]
    s_lshl_b32 s39, s39, 2
    s_mul_i32 s39, s39, s32
    v_mfma_f32_16x16x32_bf16 v[104:107], v[172:175], a[140:143], v[104:107]
    s_add_u32 s40, s40, s39
    s_lshl_b32 s39, s35, 12
    v_mfma_f32_16x16x32_bf16 v[108:111], v[160:163], a[192:195], 0
    s_add_u32 s39, s39, s57
    v_mul_f32 v144, s41, v144
    v_mfma_f32_16x16x32_bf16 v[108:111], v[164:167], a[196:199], v[108:111]
    s_mov_b32 m0, s39
    s_nop 0
    v_mfma_f32_16x16x32_bf16 v[108:111], v[168:171], a[200:203], v[108:111]
    buffer_load_dwordx4 v2, s[8:11], s40 offen lds
    v_mul_f32 v145, s41, v145
    v_mfma_f32_16x16x32_bf16 v[108:111], v[172:175], a[204:207], v[108:111]
    v_mul_f32 v146, s41, v146
    v_mul_f32 v147, s41, v147
    s_waitcnt lgkmcnt(0)
    v_mfma_f32_16x16x32_bf16 v[112:115], v[176:179], a[0:3], 0
    ds_read_b64_tr_b16 v[160:161], v10 offset:0
    v_cvt_pk_bf16_f32 v210, v144, v145
    v_mfma_f32_16x16x32_bf16 v[112:115], v[180:183], a[4:7], v[112:115]
    ds_read_b64_tr_b16 v[162:163], v10 offset:512
    v_cvt_pk_bf16_f32 v211, v146, v147
    v_mfma_f32_16x16x32_bf16 v[112:115], v[184:187], a[8:11], v[112:115]
    ds_read_b64_tr_b16 v[164:165], v10 offset:4096
    v_mul_f32 v148, s41, v148
    v_mfma_f32_16x16x32_bf16 v[112:115], v[188:191], a[12:15], v[112:115]
    ds_read_b64_tr_b16 v[166:167], v10 offset:4608
    v_mul_f32 v149, s41, v149
    v_mfma_f32_16x16x32_bf16 v[116:119], v[176:179], a[64:67], 0
    ds_read_b64_tr_b16 v[168:169], v10 offset:8192
    v_mul_f32 v150, s41, v150
    v_mfma_f32_16x16x32_bf16 v[116:119], v[180:183], a[68:71], v[116:119]
    ds_read_b64_tr_b16 v[170:171], v10 offset:8704
    v_mul_f32 v151, s41, v151
    v_mfma_f32_16x16x32_bf16 v[116:119], v[184:187], a[72:75], v[116:119]
    ds_read_b64_tr_b16 v[172:173], v10 offset:12288
    v_cvt_pk_bf16_f32 v214, v148, v149
    v_mfma_f32_16x16x32_bf16 v[116:119], v[188:191], a[76:79], v[116:119]
    ds_read_b64_tr_b16 v[174:175], v10 offset:12800
    v_cvt_pk_bf16_f32 v215, v150, v151
    v_mfma_f32_16x16x32_bf16 v[120:123], v[176:179], a[128:131], 0
    buffer_store_dwordx4 v[192:195], v16, s[4:7], s34 offen offset:0 sc1
    v_mul_f32 v152, s41, v152
    v_mfma_f32_16x16x32_bf16 v[120:123], v[180:183], a[132:135], v[120:123]
    v_mfma_f32_16x16x32_bf16 v[120:123], v[184:187], a[136:139], v[120:123]
    s_add_u32 m0, m0, 1024
    s_add_u32 s40, s40, s32
    v_mfma_f32_16x16x32_bf16 v[120:123], v[188:191], a[140:143], v[120:123]
    buffer_load_dwordx4 v3, s[8:11], s40 offen lds
    v_mul_f32 v153, s41, v153
    v_mfma_f32_16x16x32_bf16 v[124:127], v[176:179], a[192:195], 0
    v_mul_f32 v154, s41, v154
    v_mfma_f32_16x16x32_bf16 v[124:127], v[180:183], a[196:199], v[124:127]
    v_mul_f32 v155, s41, v155
    v_mfma_f32_16x16x32_bf16 v[124:127], v[184:187], a[200:203], v[124:127]
    v_mfma_f32_16x16x32_bf16 v[124:127], v[188:191], a[204:207], v[124:127]
    v_cvt_pk_bf16_f32 v218, v152, v153
    s_waitcnt lgkmcnt(0)
    v_mfma_f32_16x16x32_bf16 v[128:131], v[160:163], a[0:3], 0
    ds_read_b64_tr_b16 v[176:177], v11 offset:0
    v_mfma_f32_16x16x32_bf16 v[128:131], v[164:167], a[4:7], v[128:131]
    ds_read_b64_tr_b16 v[178:179], v11 offset:512
    v_cvt_pk_bf16_f32 v219, v154, v155
    v_mfma_f32_16x16x32_bf16 v[128:131], v[168:171], a[8:11], v[128:131]
    ds_read_b64_tr_b16 v[180:181], v11 offset:4096
    v_mfma_f32_16x16x32_bf16 v[128:131], v[172:175], a[12:15], v[128:131]
    ds_read_b64_tr_b16 v[182:183], v11 offset:4608
    v_mul_f32 v156, s41, v156
    v_mfma_f32_16x16x32_bf16 v[132:135], v[160:163], a[64:67], 0
    ds_read_b64_tr_b16 v[184:185], v11 offset:8192
    v_mfma_f32_16x16x32_bf16 v[132:135], v[164:167], a[68:71], v[132:135]
    ds_read_b64_tr_b16 v[186:187], v11 offset:8704
    v_mul_f32 v157, s41, v157
    v_mfma_f32_16x16x32_bf16 v[132:135], v[168:171], a[72:75], v[132:135]
    ds_read_b64_tr_b16 v[188:189], v11 offset:12288
    v_mul_f32 v158, s41, v158
    v_mfma_f32_16x16x32_bf16 v[132:135], v[172:175], a[76:79], v[132:135]
    ds_read_b64_tr_b16 v[190:191], v11 offset:12800
    v_mfma_f32_16x16x32_bf16 v[136:139], v[160:163], a[128:131], 0
    v_mul_f32 v159, s41, v159
    v_mfma_f32_16x16x32_bf16 v[136:139], v[164:167], a[132:135], v[136:139]
    buffer_store_dwordx4 v[196:199], v17, s[4:7], s34 offen offset:0 sc1
    v_mfma_f32_16x16x32_bf16 v[136:139], v[168:171], a[136:139], v[136:139]
    s_add_u32 m0, m0, 1024
    s_add_u32 s40, s40, s32
    v_mfma_f32_16x16x32_bf16 v[136:139], v[172:175], a[140:143], v[136:139]
    buffer_load_dwordx4 v2, s[8:11], s40 offen lds
    v_cvt_pk_bf16_f32 v222, v156, v157
    v_mfma_f32_16x16x32_bf16 v[140:143], v[160:163], a[192:195], 0
    v_cvt_pk_bf16_f32 v223, v158, v159
    v_mfma_f32_16x16x32_bf16 v[140:143], v[164:167], a[196:199], v[140:143]
    v_mfma_f32_16x16x32_bf16 v[140:143], v[168:171], a[200:203], v[140:143]
    v_mfma_f32_16x16x32_bf16 v[140:143], v[172:175], a[204:207], v[140:143]
    s_waitcnt lgkmcnt(0)
    v_mfma_f32_16x16x32_bf16 v[144:147], v[176:179], a[0:3], 0
    ds_read_b64_tr_b16 v[160:161], v12 offset:0
    v_mfma_f32_16x16x32_bf16 v[144:147], v[180:183], a[4:7], v[144:147]
    ds_read_b64_tr_b16 v[162:163], v12 offset:512
    v_mfma_f32_16x16x32_bf16 v[144:147], v[184:187], a[8:11], v[144:147]
    ds_read_b64_tr_b16 v[164:165], v12 offset:4096
    v_mfma_f32_16x16x32_bf16 v[144:147], v[188:191], a[12:15], v[144:147]
    ds_read_b64_tr_b16 v[166:167], v12 offset:4608
    v_mfma_f32_16x16x32_bf16 v[148:151], v[176:179], a[64:67], 0
    ds_read_b64_tr_b16 v[168:169], v12 offset:8192
    v_mfma_f32_16x16x32_bf16 v[148:151], v[180:183], a[68:71], v[148:151]
    ds_read_b64_tr_b16 v[170:171], v12 offset:8704
    v_mfma_f32_16x16x32_bf16 v[148:151], v[184:187], a[72:75], v[148:151]
    ds_read_b64_tr_b16 v[172:173], v12 offset:12288
    v_mfma_f32_16x16x32_bf16 v[148:151], v[188:191], a[76:79], v[148:151]
    ds_read_b64_tr_b16 v[174:175], v12 offset:12800
    v_mfma_f32_16x16x32_bf16 v[152:155], v[176:179], a[128:131], 0
    s_add_u32 s56, s56, 16384
    s_and_b32 s56, s56, 0x1ffff
    v_mfma_f32_16x16x32_bf16 v[152:155], v[180:183], a[132:135], v[152:155]
    v_mov_b32 v8, v12
    v_mov_b32 v9, v13
    v_mfma_f32_16x16x32_bf16 v[152:155], v[184:187], a[136:139], v[152:155]
    s_add_u32 m0, m0, 1024
    s_add_u32 s40, s40, s32
    v_mfma_f32_16x16x32_bf16 v[152:155], v[188:191], a[140:143], v[152:155]
    buffer_load_dwordx4 v3, s[8:11], s40 offen lds
    v_mov_b32 v10, v14
    v_mfma_f32_16x16x32_bf16 v[156:159], v[176:179], a[192:195], 0
    s_add_u32 s57, s57, 16384
    s_and_b32 s57, s57, 0x1ffff
    v_mfma_f32_16x16x32_bf16 v[156:159], v[180:183], a[196:199], v[156:159]
    s_add_u32 s31, s31, 1
    s_lshr_b32 s39, s31, 2
    v_mfma_f32_16x16x32_bf16 v[156:159], v[184:187], a[200:203], v[156:159]
    s_add_u32 s30, s30, s39
    s_and_b32 s31, s31, 3
    v_mfma_f32_16x16x32_bf16 v[156:159], v[188:191], a[204:207], v[156:159]
    v_mov_b32 v11, v15
    v_add_u32 v12, s56, v4
    v_add_u32 v13, s56, v5
    v_add_u32 v14, s56, v6
    v_add_u32 v15, s56, v7
    s_waitcnt lgkmcnt(0)
    v_mfma_f32_16x16x32_bf16 v[96:99], v[160:163], a[16:19], v[96:99]
    ds_read_b64_tr_b16 v[176:177], v9 offset:0
    s_lshl_b32 s40, s30, 7
    v_mfma_f32_16x16x32_bf16 v[96:99], v[164:167], a[20:23], v[96:99]
    ds_read_b64_tr_b16 v[178:179], v9 offset:512
    s_lshl_b32 s39, s31, 2
    v_mfma_f32_16x16x32_bf16 v[96:99], v[168:171], a[24:27], v[96:99]
    ds_read_b64_tr_b16 v[180:181], v9 offset:4096
    s_add_u32 s39, s39, s35
    v_mfma_f32_16x16x32_bf16 v[96:99], v[172:175], a[28:31], v[96:99]
    ds_read_b64_tr_b16 v[182:183], v9 offset:4608
    s_lshl_b32 s39, s39, 2
    v_mfma_f32_16x16x32_bf16 v[100:103], v[160:163], a[80:83], v[100:103]
    ds_read_b64_tr_b16 v[184:185], v9 offset:8192
    s_mul_i32 s39, s39, s32
    v_mfma_f32_16x16x32_bf16 v[100:103], v[164:167], a[84:87], v[100:103]
    ds_read_b64_tr_b16 v[186:187], v9 offset:8704
    s_add_u32 s40, s40, s39
    v_mfma_f32_16x16x32_bf16 v[100:103], v[168:171], a[88:91], v[100:103]
    ds_read_b64_tr_b16 v[188:189], v9 offset:12288
    s_lshl_b32 s39, s35, 12
    v_mfma_f32_16x16x32_bf16 v[100:103], v[172:175], a[92:95], v[100:103]
    ds_read_b64_tr_b16 v[190:191], v9 offset:12800
    s_add_u32 s39, s39, s57
    v_mfma_f32_16x16x32_bf16 v[104:107], v[160:163], a[144:147], v[104:107]
    buffer_store_dwordx4 v[200:203], v18, s[4:7], s34 offen offset:0 sc1
    v_mfma_f32_16x16x32_bf16 v[104:107], v[164:167], a[148:151], v[104:107]
    v_mfma_f32_16x16x32_bf16 v[104:107], v[168:171], a[152:155], v[104:107]
    s_mov_b32 m0, s39
    s_nop 0
    v_mfma_f32_16x16x32_bf16 v[104:107], v[172:175], a[156:159], v[104:107]
    buffer_load_dwordx4 v2, s[8:11], s40 offen lds
    v_mfma_f32_16x16x32_bf16 v[108:111], v[160:163], a[208:211], v[108:111]
    v_mfma_f32_16x16x32_bf16 v[108:111], v[164:167], a[212:215], v[108:111]
    v_mfma_f32_16x16x32_bf16 v[108:111], v[168:171], a[216:219], v[108:111]
    v_mfma_f32_16x16x32_bf16 v[108:111], v[172:175], a[220:223], v[108:111]
    s_waitcnt lgkmcnt(0)
    v_mfma_f32_16x16x32_bf16 v[112:115], v[176:179], a[16:19], v[112:115]
    ds_read_b64_tr_b16 v[160:161], v10 offset:0
    v_mfma_f32_16x16x32_bf16 v[112:115], v[180:183], a[20:23], v[112:115]
    ds_read_b64_tr_b16 v[162:163], v10 offset:512
    v_mfma_f32_16x16x32_bf16 v[112:115], v[184:187], a[24:27], v[112:115]
    ds_read_b64_tr_b16 v[164:165], v10 offset:4096
    v_mfma_f32_16x16x32_bf16 v[112:115], v[188:191], a[28:31], v[112:115]
    ds_read_b64_tr_b16 v[166:167], v10 offset:4608
    v_mfma_f32_16x16x32_bf16 v[116:119], v[176:179], a[80:83], v[116:119]
    ds_read_b64_tr_b16 v[168:169], v10 offset:8192
    v_mfma_f32_16x16x32_bf16 v[116:119], v[180:183], a[84:87], v[116:119]
    ds_read_b64_tr_b16 v[170:171], v10 offset:8704
    v_mfma_f32_16x16x32_bf16 v[116:119], v[184:187], a[88:91], v[116:119]
    ds_read_b64_tr_b16 v[172:173], v10 offset:12288
    v_mfma_f32_16x16x32_bf16 v[116:119], v[188:191], a[92:95], v[116:119]
    ds_read_b64_tr_b16 v[174:175], v10 offset:12800
    buffer_store_dwordx4 v[204:207], v19, s[4:7], s34 offen offset:0 sc1
    v_mfma_f32_16x16x32_bf16 v[120:123], v[176:179], a[144:147], v[120:123]
    v_mfma_f32_16x16x32_bf16 v[120:123], v[180:183], a[148:151], v[120:123]
    v_mfma_f32_16x16x32_bf16 v[120:123], v[184:187], a[152:155], v[120:123]
    s_add_u32 m0, m0, 1024
    s_add_u32 s40, s40, s32
    v_mfma_f32_16x16x32_bf16 v[120:123], v[188:191], a[156:159], v[120:123]
    buffer_load_dwordx4 v3, s[8:11], s40 offen lds
    v_mfma_f32_16x16x32_bf16 v[124:127], v[176:179], a[208:211], v[124:127]
    v_mfma_f32_16x16x32_bf16 v[124:127], v[180:183], a[212:215], v[124:127]
    v_mfma_f32_16x16x32_bf16 v[124:127], v[184:187], a[216:219], v[124:127]
    v_mfma_f32_16x16x32_bf16 v[124:127], v[188:191], a[220:223], v[124:127]
    s_waitcnt lgkmcnt(0)
    v_mfma_f32_16x16x32_bf16 v[128:131], v[160:163], a[16:19], v[128:131]
    ds_read_b64_tr_b16 v[176:177], v11 offset:0
    v_mfma_f32_16x16x32_bf16 v[128:131], v[164:167], a[20:23], v[128:131]
    ds_read_b64_tr_b16 v[178:179], v11 offset:512
    v_mfma_f32_16x16x32_bf16 v[128:131], v[168:171], a[24:27], v[128:131]
    ds_read_b64_tr_b16 v[180:181], v11 offset:4096
    v_mfma_f32_16x16x32_bf16 v[128:131], v[172:175], a[28:31], v[128:131]
    ds_read_b64_tr_b16 v[182:183], v11 offset:4608
    v_mfma_f32_16x16x32_bf16 v[132:135], v[160:163], a[80:83], v[132:135]
    ds_read_b64_tr_b16 v[184:185], v11 offset:8192
    v_mfma_f32_16x16x32_bf16 v[132:135], v[164:167], a[84:87], v[132:135]
    ds_read_b64_tr_b16 v[186:187], v11 offset:8704
    v_mfma_f32_16x16x32_bf16 v[132:135], v[168:171], a[88:91], v[132:135]
    ds_read_b64_tr_b16 v[188:189], v11 offset:12288
    v_mfma_f32_16x16x32_bf16 v[132:135], v[172:175], a[92:95], v[132:135]
    ds_read_b64_tr_b16 v[190:191], v11 offset:12800
    v_mfma_f32_16x16x32_bf16 v[136:139], v[160:163], a[144:147], v[136:139]
    buffer_store_dwordx4 v[208:211], v16, s[4:7], s59 offen offset:0 sc1
    v_mfma_f32_16x16x32_bf16 v[136:139], v[164:167], a[148:151], v[136:139]
    v_mfma_f32_16x16x32_bf16 v[136:139], v[168:171], a[152:155], v[136:139]
    s_add_u32 m0, m0, 1024
    s_add_u32 s40, s40, s32
    v_mfma_f32_16x16x32_bf16 v[136:139], v[172:175], a[156:159], v[136:139]
    buffer_load_dwordx4 v2, s[8:11], s40 offen lds
    v_mfma_f32_16x16x32_bf16 v[140:143], v[160:163], a[208:211], v[140:143]
    v_mfma_f32_16x16x32_bf16 v[140:143], v[164:167], a[212:215], v[140:143]
    v_mfma_f32_16x16x32_bf16 v[140:143], v[168:171], a[216:219], v[140:143]
    v_mfma_f32_16x16x32_bf16 v[140:143], v[172:175], a[220:223], v[140:143]
    s_waitcnt lgkmcnt(0)
    v_mfma_f32_16x16x32_bf16 v[144:147], v[176:179], a[16:19], v[144:147]
    ds_read_b64_tr_b16 v[160:161], v12 offset:0
    v_mfma_f32_16x16x32_bf16 v[144:147], v[180:183], a[20:23], v[144:147]
    ds_read_b64_tr_b16 v[162:163], v12 offset:512
    v_mfma_f32_16x16x32_bf16 v[144:147], v[184:187], a[24:27], v[144:147]
    ds_read_b64_tr_b16 v[164:165], v12 offset:4096
    v_mfma_f32_16x16x32_bf16 v[144:147], v[188:191], a[28:31], v[144:147]
    ds_read_b64_tr_b16 v[166:167], v12 offset:4608
    v_mfma_f32_16x16x32_bf16 v[148:151], v[176:179], a[80:83], v[148:151]
    ds_read_b64_tr_b16 v[168:169], v12 offset:8192
    v_mfma_f32_16x16x32_bf16 v[148:151], v[180:183], a[84:87], v[148:151]
    ds_read_b64_tr_b16 v[170:171], v12 offset:8704
    v_mfma_f32_16x16x32_bf16 v[148:151], v[184:187], a[88:91], v[148:151]
    ds_read_b64_tr_b16 v[172:173], v12 offset:12288
    v_mfma_f32_16x16x32_bf16 v[148:151], v[188:191], a[92:95], v[148:151]
    ds_read_b64_tr_b16 v[174:175], v12 offset:12800
    v_mfma_f32_16x16x32_bf16 v[152:155], v[176:179], a[144:147], v[152:155]
    s_add_u32 s56, s56, 16384
    s_and_b32 s56, s56, 0x1ffff
    v_mfma_f32_16x16x32_bf16 v[152:155], v[180:183], a[148:151], v[152:155]
    v_mov_b32 v8, v12
    v_mov_b32 v9, v13
    v_mfma_f32_16x16x32_bf16 v[152:155], v[184:187], a[152:155], v[152:155]
    s_add_u32 m0, m0, 1024
    s_add_u32 s40, s40, s32
    v_mfma_f32_16x16x32_bf16 v[152:155], v[188:191], a[156:159], v[152:155]
    buffer_load_dwordx4 v3, s[8:11], s40 offen lds
    v_mov_b32 v10, v14
    v_mfma_f32_16x16x32_bf16 v[156:159], v[176:179], a[208:211], v[156:159]
    s_add_u32 s57, s57, 16384
    s_and_b32 s57, s57, 0x1ffff
    v_mfma_f32_16x16x32_bf16 v[156:159], v[180:183], a[212:215], v[156:159]
    s_add_u32 s31, s31, 1
    s_lshr_b32 s39, s31, 2
    v_mfma_f32_16x16x32_bf16 v[156:159], v[184:187], a[216:219], v[156:159]
    s_add_u32 s30, s30, s39
    s_and_b32 s31, s31, 3
    v_mfma_f32_16x16x32_bf16 v[156:159], v[188:191], a[220:223], v[156:159]
    v_mov_b32 v11, v15
    v_add_u32 v12, s56, v4
    v_add_u32 v13, s56, v5
    v_add_u32 v14, s56, v6
    v_add_u32 v15, s56, v7
    s_waitcnt vmcnt(14)
    s_barrier
    s_waitcnt lgkmcnt(0)
    v_mfma_f32_16x16x32_bf16 v[96:99], v[160:163], a[32:35], v[96:99]
    ds_read_b64_tr_b16 v[176:177], v9 offset:0
    s_lshl_b32 s40, s30, 7
    v_mfma_f32_16x16x32_bf16 v[96:99], v[164:167], a[36:39], v[96:99]
    ds_read_b64_tr_b16 v[178:179], v9 offset:512
    s_lshl_b32 s39, s31, 2
    v_mfma_f32_16x16x32_bf16 v[96:99], v[168:171], a[40:43], v[96:99]
    ds_read_b64_tr_b16 v[180:181], v9 offset:4096
    s_add_u32 s39, s39, s35
    v_mfma_f32_16x16x32_bf16 v[96:99], v[172:175], a[44:47], v[96:99]
    ds_read_b64_tr_b16 v[182:183], v9 offset:4608
    s_lshl_b32 s39, s39, 2
    v_mfma_f32_16x16x32_bf16 v[100:103], v[160:163], a[96:99], v[100:103]
    ds_read_b64_tr_b16 v[184:185], v9 offset:8192
    s_mul_i32 s39, s39, s32
    v_mfma_f32_16x16x32_bf16 v[100:103], v[164:167], a[100:103], v[100:103]
    ds_read_b64_tr_b16 v[186:187], v9 offset:8704
    s_add_u32 s40, s40, s39
    v_mfma_f32_16x16x32_bf16 v[100:103], v[168:171], a[104:107], v[100:103]
    ds_read_b64_tr_b16 v[188:189], v9 offset:12288
    s_lshl_b32 s39, s35, 12
    v_mfma_f32_16x16x32_bf16 v[100:103], v[172:175], a[108:111], v[100:103]
    ds_read_b64_tr_b16 v[190:191], v9 offset:12800
    s_add_u32 s39, s39, s57
    v_mfma_f32_16x16x32_bf16 v[104:107], v[160:163], a[160:163], v[104:107]
    buffer_store_dwordx4 v[212:215], v17, s[4:7], s59 offen offset:0 sc1
    v_mfma_f32_16x16x32_bf16 v[104:107], v[164:167], a[164:167], v[104:107]
    v_mfma_f32_16x16x32_bf16 v[104:107], v[168:171], a[168:171], v[104:107]
    s_mov_b32 m0, s39
    s_nop 0
    v_mfma_f32_16x16x32_bf16 v[104:107], v[172:175], a[172:175], v[104:107]
    buffer_load_dwordx4 v2, s[8:11], s40 offen lds
    v_mfma_f32_16x16x32_bf16 v[108:111], v[160:163], a[224:227], v[108:111]
    v_mfma_f32_16x16x32_bf16 v[108:111], v[164:167], a[228:231], v[108:111]
    v_mfma_f32_16x16x32_bf16 v[108:111], v[168:171], a[232:235], v[108:111]
    v_mfma_f32_16x16x32_bf16 v[108:111], v[172:175], a[236:239], v[108:111]
    s_waitcnt lgkmcnt(0)
    v_mfma_f32_16x16x32_bf16 v[112:115], v[176:179], a[32:35], v[112:115]
    ds_read_b64_tr_b16 v[160:161], v10 offset:0
    v_mfma_f32_16x16x32_bf16 v[112:115], v[180:183], a[36:39], v[112:115]
    ds_read_b64_tr_b16 v[162:163], v10 offset:512
    v_mfma_f32_16x16x32_bf16 v[112:115], v[184:187], a[40:43], v[112:115]
    ds_read_b64_tr_b16 v[164:165], v10 offset:4096
    v_mfma_f32_16x16x32_bf16 v[112:115], v[188:191], a[44:47], v[112:115]
    ds_read_b64_tr_b16 v[166:167], v10 offset:4608
    v_mfma_f32_16x16x32_bf16 v[116:119], v[176:179], a[96:99], v[116:119]
    ds_read_b64_tr_b16 v[168:169], v10 offset:8192
    v_mfma_f32_16x16x32_bf16 v[116:119], v[180:183], a[100:103], v[116:119]
    ds_read_b64_tr_b16 v[170:171], v10 offset:8704
    v_mfma_f32_16x16x32_bf16 v[116:119], v[184:187], a[104:107], v[116:119]
    ds_read_b64_tr_b16 v[172:173], v10 offset:12288
    v_mfma_f32_16x16x32_bf16 v[116:119], v[188:191], a[108:111], v[116:119]
    ds_read_b64_tr_b16 v[174:175], v10 offset:12800
    buffer_store_dwordx4 v[216:219], v18, s[4:7], s59 offen offset:0 sc1
    v_mfma_f32_16x16x32_bf16 v[120:123], v[176:179], a[160:163], v[120:123]
    v_mfma_f32_16x16x32_bf16 v[120:123], v[180:183], a[164:167], v[120:123]
    v_mfma_f32_16x16x32_bf16 v[120:123], v[184:187], a[168:171], v[120:123]
    s_add_u32 m0, m0, 1024
    s_add_u32 s40, s40, s32
    v_mfma_f32_16x16x32_bf16 v[120:123], v[188:191], a[172:175], v[120:123]
    buffer_load_dwordx4 v3, s[8:11], s40 offen lds
    v_mfma_f32_16x16x32_bf16 v[124:127], v[176:179], a[224:227], v[124:127]
    v_mfma_f32_16x16x32_bf16 v[124:127], v[180:183], a[228:231], v[124:127]
    v_mfma_f32_16x16x32_bf16 v[124:127], v[184:187], a[232:235], v[124:127]
    v_mfma_f32_16x16x32_bf16 v[124:127], v[188:191], a[236:239], v[124:127]
    s_waitcnt lgkmcnt(0)
    v_mfma_f32_16x16x32_bf16 v[128:131], v[160:163], a[32:35], v[128:131]
    ds_read_b64_tr_b16 v[176:177], v11 offset:0
    v_mfma_f32_16x16x32_bf16 v[128:131], v[164:167], a[36:39], v[128:131]
    ds_read_b64_tr_b16 v[178:179], v11 offset:512
    v_mfma_f32_16x16x32_bf16 v[128:131], v[168:171], a[40:43], v[128:131]
    ds_read_b64_tr_b16 v[180:181], v11 offset:4096
    v_mfma_f32_16x16x32_bf16 v[128:131], v[172:175], a[44:47], v[128:131]
    ds_read_b64_tr_b16 v[182:183], v11 offset:4608
    v_mfma_f32_16x16x32_bf16 v[132:135], v[160:163], a[96:99], v[132:135]
    ds_read_b64_tr_b16 v[184:185], v11 offset:8192
    v_mfma_f32_16x16x32_bf16 v[132:135], v[164:167], a[100:103], v[132:135]
    ds_read_b64_tr_b16 v[186:187], v11 offset:8704
    v_mfma_f32_16x16x32_bf16 v[132:135], v[168:171], a[104:107], v[132:135]
    ds_read_b64_tr_b16 v[188:189], v11 offset:12288
    v_mfma_f32_16x16x32_bf16 v[132:135], v[172:175], a[108:111], v[132:135]
    ds_read_b64_tr_b16 v[190:191], v11 offset:12800
    v_mfma_f32_16x16x32_bf16 v[136:139], v[160:163], a[160:163], v[136:139]
    buffer_store_dwordx4 v[220:223], v19, s[4:7], s59 offen offset:0 sc1
    v_mfma_f32_16x16x32_bf16 v[136:139], v[164:167], a[164:167], v[136:139]
    v_mfma_f32_16x16x32_bf16 v[136:139], v[168:171], a[168:171], v[136:139]
    s_add_u32 m0, m0, 1024
    s_add_u32 s40, s40, s32
    v_mfma_f32_16x16x32_bf16 v[136:139], v[172:175], a[172:175], v[136:139]
    buffer_load_dwordx4 v2, s[8:11], s40 offen lds
    v_mfma_f32_16x16x32_bf16 v[140:143], v[160:163], a[224:227], v[140:143]
    v_mfma_f32_16x16x32_bf16 v[140:143], v[164:167], a[228:231], v[140:143]
    v_mfma_f32_16x16x32_bf16 v[140:143], v[168:171], a[232:235], v[140:143]
    v_mfma_f32_16x16x32_bf16 v[140:143], v[172:175], a[236:239], v[140:143]
    s_waitcnt lgkmcnt(0)
    v_mfma_f32_16x16x32_bf16 v[144:147], v[176:179], a[32:35], v[144:147]
    ds_read_b64_tr_b16 v[160:161], v12 offset:0
    v_mfma_f32_16x16x32_bf16 v[144:147], v[180:183], a[36:39], v[144:147]
    ds_read_b64_tr_b16 v[162:163], v12 offset:512
    v_mfma_f32_16x16x32_bf16 v[144:147], v[184:187], a[40:43], v[144:147]
    ds_read_b64_tr_b16 v[164:165], v12 offset:4096
    v_mfma_f32_16x16x32_bf16 v[144:147], v[188:191], a[44:47], v[144:147]
    ds_read_b64_tr_b16 v[166:167], v12 offset:4608
    v_mfma_f32_16x16x32_bf16 v[148:151], v[176:179], a[96:99], v[148:151]
    ds_read_b64_tr_b16 v[168:169], v12 offset:8192
    v_mfma_f32_16x16x32_bf16 v[148:151], v[180:183], a[100:103], v[148:151]
    ds_read_b64_tr_b16 v[170:171], v12 offset:8704
    v_mfma_f32_16x16x32_bf16 v[148:151], v[184:187], a[104:107], v[148:151]
    ds_read_b64_tr_b16 v[172:173], v12 offset:12288
    v_mfma_f32_16x16x32_bf16 v[148:151], v[188:191], a[108:111], v[148:151]
    ds_read_b64_tr_b16 v[174:175], v12 offset:12800
    v_mfma_f32_16x16x32_bf16 v[152:155], v[176:179], a[160:163], v[152:155]
    s_add_u32 s79, s29, 3
    s_lshl_b32 s79, s79, 7
    v_mfma_f32_16x16x32_bf16 v[152:155], v[180:183], a[164:167], v[152:155]
    buffer_load_dword v27, v22, s[8:11], s79 offen
    s_add_u32 s56, s56, 16384
    v_mfma_f32_16x16x32_bf16 v[152:155], v[184:187], a[168:171], v[152:155]
    s_add_u32 m0, m0, 1024
    s_add_u32 s40, s40, s32
    v_mfma_f32_16x16x32_bf16 v[152:155], v[188:191], a[172:175], v[152:155]
    buffer_load_dwordx4 v3, s[8:11], s40 offen lds
    s_and_b32 s56, s56, 0x1ffff
    v_mfma_f32_16x16x32_bf16 v[156:159], v[176:179], a[224:227], v[156:159]
    s_add_u32 s57, s57, 16384
    s_and_b32 s57, s57, 0x1ffff
    v_mfma_f32_16x16x32_bf16 v[156:159], v[180:183], a[228:231], v[156:159]
    s_add_u32 s31, s31, 1
    s_lshr_b32 s39, s31, 2
    v_mfma_f32_16x16x32_bf16 v[156:159], v[184:187], a[232:235], v[156:159]
    s_add_u32 s30, s30, s39
    s_and_b32 s31, s31, 3
    v_mfma_f32_16x16x32_bf16 v[156:159], v[188:191], a[236:239], v[156:159]
    v_mov_b32 v8, v12
    v_mov_b32 v9, v13
    v_mov_b32 v10, v14
    v_mov_b32 v11, v15
    v_add_u32 v12, s56, v4
    v_add_u32 v13, s56, v5
    v_add_u32 v14, s56, v6
    v_add_u32 v15, s56, v7
    s_waitcnt lgkmcnt(0)
    v_mfma_f32_16x16x32_bf16 v[96:99], v[160:163], a[48:51], v[96:99]
    ds_read_b64_tr_b16 v[176:177], v9 offset:0
    s_lshl_b32 s40, s30, 7
    v_mfma_f32_16x16x32_bf16 v[96:99], v[164:167], a[52:55], v[96:99]
    ds_read_b64_tr_b16 v[178:179], v9 offset:512
    s_lshl_b32 s39, s31, 2
    v_mfma_f32_16x16x32_bf16 v[96:99], v[168:171], a[56:59], v[96:99]
    ds_read_b64_tr_b16 v[180:181], v9 offset:4096
    s_add_u32 s39, s39, s35
    v_mfma_f32_16x16x32_bf16 v[96:99], v[172:175], a[60:63], v[96:99]
    ds_read_b64_tr_b16 v[182:183], v9 offset:4608
    s_lshl_b32 s39, s39, 2
    v_mfma_f32_16x16x32_bf16 v[100:103], v[160:163], a[112:115], v[100:103]
    ds_read_b64_tr_b16 v[184:185], v9 offset:8192
    s_mul_i32 s39, s39, s32
    v_mfma_f32_16x16x32_bf16 v[100:103], v[164:167], a[116:119], v[100:103]
    ds_read_b64_tr_b16 v[186:187], v9 offset:8704
    s_add_u32 s40, s40, s39
    v_mfma_f32_16x16x32_bf16 v[100:103], v[168:171], a[120:123], v[100:103]
    ds_read_b64_tr_b16 v[188:189], v9 offset:12288
    s_lshl_b32 s39, s35, 12
    v_mfma_f32_16x16x32_bf16 v[100:103], v[172:175], a[124:127], v[100:103]
    ds_read_b64_tr_b16 v[190:191], v9 offset:12800
    s_add_u32 s39, s39, s57
    v_mfma_f32_16x16x32_bf16 v[104:107], v[160:163], a[176:179], v[104:107]
    v_mfma_f32_16x16x32_bf16 v[104:107], v[164:167], a[180:183], v[104:107]
    v_mfma_f32_16x16x32_bf16 v[104:107], v[168:171], a[184:187], v[104:107]
    s_mov_b32 m0, s39
    s_nop 0
    v_mfma_f32_16x16x32_bf16 v[104:107], v[172:175], a[188:191], v[104:107]
    buffer_load_dwordx4 v2, s[8:11], s40 offen lds
    v_mfma_f32_16x16x32_bf16 v[108:111], v[160:163], a[240:243], v[108:111]
    v_mfma_f32_16x16x32_bf16 v[108:111], v[164:167], a[244:247], v[108:111]
    v_mfma_f32_16x16x32_bf16 v[108:111], v[168:171], a[248:251], v[108:111]
    v_mfma_f32_16x16x32_bf16 v[108:111], v[172:175], a[252:255], v[108:111]
    s_waitcnt lgkmcnt(0)
    v_mfma_f32_16x16x32_bf16 v[112:115], v[176:179], a[48:51], v[112:115]
    ds_read_b64_tr_b16 v[160:161], v10 offset:0
    v_mfma_f32_16x16x32_bf16 v[112:115], v[180:183], a[52:55], v[112:115]
    ds_read_b64_tr_b16 v[162:163], v10 offset:512
    v_mfma_f32_16x16x32_bf16 v[112:115], v[184:187], a[56:59], v[112:115]
    ds_read_b64_tr_b16 v[164:165], v10 offset:4096
    v_mfma_f32_16x16x32_bf16 v[112:115], v[188:191], a[60:63], v[112:115]
    ds_read_b64_tr_b16 v[166:167], v10 offset:4608
    v_mul_f32 v96, s41, v96
    v_mfma_f32_16x16x32_bf16 v[116:119], v[176:179], a[112:115], v[116:119]
    ds_read_b64_tr_b16 v[168:169], v10 offset:8192
    v_mul_f32 v97, s41, v97
    v_mfma_f32_16x16x32_bf16 v[116:119], v[180:183], a[116:119], v[116:119]
    ds_read_b64_tr_b16 v[170:171], v10 offset:8704
    v_mul_f32 v98, s41, v98
    v_mfma_f32_16x16x32_bf16 v[116:119], v[184:187], a[120:123], v[116:119]
    ds_read_b64_tr_b16 v[172:173], v10 offset:12288
    v_mul_f32 v99, s41, v99
    v_mfma_f32_16x16x32_bf16 v[116:119], v[188:191], a[124:127], v[116:119]
    ds_read_b64_tr_b16 v[174:175], v10 offset:12800
    v_cvt_pk_bf16_f32 v192, v96, v97
    v_mfma_f32_16x16x32_bf16 v[120:123], v[176:179], a[176:179], v[120:123]
    v_mfma_f32_16x16x32_bf16 v[120:123], v[180:183], a[180:183], v[120:123]
    v_cvt_pk_bf16_f32 v193, v98, v99
    v_mfma_f32_16x16x32_bf16 v[120:123], v[184:187], a[184:187], v[120:123]
    s_add_u32 m0, m0, 1024
    s_add_u32 s40, s40, s32
    v_mfma_f32_16x16x32_bf16 v[120:123], v[188:191], a[188:191], v[120:123]
    buffer_load_dwordx4 v3, s[8:11], s40 offen lds
    v_mul_f32 v100, s41, v100
    v_mfma_f32_16x16x32_bf16 v[124:127], v[176:179], a[240:243], v[124:127]
    v_mul_f32 v101, s41, v101
    v_mul_f32 v102, s41, v102
    v_mfma_f32_16x16x32_bf16 v[124:127], v[180:183], a[244:247], v[124:127]
    v_mul_f32 v103, s41, v103
    v_mfma_f32_16x16x32_bf16 v[124:127], v[184:187], a[248:251], v[124:127]
    v_mfma_f32_16x16x32_bf16 v[124:127], v[188:191], a[252:255], v[124:127]
    v_cvt_pk_bf16_f32 v196, v100, v101
    s_waitcnt lgkmcnt(0)
    v_mfma_f32_16x16x32_bf16 v[128:131], v[160:163], a[48:51], v[128:131]
    ds_read_b64_tr_b16 v[176:177], v11 offset:0
    v_cvt_pk_bf16_f32 v197, v102, v103
    v_mfma_f32_16x16x32_bf16 v[128:131], v[164:167], a[52:55], v[128:131]
    ds_read_b64_tr_b16 v[178:179], v11 offset:512
    v_mul_f32 v104, s41, v104
    v_mfma_f32_16x16x32_bf16 v[128:131], v[168:171], a[56:59], v[128:131]
    ds_read_b64_tr_b16 v[180:181], v11 offset:4096
    v_mul_f32 v105, s41, v105
    v_mfma_f32_16x16x32_bf16 v[128:131], v[172:175], a[60:63], v[128:131]
    ds_read_b64_tr_b16 v[182:183], v11 offset:4608
    v_mul_f32 v106, s41, v106
    v_mfma_f32_16x16x32_bf16 v[132:135], v[160:163], a[112:115], v[132:135]
    ds_read_b64_tr_b16 v[184:185], v11 offset:8192
    v_mul_f32 v112, s41, v112
    v_mfma_f32_16x16x32_bf16 v[132:135], v[164:167], a[116:119], v[132:135]
    ds_read_b64_tr_b16 v[186:187], v11 offset:8704
    v_mul_f32 v107, s41, v107
    v_mfma_f32_16x16x32_bf16 v[132:135], v[168:171], a[120:123], v[132:135]
    ds_read_b64_tr_b16 v[188:189], v11 offset:12288
    v_cvt_pk_bf16_f32 v200, v104, v105
    v_mfma_f32_16x16x32_bf16 v[132:135], v[172:175], a[124:127], v[132:135]
    ds_read_b64_tr_b16 v[190:191], v11 offset:12800
    v_cvt_pk_bf16_f32 v201, v106, v107
    v_mfma_f32_16x16x32_bf16 v[136:139], v[160:163], a[176:179], v[136:139]
    v_mul_f32 v108, s41, v108
    v_mul_f32 v113, s41, v113
    v_mfma_f32_16x16x32_bf16 v[136:139], v[164:167], a[180:183], v[136:139]
    v_mul_f32 v109, s41, v109
    v_mul_f32 v114, s41, v114
    v_mfma_f32_16x16x32_bf16 v[136:139], v[168:171], a[184:187], v[136:139]
    s_add_u32 m0, m0, 1024
    s_add_u32 s40, s40, s32
    v_mfma_f32_16x16x32_bf16 v[136:139], v[172:175], a[188:191], v[136:139]
    buffer_load_dwordx4 v2, s[8:11], s40 offen lds
    v_mul_f32 v110, s41, v110
    v_mfma_f32_16x16x32_bf16 v[140:143], v[160:163], a[240:243], v[140:143]
    v_mul_f32 v111, s41, v111
    v_mul_f32 v115, s41, v115
    v_mfma_f32_16x16x32_bf16 v[140:143], v[164:167], a[244:247], v[140:143]
    v_cvt_pk_bf16_f32 v204, v108, v109
    v_cvt_pk_bf16_f32 v194, v112, v113
    v_mfma_f32_16x16x32_bf16 v[140:143], v[168:171], a[248:251], v[140:143]
    v_cvt_pk_bf16_f32 v205, v110, v111
    v_cvt_pk_bf16_f32 v195, v114, v115
    v_mfma_f32_16x16x32_bf16 v[140:143], v[172:175], a[252:255], v[140:143]
    v_mul_f32 v116, s41, v116
    v_mul_f32 v117, s41, v117
    s_waitcnt lgkmcnt(0)
    v_mfma_f32_16x16x32_bf16 v[144:147], v[176:179], a[48:51], v[144:147]
    ds_read_b64_tr_b16 v[160:161], v12 offset:0
    v_mul_f32 v118, s41, v118
    v_mfma_f32_16x16x32_bf16 v[144:147], v[180:183], a[52:55], v[144:147]
    ds_read_b64_tr_b16 v[162:163], v12 offset:512
    v_mul_f32 v119, s41, v119
    v_mfma_f32_16x16x32_bf16 v[144:147], v[184:187], a[56:59], v[144:147]
    ds_read_b64_tr_b16 v[164:165], v12 offset:4096
    v_cvt_pk_bf16_f32 v198, v116, v117
    v_mfma_f32_16x16x32_bf16 v[144:147], v[188:191], a[60:63], v[144:147]
    ds_read_b64_tr_b16 v[166:167], v12 offset:4608
    v_cvt_pk_bf16_f32 v199, v118, v119
    v_mfma_f32_16x16x32_bf16 v[148:151], v[176:179], a[112:115], v[148:151]
    ds_read_b64_tr_b16 v[168:169], v12 offset:8192
    v_mul_f32 v120, s41, v120
    v_mfma_f32_16x16x32_bf16 v[148:151], v[180:183], a[116:119], v[148:151]
    ds_read_b64_tr_b16 v[170:171], v12 offset:8704
    v_mul_f32 v121, s41, v121
    v_mfma_f32_16x16x32_bf16 v[148:151], v[184:187], a[120:123], v[148:151]
    ds_read_b64_tr_b16 v[172:173], v12 offset:12288
    v_mul_f32 v122, s41, v122
    v_mfma_f32_16x16x32_bf16 v[148:151], v[188:191], a[124:127], v[148:151]
    ds_read_b64_tr_b16 v[174:175], v12 offset:12800
    v_mul_f32 v123, s41, v123
    v_mfma_f32_16x16x32_bf16 v[152:155], v[176:179], a[176:179], v[152:155]
    v_cvt_pk_bf16_f32 v202, v120, v121
    v_cvt_pk_bf16_f32 v203, v122, v123
    v_mfma_f32_16x16x32_bf16 v[152:155], v[180:183], a[180:183], v[152:155]
    v_mul_f32 v124, s41, v124
    v_mul_f32 v125, s41, v125
    v_mfma_f32_16x16x32_bf16 v[152:155], v[184:187], a[184:187], v[152:155]
    s_add_u32 m0, m0, 1024
    s_add_u32 s40, s40, s32
    v_mfma_f32_16x16x32_bf16 v[152:155], v[188:191], a[188:191], v[152:155]
    buffer_load_dwordx4 v3, s[8:11], s40 offen lds
    v_mul_f32 v126, s41, v126
    v_mfma_f32_16x16x32_bf16 v[156:159], v[176:179], a[240:243], v[156:159]
    s_add_u32 s57, s57, 16384
    s_and_b32 s57, s57, 0x1ffff
    v_mfma_f32_16x16x32_bf16 v[156:159], v[180:183], a[244:247], v[156:159]
    s_add_u32 s31, s31, 1
    s_lshr_b32 s39, s31, 2
    v_mfma_f32_16x16x32_bf16 v[156:159], v[184:187], a[248:251], v[156:159]
    s_add_u32 s30, s30, s39
    s_and_b32 s31, s31, 3
    v_mfma_f32_16x16x32_bf16 v[156:159], v[188:191], a[252:255], v[156:159]
    v_mul_f32 v127, s41, v127
    v_cvt_pk_bf16_f32 v206, v124, v125
    v_cvt_pk_bf16_f32 v207, v126, v127
    v_mul_f32 v128, s41, v128
    v_mul_f32 v129, s41, v129
    v_mul_f32 v130, s41, v130
    v_mul_f32 v131, s41, v131
    v_cvt_pk_bf16_f32 v208, v128, v129
    v_cvt_pk_bf16_f32 v209, v130, v131
    v_mul_f32 v132, s41, v132
    v_mul_f32 v133, s41, v133
    v_mul_f32 v134, s41, v134
    v_mul_f32 v135, s41, v135
    v_cvt_pk_bf16_f32 v212, v132, v133
    v_cvt_pk_bf16_f32 v213, v134, v135
    v_mul_f32 v136, s41, v136
    v_mul_f32 v137, s41, v137
    v_mul_f32 v138, s41, v138
    v_mul_f32 v139, s41, v139
    v_cvt_pk_bf16_f32 v216, v136, v137
    v_cvt_pk_bf16_f32 v217, v138, v139
    v_mul_f32 v140, s41, v140
    v_mul_f32 v141, s41, v141
    v_mul_f32 v142, s41, v142
    v_mul_f32 v143, s41, v143
    v_cvt_pk_bf16_f32 v220, v140, v141
    v_cvt_pk_bf16_f32 v221, v142, v143
    s_add_u32 s56, s56, 16384
    s_and_b32 s56, s56, 0x1ffff
    v_mov_b32 v8, v12
    v_mov_b32 v9, v13
    v_mov_b32 v10, v14
    v_mov_b32 v11, v15
    v_add_u32 v12, s56, v4
    v_add_u32 v13, s56, v5
    v_add_u32 v14, s56, v6
    v_add_u32 v15, s56, v7
    s_add_u32 s29, s29, 1
    s_cmp_lt_u32 s29, s44
    s_cbranch_scc1 p1_kernel_segq_loop
p1_kernel_segq_skip:
    s_mov_b32 s34, s33
    s_mov_b32 s59, s58
    s_nop 7
    v_mul_f32 v144, s41, v144
    v_mul_f32 v145, s41, v145
    v_mul_f32 v146, s41, v146
    v_mul_f32 v147, s41, v147
    v_cvt_pk_bf16_f32 v210, v144, v145
    v_cvt_pk_bf16_f32 v211, v146, v147
    v_mul_f32 v148, s41, v148
    v_mul_f32 v149, s41, v149
    v_mul_f32 v150, s41, v150
    v_mul_f32 v151, s41, v151
    v_cvt_pk_bf16_f32 v214, v148, v149
    v_cvt_pk_bf16_f32 v215, v150, v151
    v_mul_f32 v152, s41, v152
    v_mul_f32 v153, s41, v153
    v_mul_f32 v154, s41, v154
    v_mul_f32 v155, s41, v155
    v_cvt_pk_bf16_f32 v218, v152, v153
    v_cvt_pk_bf16_f32 v219, v154, v155
    v_mul_f32 v156, s41, v156
    v_mul_f32 v157, s41, v157
    v_mul_f32 v158, s41, v158
    v_mul_f32 v159, s41, v159
    v_cvt_pk_bf16_f32 v222, v156, v157
    v_cvt_pk_bf16_f32 v223, v158, v159
    s_nop 1
    buffer_store_dwordx4 v[192:195], v16, s[4:7], s34 offen offset:0 sc1
    buffer_store_dwordx4 v[196:199], v17, s[4:7], s34 offen offset:0 sc1
    buffer_store_dwordx4 v[200:203], v18, s[4:7], s34 offen offset:0 sc1
    buffer_store_dwordx4 v[204:207], v19, s[4:7], s34 offen offset:0 sc1
    buffer_store_dwordx4 v[208:211], v16, s[4:7], s59 offen offset:0 sc1
    buffer_store_dwordx4 v[212:215], v17, s[4:7], s59 offen offset:0 sc1
    buffer_store_dwordx4 v[216:219], v18, s[4:7], s59 offen offset:0 sc1
    buffer_store_dwordx4 v[220:223], v19, s[4:7], s59 offen offset:0 sc1
    s_branch p1_kernel_done
p1_kernel_run_h:
    s_mul_i32 s47, s78, 175104
    s_add_u32 s47, s47, 0x3020000
    v_add_u32 v16, 0, v1
    v_add_u32 v17, 175104, v1
    v_add_u32 v18, 350208, v1
    v_add_u32 v19, 525312, v1
    s_mov_b32 s43, 0xbdd2d3e8
    v_mov_b32 v25, 0xc0135761
    s_add_u32 s42, s68, 512
    buffer_load_dwordx4 v[32:35], v28, s[12:15], s42 offen
    s_add_u32 s42, s68, 8704
    buffer_load_dwordx4 v[36:39], v28, s[12:15], s42 offen
    s_add_u32 s42, s68, 16896
    buffer_load_dwordx4 v[40:43], v28, s[12:15], s42 offen
    s_add_u32 s42, s68, 25088
    buffer_load_dwordx4 v[44:47], v28, s[12:15], s42 offen
    s_add_u32 s42, s68, 33280
    buffer_load_dwordx4 v[48:51], v28, s[12:15], s42 offen
    s_add_u32 s42, s68, 41472
    buffer_load_dwordx4 v[52:55], v28, s[12:15], s42 offen
    s_add_u32 s42, s68, 49664
    buffer_load_dwordx4 v[56:59], v28, s[12:15], s42 offen
    s_add_u32 s42, s68, 57856
    buffer_load_dwordx4 v[60:63], v28, s[12:15], s42 offen
    s_add_u32 s42, s68, 640
    buffer_load_dwordx4 v[64:67], v28, s[12:15], s42 offen
    s_add_u32 s42, s68, 8832
    buffer_load_dwordx4 v[68:71], v28, s[12:15], s42 offen
    s_add_u32 s42, s68, 17024
    buffer_load_dwordx4 v[72:75], v28, s[12:15], s42 offen
    s_add_u32 s42, s68, 25216
    buffer_load_dwordx4 v[76:79], v28, s[12:15], s42 offen
    s_add_u32 s42, s68, 33408
    buffer_load_dwordx4 v[80:83], v28, s[12:15], s42 offen
    s_add_u32 s42, s68, 41600
    buffer_load_dwordx4 v[84:87], v28, s[12:15], s42 offen
    s_add_u32 s42, s68, 49792
    buffer_load_dwordx4 v[88:91], v28, s[12:15], s42 offen
    s_add_u32 s42, s68, 57984
    buffer_load_dwordx4 v[92:95], v28, s[12:15], s42 offen
    s_lshl_b32 s40, s30, 7
    s_lshl_b32 s39, s31, 2
    s_add_u32 s39, s39, s35
    s_lshl_b32 s39, s39, 2
    s_mul_i32 s39, s39, s32
    s_add_u32 s40, s40, s39
    s_lshl_b32 s39, s35, 12
    s_add_u32 s39, s39, s57
    s_mov_b32 m0, s39
    s_nop 0
    buffer_load_dwordx4 v2, s[8:11], s40 offen lds
    s_add_u32 m0, m0, 1024
    s_add_u32 s40, s40, s32
    buffer_load_dwordx4 v3, s[8:11], s40 offen lds
    s_add_u32 m0, m0, 1024
    s_add_u32 s40, s40, s32
    buffer_load_dwordx4 v2, s[8:11], s40 offen lds
    s_add_u32 m0, m0, 1024
    s_add_u32 s40, s40, s32
    buffer_load_dwordx4 v3, s[8:11], s40 offen lds
    s_add_u32 s57, s57, 16384
    s_and_b32 s57, s57, 0x1ffff
    s_add_u32 s31, s31, 1
    s_lshr_b32 s39, s31, 2
    s_add_u32 s30, s30, s39
    s_and_b32 s31, s31, 3
    s_lshl_b32 s40, s30, 7
    s_lshl_b32 s39, s31, 2
    s_add_u32 s39, s39, s35
    s_lshl_b32 s39, s39, 2
    s_mul_i32 s39, s39, s32
    s_add_u32 s40, s40, s39
    s_lshl_b32 s39, s35, 12
    s_add_u32 s39, s39, s57
    s_mov_b32 m0, s39
    s_nop 0
    buffer_load_dwordx4 v2, s[8:11], s40 offen lds
    s_add_u32 m0, m0, 1024
    s_add_u32 s40, s40, s32
    buffer_load_dwordx4 v3, s[8:11], s40 offen lds
    s_add_u32 m0, m0, 1024
    s_add_u32 s40, s40, s32
    buffer_load_dwordx4 v2, s[8:11], s40 offen lds
    s_add_u32 m0, m0, 1024
    s_add_u32 s40, s40, s32
    buffer_load_dwordx4 v3, s[8:11], s40 offen lds
    s_add_u32 s57, s57, 16384
    s_and_b32 s57, s57, 0x1ffff
    s_add_u32 s31, s31, 1
    s_lshr_b32 s39, s31, 2
    s_add_u32 s30, s30, s39
    s_and_b32 s31, s31, 3
    s_waitcnt vmcnt(32)
    ds_write_b128 v29, v[192:195] offset:0
    ds_write_b128 v30, v[196:199] offset:1024
    ds_write_b128 v29, v[200:203] offset:2048
    ds_write_b128 v30, v[204:207] offset:3072
    ds_write_b128 v29, v[208:211] offset:4096
    ds_write_b128 v30, v[212:215] offset:5120
    ds_write_b128 v29, v[216:219] offset:6144
    ds_write_b128 v30, v[220:223] offset:7168
    s_waitcnt lgkmcnt(0)
    ds_read_b128 a[16:19], v31 offset:0
    ds_read_b128 a[20:23], v23 offset:0
    ds_read_b128 a[80:83], v31 offset:2048
    ds_read_b128 a[84:87], v23 offset:2048
    ds_read_b128 a[144:147], v31 offset:4096
    ds_read_b128 a[148:151], v23 offset:4096
    ds_read_b128 a[208:211], v31 offset:6144
    ds_read_b128 a[212:215], v23 offset:6144
    s_waitcnt lgkmcnt(0)
    s_add_u32 s42, s68, 768
    buffer_load_dwordx4 v[192:195], v28, s[12:15], s42 offen
    s_add_u32 s42, s68, 8960
    buffer_load_dwordx4 v[196:199], v28, s[12:15], s42 offen
    s_add_u32 s42, s68, 17152
    buffer_load_dwordx4 v[200:203], v28, s[12:15], s42 offen
    s_add_u32 s42, s68, 25344
    buffer_load_dwordx4 v[204:207], v28, s[12:15], s42 offen
    s_add_u32 s42, s68, 33536
    buffer_load_dwordx4 v[208:211], v28, s[12:15], s42 offen
    s_add_u32 s42, s68, 41728
    buffer_load_dwordx4 v[212:215], v28, s[12:15], s42 offen
    s_add_u32 s42, s68, 49920
    buffer_load_dwordx4 v[216:219], v28, s[12:15], s42 offen
    s_add_u32 s42, s68, 58112
    buffer_load_dwordx4 v[220:223], v28, s[12:15], s42 offen
    s_waitcnt vmcnt(32)
    ds_write_b128 v29, v[224:227] offset:0
    ds_write_b128 v30, v[228:231] offset:1024
    ds_write_b128 v29, v[232:235] offset:2048
    ds_write_b128 v30, v[236:239] offset:3072
    ds_write_b128 v29, v[240:243] offset:4096
    ds_write_b128 v30, v[244:247] offset:5120
    ds_write_b128 v29, v[248:251] offset:6144
    ds_write_b128 v30, v[252:255] offset:7168
    s_waitcnt lgkmcnt(0)
    ds_read_b128 a[24:27], v31 offset:0
    ds_read_b128 a[28:31], v23 offset:0
    ds_read_b128 a[88:91], v31 offset:2048
    ds_read_b128 a[92:95], v23 offset:2048
    ds_read_b128 a[152:155], v31 offset:4096
    ds_read_b128 a[156:159], v23 offset:4096
    ds_read_b128 a[216:219], v31 offset:6144
    ds_read_b128 a[220:223], v23 offset:6144
    s_waitcnt lgkmcnt(0)
    s_add_u32 s42, s68, 896
    buffer_load_dwordx4 v[224:227], v28, s[12:15], s42 offen
    s_add_u32 s42, s68, 9088
    buffer_load_dwordx4 v[228:231], v28, s[12:15], s42 offen
    s_add_u32 s42, s68, 17280
    buffer_load_dwordx4 v[232:235], v28, s[12:15], s42 offen
    s_add_u32 s42, s68, 25472
    buffer_load_dwordx4 v[236:239], v28, s[12:15], s42 offen
    s_add_u32 s42, s68, 33664
    buffer_load_dwordx4 v[240:243], v28, s[12:15], s42 offen
    s_add_u32 s42, s68, 41856
    buffer_load_dwordx4 v[244:247], v28, s[12:15], s42 offen
    s_add_u32 s42, s68, 50048
    buffer_load_dwordx4 v[248:251], v28, s[12:15], s42 offen
    s_add_u32 s42, s68, 58240
    buffer_load_dwordx4 v[252:255], v28, s[12:15], s42 offen
    s_waitcnt vmcnt(32)
    ds_write_b128 v29, v[32:35] offset:0
    ds_write_b128 v30, v[36:39] offset:1024
    ds_write_b128 v29, v[40:43] offset:2048
    ds_write_b128 v30, v[44:47] offset:3072
    ds_write_b128 v29, v[48:51] offset:4096
    ds_write_b128 v30, v[52:55] offset:5120
    ds_write_b128 v29, v[56:59] offset:6144
    ds_write_b128 v30, v[60:63] offset:7168
    s_waitcnt lgkmcnt(0)
    ds_read_b128 a[32:35], v31 offset:0
    ds_read_b128 a[36:39], v23 offset:0
    ds_read_b128 a[96:99], v31 offset:2048
    ds_read_b128 a[100:103], v23 offset:2048
    ds_read_b128 a[160:163], v31 offset:4096
    ds_read_b128 a[164:167], v23 offset:4096
    ds_read_b128 a[224:227], v31 offset:6144
    ds_read_b128 a[228:231], v23 offset:6144
    s_waitcnt lgkmcnt(0)
    s_lshl_b32 s40, s30, 7
    s_lshl_b32 s39, s31, 2
    s_add_u32 s39, s39, s35
    s_lshl_b32 s39, s39, 2
    s_mul_i32 s39, s39, s32
    s_add_u32 s40, s40, s39
    s_lshl_b32 s39, s35, 12
    s_add_u32 s39, s39, s57
    s_mov_b32 m0, s39
    s_nop 0
    buffer_load_dwordx4 v2, s[8:11], s40 offen lds
    s_add_u32 m0, m0, 1024
    s_add_u32 s40, s40, s32
    buffer_load_dwordx4 v3, s[8:11], s40 offen lds
    s_add_u32 m0, m0, 1024
    s_add_u32 s40, s40, s32
    buffer_load_dwordx4 v2, s[8:11], s40 offen lds
    s_add_u32 m0, m0, 1024
    s_add_u32 s40, s40, s32
    buffer_load_dwordx4 v3, s[8:11], s40 offen lds
    s_add_u32 s57, s57, 16384
    s_and_b32 s57, s57, 0x1ffff
    s_add_u32 s31, s31, 1
    s_lshr_b32 s39, s31, 2
    s_add_u32 s30, s30, s39
    s_and_b32 s31, s31, 3
    s_waitcnt vmcnt(28)
    ds_write_b128 v29, v[64:67] offset:0
    ds_write_b128 v30, v[68:71] offset:1024
    ds_write_b128 v29, v[72:75] offset:2048
    ds_write_b128 v30, v[76:79] offset:3072
    ds_write_b128 v29, v[80:83] offset:4096
    ds_write_b128 v30, v[84:87] offset:5120
    ds_write_b128 v29, v[88:91] offset:6144
    ds_write_b128 v30, v[92:95] offset:7168
    s_waitcnt lgkmcnt(0)
    ds_read_b128 a[40:43], v31 offset:0
    ds_read_b128 a[44:47], v23 offset:0
    ds_read_b128 a[104:107], v31 offset:2048
    ds_read_b128 a[108:111], v23 offset:2048
    ds_read_b128 a[168:171], v31 offset:4096
    ds_read_b128 a[172:175], v23 offset:4096
    ds_read_b128 a[232:235], v31 offset:6144
    ds_read_b128 a[236:239], v23 offset:6144
    s_waitcnt lgkmcnt(0)
    s_lshl_b32 s40, s30, 7
    s_lshl_b32 s39, s31, 2
    s_add_u32 s39, s39, s35
    s_lshl_b32 s39, s39, 2
    s_mul_i32 s39, s39, s32
    s_add_u32 s40, s40, s39
    s_lshl_b32 s39, s35, 12
    s_add_u32 s39, s39, s57
    s_mov_b32 m0, s39
    s_nop 0
    buffer_load_dwordx4 v2, s[8:11], s40 offen lds
    s_add_u32 m0, m0, 1024
    s_add_u32 s40, s40, s32
    buffer_load_dwordx4 v3, s[8:11], s40 offen lds
    s_add_u32 m0, m0, 1024
    s_add_u32 s40, s40, s32
    buffer_load_dwordx4 v2, s[8:11], s40 offen lds
    s_add_u32 m0, m0, 1024
    s_add_u32 s40, s40, s32
    buffer_load_dwordx4 v3, s[8:11], s40 offen lds
    s_add_u32 s57, s57, 16384
    s_and_b32 s57, s57, 0x1ffff
    s_add_u32 s31, s31, 1
    s_lshr_b32 s39, s31, 2
    s_add_u32 s30, s30, s39
    s_and_b32 s31, s31, 3
    s_waitcnt vmcnt(16)
    ds_write_b128 v29, v[192:195] offset:0
    ds_write_b128 v30, v[196:199] offset:1024
    ds_write_b128 v29, v[200:203] offset:2048
    ds_write_b128 v30, v[204:207] offset:3072
    ds_write_b128 v29, v[208:211] offset:4096
    ds_write_b128 v30, v[212:215] offset:5120
    ds_write_b128 v29, v[216:219] offset:6144
    ds_write_b128 v30, v[220:223] offset:7168
    s_waitcnt lgkmcnt(0)
    ds_read_b128 a[48:51], v31 offset:0
    ds_read_b128 a[52:55], v23 offset:0
    ds_read_b128 a[112:115], v31 offset:2048
    ds_read_b128 a[116:119], v23 offset:2048
    ds_read_b128 a[176:179], v31 offset:4096
    ds_read_b128 a[180:183], v23 offset:4096
    ds_read_b128 a[240:243], v31 offset:6144
    ds_read_b128 a[244:247], v23 offset:6144
    s_waitcnt lgkmcnt(0)
    s_lshl_b32 s40, s30, 7
    s_lshl_b32 s39, s31, 2
    s_add_u32 s39, s39, s35
    s_lshl_b32 s39, s39, 2
    s_mul_i32 s39, s39, s32
    s_add_u32 s40, s40, s39
    s_lshl_b32 s39, s35, 12
    s_add_u32 s39, s39, s57
    s_mov_b32 m0, s39
    s_nop 0
    buffer_load_dwordx4 v2, s[8:11], s40 offen lds
    s_add_u32 m0, m0, 1024
    s_add_u32 s40, s40, s32
    buffer_load_dwordx4 v3, s[8:11], s40 offen lds
    s_add_u32 m0, m0, 1024
    s_add_u32 s40, s40, s32
    buffer_load_dwordx4 v2, s[8:11], s40 offen lds
    s_add_u32 m0, m0, 1024
    s_add_u32 s40, s40, s32
    buffer_load_dwordx4 v3, s[8:11], s40 offen lds
    s_add_u32 s57, s57, 16384
    s_and_b32 s57, s57, 0x1ffff
    s_add_u32 s31, s31, 1
    s_lshr_b32 s39, s31, 2
    s_add_u32 s30, s30, s39
    s_and_b32 s31, s31, 3
    s_waitcnt vmcnt(12)
    ds_write_b128 v29, v[224:227] offset:0
    ds_write_b128 v30, v[228:231] offset:1024
    ds_write_b128 v29, v[232:235] offset:2048
    ds_write_b128 v30, v[236:239] offset:3072
    ds_write_b128 v29, v[240:243] offset:4096
    ds_write_b128 v30, v[244:247] offset:5120
    ds_write_b128 v29, v[248:251] offset:6144
    ds_write_b128 v30, v[252:255] offset:7168
    s_waitcnt lgkmcnt(0)
    ds_read_b128 a[56:59], v31 offset:0
    ds_read_b128 a[60:63], v23 offset:0
    ds_read_b128 a[120:123], v31 offset:2048
    ds_read_b128 a[124:127], v23 offset:2048
    ds_read_b128 a[184:187], v31 offset:4096
    ds_read_b128 a[188:191], v23 offset:4096
    ds_read_b128 a[248:251], v31 offset:6144
    ds_read_b128 a[252:255], v23 offset:6144
    s_waitcnt lgkmcnt(0)
    v_mov_b32 v40, 0x3f803f80
    v_mov_b32 v41, 0x3f803f80
    v_mov_b32 v42, 0x3f803f80
    v_mov_b32 v43, 0x3f803f80
    v_lshlrev_b32 v26, 4, v21
    v_and_b32 v27, 8, v20
    v_cmp_eq_u32 s[48:49], 0, v27
    buffer_load_dwordx4 v[192:195], v26, s[20:23], 0 offen offset:0
    buffer_load_dwordx4 v[196:199], v26, s[20:23], 0 offen offset:64
    buffer_load_dwordx4 v[200:203], v26, s[20:23], 0 offen offset:128
    buffer_load_dwordx4 v[204:207], v26, s[20:23], 0 offen offset:192
    buffer_load_dwordx4 v[208:211], v26, s[20:23], 0 offen offset:256
    buffer_load_dwordx4 v[212:215], v26, s[20:23], 0 offen offset:320
    buffer_load_dwordx4 v[216:219], v26, s[20:23], 0 offen offset:384
    buffer_load_dwordx4 v[220:223], v26, s[20:23], 0 offen offset:448
    buffer_load_dwordx4 v[224:227], v26, s[20:23], 0 offen offset:512
    buffer_load_dwordx4 v[228:231], v26, s[20:23], 0 offen offset:576
    buffer_load_dwordx4 v[232:235], v26, s[20:23], 0 offen offset:640
    buffer_load_dwordx4 v[236:239], v26, s[20:23], 0 offen offset:704
    buffer_load_dwordx4 v[240:243], v26, s[20:23], 0 offen offset:768
    buffer_load_dwordx4 v[244:247], v26, s[20:23], 0 offen offset:832
    buffer_load_dwordx4 v[248:251], v26, s[20:23], 0 offen offset:896
    buffer_load_dwordx4 v[252:255], v26, s[20:23], 0 offen offset:960
    s_add_u32 s46, s29, 0
    s_lshl_b32 s46, s46, 7
    buffer_load_dwordx2 v[44:45], v24, s[16:19], s46 offen offset:0
    buffer_load_dwordx2 v[46:47], v24, s[16:19], s46 offen offset:32
    buffer_load_dwordx2 v[48:49], v24, s[16:19], s46 offen offset:64
    buffer_load_dwordx2 v[50:51], v24, s[16:19], s46 offen offset:96
    s_waitcnt vmcnt(0)
    v_cndmask_b32 v192, v192, v40, s[48:49]
    v_cndmask_b32 v193, v193, v40, s[48:49]
    v_cndmask_b32 v194, v194, v40, s[48:49]
    v_cndmask_b32 v195, v195, v40, s[48:49]
    v_cndmask_b32 v196, v196, v40, s[48:49]
    v_cndmask_b32 v197, v197, v40, s[48:49]
    v_cndmask_b32 v198, v198, v40, s[48:49]
    v_cndmask_b32 v199, v199, v40, s[48:49]
    v_cndmask_b32 v200, v200, v40, s[48:49]
    v_cndmask_b32 v201, v201, v40, s[48:49]
    v_cndmask_b32 v202, v202, v40, s[48:49]
    v_cndmask_b32 v203, v203, v40, s[48:49]
    v_cndmask_b32 v204, v204, v40, s[48:49]
    v_cndmask_b32 v205, v205, v40, s[48:49]
    v_cndmask_b32 v206, v206, v40, s[48:49]
    v_cndmask_b32 v207, v207, v40, s[48:49]
    v_cndmask_b32 v208, v208, v40, s[48:49]
    v_cndmask_b32 v209, v209, v40, s[48:49]
    v_cndmask_b32 v210, v210, v40, s[48:49]
    v_cndmask_b32 v211, v211, v40, s[48:49]
    v_cndmask_b32 v212, v212, v40, s[48:49]
    v_cndmask_b32 v213, v213, v40, s[48:49]
    v_cndmask_b32 v214, v214, v40, s[48:49]
    v_cndmask_b32 v215, v215, v40, s[48:49]
    v_cndmask_b32 v216, v216, v40, s[48:49]
    v_cndmask_b32 v217, v217, v40, s[48:49]
    v_cndmask_b32 v218, v218, v40, s[48:49]
    v_cndmask_b32 v219, v219, v40, s[48:49]
    v_cndmask_b32 v220, v220, v40, s[48:49]
    v_cndmask_b32 v221, v221, v40, s[48:49]
    v_cndmask_b32 v222, v222, v40, s[48:49]
    v_cndmask_b32 v223, v223, v40, s[48:49]
    v_cndmask_b32 v224, v224, v40, s[48:49]
    v_cndmask_b32 v225, v225, v40, s[48:49]
    v_cndmask_b32 v226, v226, v40, s[48:49]
    v_cndmask_b32 v227, v227, v40, s[48:49]
    v_cndmask_b32 v228, v228, v40, s[48:49]
    v_cndmask_b32 v229, v229, v40, s[48:49]
    v_cndmask_b32 v230, v230, v40, s[48:49]
    v_cndmask_b32 v231, v231, v40, s[48:49]
    v_cndmask_b32 v232, v232, v40, s[48:49]
    v_cndmask_b32 v233, v233, v40, s[48:49]
    v_cndmask_b32 v234, v234, v40, s[48:49]
    v_cndmask_b32 v235, v235, v40, s[48:49]
    v_cndmask_b32 v236, v236, v40, s[48:49]
    v_cndmask_b32 v237, v237, v40, s[48:49]
    v_cndmask_b32 v238, v238, v40, s[48:49]
    v_cndmask_b32 v239, v239, v40, s[48:49]
    v_cndmask_b32 v240, v240, v40, s[48:49]
    v_cndmask_b32 v241, v241, v40, s[48:49]
    v_cndmask_b32 v242, v242, v40, s[48:49]
    v_cndmask_b32 v243, v243, v40, s[48:49]
    v_cndmask_b32 v244, v244, v40, s[48:49]
    v_cndmask_b32 v245, v245, v40, s[48:49]
    v_cndmask_b32 v246, v246, v40, s[48:49]
    v_cndmask_b32 v247, v247, v40, s[48:49]
    v_cndmask_b32 v248, v248, v40, s[48:49]
    v_cndmask_b32 v249, v249, v40, s[48:49]
    v_cndmask_b32 v250, v250, v40, s[48:49]
    v_cndmask_b32 v251, v251, v40, s[48:49]
    v_cndmask_b32 v252, v252, v40, s[48:49]
    v_cndmask_b32 v253, v253, v40, s[48:49]
    v_cndmask_b32 v254, v254, v40, s[48:49]
    v_cndmask_b32 v255, v255, v40, s[48:49]
    s_nop 1
    v_mfma_f32_16x16x32_bf16 v[96:99], v[192:195], a[0:3], 0
    v_mfma_f32_16x16x32_bf16 v[96:99], v[196:199], a[4:7], v[96:99]
    v_mfma_f32_16x16x32_bf16 v[96:99], v[200:203], a[8:11], v[96:99]
    v_mfma_f32_16x16x32_bf16 v[96:99], v[204:207], a[12:15], v[96:99]
    v_mfma_f32_16x16x32_bf16 v[96:99], v[208:211], a[16:19], v[96:99]
    v_mfma_f32_16x16x32_bf16 v[96:99], v[212:215], a[20:23], v[96:99]
    v_mfma_f32_16x16x32_bf16 v[96:99], v[216:219], a[24:27], v[96:99]
    v_mfma_f32_16x16x32_bf16 v[96:99], v[220:223], a[28:31], v[96:99]
    v_mfma_f32_16x16x32_bf16 v[96:99], v[224:227], a[32:35], v[96:99]
    v_mfma_f32_16x16x32_bf16 v[96:99], v[228:231], a[36:39], v[96:99]
    v_mfma_f32_16x16x32_bf16 v[96:99], v[232:235], a[40:43], v[96:99]
    v_mfma_f32_16x16x32_bf16 v[96:99], v[236:239], a[44:47], v[96:99]
    v_mfma_f32_16x16x32_bf16 v[96:99], v[240:243], a[48:51], v[96:99]
    v_mfma_f32_16x16x32_bf16 v[96:99], v[244:247], a[52:55], v[96:99]
    v_mfma_f32_16x16x32_bf16 v[96:99], v[248:251], a[56:59], v[96:99]
    v_mfma_f32_16x16x32_bf16 v[96:99], v[252:255], a[60:63], v[96:99]
    v_mfma_f32_16x16x32_bf16 v[112:115], a[0:3], a[0:3], 0
    v_mfma_f32_16x16x32_bf16 v[112:115], a[4:7], a[4:7], v[112:115]
    v_mfma_f32_16x16x32_bf16 v[112:115], a[8:11], a[8:11], v[112:115]
    v_mfma_f32_16x16x32_bf16 v[112:115], a[12:15], a[12:15], v[112:115]
    v_mfma_f32_16x16x32_bf16 v[112:115], a[16:19], a[16:19], v[112:115]
    v_mfma_f32_16x16x32_bf16 v[112:115], a[20:23], a[20:23], v[112:115]
    v_mfma_f32_16x16x32_bf16 v[112:115], a[24:27], a[24:27], v[112:115]
    v_mfma_f32_16x16x32_bf16 v[112:115], a[28:31], a[28:31], v[112:115]
    v_mfma_f32_16x16x32_bf16 v[112:115], a[32:35], a[32:35], v[112:115]
    v_mfma_f32_16x16x32_bf16 v[112:115], a[36:39], a[36:39], v[112:115]
    v_mfma_f32_16x16x32_bf16 v[112:115], a[40:43], a[40:43], v[112:115]
    v_mfma_f32_16x16x32_bf16 v[112:115], a[44:47], a[44:47], v[112:115]
    v_mfma_f32_16x16x32_bf16 v[112:115], a[48:51], a[48:51], v[112:115]
    v_mfma_f32_16x16x32_bf16 v[112:115], a[52:55], a[52:55], v[112:115]
    v_mfma_f32_16x16x32_bf16 v[112:115], a[56:59], a[56:59], v[112:115]
    v_mfma_f32_16x16x32_bf16 v[112:115], a[60:63], a[60:63], v[112:115]
    v_mfma_f32_16x16x32_bf16 v[100:103], v[192:195], a[64:67], 0
    v_mfma_f32_16x16x32_bf16 v[100:103], v[196:199], a[68:71], v[100:103]
    v_mfma_f32_16x16x32_bf16 v[100:103], v[200:203], a[72:75], v[100:103]
    v_mfma_f32_16x16x32_bf16 v[100:103], v[204:207], a[76:79], v[100:103]
    v_mfma_f32_16x16x32_bf16 v[100:103], v[208:211], a[80:83], v[100:103]
    v_mfma_f32_16x16x32_bf16 v[100:103], v[212:215], a[84:87], v[100:103]
    v_mfma_f32_16x16x32_bf16 v[100:103], v[216:219], a[88:91], v[100:103]
    v_mfma_f32_16x16x32_bf16 v[100:103], v[220:223], a[92:95], v[100:103]
    v_mfma_f32_16x16x32_bf16 v[100:103], v[224:227], a[96:99], v[100:103]
    v_mfma_f32_16x16x32_bf16 v[100:103], v[228:231], a[100:103], v[100:103]
    v_mfma_f32_16x16x32_bf16 v[100:103], v[232:235], a[104:107], v[100:103]
    v_mfma_f32_16x16x32_bf16 v[100:103], v[236:239], a[108:111], v[100:103]
    v_mfma_f32_16x16x32_bf16 v[100:103], v[240:243], a[112:115], v[100:103]
    v_mfma_f32_16x16x32_bf16 v[100:103], v[244:247], a[116:119], v[100:103]
    v_mfma_f32_16x16x32_bf16 v[100:103], v[248:251], a[120:123], v[100:103]
    v_mfma_f32_16x16x32_bf16 v[100:103], v[252:255], a[124:127], v[100:103]
    v_mfma_f32_16x16x32_bf16 v[116:119], a[64:67], a[64:67], 0
    v_mfma_f32_16x16x32_bf16 v[116:119], a[68:71], a[68:71], v[116:119]
    v_mfma_f32_16x16x32_bf16 v[116:119], a[72:75], a[72:75], v[116:119]
    v_mfma_f32_16x16x32_bf16 v[116:119], a[76:79], a[76:79], v[116:119]
    v_mfma_f32_16x16x32_bf16 v[116:119], a[80:83], a[80:83], v[116:119]
    v_mfma_f32_16x16x32_bf16 v[116:119], a[84:87], a[84:87], v[116:119]
    v_mfma_f32_16x16x32_bf16 v[116:119], a[88:91], a[88:91], v[116:119]
    v_mfma_f32_16x16x32_bf16 v[116:119], a[92:95], a[92:95], v[116:119]
    v_mfma_f32_16x16x32_bf16 v[116:119], a[96:99], a[96:99], v[116:119]
    v_mfma_f32_16x16x32_bf16 v[116:119], a[100:103], a[100:103], v[116:119]
    v_mfma_f32_16x16x32_bf16 v[116:119], a[104:107], a[104:107], v[116:119]
    v_mfma_f32_16x16x32_bf16 v[116:119], a[108:111], a[108:111], v[116:119]
    v_mfma_f32_16x16x32_bf16 v[116:119], a[112:115], a[112:115], v[116:119]
    v_mfma_f32_16x16x32_bf16 v[116:119], a[116:119], a[116:119], v[116:119]
    v_mfma_f32_16x16x32_bf16 v[116:119], a[120:123], a[120:123], v[116:119]
    v_mfma_f32_16x16x32_bf16 v[116:119], a[124:127], a[124:127], v[116:119]
    v_mfma_f32_16x16x32_bf16 v[104:107], v[192:195], a[128:131], 0
    v_mfma_f32_16x16x32_bf16 v[104:107], v[196:199], a[132:135], v[104:107]
    v_mfma_f32_16x16x32_bf16 v[104:107], v[200:203], a[136:139], v[104:107]
    v_mfma_f32_16x16x32_bf16 v[104:107], v[204:207], a[140:143], v[104:107]
    v_mfma_f32_16x16x32_bf16 v[104:107], v[208:211], a[144:147], v[104:107]
    v_mfma_f32_16x16x32_bf16 v[104:107], v[212:215], a[148:151], v[104:107]
    v_mfma_f32_16x16x32_bf16 v[104:107], v[216:219], a[152:155], v[104:107]
    v_mfma_f32_16x16x32_bf16 v[104:107], v[220:223], a[156:159], v[104:107]
    v_mfma_f32_16x16x32_bf16 v[104:107], v[224:227], a[160:163], v[104:107]
    v_mfma_f32_16x16x32_bf16 v[104:107], v[228:231], a[164:167], v[104:107]
    v_mfma_f32_16x16x32_bf16 v[104:107], v[232:235], a[168:171], v[104:107]
    v_mfma_f32_16x16x32_bf16 v[104:107], v[236:239], a[172:175], v[104:107]
    v_mfma_f32_16x16x32_bf16 v[104:107], v[240:243], a[176:179], v[104:107]
    v_mfma_f32_16x16x32_bf16 v[104:107], v[244:247], a[180:183], v[104:107]
    v_mfma_f32_16x16x32_bf16 v[104:107], v[248:251], a[184:187], v[104:107]
    v_mfma_f32_16x16x32_bf16 v[104:107], v[252:255], a[188:191], v[104:107]
    v_mfma_f32_16x16x32_bf16 v[120:123], a[128:131], a[128:131], 0
    v_mfma_f32_16x16x32_bf16 v[120:123], a[132:135], a[132:135], v[120:123]
    v_mfma_f32_16x16x32_bf16 v[120:123], a[136:139], a[136:139], v[120:123]
    v_mfma_f32_16x16x32_bf16 v[120:123], a[140:143], a[140:143], v[120:123]
    v_mfma_f32_16x16x32_bf16 v[120:123], a[144:147], a[144:147], v[120:123]
    v_mfma_f32_16x16x32_bf16 v[120:123], a[148:151], a[148:151], v[120:123]
    v_mfma_f32_16x16x32_bf16 v[120:123], a[152:155], a[152:155], v[120:123]
    v_mfma_f32_16x16x32_bf16 v[120:123], a[156:159], a[156:159], v[120:123]
    v_mfma_f32_16x16x32_bf16 v[120:123], a[160:163], a[160:163], v[120:123]
    v_mfma_f32_16x16x32_bf16 v[120:123], a[164:167], a[164:167], v[120:123]
    v_mfma_f32_16x16x32_bf16 v[120:123], a[168:171], a[168:171], v[120:123]
    v_mfma_f32_16x16x32_bf16 v[120:123], a[172:175], a[172:175], v[120:123]
    v_mfma_f32_16x16x32_bf16 v[120:123], a[176:179], a[176:179], v[120:123]
    v_mfma_f32_16x16x32_bf16 v[120:123], a[180:183], a[180:183], v[120:123]
    v_mfma_f32_16x16x32_bf16 v[120:123], a[184:187], a[184:187], v[120:123]
    v_mfma_f32_16x16x32_bf16 v[120:123], a[188:191], a[188:191], v[120:123]
    v_mfma_f32_16x16x32_bf16 v[108:111], v[192:195], a[192:195], 0
    v_mfma_f32_16x16x32_bf16 v[108:111], v[196:199], a[196:199], v[108:111]
    v_mfma_f32_16x16x32_bf16 v[108:111], v[200:203], a[200:203], v[108:111]
    v_mfma_f32_16x16x32_bf16 v[108:111], v[204:207], a[204:207], v[108:111]
    v_mfma_f32_16x16x32_bf16 v[108:111], v[208:211], a[208:211], v[108:111]
    v_mfma_f32_16x16x32_bf16 v[108:111], v[212:215], a[212:215], v[108:111]
    v_mfma_f32_16x16x32_bf16 v[108:111], v[216:219], a[216:219], v[108:111]
    v_mfma_f32_16x16x32_bf16 v[108:111], v[220:223], a[220:223], v[108:111]
    v_mfma_f32_16x16x32_bf16 v[108:111], v[224:227], a[224:227], v[108:111]
    v_mfma_f32_16x16x32_bf16 v[108:111], v[228:231], a[228:231], v[108:111]
    v_mfma_f32_16x16x32_bf16 v[108:111], v[232:235], a[232:235], v[108:111]
    v_mfma_f32_16x16x32_bf16 v[108:111], v[236:239], a[236:239], v[108:111]
    v_mfma_f32_16x16x32_bf16 v[108:111], v[240:243], a[240:243], v[108:111]
    v_mfma_f32_16x16x32_bf16 v[108:111], v[244:247], a[244:247], v[108:111]
    v_mfma_f32_16x16x32_bf16 v[108:111], v[248:251], a[248:251], v[108:111]
    v_mfma_f32_16x16x32_bf16 v[108:111], v[252:255], a[252:255], v[108:111]
    v_mfma_f32_16x16x32_bf16 v[124:127], a[192:195], a[192:195], 0
    v_mfma_f32_16x16x32_bf16 v[124:127], a[196:199], a[196:199], v[124:127]
    v_mfma_f32_16x16x32_bf16 v[124:127], a[200:203], a[200:203], v[124:127]
    v_mfma_f32_16x16x32_bf16 v[124:127], a[204:207], a[204:207], v[124:127]
    v_mfma_f32_16x16x32_bf16 v[124:127], a[208:211], a[208:211], v[124:127]
    v_mfma_f32_16x16x32_bf16 v[124:127], a[212:215], a[212:215], v[124:127]
    v_mfma_f32_16x16x32_bf16 v[124:127], a[216:219], a[216:219], v[124:127]
    v_mfma_f32_16x16x32_bf16 v[124:127], a[220:223], a[220:223], v[124:127]
    v_mfma_f32_16x16x32_bf16 v[124:127], a[224:227], a[224:227], v[124:127]
    v_mfma_f32_16x16x32_bf16 v[124:127], a[228:231], a[228:231], v[124:127]
    v_mfma_f32_16x16x32_bf16 v[124:127], a[232:235], a[232:235], v[124:127]
    v_mfma_f32_16x16x32_bf16 v[124:127], a[236:239], a[236:239], v[124:127]
    v_mfma_f32_16x16x32_bf16 v[124:127], a[240:243], a[240:243], v[124:127]
    v_mfma_f32_16x16x32_bf16 v[124:127], a[244:247], a[244:247], v[124:127]
    v_mfma_f32_16x16x32_bf16 v[124:127], a[248:251], a[248:251], v[124:127]
    v_mfma_f32_16x16x32_bf16 v[124:127], a[252:255], a[252:255], v[124:127]
    s_nop 7
    v_and_b32 v27, 3, v20
    v_cmp_eq_u32 s[50:51], 1, v27
    v_cmp_eq_u32 s[52:53], 2, v27
    v_cmp_eq_u32 s[54:55], 3, v27
    v_bfe_u32 v27, v20, 2, 2
    v_cmp_eq_u32 vcc, v27, v21
    v_mov_b32 v26, v112
    v_cndmask_b32 v26, v26, v113, s[50:51]
    v_cndmask_b32 v26, v26, v114, s[52:53]
    v_cndmask_b32 v26, v26, v115, s[54:55]
    v_cndmask_b32 v26, 0, v26, vcc
    v_mov_b32 v27, v26
    s_nop 1
    v_permlane32_swap_b32 v26, v27
    s_nop 1
    v_add_f32 v26, v26, v27
    v_mov_b32 v27, v26
    s_nop 1
    v_permlane16_swap_b32 v26, v27
    s_nop 1
    v_add_f32 v26, v26, v27
    v_mov_b32 v27, v96
    v_mov_b32 v28, v96
    s_nop 1
    v_permlane32_swap_b32 v27, v28
    s_nop 1
    v_mul_f32 v36, 0x3b000000, v27
    v_mul_f32 v26, 0x3b000000, v26
    v_fma_f32 v26, -v36, v36, v26
    v_max_f32 v26, 0, v26
    v_add_f32 v26, 0x3727c5ac, v26
    v_rsq_f32 v32, v26
    v_mul_f32 v28, 0xbfb8aa3b, v28
    v_exp_f32 v28, v28
    s_nop 1
    v_add_f32 v28, 1.0, v28
    v_rcp_f32 v84, v28
    v_mov_b32 v26, v116
    v_cndmask_b32 v26, v26, v117, s[50:51]
    v_cndmask_b32 v26, v26, v118, s[52:53]
    v_cndmask_b32 v26, v26, v119, s[54:55]
    v_cndmask_b32 v26, 0, v26, vcc
    v_mov_b32 v27, v26
    s_nop 1
    v_permlane32_swap_b32 v26, v27
    s_nop 1
    v_add_f32 v26, v26, v27
    v_mov_b32 v27, v26
    s_nop 1
    v_permlane16_swap_b32 v26, v27
    s_nop 1
    v_add_f32 v26, v26, v27
    v_mov_b32 v27, v100
    v_mov_b32 v28, v100
    s_nop 1
    v_permlane32_swap_b32 v27, v28
    s_nop 1
    v_mul_f32 v37, 0x3b000000, v27
    v_mul_f32 v26, 0x3b000000, v26
    v_fma_f32 v26, -v37, v37, v26
    v_max_f32 v26, 0, v26
    v_add_f32 v26, 0x3727c5ac, v26
    v_rsq_f32 v33, v26
    v_mul_f32 v28, 0xbfb8aa3b, v28
    v_exp_f32 v28, v28
    s_nop 1
    v_add_f32 v28, 1.0, v28
    v_rcp_f32 v85, v28
    v_mov_b32 v26, v120
    v_cndmask_b32 v26, v26, v121, s[50:51]
    v_cndmask_b32 v26, v26, v122, s[52:53]
    v_cndmask_b32 v26, v26, v123, s[54:55]
    v_cndmask_b32 v26, 0, v26, vcc
    v_mov_b32 v27, v26
    s_nop 1
    v_permlane32_swap_b32 v26, v27
    s_nop 1
    v_add_f32 v26, v26, v27
    v_mov_b32 v27, v26
    s_nop 1
    v_permlane16_swap_b32 v26, v27
    s_nop 1
    v_add_f32 v26, v26, v27
    v_mov_b32 v27, v104
    v_mov_b32 v28, v104
    s_nop 1
    v_permlane32_swap_b32 v27, v28
    s_nop 1
    v_mul_f32 v38, 0x3b000000, v27
    v_mul_f32 v26, 0x3b000000, v26
    v_fma_f32 v26, -v38, v38, v26
    v_max_f32 v26, 0, v26
    v_add_f32 v26, 0x3727c5ac, v26
    v_rsq_f32 v34, v26
    v_mul_f32 v28, 0xbfb8aa3b, v28
    v_exp_f32 v28, v28
    s_nop 1
    v_add_f32 v28, 1.0, v28
    v_rcp_f32 v86, v28
    v_mov_b32 v26, v124
    v_cndmask_b32 v26, v26, v125, s[50:51]
    v_cndmask_b32 v26, v26, v126, s[52:53]
    v_cndmask_b32 v26, v26, v127, s[54:55]
    v_cndmask_b32 v26, 0, v26, vcc
    v_mov_b32 v27, v26
    s_nop 1
    v_permlane32_swap_b32 v26, v27
    s_nop 1
    v_add_f32 v26, v26, v27
    v_mov_b32 v27, v26
    s_nop 1
    v_permlane16_swap_b32 v26, v27
    s_nop 1
    v_add_f32 v26, v26, v27
    v_mov_b32 v27, v108
    v_mov_b32 v28, v108
    s_nop 1
    v_permlane32_swap_b32 v27, v28
    s_nop 1
    v_mul_f32 v39, 0x3b000000, v27
    v_mul_f32 v26, 0x3b000000, v26
    v_fma_f32 v26, -v39, v39, v26
    v_max_f32 v26, 0, v26
    v_add_f32 v26, 0x3727c5ac, v26
    v_rsq_f32 v35, v26
    v_mul_f32 v28, 0xbfb8aa3b, v28
    v_exp_f32 v28, v28
    s_nop 1
    v_add_f32 v28, 1.0, v28
    v_rcp_f32 v87, v28
    s_cmp_lg_u32 s29, 0
    s_cbranch_scc1 p1_kernel_h_nog
    v_and_b32 v26, 15, v20
    v_lshlrev_b32 v26, 2, v26
    s_lshl_b32 s69, s78, 6
    s_add_u32 s69, s69, 0x5000000
    v_cmp_gt_u32 vcc, 16, v20
    s_and_saveexec_b64 s[62:63], vcc
    buffer_store_dword v84, v26, s[4:7], s69 offen offset:0 sc1
    buffer_store_dword v85, v26, s[4:7], s69 offen offset:64 sc1
    buffer_store_dword v86, v26, s[4:7], s69 offen offset:128 sc1
    buffer_store_dword v87, v26, s[4:7], s69 offen offset:192 sc1
    s_mov_b64 exec, s[62:63]
p1_kernel_h_nog:
    s_waitcnt vmcnt(0)
    s_barrier
    ds_read_b64_tr_b16 v[160:161], v8 offset:0
    ds_read_b64_tr_b16 v[162:163], v8 offset:512
    ds_read_b64_tr_b16 v[164:165], v8 offset:4096
    ds_read_b64_tr_b16 v[166:167], v8 offset:4608
    ds_read_b64_tr_b16 v[168:169], v8 offset:8192
    ds_read_b64_tr_b16 v[170:171], v8 offset:8704
    ds_read_b64_tr_b16 v[172:173], v8 offset:12288
    ds_read_b64_tr_b16 v[174:175], v8 offset:12800
    s_cmp_ge_u32 s29, s44
    s_cbranch_scc1 p1_kernel_segh_skip
p1_kernel_segh_loop:
    s_waitcnt vmcnt(22)
    s_barrier
    s_waitcnt lgkmcnt(0)
    v_mfma_f32_16x16x32_bf16 v[96:99], v[160:163], a[0:3], 0
    ds_read_b64_tr_b16 v[176:177], v9 offset:0
    s_mov_b32 s34, s33
    s_mov_b32 s59, s58
    s_mov_b32 s37, 0
    v_mfma_f32_16x16x32_bf16 v[96:99], v[164:167], a[4:7], v[96:99]
    ds_read_b64_tr_b16 v[178:179], v9 offset:512
    s_lshl_b32 s38, s29, 11
    s_add_u32 s37, s37, s38
    s_add_u32 s33, s37, s47
    v_mfma_f32_16x16x32_bf16 v[96:99], v[168:171], a[8:11], v[96:99]
    ds_read_b64_tr_b16 v[180:181], v9 offset:4096
    s_add_u32 s58, s33, 1024
    s_cmp_eq_u32 s29, 21
    s_cselect_b32 s58, 0x10000000, s58
    v_mfma_f32_16x16x32_bf16 v[96:99], v[172:175], a[12:15], v[96:99]
    ds_read_b64_tr_b16 v[182:183], v9 offset:4608
    s_lshl_b32 s40, s30, 7
    s_lshl_b32 s39, s31, 2
    s_add_u32 s39, s39, s35
    v_mfma_f32_16x16x32_bf16 v[100:103], v[160:163], a[64:67], 0
    ds_read_b64_tr_b16 v[184:185], v9 offset:8192
    s_lshl_b32 s39, s39, 2
    s_mul_i32 s39, s39, s32
    s_add_u32 s40, s40, s39
    v_mfma_f32_16x16x32_bf16 v[100:103], v[164:167], a[68:71], v[100:103]
    ds_read_b64_tr_b16 v[186:187], v9 offset:8704
    s_lshl_b32 s39, s35, 12
    s_add_u32 s39, s39, s57
    v_fma_f32 v228, -v80, v36, v144
    v_mfma_f32_16x16x32_bf16 v[100:103], v[168:171], a[72:75], v[100:103]
    ds_read_b64_tr_b16 v[188:189], v9 offset:12288
    v_fma_f32 v229, -v81, v36, v145
    v_mfma_f32_16x16x32_bf16 v[100:103], v[172:175], a[76:79], v[100:103]
    ds_read_b64_tr_b16 v[190:191], v9 offset:12800
    v_mfma_f32_16x16x32_bf16 v[104:107], v[160:163], a[128:131], 0
    v_mfma_f32_16x16x32_bf16 v[104:107], v[164:167], a[132:135], v[104:107]
    v_fma_f32 v230, -v82, v36, v146
    v_mfma_f32_16x16x32_bf16 v[104:107], v[168:171], a[136:139], v[104:107]
    s_mov_b32 m0, s39
    s_nop 0
    v_mfma_f32_16x16x32_bf16 v[104:107], v[172:175], a[140:143], v[104:107]
    buffer_load_dwordx4 v2, s[8:11], s40 offen lds
    v_mfma_f32_16x16x32_bf16 v[108:111], v[160:163], a[192:195], 0
    v_mfma_f32_16x16x32_bf16 v[108:111], v[164:167], a[196:199], v[108:111]
    v_fma_f32 v231, -v83, v36, v147
    v_mfma_f32_16x16x32_bf16 v[108:111], v[168:171], a[200:203], v[108:111]
    v_mfma_f32_16x16x32_bf16 v[108:111], v[172:175], a[204:207], v[108:111]
    v_mfma_f32_16x16x32_bf16 v[68:71], v[160:163], v[40:43], 0
    v_fma_f32 v236, -v80, v37, v148
    v_mfma_f32_16x16x32_bf16 v[68:71], v[164:167], v[40:43], v[68:71]
    v_mfma_f32_16x16x32_bf16 v[68:71], v[168:171], v[40:43], v[68:71]
    v_mfma_f32_16x16x32_bf16 v[68:71], v[172:175], v[40:43], v[68:71]
    s_waitcnt lgkmcnt(0)
    v_mfma_f32_16x16x32_bf16 v[112:115], v[176:179], a[0:3], 0
    ds_read_b64_tr_b16 v[160:161], v10 offset:0
    v_fma_f32 v237, -v81, v37, v149
    v_mfma_f32_16x16x32_bf16 v[112:115], v[180:183], a[4:7], v[112:115]
    ds_read_b64_tr_b16 v[162:163], v10 offset:512
    v_mfma_f32_16x16x32_bf16 v[112:115], v[184:187], a[8:11], v[112:115]
    ds_read_b64_tr_b16 v[164:165], v10 offset:4096
    v_mfma_f32_16x16x32_bf16 v[112:115], v[188:191], a[12:15], v[112:115]
    ds_read_b64_tr_b16 v[166:167], v10 offset:4608
    v_fma_f32 v238, -v82, v37, v150
    v_mfma_f32_16x16x32_bf16 v[116:119], v[176:179], a[64:67], 0
    ds_read_b64_tr_b16 v[168:169], v10 offset:8192
    v_mfma_f32_16x16x32_bf16 v[116:119], v[180:183], a[68:71], v[116:119]
    ds_read_b64_tr_b16 v[170:171], v10 offset:8704
    v_mfma_f32_16x16x32_bf16 v[116:119], v[184:187], a[72:75], v[116:119]
    ds_read_b64_tr_b16 v[172:173], v10 offset:12288
    v_mfma_f32_16x16x32_bf16 v[116:119], v[188:191], a[76:79], v[116:119]
    ds_read_b64_tr_b16 v[174:175], v10 offset:12800
    v_fma_f32 v239, -v83, v37, v151
    v_mfma_f32_16x16x32_bf16 v[120:123], v[176:179], a[128:131], 0
    v_mfma_f32_16x16x32_bf16 v[120:123], v[180:183], a[132:135], v[120:123]
    v_mfma_f32_16x16x32_bf16 v[120:123], v[184:187], a[136:139], v[120:123]
    s_add_u32 m0, m0, 1024
    s_add_u32 s40, s40, s32
    v_fma_f32 v244, -v80, v38, v152
    v_mfma_f32_16x16x32_bf16 v[120:123], v[188:191], a[140:143], v[120:123]
    buffer_load_dwordx4 v3, s[8:11], s40 offen lds
    v_mfma_f32_16x16x32_bf16 v[124:127], v[176:179], a[192:195], 0
    v_mfma_f32_16x16x32_bf16 v[124:127], v[180:183], a[196:199], v[124:127]
    v_fma_f32 v245, -v81, v38, v153
    v_mfma_f32_16x16x32_bf16 v[124:127], v[184:187], a[200:203], v[124:127]
    v_mfma_f32_16x16x32_bf16 v[124:127], v[188:191], a[204:207], v[124:127]
    v_mfma_f32_16x16x32_bf16 v[72:75], v[176:179], v[40:43], 0
    v_mfma_f32_16x16x32_bf16 v[72:75], v[180:183], v[40:43], v[72:75]
    v_fma_f32 v246, -v82, v38, v154
    v_mfma_f32_16x16x32_bf16 v[72:75], v[184:187], v[40:43], v[72:75]
    v_mfma_f32_16x16x32_bf16 v[72:75], v[188:191], v[40:43], v[72:75]
    s_waitcnt lgkmcnt(0)
    v_mfma_f32_16x16x32_bf16 v[128:131], v[160:163], a[0:3], 0
    ds_read_b64_tr_b16 v[176:177], v11 offset:0
    v_fma_f32 v247, -v83, v38, v155
    v_mfma_f32_16x16x32_bf16 v[128:131], v[164:167], a[4:7], v[128:131]
    ds_read_b64_tr_b16 v[178:179], v11 offset:512
    v_mfma_f32_16x16x32_bf16 v[128:131], v[168:171], a[8:11], v[128:131]
    ds_read_b64_tr_b16 v[180:181], v11 offset:4096
    v_mfma_f32_16x16x32_bf16 v[128:131], v[172:175], a[12:15], v[128:131]
    ds_read_b64_tr_b16 v[182:183], v11 offset:4608
    v_mfma_f32_16x16x32_bf16 v[132:135], v[160:163], a[64:67], 0
    ds_read_b64_tr_b16 v[184:185], v11 offset:8192
    v_fma_f32 v252, -v80, v39, v156
    v_mfma_f32_16x16x32_bf16 v[132:135], v[164:167], a[68:71], v[132:135]
    ds_read_b64_tr_b16 v[186:187], v11 offset:8704
    v_mfma_f32_16x16x32_bf16 v[132:135], v[168:171], a[72:75], v[132:135]
    ds_read_b64_tr_b16 v[188:189], v11 offset:12288
    v_mfma_f32_16x16x32_bf16 v[132:135], v[172:175], a[76:79], v[132:135]
    ds_read_b64_tr_b16 v[190:191], v11 offset:12800
    v_fma_f32 v253, -v81, v39, v157
    v_mfma_f32_16x16x32_bf16 v[136:139], v[160:163], a[128:131], 0
    v_mfma_f32_16x16x32_bf16 v[136:139], v[164:167], a[132:135], v[136:139]
    v_mfma_f32_16x16x32_bf16 v[136:139], v[168:171], a[136:139], v[136:139]
    s_add_u32 m0, m0, 1024
    s_add_u32 s40, s40, s32
    v_mfma_f32_16x16x32_bf16 v[136:139], v[172:175], a[140:143], v[136:139]
    buffer_load_dwordx4 v2, s[8:11], s40 offen lds
    v_fma_f32 v254, -v82, v39, v158
    v_mfma_f32_16x16x32_bf16 v[140:143], v[160:163], a[192:195], 0
    v_mfma_f32_16x16x32_bf16 v[140:143], v[164:167], a[196:199], v[140:143]
    v_mfma_f32_16x16x32_bf16 v[140:143], v[168:171], a[200:203], v[140:143]
    v_fma_f32 v255, -v83, v39, v159
    v_mfma_f32_16x16x32_bf16 v[140:143], v[172:175], a[204:207], v[140:143]
    v_mfma_f32_16x16x32_bf16 v[76:79], v[160:163], v[40:43], 0
    v_mfma_f32_16x16x32_bf16 v[76:79], v[164:167], v[40:43], v[76:79]
    v_mfma_f32_16x16x32_bf16 v[76:79], v[168:171], v[40:43], v[76:79]
    v_mfma_f32_16x16x32_bf16 v[76:79], v[172:175], v[40:43], v[76:79]
    s_waitcnt lgkmcnt(0)
    v_mfma_f32_16x16x32_bf16 v[144:147], v[176:179], a[0:3], 0
    ds_read_b64_tr_b16 v[160:161], v12 offset:0
    v_fma_f32 v192, v192, v32, v52
    v_fma_f32 v193, v193, v32, v53
    v_fma_f32 v194, v194, v32, v54
    v_mfma_f32_16x16x32_bf16 v[144:147], v[180:183], a[4:7], v[144:147]
    ds_read_b64_tr_b16 v[162:163], v12 offset:512
    v_fma_f32 v195, v195, v32, v55
    v_mul_f32 v84, v192, v192
    v_mul_f32 v85, v193, v193
    v_mfma_f32_16x16x32_bf16 v[144:147], v[184:187], a[8:11], v[144:147]
    ds_read_b64_tr_b16 v[164:165], v12 offset:4096
    v_mul_f32 v86, v194, v194
    v_mul_f32 v87, v195, v195
    v_fma_f32 v84, v84, s43, v25
    v_mfma_f32_16x16x32_bf16 v[144:147], v[188:191], a[12:15], v[144:147]
    ds_read_b64_tr_b16 v[166:167], v12 offset:4608
    v_fma_f32 v85, v85, s43, v25
    v_fma_f32 v86, v86, s43, v25
    v_mfma_f32_16x16x32_bf16 v[148:151], v[176:179], a[64:67], 0
    ds_read_b64_tr_b16 v[168:169], v12 offset:8192
    v_fma_f32 v87, v87, s43, v25
    v_mul_f32 v84, v84, v192
    v_mul_f32 v85, v85, v193
    v_mfma_f32_16x16x32_bf16 v[148:151], v[180:183], a[68:71], v[148:151]
    ds_read_b64_tr_b16 v[170:171], v12 offset:8704
    v_mul_f32 v86, v86, v194
    v_mul_f32 v87, v87, v195
    v_exp_f32 v84, v84
    v_mfma_f32_16x16x32_bf16 v[148:151], v[184:187], a[72:75], v[148:151]
    ds_read_b64_tr_b16 v[172:173], v12 offset:12288
    v_exp_f32 v85, v85
    v_exp_f32 v86, v86
    v_exp_f32 v87, v87
    v_mfma_f32_16x16x32_bf16 v[148:151], v[188:191], a[76:79], v[148:151]
    ds_read_b64_tr_b16 v[174:175], v12 offset:12800
    v_add_f32 v84, 1.0, v84
    v_add_f32 v85, 1.0, v85
    v_mfma_f32_16x16x32_bf16 v[152:155], v[176:179], a[128:131], 0
    v_add_f32 v86, 1.0, v86
    v_add_f32 v87, 1.0, v87
    v_rcp_f32 v84, v84
    s_add_u32 s56, s56, 16384
    v_mfma_f32_16x16x32_bf16 v[152:155], v[180:183], a[132:135], v[152:155]
    v_rcp_f32 v85, v85
    v_rcp_f32 v86, v86
    v_rcp_f32 v87, v87
    s_and_b32 s56, s56, 0x1ffff
    v_mfma_f32_16x16x32_bf16 v[152:155], v[184:187], a[136:139], v[152:155]
    s_add_u32 m0, m0, 1024
    s_add_u32 s40, s40, s32
    v_mul_f32 v192, v192, v84
    v_mul_f32 v193, v193, v85
    v_mfma_f32_16x16x32_bf16 v[152:155], v[188:191], a[140:143], v[152:155]
    buffer_load_dwordx4 v3, s[8:11], s40 offen lds
    v_mul_f32 v194, v194, v86
    v_mul_f32 v195, v195, v87
    v_cvt_pk_bf16_f32 v192, v192, v193
    v_mfma_f32_16x16x32_bf16 v[156:159], v[176:179], a[192:195], 0
    s_add_u32 s57, s57, 16384
    s_and_b32 s57, s57, 0x1ffff
    s_add_u32 s31, s31, 1
    s_lshr_b32 s39, s31, 2
    v_mfma_f32_16x16x32_bf16 v[156:159], v[180:183], a[196:199], v[156:159]
    s_add_u32 s30, s30, s39
    s_and_b32 s31, s31, 3
    v_cvt_pk_bf16_f32 v193, v194, v195
    v_fma_f32 v196, v196, v32, v56
    v_mfma_f32_16x16x32_bf16 v[156:159], v[184:187], a[200:203], v[156:159]
    v_fma_f32 v197, v197, v32, v57
    v_fma_f32 v198, v198, v32, v58
    v_fma_f32 v199, v199, v32, v59
    v_mul_f32 v88, v196, v196
    v_mfma_f32_16x16x32_bf16 v[156:159], v[188:191], a[204:207], v[156:159]
    v_mul_f32 v89, v197, v197
    v_mul_f32 v90, v198, v198
    v_mul_f32 v91, v199, v199
    v_fma_f32 v88, v88, s43, v25
    v_mfma_f32_16x16x32_bf16 v[80:83], v[176:179], v[40:43], 0
    v_fma_f32 v89, v89, s43, v25
    v_fma_f32 v90, v90, s43, v25
    v_fma_f32 v91, v91, s43, v25
    v_mul_f32 v88, v88, v196
    v_mfma_f32_16x16x32_bf16 v[80:83], v[180:183], v[40:43], v[80:83]
    v_mul_f32 v89, v89, v197
    v_mul_f32 v90, v90, v198
    v_mul_f32 v91, v91, v199
    v_mov_b32 v8, v12
    v_mfma_f32_16x16x32_bf16 v[80:83], v[184:187], v[40:43], v[80:83]
    v_exp_f32 v88, v88
    v_exp_f32 v89, v89
    v_exp_f32 v90, v90
    v_mov_b32 v9, v13
    v_mfma_f32_16x16x32_bf16 v[80:83], v[188:191], v[40:43], v[80:83]
    v_exp_f32 v91, v91
    v_add_f32 v88, 1.0, v88
    v_mov_b32 v10, v14
    v_mov_b32 v11, v15
    v_add_u32 v12, s56, v4
    v_add_u32 v13, s56, v5
    v_add_u32 v14, s56, v6
    v_add_u32 v15, s56, v7
    s_waitcnt lgkmcnt(0)
    v_mfma_f32_16x16x32_bf16 v[96:99], v[160:163], a[16:19], v[96:99]
    ds_read_b64_tr_b16 v[176:177], v9 offset:0
    s_add_u32 s46, s29, 0
    s_lshl_b32 s46, s46, 7
    buffer_load_dwordx2 v[44:45], v24, s[16:19], s46 offen offset:0
    v_mfma_f32_16x16x32_bf16 v[96:99], v[164:167], a[20:23], v[96:99]
    ds_read_b64_tr_b16 v[178:179], v9 offset:512
    buffer_load_dwordx2 v[46:47], v24, s[16:19], s46 offen offset:32
    buffer_load_dwordx2 v[48:49], v24, s[16:19], s46 offen offset:64
    buffer_load_dwordx2 v[50:51], v24, s[16:19], s46 offen offset:96
    v_mfma_f32_16x16x32_bf16 v[96:99], v[168:171], a[24:27], v[96:99]
    ds_read_b64_tr_b16 v[180:181], v9 offset:4096
    s_lshl_b32 s40, s30, 7
    s_lshl_b32 s39, s31, 2
    s_add_u32 s39, s39, s35
    v_mfma_f32_16x16x32_bf16 v[96:99], v[172:175], a[28:31], v[96:99]
    ds_read_b64_tr_b16 v[182:183], v9 offset:4608
    s_lshl_b32 s39, s39, 2
    s_mul_i32 s39, s39, s32
    s_add_u32 s40, s40, s39
    v_mfma_f32_16x16x32_bf16 v[100:103], v[160:163], a[80:83], v[100:103]
    ds_read_b64_tr_b16 v[184:185], v9 offset:8192
    s_lshl_b32 s39, s35, 12
    s_add_u32 s39, s39, s57
    v_add_f32 v89, 1.0, v89
    v_mfma_f32_16x16x32_bf16 v[100:103], v[164:167], a[84:87], v[100:103]
    ds_read_b64_tr_b16 v[186:187], v9 offset:8704
    v_add_f32 v90, 1.0, v90
    v_add_f32 v91, 1.0, v91
    v_rcp_f32 v88, v88
    v_mfma_f32_16x16x32_bf16 v[100:103], v[168:171], a[88:91], v[100:103]
    ds_read_b64_tr_b16 v[188:189], v9 offset:12288
    v_rcp_f32 v89, v89
    v_rcp_f32 v90, v90
    v_rcp_f32 v91, v91
    v_mfma_f32_16x16x32_bf16 v[100:103], v[172:175], a[92:95], v[100:103]
    ds_read_b64_tr_b16 v[190:191], v9 offset:12800
    v_mul_f32 v196, v196, v88
    v_mul_f32 v197, v197, v89
    v_mul_f32 v198, v198, v90
    v_mfma_f32_16x16x32_bf16 v[104:107], v[160:163], a[144:147], v[104:107]
    v_mul_f32 v199, v199, v91
    v_cvt_pk_bf16_f32 v194, v196, v197
    v_cvt_pk_bf16_f32 v195, v198, v199
    buffer_store_dwordx4 v[192:195], v16, s[4:7], s34 offen offset:0 sc1
    v_mfma_f32_16x16x32_bf16 v[104:107], v[164:167], a[148:151], v[104:107]
    v_fma_f32 v200, v200, v33, v52
    v_fma_f32 v201, v201, v33, v53
    v_fma_f32 v202, v202, v33, v54
    v_fma_f32 v203, v203, v33, v55
    v_mfma_f32_16x16x32_bf16 v[104:107], v[168:171], a[152:155], v[104:107]
    s_mov_b32 m0, s39
    s_nop 0
    v_mul_f32 v84, v200, v200
    v_mul_f32 v85, v201, v201
    v_mfma_f32_16x16x32_bf16 v[104:107], v[172:175], a[156:159], v[104:107]
    buffer_load_dwordx4 v2, s[8:11], s40 offen lds
    v_mul_f32 v86, v202, v202
    v_mul_f32 v87, v203, v203
    v_fma_f32 v84, v84, s43, v25
    v_mfma_f32_16x16x32_bf16 v[108:111], v[160:163], a[208:211], v[108:111]
    v_fma_f32 v85, v85, s43, v25
    v_fma_f32 v86, v86, s43, v25
    v_fma_f32 v87, v87, s43, v25
    v_mul_f32 v84, v84, v200
    v_mfma_f32_16x16x32_bf16 v[108:111], v[164:167], a[212:215], v[108:111]
    v_mul_f32 v85, v85, v201
    v_mul_f32 v86, v86, v202
    v_mul_f32 v87, v87, v203
    v_exp_f32 v84, v84
    v_mfma_f32_16x16x32_bf16 v[108:111], v[168:171], a[216:219], v[108:111]
    v_exp_f32 v85, v85
    v_exp_f32 v86, v86
    v_exp_f32 v87, v87
    v_add_f32 v84, 1.0, v84
    v_mfma_f32_16x16x32_bf16 v[108:111], v[172:175], a[220:223], v[108:111]
    v_add_f32 v85, 1.0, v85
    v_add_f32 v86, 1.0, v86
    v_add_f32 v87, 1.0, v87
    v_rcp_f32 v84, v84
    v_mfma_f32_16x16x32_bf16 v[68:71], v[160:163], v[40:43], v[68:71]
    v_rcp_f32 v85, v85
    v_rcp_f32 v86, v86
    v_rcp_f32 v87, v87
    v_mul_f32 v200, v200, v84
    v_mfma_f32_16x16x32_bf16 v[68:71], v[164:167], v[40:43], v[68:71]
    v_mul_f32 v201, v201, v85
    v_mul_f32 v202, v202, v86
    v_mul_f32 v203, v203, v87
    v_cvt_pk_bf16_f32 v200, v200, v201
    v_mfma_f32_16x16x32_bf16 v[68:71], v[168:171], v[40:43], v[68:71]
    v_cvt_pk_bf16_f32 v201, v202, v203
    v_fma_f32 v204, v204, v33, v56
    v_fma_f32 v205, v205, v33, v57
    v_fma_f32 v206, v206, v33, v58
    v_mfma_f32_16x16x32_bf16 v[68:71], v[172:175], v[40:43], v[68:71]
    v_fma_f32 v207, v207, v33, v59
    v_mul_f32 v88, v204, v204
    v_mul_f32 v89, v205, v205
    v_mul_f32 v90, v206, v206
    s_waitcnt lgkmcnt(0)
    v_mfma_f32_16x16x32_bf16 v[112:115], v[176:179], a[16:19], v[112:115]
    ds_read_b64_tr_b16 v[160:161], v10 offset:0
    v_mul_f32 v91, v207, v207
    v_fma_f32 v88, v88, s43, v25
    v_fma_f32 v89, v89, s43, v25
    v_mfma_f32_16x16x32_bf16 v[112:115], v[180:183], a[20:23], v[112:115]
    ds_read_b64_tr_b16 v[162:163], v10 offset:512
    v_fma_f32 v90, v90, s43, v25
    v_fma_f32 v91, v91, s43, v25
    v_mul_f32 v88, v88, v204
    v_mfma_f32_16x16x32_bf16 v[112:115], v[184:187], a[24:27], v[112:115]
    ds_read_b64_tr_b16 v[164:165], v10 offset:4096
    v_mul_f32 v89, v89, v205
    v_mul_f32 v90, v90, v206
    v_mfma_f32_16x16x32_bf16 v[112:115], v[188:191], a[28:31], v[112:115]
    ds_read_b64_tr_b16 v[166:167], v10 offset:4608
    v_mul_f32 v91, v91, v207
    v_exp_f32 v88, v88
    v_exp_f32 v89, v89
    v_mfma_f32_16x16x32_bf16 v[116:119], v[176:179], a[80:83], v[116:119]
    ds_read_b64_tr_b16 v[168:169], v10 offset:8192
    v_exp_f32 v90, v90
    v_exp_f32 v91, v91
    v_add_f32 v88, 1.0, v88
    v_mfma_f32_16x16x32_bf16 v[116:119], v[180:183], a[84:87], v[116:119]
    ds_read_b64_tr_b16 v[170:171], v10 offset:8704
    v_add_f32 v89, 1.0, v89
    v_add_f32 v90, 1.0, v90
    v_add_f32 v91, 1.0, v91
    v_mfma_f32_16x16x32_bf16 v[116:119], v[184:187], a[88:91], v[116:119]
    ds_read_b64_tr_b16 v[172:173], v10 offset:12288
    v_rcp_f32 v88, v88
    v_rcp_f32 v89, v89
    v_mfma_f32_16x16x32_bf16 v[116:119], v[188:191], a[92:95], v[116:119]
    ds_read_b64_tr_b16 v[174:175], v10 offset:12800
    v_rcp_f32 v90, v90
    v_rcp_f32 v91, v91
    v_mul_f32 v204, v204, v88
    v_mfma_f32_16x16x32_bf16 v[120:123], v[176:179], a[144:147], v[120:123]
    v_mul_f32 v205, v205, v89
    v_mul_f32 v206, v206, v90
    v_mul_f32 v207, v207, v91
    v_mfma_f32_16x16x32_bf16 v[120:123], v[180:183], a[148:151], v[120:123]
    v_cvt_pk_bf16_f32 v202, v204, v205
    v_cvt_pk_bf16_f32 v203, v206, v207
    buffer_store_dwordx4 v[200:203], v17, s[4:7], s34 offen offset:0 sc1
    v_mfma_f32_16x16x32_bf16 v[120:123], v[184:187], a[152:155], v[120:123]
    s_add_u32 m0, m0, 1024
    s_add_u32 s40, s40, s32
    v_fma_f32 v208, v208, v34, v52
    v_fma_f32 v209, v209, v34, v53
    v_mfma_f32_16x16x32_bf16 v[120:123], v[188:191], a[156:159], v[120:123]
    buffer_load_dwordx4 v3, s[8:11], s40 offen lds
    v_fma_f32 v210, v210, v34, v54
    v_fma_f32 v211, v211, v34, v55
    v_mul_f32 v84, v208, v208
    v_mfma_f32_16x16x32_bf16 v[124:127], v[176:179], a[208:211], v[124:127]
    v_mul_f32 v85, v209, v209
    v_mul_f32 v86, v210, v210
    v_mul_f32 v87, v211, v211
    v_mfma_f32_16x16x32_bf16 v[124:127], v[180:183], a[212:215], v[124:127]
    v_fma_f32 v84, v84, s43, v25
    v_fma_f32 v85, v85, s43, v25
    v_fma_f32 v86, v86, s43, v25
    v_mfma_f32_16x16x32_bf16 v[124:127], v[184:187], a[216:219], v[124:127]
    v_fma_f32 v87, v87, s43, v25
    v_mul_f32 v84, v84, v208
    v_mfma_f32_16x16x32_bf16 v[124:127], v[188:191], a[220:223], v[124:127]
    v_mul_f32 v85, v85, v209
    v_mul_f32 v86, v86, v210
    v_mul_f32 v87, v87, v211
    v_mfma_f32_16x16x32_bf16 v[72:75], v[176:179], v[40:43], v[72:75]
    v_exp_f32 v84, v84
    v_exp_f32 v85, v85
    v_exp_f32 v86, v86
    v_mfma_f32_16x16x32_bf16 v[72:75], v[180:183], v[40:43], v[72:75]
    v_exp_f32 v87, v87
    v_add_f32 v84, 1.0, v84
    v_add_f32 v85, 1.0, v85
    v_mfma_f32_16x16x32_bf16 v[72:75], v[184:187], v[40:43], v[72:75]
    v_add_f32 v86, 1.0, v86
    v_add_f32 v87, 1.0, v87
    v_mfma_f32_16x16x32_bf16 v[72:75], v[188:191], v[40:43], v[72:75]
    v_rcp_f32 v84, v84
    v_rcp_f32 v85, v85
    v_rcp_f32 v86, v86
    s_waitcnt lgkmcnt(0)
    v_mfma_f32_16x16x32_bf16 v[128:131], v[160:163], a[16:19], v[128:131]
    ds_read_b64_tr_b16 v[176:177], v11 offset:0
    v_rcp_f32 v87, v87
    v_mul_f32 v208, v208, v84
    v_mul_f32 v209, v209, v85
    v_mfma_f32_16x16x32_bf16 v[128:131], v[164:167], a[20:23], v[128:131]
    ds_read_b64_tr_b16 v[178:179], v11 offset:512
    v_mul_f32 v210, v210, v86
    v_mul_f32 v211, v211, v87
    v_mfma_f32_16x16x32_bf16 v[128:131], v[168:171], a[24:27], v[128:131]
    ds_read_b64_tr_b16 v[180:181], v11 offset:4096
    v_cvt_pk_bf16_f32 v208, v208, v209
    v_cvt_pk_bf16_f32 v209, v210, v211
    v_fma_f32 v212, v212, v34, v56
    v_mfma_f32_16x16x32_bf16 v[128:131], v[172:175], a[28:31], v[128:131]
    ds_read_b64_tr_b16 v[182:183], v11 offset:4608
    v_fma_f32 v213, v213, v34, v57
    v_fma_f32 v214, v214, v34, v58
    v_fma_f32 v215, v215, v34, v59
    v_mfma_f32_16x16x32_bf16 v[132:135], v[160:163], a[80:83], v[132:135]
    ds_read_b64_tr_b16 v[184:185], v11 offset:8192
    v_mul_f32 v88, v212, v212
    v_mul_f32 v89, v213, v213
    v_mul_f32 v90, v214, v214
    v_mfma_f32_16x16x32_bf16 v[132:135], v[164:167], a[84:87], v[132:135]
    ds_read_b64_tr_b16 v[186:187], v11 offset:8704
    v_mul_f32 v91, v215, v215
    v_fma_f32 v88, v88, s43, v25
    v_mfma_f32_16x16x32_bf16 v[132:135], v[168:171], a[88:91], v[132:135]
    ds_read_b64_tr_b16 v[188:189], v11 offset:12288
    v_fma_f32 v89, v89, s43, v25
    v_fma_f32 v90, v90, s43, v25
    v_fma_f32 v91, v91, s43, v25
    v_mfma_f32_16x16x32_bf16 v[132:135], v[172:175], a[92:95], v[132:135]
    ds_read_b64_tr_b16 v[190:191], v11 offset:12800
    v_mul_f32 v88, v88, v212
    v_mul_f32 v89, v89, v213
    v_mul_f32 v90, v90, v214
    v_mfma_f32_16x16x32_bf16 v[136:139], v[160:163], a[144:147], v[136:139]
    v_mul_f32 v91, v91, v215
    v_exp_f32 v88, v88
    v_exp_f32 v89, v89
    v_mfma_f32_16x16x32_bf16 v[136:139], v[164:167], a[148:151], v[136:139]
    v_exp_f32 v90, v90
    v_exp_f32 v91, v91
    v_mfma_f32_16x16x32_bf16 v[136:139], v[168:171], a[152:155], v[136:139]
    s_add_u32 m0, m0, 1024
    s_add_u32 s40, s40, s32
    v_add_f32 v88, 1.0, v88
    v_add_f32 v89, 1.0, v89
    v_mfma_f32_16x16x32_bf16 v[136:139], v[172:175], a[156:159], v[136:139]
    buffer_load_dwordx4 v2, s[8:11], s40 offen lds
    v_add_f32 v90, 1.0, v90
    v_add_f32 v91, 1.0, v91
    v_rcp_f32 v88, v88
    v_mfma_f32_16x16x32_bf16 v[140:143], v[160:163], a[208:211], v[140:143]
    v_rcp_f32 v89, v89
    v_rcp_f32 v90, v90
    v_rcp_f32 v91, v91
    v_mul_f32 v212, v212, v88
    v_mfma_f32_16x16x32_bf16 v[140:143], v[164:167], a[212:215], v[140:143]
    v_mul_f32 v213, v213, v89
    v_mul_f32 v214, v214, v90
    v_mfma_f32_16x16x32_bf16 v[140:143], v[168:171], a[216:219], v[140:143]
    v_mul_f32 v215, v215, v91
    v_cvt_pk_bf16_f32 v210, v212, v213
    v_cvt_pk_bf16_f32 v211, v214, v215
    v_mfma_f32_16x16x32_bf16 v[140:143], v[172:175], a[220:223], v[140:143]
    buffer_store_dwordx4 v[208:211], v18, s[4:7], s34 offen offset:0 sc1
    v_fma_f32 v216, v216, v35, v52
    v_fma_f32 v217, v217, v35, v53
    v_mfma_f32_16x16x32_bf16 v[76:79], v[160:163], v[40:43], v[76:79]
    v_fma_f32 v218, v218, v35, v54
    v_fma_f32 v219, v219, v35, v55
    v_mul_f32 v84, v216, v216
    v_mfma_f32_16x16x32_bf16 v[76:79], v[164:167], v[40:43], v[76:79]
    v_mul_f32 v85, v217, v217
    v_mul_f32 v86, v218, v218
    v_mfma_f32_16x16x32_bf16 v[76:79], v[168:171], v[40:43], v[76:79]
    v_mul_f32 v87, v219, v219
    v_fma_f32 v84, v84, s43, v25
    v_fma_f32 v85, v85, s43, v25
    v_mfma_f32_16x16x32_bf16 v[76:79], v[172:175], v[40:43], v[76:79]
    v_fma_f32 v86, v86, s43, v25
    v_fma_f32 v87, v87, s43, v25
    v_mul_f32 v84, v84, v216
    s_waitcnt lgkmcnt(0)
    v_mfma_f32_16x16x32_bf16 v[144:147], v[176:179], a[16:19], v[144:147]
    ds_read_b64_tr_b16 v[160:161], v12 offset:0
    v_mul_f32 v85, v85, v217
    v_mul_f32 v86, v86, v218
    v_mfma_f32_16x16x32_bf16 v[144:147], v[180:183], a[20:23], v[144:147]
    ds_read_b64_tr_b16 v[162:163], v12 offset:512
    v_mul_f32 v87, v87, v219
    v_exp_f32 v84, v84
    v_exp_f32 v85, v85
    v_mfma_f32_16x16x32_bf16 v[144:147], v[184:187], a[24:27], v[144:147]
    ds_read_b64_tr_b16 v[164:165], v12 offset:4096
    v_exp_f32 v86, v86
    v_exp_f32 v87, v87
    v_add_f32 v84, 1.0, v84
    v_mfma_f32_16x16x32_bf16 v[144:147], v[188:191], a[28:31], v[144:147]
    ds_read_b64_tr_b16 v[166:167], v12 offset:4608
    v_add_f32 v85, 1.0, v85
    v_add_f32 v86, 1.0, v86
    v_add_f32 v87, 1.0, v87
    v_mfma_f32_16x16x32_bf16 v[148:151], v[176:179], a[80:83], v[148:151]
    ds_read_b64_tr_b16 v[168:169], v12 offset:8192
    v_rcp_f32 v84, v84
    v_rcp_f32 v85, v85
    v_mfma_f32_16x16x32_bf16 v[148:151], v[180:183], a[84:87], v[148:151]
    ds_read_b64_tr_b16 v[170:171], v12 offset:8704
    v_rcp_f32 v86, v86
    v_rcp_f32 v87, v87
    v_mul_f32 v216, v216, v84
    v_mfma_f32_16x16x32_bf16 v[148:151], v[184:187], a[88:91], v[148:151]
    ds_read_b64_tr_b16 v[172:173], v12 offset:12288
    v_mul_f32 v217, v217, v85
    v_mul_f32 v218, v218, v86
    v_mul_f32 v219, v219, v87
    v_mfma_f32_16x16x32_bf16 v[148:151], v[188:191], a[92:95], v[148:151]
    ds_read_b64_tr_b16 v[174:175], v12 offset:12800
    v_cvt_pk_bf16_f32 v216, v216, v217
    v_cvt_pk_bf16_f32 v217, v218, v219
    v_fma_f32 v220, v220, v35, v56
    v_mfma_f32_16x16x32_bf16 v[152:155], v[176:179], a[144:147], v[152:155]
    v_fma_f32 v221, v221, v35, v57
    v_fma_f32 v222, v222, v35, v58
    s_add_u32 s56, s56, 16384
    s_and_b32 s56, s56, 0x1ffff
    v_mfma_f32_16x16x32_bf16 v[152:155], v[180:183], a[148:151], v[152:155]
    v_fma_f32 v223, v223, v35, v59
    v_mul_f32 v88, v220, v220
    v_mul_f32 v89, v221, v221
    v_mov_b32 v8, v12
    v_mfma_f32_16x16x32_bf16 v[152:155], v[184:187], a[152:155], v[152:155]
    s_add_u32 m0, m0, 1024
    s_add_u32 s40, s40, s32
    v_mul_f32 v90, v222, v222
    v_mul_f32 v91, v223, v223
    v_mfma_f32_16x16x32_bf16 v[152:155], v[188:191], a[156:159], v[152:155]
    buffer_load_dwordx4 v3, s[8:11], s40 offen lds
    v_fma_f32 v88, v88, s43, v25
    v_fma_f32 v89, v89, s43, v25
    v_fma_f32 v90, v90, s43, v25
    v_mfma_f32_16x16x32_bf16 v[156:159], v[176:179], a[208:211], v[156:159]
    s_add_u32 s57, s57, 16384
    s_and_b32 s57, s57, 0x1ffff
    s_add_u32 s31, s31, 1
    s_lshr_b32 s39, s31, 2
    v_mfma_f32_16x16x32_bf16 v[156:159], v[180:183], a[212:215], v[156:159]
    s_add_u32 s30, s30, s39
    s_and_b32 s31, s31, 3
    v_fma_f32 v91, v91, s43, v25
    v_mul_f32 v88, v88, v220
    v_mfma_f32_16x16x32_bf16 v[156:159], v[184:187], a[216:219], v[156:159]
    v_mul_f32 v89, v89, v221
    v_mul_f32 v90, v90, v222
    v_mul_f32 v91, v91, v223
    v_exp_f32 v88, v88
    v_mfma_f32_16x16x32_bf16 v[156:159], v[188:191], a[220:223], v[156:159]
    v_exp_f32 v89, v89
    v_exp_f32 v90, v90
    v_exp_f32 v91, v91
    v_add_f32 v88, 1.0, v88
    v_mfma_f32_16x16x32_bf16 v[80:83], v[176:179], v[40:43], v[80:83]
    v_add_f32 v89, 1.0, v89
    v_add_f32 v90, 1.0, v90
    v_add_f32 v91, 1.0, v91
    v_rcp_f32 v88, v88
    v_mfma_f32_16x16x32_bf16 v[80:83], v[180:183], v[40:43], v[80:83]
    v_rcp_f32 v89, v89
    v_rcp_f32 v90, v90
    v_rcp_f32 v91, v91
    v_mov_b32 v9, v13
    v_mfma_f32_16x16x32_bf16 v[80:83], v[184:187], v[40:43], v[80:83]
    v_mul_f32 v220, v220, v88
    v_mul_f32 v221, v221, v89
    v_mul_f32 v222, v222, v90
    v_mov_b32 v10, v14
    v_mfma_f32_16x16x32_bf16 v[80:83], v[188:191], v[40:43], v[80:83]
    v_mul_f32 v223, v223, v91
    v_cvt_pk_bf16_f32 v218, v220, v221
    v_mov_b32 v11, v15
    v_add_u32 v12, s56, v4
    v_add_u32 v13, s56, v5
    v_add_u32 v14, s56, v6
    v_add_u32 v15, s56, v7
    s_waitcnt vmcnt(19)
    s_barrier
    s_waitcnt lgkmcnt(0)
    v_mfma_f32_16x16x32_bf16 v[96:99], v[160:163], a[32:35], v[96:99]
    ds_read_b64_tr_b16 v[176:177], v9 offset:0
    s_lshl_b32 s40, s30, 7
    s_lshl_b32 s39, s31, 2
    s_add_u32 s39, s39, s35
    v_mfma_f32_16x16x32_bf16 v[96:99], v[164:167], a[36:39], v[96:99]
    ds_read_b64_tr_b16 v[178:179], v9 offset:512
    s_lshl_b32 s39, s39, 2
    s_mul_i32 s39, s39, s32
    s_add_u32 s40, s40, s39
    v_mfma_f32_16x16x32_bf16 v[96:99], v[168:171], a[40:43], v[96:99]
    ds_read_b64_tr_b16 v[180:181], v9 offset:4096
    s_lshl_b32 s39, s35, 12
    s_add_u32 s39, s39, s57
    v_cvt_pk_bf16_f32 v219, v222, v223
    v_mfma_f32_16x16x32_bf16 v[96:99], v[172:175], a[44:47], v[96:99]
    ds_read_b64_tr_b16 v[182:183], v9 offset:4608
    buffer_store_dwordx4 v[216:219], v19, s[4:7], s34 offen offset:0 sc1
    v_fma_f32 v224, v224, v32, v60
    v_fma_f32 v225, v225, v32, v61
    v_mfma_f32_16x16x32_bf16 v[100:103], v[160:163], a[96:99], v[100:103]
    ds_read_b64_tr_b16 v[184:185], v9 offset:8192
    v_fma_f32 v226, v226, v32, v62
    v_fma_f32 v227, v227, v32, v63
    v_mul_f32 v84, v224, v224
    v_mfma_f32_16x16x32_bf16 v[100:103], v[164:167], a[100:103], v[100:103]
    ds_read_b64_tr_b16 v[186:187], v9 offset:8704
    v_mul_f32 v85, v225, v225
    v_mul_f32 v86, v226, v226
    v_mul_f32 v87, v227, v227
    v_mfma_f32_16x16x32_bf16 v[100:103], v[168:171], a[104:107], v[100:103]
    ds_read_b64_tr_b16 v[188:189], v9 offset:12288
    v_fma_f32 v84, v84, s43, v25
    v_fma_f32 v85, v85, s43, v25
    v_fma_f32 v86, v86, s43, v25
    v_mfma_f32_16x16x32_bf16 v[100:103], v[172:175], a[108:111], v[100:103]
    ds_read_b64_tr_b16 v[190:191], v9 offset:12800
    v_fma_f32 v87, v87, s43, v25
    v_mul_f32 v84, v84, v224
    v_mul_f32 v85, v85, v225
    v_mfma_f32_16x16x32_bf16 v[104:107], v[160:163], a[160:163], v[104:107]
    v_mul_f32 v86, v86, v226
    v_mul_f32 v87, v87, v227
    v_exp_f32 v84, v84
    v_exp_f32 v85, v85
    v_mfma_f32_16x16x32_bf16 v[104:107], v[164:167], a[164:167], v[104:107]
    v_exp_f32 v86, v86
    v_exp_f32 v87, v87
    v_add_f32 v84, 1.0, v84
    v_add_f32 v85, 1.0, v85
    v_mfma_f32_16x16x32_bf16 v[104:107], v[168:171], a[168:171], v[104:107]
    s_mov_b32 m0, s39
    s_nop 0
    v_add_f32 v86, 1.0, v86
    v_add_f32 v87, 1.0, v87
    v_mfma_f32_16x16x32_bf16 v[104:107], v[172:175], a[172:175], v[104:107]
    buffer_load_dwordx4 v2, s[8:11], s40 offen lds
    v_rcp_f32 v84, v84
    v_rcp_f32 v85, v85
    v_rcp_f32 v86, v86
    v_mfma_f32_16x16x32_bf16 v[108:111], v[160:163], a[224:227], v[108:111]
    v_rcp_f32 v87, v87
    v_mul_f32 v224, v224, v84
    v_mul_f32 v225, v225, v85
    v_mul_f32 v226, v226, v86
    v_mfma_f32_16x16x32_bf16 v[108:111], v[164:167], a[228:231], v[108:111]
    v_mul_f32 v227, v227, v87
    v_cvt_pk_bf16_f32 v224, v224, v225
    v_cvt_pk_bf16_f32 v225, v226, v227
    v_fma_f32 v228, v228, v32, v64
    v_mfma_f32_16x16x32_bf16 v[108:111], v[168:171], a[232:235], v[108:111]
    v_fma_f32 v229, v229, v32, v65
    v_fma_f32 v230, v230, v32, v66
    v_fma_f32 v231, v231, v32, v67
    v_mul_f32 v88, v228, v228
    v_mfma_f32_16x16x32_bf16 v[108:111], v[172:175], a[236:239], v[108:111]
    v_mul_f32 v89, v229, v229
    v_mul_f32 v90, v230, v230
    v_mul_f32 v91, v231, v231
    v_mfma_f32_16x16x32_bf16 v[68:71], v[160:163], v[40:43], v[68:71]
    v_fma_f32 v88, v88, s43, v25
    v_fma_f32 v89, v89, s43, v25
    v_fma_f32 v90, v90, s43, v25
    v_mfma_f32_16x16x32_bf16 v[68:71], v[164:167], v[40:43], v[68:71]
    v_fma_f32 v91, v91, s43, v25
    v_mul_f32 v88, v88, v228
    v_mul_f32 v89, v89, v229
    v_mfma_f32_16x16x32_bf16 v[68:71], v[168:171], v[40:43], v[68:71]
    v_mul_f32 v90, v90, v230
    v_mul_f32 v91, v91, v231
    v_exp_f32 v88, v88
    v_mfma_f32_16x16x32_bf16 v[68:71], v[172:175], v[40:43], v[68:71]
    v_exp_f32 v89, v89
    v_exp_f32 v90, v90
    s_waitcnt lgkmcnt(0)
    v_mfma_f32_16x16x32_bf16 v[112:115], v[176:179], a[32:35], v[112:115]
    ds_read_b64_tr_b16 v[160:161], v10 offset:0
    v_exp_f32 v91, v91
    v_add_f32 v88, 1.0, v88
    v_add_f32 v89, 1.0, v89
    v_mfma_f32_16x16x32_bf16 v[112:115], v[180:183], a[36:39], v[112:115]
    ds_read_b64_tr_b16 v[162:163], v10 offset:512
    v_add_f32 v90, 1.0, v90
    v_add_f32 v91, 1.0, v91
    v_rcp_f32 v88, v88
    v_mfma_f32_16x16x32_bf16 v[112:115], v[184:187], a[40:43], v[112:115]
    ds_read_b64_tr_b16 v[164:165], v10 offset:4096
    v_rcp_f32 v89, v89
    v_rcp_f32 v90, v90
    v_mfma_f32_16x16x32_bf16 v[112:115], v[188:191], a[44:47], v[112:115]
    ds_read_b64_tr_b16 v[166:167], v10 offset:4608
    v_rcp_f32 v91, v91
    v_mul_f32 v228, v228, v88
    v_mul_f32 v229, v229, v89
    v_mfma_f32_16x16x32_bf16 v[116:119], v[176:179], a[96:99], v[116:119]
    ds_read_b64_tr_b16 v[168:169], v10 offset:8192
    v_mul_f32 v230, v230, v90
    v_mul_f32 v231, v231, v91
    v_cvt_pk_bf16_f32 v226, v228, v229
    v_mfma_f32_16x16x32_bf16 v[116:119], v[180:183], a[100:103], v[116:119]
    ds_read_b64_tr_b16 v[170:171], v10 offset:8704
    v_cvt_pk_bf16_f32 v227, v230, v231
    buffer_store_dwordx4 v[224:227], v16, s[4:7], s59 offen offset:0 sc1
    v_fma_f32 v232, v232, v33, v60
    v_mfma_f32_16x16x32_bf16 v[116:119], v[184:187], a[104:107], v[116:119]
    ds_read_b64_tr_b16 v[172:173], v10 offset:12288
    v_fma_f32 v233, v233, v33, v61
    v_fma_f32 v234, v234, v33, v62
    v_mfma_f32_16x16x32_bf16 v[116:119], v[188:191], a[108:111], v[116:119]
    ds_read_b64_tr_b16 v[174:175], v10 offset:12800
    v_fma_f32 v235, v235, v33, v63
    v_mul_f32 v84, v232, v232
    v_mul_f32 v85, v233, v233
    v_mfma_f32_16x16x32_bf16 v[120:123], v[176:179], a[160:163], v[120:123]
    v_mul_f32 v86, v234, v234
    v_mul_f32 v87, v235, v235
    v_fma_f32 v84, v84, s43, v25
    v_mfma_f32_16x16x32_bf16 v[120:123], v[180:183], a[164:167], v[120:123]
    v_fma_f32 v85, v85, s43, v25
    v_fma_f32 v86, v86, s43, v25
    v_fma_f32 v87, v87, s43, v25
    v_mfma_f32_16x16x32_bf16 v[120:123], v[184:187], a[168:171], v[120:123]
    s_add_u32 m0, m0, 1024
    s_add_u32 s40, s40, s32
    v_mul_f32 v84, v84, v232
    v_mul_f32 v85, v85, v233
    v_mfma_f32_16x16x32_bf16 v[120:123], v[188:191], a[172:175], v[120:123]
    buffer_load_dwordx4 v3, s[8:11], s40 offen lds
    v_mul_f32 v86, v86, v234
    v_mul_f32 v87, v87, v235
    v_exp_f32 v84, v84
    v_mfma_f32_16x16x32_bf16 v[124:127], v[176:179], a[224:227], v[124:127]
    v_exp_f32 v85, v85
    v_exp_f32 v86, v86
    v_exp_f32 v87, v87
    v_mfma_f32_16x16x32_bf16 v[124:127], v[180:183], a[228:231], v[124:127]
    v_add_f32 v84, 1.0, v84
    v_add_f32 v85, 1.0, v85
    v_add_f32 v86, 1.0, v86
    v_mfma_f32_16x16x32_bf16 v[124:127], v[184:187], a[232:235], v[124:127]
    v_add_f32 v87, 1.0, v87
    v_rcp_f32 v84, v84
    v_mfma_f32_16x16x32_bf16 v[124:127], v[188:191], a[236:239], v[124:127]
    v_rcp_f32 v85, v85
    v_rcp_f32 v86, v86
    v_rcp_f32 v87, v87
    v_mfma_f32_16x16x32_bf16 v[72:75], v[176:179], v[40:43], v[72:75]
    v_mul_f32 v232, v232, v84
    v_mul_f32 v233, v233, v85
    v_mul_f32 v234, v234, v86
    v_mfma_f32_16x16x32_bf16 v[72:75], v[180:183], v[40:43], v[72:75]
    v_mul_f32 v235, v235, v87
    v_cvt_pk_bf16_f32 v232, v232, v233
    v_cvt_pk_bf16_f32 v233, v234, v235
    v_mfma_f32_16x16x32_bf16 v[72:75], v[184:187], v[40:43], v[72:75]
    v_fma_f32 v236, v236, v33, v64
    v_fma_f32 v237, v237, v33, v65
    v_mfma_f32_16x16x32_bf16 v[72:75], v[188:191], v[40:43], v[72:75]
    v_fma_f32 v238, v238, v33, v66
    v_fma_f32 v239, v239, v33, v67
    v_mul_f32 v88, v236, v236
    s_waitcnt lgkmcnt(0)
    v_mfma_f32_16x16x32_bf16 v[128:131], v[160:163], a[32:35], v[128:131]
    ds_read_b64_tr_b16 v[176:177], v11 offset:0
    v_mul_f32 v89, v237, v237
    v_mul_f32 v90, v238, v238
    v_mul_f32 v91, v239, v239
    v_mfma_f32_16x16x32_bf16 v[128:131], v[164:167], a[36:39], v[128:131]
    ds_read_b64_tr_b16 v[178:179], v11 offset:512
    v_fma_f32 v88, v88, s43, v25
    v_fma_f32 v89, v89, s43, v25
    v_mfma_f32_16x16x32_bf16 v[128:131], v[168:171], a[40:43], v[128:131]
    ds_read_b64_tr_b16 v[180:181], v11 offset:4096
    v_fma_f32 v90, v90, s43, v25
    v_fma_f32 v91, v91, s43, v25
    v_mul_f32 v88, v88, v236
    v_mfma_f32_16x16x32_bf16 v[128:131], v[172:175], a[44:47], v[128:131]
    ds_read_b64_tr_b16 v[182:183], v11 offset:4608
    v_mul_f32 v89, v89, v237
    v_mul_f32 v90, v90, v238
    v_mul_f32 v91, v91, v239
    v_mfma_f32_16x16x32_bf16 v[132:135], v[160:163], a[96:99], v[132:135]
    ds_read_b64_tr_b16 v[184:185], v11 offset:8192
    v_exp_f32 v88, v88
    v_exp_f32 v89, v89
    v_exp_f32 v90, v90
    v_mfma_f32_16x16x32_bf16 v[132:135], v[164:167], a[100:103], v[132:135]
    ds_read_b64_tr_b16 v[186:187], v11 offset:8704
    v_exp_f32 v91, v91
    v_add_f32 v88, 1.0, v88
    v_mfma_f32_16x16x32_bf16 v[132:135], v[168:171], a[104:107], v[132:135]
    ds_read_b64_tr_b16 v[188:189], v11 offset:12288
    v_add_f32 v89, 1.0, v89
    v_add_f32 v90, 1.0, v90
    v_add_f32 v91, 1.0, v91
    v_mfma_f32_16x16x32_bf16 v[132:135], v[172:175], a[108:111], v[132:135]
    ds_read_b64_tr_b16 v[190:191], v11 offset:12800
    v_rcp_f32 v88, v88
    v_rcp_f32 v89, v89
    v_rcp_f32 v90, v90
    v_mfma_f32_16x16x32_bf16 v[136:139], v[160:163], a[160:163], v[136:139]
    v_rcp_f32 v91, v91
    v_mul_f32 v236, v236, v88
    v_mul_f32 v237, v237, v89
    v_mfma_f32_16x16x32_bf16 v[136:139], v[164:167], a[164:167], v[136:139]
    v_mul_f32 v238, v238, v90
    v_mul_f32 v239, v239, v91
    v_mfma_f32_16x16x32_bf16 v[136:139], v[168:171], a[168:171], v[136:139]
    s_add_u32 m0, m0, 1024
    s_add_u32 s40, s40, s32
    v_cvt_pk_bf16_f32 v234, v236, v237
    v_cvt_pk_bf16_f32 v235, v238, v239
    v_mfma_f32_16x16x32_bf16 v[136:139], v[172:175], a[172:175], v[136:139]
    buffer_load_dwordx4 v2, s[8:11], s40 offen lds
    buffer_store_dwordx4 v[232:235], v17, s[4:7], s59 offen offset:0 sc1
    v_fma_f32 v240, v240, v34, v60
    v_fma_f32 v241, v241, v34, v61
    v_mfma_f32_16x16x32_bf16 v[140:143], v[160:163], a[224:227], v[140:143]
    v_fma_f32 v242, v242, v34, v62
    v_fma_f32 v243, v243, v34, v63
    v_mul_f32 v84, v240, v240
    v_mul_f32 v85, v241, v241
    v_mfma_f32_16x16x32_bf16 v[140:143], v[164:167], a[228:231], v[140:143]
    v_mul_f32 v86, v242, v242
    v_mul_f32 v87, v243, v243
    v_mfma_f32_16x16x32_bf16 v[140:143], v[168:171], a[232:235], v[140:143]
    v_fma_f32 v84, v84, s43, v25
    v_fma_f32 v85, v85, s43, v25
    v_fma_f32 v86, v86, s43, v25
    v_mfma_f32_16x16x32_bf16 v[140:143], v[172:175], a[236:239], v[140:143]
    v_fma_f32 v87, v87, s43, v25
    v_mul_f32 v84, v84, v240
    v_mul_f32 v85, v85, v241
    v_mfma_f32_16x16x32_bf16 v[76:79], v[160:163], v[40:43], v[76:79]
    v_mul_f32 v86, v86, v242
    v_mul_f32 v87, v87, v243
    v_exp_f32 v84, v84
    v_mfma_f32_16x16x32_bf16 v[76:79], v[164:167], v[40:43], v[76:79]
    v_exp_f32 v85, v85
    v_exp_f32 v86, v86
    v_mfma_f32_16x16x32_bf16 v[76:79], v[168:171], v[40:43], v[76:79]
    v_exp_f32 v87, v87
    v_add_f32 v84, 1.0, v84
    v_add_f32 v85, 1.0, v85
    v_mfma_f32_16x16x32_bf16 v[76:79], v[172:175], v[40:43], v[76:79]
    v_add_f32 v86, 1.0, v86
    v_add_f32 v87, 1.0, v87
    v_rcp_f32 v84, v84
    s_waitcnt lgkmcnt(0)
    v_mfma_f32_16x16x32_bf16 v[144:147], v[176:179], a[32:35], v[144:147]
    ds_read_b64_tr_b16 v[160:161], v12 offset:0
    v_rcp_f32 v85, v85
    v_rcp_f32 v86, v86
    v_mfma_f32_16x16x32_bf16 v[144:147], v[180:183], a[36:39], v[144:147]
    ds_read_b64_tr_b16 v[162:163], v12 offset:512
    v_rcp_f32 v87, v87
    v_mul_f32 v240, v240, v84
    v_mul_f32 v241, v241, v85
    v_mfma_f32_16x16x32_bf16 v[144:147], v[184:187], a[40:43], v[144:147]
    ds_read_b64_tr_b16 v[164:165], v12 offset:4096
    v_mul_f32 v242, v242, v86
    v_mul_f32 v243, v243, v87
    v_cvt_pk_bf16_f32 v240, v240, v241
    v_mfma_f32_16x16x32_bf16 v[144:147], v[188:191], a[44:47], v[144:147]
    ds_read_b64_tr_b16 v[166:167], v12 offset:4608
    v_cvt_pk_bf16_f32 v241, v242, v243
    v_fma_f32 v244, v244, v34, v64
    v_fma_f32 v245, v245, v34, v65
    v_mfma_f32_16x16x32_bf16 v[148:151], v[176:179], a[96:99], v[148:151]
    ds_read_b64_tr_b16 v[168:169], v12 offset:8192
    v_fma_f32 v246, v246, v34, v66
    v_fma_f32 v247, v247, v34, v67
    v_mfma_f32_16x16x32_bf16 v[148:151], v[180:183], a[100:103], v[148:151]
    ds_read_b64_tr_b16 v[170:171], v12 offset:8704
    v_mul_f32 v88, v244, v244
    v_mul_f32 v89, v245, v245
    v_mul_f32 v90, v246, v246
    v_mfma_f32_16x16x32_bf16 v[148:151], v[184:187], a[104:107], v[148:151]
    ds_read_b64_tr_b16 v[172:173], v12 offset:12288
    v_mul_f32 v91, v247, v247
    v_fma_f32 v88, v88, s43, v25
    v_fma_f32 v89, v89, s43, v25
    v_mfma_f32_16x16x32_bf16 v[148:151], v[188:191], a[108:111], v[148:151]
    ds_read_b64_tr_b16 v[174:175], v12 offset:12800
    v_fma_f32 v90, v90, s43, v25
    v_fma_f32 v91, v91, s43, v25
    v_mul_f32 v88, v88, v244
    v_mfma_f32_16x16x32_bf16 v[152:155], v[176:179], a[160:163], v[152:155]
    v_mul_f32 v89, v89, v245
    v_mul_f32 v90, v90, v246
    s_add_u32 s56, s56, 16384
    s_and_b32 s56, s56, 0x1ffff
    v_mfma_f32_16x16x32_bf16 v[152:155], v[180:183], a[164:167], v[152:155]
    v_mul_f32 v91, v91, v247
    v_exp_f32 v88, v88
    v_exp_f32 v89, v89
    v_mov_b32 v8, v12
    v_mfma_f32_16x16x32_bf16 v[152:155], v[184:187], a[168:171], v[152:155]
    s_add_u32 m0, m0, 1024
    s_add_u32 s40, s40, s32
    v_exp_f32 v90, v90
    v_exp_f32 v91, v91
    v_mfma_f32_16x16x32_bf16 v[152:155], v[188:191], a[172:175], v[152:155]
    buffer_load_dwordx4 v3, s[8:11], s40 offen lds
    v_add_f32 v88, 1.0, v88
    v_add_f32 v89, 1.0, v89
    v_add_f32 v90, 1.0, v90
    v_mfma_f32_16x16x32_bf16 v[156:159], v[176:179], a[224:227], v[156:159]
    s_add_u32 s57, s57, 16384
    s_and_b32 s57, s57, 0x1ffff
    s_add_u32 s31, s31, 1
    s_lshr_b32 s39, s31, 2
    v_mfma_f32_16x16x32_bf16 v[156:159], v[180:183], a[228:231], v[156:159]
    s_add_u32 s30, s30, s39
    s_and_b32 s31, s31, 3
    s_add_u32 s79, s29, 3
    s_lshl_b32 s79, s79, 7
    v_mfma_f32_16x16x32_bf16 v[156:159], v[184:187], a[232:235], v[156:159]
    buffer_load_dword v27, v22, s[8:11], s79 offen
    v_add_f32 v91, 1.0, v91
    v_rcp_f32 v88, v88
    v_rcp_f32 v89, v89
    v_mfma_f32_16x16x32_bf16 v[156:159], v[188:191], a[236:239], v[156:159]
    v_rcp_f32 v90, v90
    v_rcp_f32 v91, v91
    v_mul_f32 v244, v244, v88
    v_mul_f32 v245, v245, v89
    v_mfma_f32_16x16x32_bf16 v[80:83], v[176:179], v[40:43], v[80:83]
    v_mul_f32 v246, v246, v90
    v_mul_f32 v247, v247, v91
    v_cvt_pk_bf16_f32 v242, v244, v245
    v_cvt_pk_bf16_f32 v243, v246, v247
    v_mfma_f32_16x16x32_bf16 v[80:83], v[180:183], v[40:43], v[80:83]
    buffer_store_dwordx4 v[240:243], v18, s[4:7], s59 offen offset:0 sc1
    v_fma_f32 v248, v248, v35, v60
    v_fma_f32 v249, v249, v35, v61
    v_fma_f32 v250, v250, v35, v62
    v_mfma_f32_16x16x32_bf16 v[80:83], v[184:187], v[40:43], v[80:83]
    v_fma_f32 v251, v251, v35, v63
    v_mul_f32 v84, v248, v248
    v_mul_f32 v85, v249, v249
    v_mul_f32 v86, v250, v250
    v_mfma_f32_16x16x32_bf16 v[80:83], v[188:191], v[40:43], v[80:83]
    v_mul_f32 v87, v251, v251
    v_fma_f32 v84, v84, s43, v25
    v_fma_f32 v85, v85, s43, v25
    v_mov_b32 v9, v13
    v_mov_b32 v10, v14
    v_mov_b32 v11, v15
    v_add_u32 v12, s56, v4
    v_add_u32 v13, s56, v5
    v_add_u32 v14, s56, v6
    v_add_u32 v15, s56, v7
    s_waitcnt lgkmcnt(0)
    v_mfma_f32_16x16x32_bf16 v[96:99], v[160:163], a[48:51], v[96:99]
    ds_read_b64_tr_b16 v[176:177], v9 offset:0
    s_lshl_b32 s40, s30, 7
    s_lshl_b32 s39, s31, 2
    s_add_u32 s39, s39, s35
    v_mfma_f32_16x16x32_bf16 v[96:99], v[164:167], a[52:55], v[96:99]
    ds_read_b64_tr_b16 v[178:179], v9 offset:512
    s_lshl_b32 s39, s39, 2
    s_mul_i32 s39, s39, s32
    s_add_u32 s40, s40, s39
    v_mfma_f32_16x16x32_bf16 v[96:99], v[168:171], a[56:59], v[96:99]
    ds_read_b64_tr_b16 v[180:181], v9 offset:4096
    s_lshl_b32 s39, s35, 12
    s_add_u32 s39, s39, s57
    v_fma_f32 v86, v86, s43, v25
    v_mfma_f32_16x16x32_bf16 v[96:99], v[172:175], a[60:63], v[96:99]
    ds_read_b64_tr_b16 v[182:183], v9 offset:4608
    v_fma_f32 v87, v87, s43, v25
    v_mul_f32 v84, v84, v248
    v_mul_f32 v85, v85, v249
    v_mfma_f32_16x16x32_bf16 v[100:103], v[160:163], a[112:115], v[100:103]
    ds_read_b64_tr_b16 v[184:185], v9 offset:8192
    v_mul_f32 v86, v86, v250
    v_mul_f32 v87, v87, v251
    v_exp_f32 v84, v84
    v_mfma_f32_16x16x32_bf16 v[100:103], v[164:167], a[116:119], v[100:103]
    ds_read_b64_tr_b16 v[186:187], v9 offset:8704
    v_exp_f32 v85, v85
    v_exp_f32 v86, v86
    v_exp_f32 v87, v87
    v_mfma_f32_16x16x32_bf16 v[100:103], v[168:171], a[120:123], v[100:103]
    ds_read_b64_tr_b16 v[188:189], v9 offset:12288
    v_add_f32 v84, 1.0, v84
    v_add_f32 v85, 1.0, v85
    v_add_f32 v86, 1.0, v86
    v_mfma_f32_16x16x32_bf16 v[100:103], v[172:175], a[124:127], v[100:103]
    ds_read_b64_tr_b16 v[190:191], v9 offset:12800
    v_add_f32 v87, 1.0, v87
    v_rcp_f32 v84, v84
    v_rcp_f32 v85, v85
    v_mfma_f32_16x16x32_bf16 v[104:107], v[160:163], a[176:179], v[104:107]
    v_rcp_f32 v86, v86
    v_rcp_f32 v87, v87
    v_mul_f32 v248, v248, v84
    v_mul_f32 v249, v249, v85
    v_mfma_f32_16x16x32_bf16 v[104:107], v[164:167], a[180:183], v[104:107]
    v_mul_f32 v250, v250, v86
    v_mul_f32 v251, v251, v87
    v_cvt_pk_bf16_f32 v248, v248, v249
    v_cvt_pk_bf16_f32 v249, v250, v251
    v_mfma_f32_16x16x32_bf16 v[104:107], v[168:171], a[184:187], v[104:107]
    s_mov_b32 m0, s39
    s_nop 0
    v_fma_f32 v252, v252, v35, v64
    v_fma_f32 v253, v253, v35, v65
    v_mfma_f32_16x16x32_bf16 v[104:107], v[172:175], a[188:191], v[104:107]
    buffer_load_dwordx4 v2, s[8:11], s40 offen lds
    v_fma_f32 v254, v254, v35, v66
    v_fma_f32 v255, v255, v35, v67
    v_mul_f32 v88, v252, v252
    v_mfma_f32_16x16x32_bf16 v[108:111], v[160:163], a[240:243], v[108:111]
    v_mul_f32 v89, v253, v253
    v_mul_f32 v90, v254, v254
    v_mul_f32 v91, v255, v255
    v_fma_f32 v88, v88, s43, v25
    v_mfma_f32_16x16x32_bf16 v[108:111], v[164:167], a[244:247], v[108:111]
    v_fma_f32 v89, v89, s43, v25
    v_fma_f32 v90, v90, s43, v25
    v_fma_f32 v91, v91, s43, v25
    v_mul_f32 v88, v88, v252
    v_mfma_f32_16x16x32_bf16 v[108:111], v[168:171], a[248:251], v[108:111]
    v_mul_f32 v89, v89, v253
    v_mul_f32 v90, v90, v254
    v_mul_f32 v91, v91, v255
    v_exp_f32 v88, v88
    v_mfma_f32_16x16x32_bf16 v[108:111], v[172:175], a[252:255], v[108:111]
    v_exp_f32 v89, v89
    v_exp_f32 v90, v90
    v_mfma_f32_16x16x32_bf16 v[68:71], v[160:163], v[40:43], v[68:71]
    v_exp_f32 v91, v91
    v_add_f32 v88, 1.0, v88
    v_add_f32 v89, 1.0, v89
    v_mfma_f32_16x16x32_bf16 v[68:71], v[164:167], v[40:43], v[68:71]
    v_add_f32 v90, 1.0, v90
    v_add_f32 v91, 1.0, v91
    v_rcp_f32 v88, v88
    v_mfma_f32_16x16x32_bf16 v[68:71], v[168:171], v[40:43], v[68:71]
    v_rcp_f32 v89, v89
    v_rcp_f32 v90, v90
    v_mfma_f32_16x16x32_bf16 v[68:71], v[172:175], v[40:43], v[68:71]
    v_rcp_f32 v91, v91
    v_mul_f32 v252, v252, v88
    v_mul_f32 v253, v253, v89
    s_waitcnt lgkmcnt(0)
    v_mfma_f32_16x16x32_bf16 v[112:115], v[176:179], a[48:51], v[112:115]
    ds_read_b64_tr_b16 v[160:161], v10 offset:0
    v_mul_f32 v254, v254, v90
    v_mul_f32 v255, v255, v91
    v_cvt_pk_bf16_f32 v250, v252, v253
    v_mfma_f32_16x16x32_bf16 v[112:115], v[180:183], a[52:55], v[112:115]
    ds_read_b64_tr_b16 v[162:163], v10 offset:512
    v_cvt_pk_bf16_f32 v251, v254, v255
    buffer_store_dwordx4 v[248:251], v19, s[4:7], s59 offen offset:0 sc1
    v_mfma_f32_16x16x32_bf16 v[112:115], v[184:187], a[56:59], v[112:115]
    ds_read_b64_tr_b16 v[164:165], v10 offset:4096
    v_mfma_f32_16x16x32_bf16 v[112:115], v[188:191], a[60:63], v[112:115]
    ds_read_b64_tr_b16 v[166:167], v10 offset:4608
    v_fma_f32 v192, -v68, v36, v96
    v_mfma_f32_16x16x32_bf16 v[116:119], v[176:179], a[112:115], v[116:119]
    ds_read_b64_tr_b16 v[168:169], v10 offset:8192
    v_fma_f32 v193, -v69, v36, v97
    v_mfma_f32_16x16x32_bf16 v[116:119], v[180:183], a[116:119], v[116:119]
    ds_read_b64_tr_b16 v[170:171], v10 offset:8704
    v_fma_f32 v194, -v70, v36, v98
    v_mfma_f32_16x16x32_bf16 v[116:119], v[184:187], a[120:123], v[116:119]
    ds_read_b64_tr_b16 v[172:173], v10 offset:12288
    v_fma_f32 v195, -v71, v36, v99
    v_mfma_f32_16x16x32_bf16 v[116:119], v[188:191], a[124:127], v[116:119]
    ds_read_b64_tr_b16 v[174:175], v10 offset:12800
    v_fma_f32 v200, -v68, v37, v100
    v_mfma_f32_16x16x32_bf16 v[120:123], v[176:179], a[176:179], v[120:123]
    v_fma_f32 v201, -v69, v37, v101
    v_mfma_f32_16x16x32_bf16 v[120:123], v[180:183], a[180:183], v[120:123]
    v_fma_f32 v202, -v70, v37, v102
    v_mfma_f32_16x16x32_bf16 v[120:123], v[184:187], a[184:187], v[120:123]
    s_add_u32 m0, m0, 1024
    s_add_u32 s40, s40, s32
    v_fma_f32 v203, -v71, v37, v103
    v_mfma_f32_16x16x32_bf16 v[120:123], v[188:191], a[188:191], v[120:123]
    buffer_load_dwordx4 v3, s[8:11], s40 offen lds
    v_fma_f32 v208, -v68, v38, v104
    v_mfma_f32_16x16x32_bf16 v[124:127], v[176:179], a[240:243], v[124:127]
    v_fma_f32 v209, -v69, v38, v105
    v_mfma_f32_16x16x32_bf16 v[124:127], v[180:183], a[244:247], v[124:127]
    v_fma_f32 v210, -v70, v38, v106
    v_mfma_f32_16x16x32_bf16 v[124:127], v[184:187], a[248:251], v[124:127]
    v_fma_f32 v211, -v71, v38, v107
    v_mfma_f32_16x16x32_bf16 v[124:127], v[188:191], a[252:255], v[124:127]
    v_fma_f32 v216, -v68, v39, v108
    v_mfma_f32_16x16x32_bf16 v[72:75], v[176:179], v[40:43], v[72:75]
    v_fma_f32 v217, -v69, v39, v109
    v_mfma_f32_16x16x32_bf16 v[72:75], v[180:183], v[40:43], v[72:75]
    v_fma_f32 v218, -v70, v39, v110
    v_mfma_f32_16x16x32_bf16 v[72:75], v[184:187], v[40:43], v[72:75]
    v_fma_f32 v219, -v71, v39, v111
    v_mfma_f32_16x16x32_bf16 v[72:75], v[188:191], v[40:43], v[72:75]
    s_waitcnt lgkmcnt(0)
    v_mfma_f32_16x16x32_bf16 v[128:131], v[160:163], a[48:51], v[128:131]
    ds_read_b64_tr_b16 v[176:177], v11 offset:0
    v_mfma_f32_16x16x32_bf16 v[128:131], v[164:167], a[52:55], v[128:131]
    ds_read_b64_tr_b16 v[178:179], v11 offset:512
    v_mfma_f32_16x16x32_bf16 v[128:131], v[168:171], a[56:59], v[128:131]
    ds_read_b64_tr_b16 v[180:181], v11 offset:4096
    v_mfma_f32_16x16x32_bf16 v[128:131], v[172:175], a[60:63], v[128:131]
    ds_read_b64_tr_b16 v[182:183], v11 offset:4608
    v_fma_f32 v196, -v72, v36, v112
    v_mfma_f32_16x16x32_bf16 v[132:135], v[160:163], a[112:115], v[132:135]
    ds_read_b64_tr_b16 v[184:185], v11 offset:8192
    v_fma_f32 v197, -v73, v36, v113
    v_mfma_f32_16x16x32_bf16 v[132:135], v[164:167], a[116:119], v[132:135]
    ds_read_b64_tr_b16 v[186:187], v11 offset:8704
    v_fma_f32 v198, -v74, v36, v114
    v_mfma_f32_16x16x32_bf16 v[132:135], v[168:171], a[120:123], v[132:135]
    ds_read_b64_tr_b16 v[188:189], v11 offset:12288
    v_fma_f32 v199, -v75, v36, v115
    v_mfma_f32_16x16x32_bf16 v[132:135], v[172:175], a[124:127], v[132:135]
    ds_read_b64_tr_b16 v[190:191], v11 offset:12800
    v_fma_f32 v204, -v72, v37, v116
    v_mfma_f32_16x16x32_bf16 v[136:139], v[160:163], a[176:179], v[136:139]
    v_fma_f32 v205, -v73, v37, v117
    v_mfma_f32_16x16x32_bf16 v[136:139], v[164:167], a[180:183], v[136:139]
    v_fma_f32 v206, -v74, v37, v118
    v_mfma_f32_16x16x32_bf16 v[136:139], v[168:171], a[184:187], v[136:139]
    s_add_u32 m0, m0, 1024
    s_add_u32 s40, s40, s32
    v_fma_f32 v207, -v75, v37, v119
    v_mfma_f32_16x16x32_bf16 v[136:139], v[172:175], a[188:191], v[136:139]
    buffer_load_dwordx4 v2, s[8:11], s40 offen lds
    v_fma_f32 v212, -v72, v38, v120
    v_mfma_f32_16x16x32_bf16 v[140:143], v[160:163], a[240:243], v[140:143]
    v_fma_f32 v213, -v73, v38, v121
    v_mfma_f32_16x16x32_bf16 v[140:143], v[164:167], a[244:247], v[140:143]
    v_fma_f32 v214, -v74, v38, v122
    v_mfma_f32_16x16x32_bf16 v[140:143], v[168:171], a[248:251], v[140:143]
    v_fma_f32 v215, -v75, v38, v123
    v_mfma_f32_16x16x32_bf16 v[140:143], v[172:175], a[252:255], v[140:143]
    v_fma_f32 v220, -v72, v39, v124
    v_mfma_f32_16x16x32_bf16 v[76:79], v[160:163], v[40:43], v[76:79]
    v_fma_f32 v221, -v73, v39, v125
    v_mfma_f32_16x16x32_bf16 v[76:79], v[164:167], v[40:43], v[76:79]
    v_fma_f32 v222, -v74, v39, v126
    v_mfma_f32_16x16x32_bf16 v[76:79], v[168:171], v[40:43], v[76:79]
    v_fma_f32 v223, -v75, v39, v127
    v_mfma_f32_16x16x32_bf16 v[76:79], v[172:175], v[40:43], v[76:79]
    s_waitcnt lgkmcnt(0)
    v_mfma_f32_16x16x32_bf16 v[144:147], v[176:179], a[48:51], v[144:147]
    ds_read_b64_tr_b16 v[160:161], v12 offset:0
    v_mfma_f32_16x16x32_bf16 v[144:147], v[180:183], a[52:55], v[144:147]
    ds_read_b64_tr_b16 v[162:163], v12 offset:512
    v_mfma_f32_16x16x32_bf16 v[144:147], v[184:187], a[56:59], v[144:147]
    ds_read_b64_tr_b16 v[164:165], v12 offset:4096
    v_mfma_f32_16x16x32_bf16 v[144:147], v[188:191], a[60:63], v[144:147]
    ds_read_b64_tr_b16 v[166:167], v12 offset:4608
    v_fma_f32 v224, -v76, v36, v128
    v_mfma_f32_16x16x32_bf16 v[148:151], v[176:179], a[112:115], v[148:151]
    ds_read_b64_tr_b16 v[168:169], v12 offset:8192
    v_fma_f32 v225, -v77, v36, v129
    v_mfma_f32_16x16x32_bf16 v[148:151], v[180:183], a[116:119], v[148:151]
    ds_read_b64_tr_b16 v[170:171], v12 offset:8704
    v_fma_f32 v226, -v78, v36, v130
    v_mfma_f32_16x16x32_bf16 v[148:151], v[184:187], a[120:123], v[148:151]
    ds_read_b64_tr_b16 v[172:173], v12 offset:12288
    v_fma_f32 v227, -v79, v36, v131
    v_mfma_f32_16x16x32_bf16 v[148:151], v[188:191], a[124:127], v[148:151]
    ds_read_b64_tr_b16 v[174:175], v12 offset:12800
    v_fma_f32 v232, -v76, v37, v132
    v_mfma_f32_16x16x32_bf16 v[152:155], v[176:179], a[176:179], v[152:155]
    v_fma_f32 v233, -v77, v37, v133
    s_waitcnt vmcnt(20)
    v_lshlrev_b32 v52, 16, v44
    v_and_b32 v53, 0xffff0000, v44
    v_mfma_f32_16x16x32_bf16 v[152:155], v[180:183], a[180:183], v[152:155]
    v_fma_f32 v234, -v78, v37, v134
    v_lshlrev_b32 v54, 16, v45
    v_and_b32 v55, 0xffff0000, v45
    v_lshlrev_b32 v56, 16, v46
    v_mfma_f32_16x16x32_bf16 v[152:155], v[184:187], a[184:187], v[152:155]
    s_add_u32 m0, m0, 1024
    s_add_u32 s40, s40, s32
    v_fma_f32 v235, -v79, v37, v135
    v_and_b32 v57, 0xffff0000, v46
    v_mfma_f32_16x16x32_bf16 v[152:155], v[188:191], a[188:191], v[152:155]
    buffer_load_dwordx4 v3, s[8:11], s40 offen lds
    v_fma_f32 v240, -v76, v38, v136
    v_lshlrev_b32 v58, 16, v47
    v_and_b32 v59, 0xffff0000, v47
    v_mfma_f32_16x16x32_bf16 v[156:159], v[176:179], a[240:243], v[156:159]
    s_add_u32 s57, s57, 16384
    s_and_b32 s57, s57, 0x1ffff
    s_add_u32 s31, s31, 1
    s_lshr_b32 s39, s31, 2
    v_mfma_f32_16x16x32_bf16 v[156:159], v[180:183], a[244:247], v[156:159]
    s_add_u32 s30, s30, s39
    s_and_b32 s31, s31, 3
    v_fma_f32 v241, -v77, v38, v137
    v_fma_f32 v242, -v78, v38, v138
    v_mfma_f32_16x16x32_bf16 v[156:159], v[184:187], a[248:251], v[156:159]
    v_fma_f32 v243, -v79, v38, v139
    v_lshlrev_b32 v60, 16, v48
    v_and_b32 v61, 0xffff0000, v48
    v_lshlrev_b32 v62, 16, v49
    v_mfma_f32_16x16x32_bf16 v[156:159], v[188:191], a[252:255], v[156:159]
    v_fma_f32 v248, -v76, v39, v140
    v_and_b32 v63, 0xffff0000, v49
    v_lshlrev_b32 v64, 16, v50
    v_and_b32 v65, 0xffff0000, v50
    v_mfma_f32_16x16x32_bf16 v[80:83], v[176:179], v[40:43], v[80:83]
    v_fma_f32 v249, -v77, v39, v141
    v_lshlrev_b32 v66, 16, v51
    v_and_b32 v67, 0xffff0000, v51
    s_add_u32 s56, s56, 16384
    v_mfma_f32_16x16x32_bf16 v[80:83], v[180:183], v[40:43], v[80:83]
    v_fma_f32 v250, -v78, v39, v142
    s_and_b32 s56, s56, 0x1ffff
    v_mov_b32 v8, v12
    v_mov_b32 v9, v13
    v_mfma_f32_16x16x32_bf16 v[80:83], v[184:187], v[40:43], v[80:83]
    v_fma_f32 v251, -v79, v39, v143
    v_mov_b32 v10, v14
    v_mov_b32 v11, v15
    v_add_u32 v12, s56, v4
    v_mfma_f32_16x16x32_bf16 v[80:83], v[188:191], v[40:43], v[80:83]
    v_add_u32 v13, s56, v5
    v_add_u32 v14, s56, v6
    v_add_u32 v15, s56, v7
    s_add_u32 s29, s29, 1
    s_cmp_lt_u32 s29, s44
    s_cbranch_scc1 p1_kernel_segh_loop
p1_kernel_segh_skip:
    s_mov_b32 s34, s33
    s_mov_b32 s59, s58
    s_nop 7
    v_fma_f32 v228, -v80, v36, v144
    v_fma_f32 v229, -v81, v36, v145
    v_fma_f32 v230, -v82, v36, v146
    v_fma_f32 v231, -v83, v36, v147
    v_fma_f32 v236, -v80, v37, v148
    v_fma_f32 v237, -v81, v37, v149
    v_fma_f32 v238, -v82, v37, v150
    v_fma_f32 v239, -v83, v37, v151
    v_fma_f32 v244, -v80, v38, v152
    v_fma_f32 v245, -v81, v38, v153
    v_fma_f32 v246, -v82, v38, v154
    v_fma_f32 v247, -v83, v38, v155
    v_fma_f32 v252, -v80, v39, v156
    v_fma_f32 v253, -v81, v39, v157
    v_fma_f32 v254, -v82, v39, v158
    v_fma_f32 v255, -v83, v39, v159
    v_fma_f32 v192, v192, v32, v52
    v_fma_f32 v193, v193, v32, v53
    v_fma_f32 v194, v194, v32, v54
    v_fma_f32 v195, v195, v32, v55
    v_mul_f32 v84, v192, v192
    v_mul_f32 v85, v193, v193
    v_mul_f32 v86, v194, v194
    v_mul_f32 v87, v195, v195
    v_fma_f32 v84, v84, s43, v25
    v_fma_f32 v85, v85, s43, v25
    v_fma_f32 v86, v86, s43, v25
    v_fma_f32 v87, v87, s43, v25
    v_mul_f32 v84, v84, v192
    v_mul_f32 v85, v85, v193
    v_mul_f32 v86, v86, v194
    v_mul_f32 v87, v87, v195
    v_exp_f32 v84, v84
    v_exp_f32 v85, v85
    v_exp_f32 v86, v86
    v_exp_f32 v87, v87
    v_add_f32 v84, 1.0, v84
    v_add_f32 v85, 1.0, v85
    v_add_f32 v86, 1.0, v86
    v_add_f32 v87, 1.0, v87
    v_rcp_f32 v84, v84
    v_rcp_f32 v85, v85
    v_rcp_f32 v86, v86
    v_rcp_f32 v87, v87
    v_mul_f32 v192, v192, v84
    v_mul_f32 v193, v193, v85
    v_mul_f32 v194, v194, v86
    v_mul_f32 v195, v195, v87
    v_cvt_pk_bf16_f32 v192, v192, v193
    v_cvt_pk_bf16_f32 v193, v194, v195
    v_fma_f32 v196, v196, v32, v56
    v_fma_f32 v197, v197, v32, v57
    v_fma_f32 v198, v198, v32, v58
    v_fma_f32 v199, v199, v32, v59
    v_mul_f32 v88, v196, v196
    v_mul_f32 v89, v197, v197
    v_mul_f32 v90, v198, v198
    v_mul_f32 v91, v199, v199
    v_fma_f32 v88, v88, s43, v25
    v_fma_f32 v89, v89, s43, v25
    v_fma_f32 v90, v90, s43, v25
    v_fma_f32 v91, v91, s43, v25
    v_mul_f32 v88, v88, v196
    v_mul_f32 v89, v89, v197
    v_mul_f32 v90, v90, v198
    v_mul_f32 v91, v91, v199
    v_exp_f32 v88, v88
    v_exp_f32 v89, v89
    v_exp_f32 v90, v90
    v_exp_f32 v91, v91
    v_add_f32 v88, 1.0, v88
    v_add_f32 v89, 1.0, v89
    v_add_f32 v90, 1.0, v90
    v_add_f32 v91, 1.0, v91
    v_rcp_f32 v88, v88
    v_rcp_f32 v89, v89
    v_rcp_f32 v90, v90
    v_rcp_f32 v91, v91
    v_mul_f32 v196, v196, v88
    v_mul_f32 v197, v197, v89
    v_mul_f32 v198, v198, v90
    v_mul_f32 v199, v199, v91
    v_cvt_pk_bf16_f32 v194, v196, v197
    v_cvt_pk_bf16_f32 v195, v198, v199
    buffer_store_dwordx4 v[192:195], v16, s[4:7], s34 offen offset:0 sc1
    v_fma_f32 v200, v200, v33, v52
    v_fma_f32 v201, v201, v33, v53
    v_fma_f32 v202, v202, v33, v54
    v_fma_f32 v203, v203, v33, v55
    v_mul_f32 v84, v200, v200
    v_mul_f32 v85, v201, v201
    v_mul_f32 v86, v202, v202
    v_mul_f32 v87, v203, v203
    v_fma_f32 v84, v84, s43, v25
    v_fma_f32 v85, v85, s43, v25
    v_fma_f32 v86, v86, s43, v25
    v_fma_f32 v87, v87, s43, v25
    v_mul_f32 v84, v84, v200
    v_mul_f32 v85, v85, v201
    v_mul_f32 v86, v86, v202
    v_mul_f32 v87, v87, v203
    v_exp_f32 v84, v84
    v_exp_f32 v85, v85
    v_exp_f32 v86, v86
    v_exp_f32 v87, v87
    v_add_f32 v84, 1.0, v84
    v_add_f32 v85, 1.0, v85
    v_add_f32 v86, 1.0, v86
    v_add_f32 v87, 1.0, v87
    v_rcp_f32 v84, v84
    v_rcp_f32 v85, v85
    v_rcp_f32 v86, v86
    v_rcp_f32 v87, v87
    v_mul_f32 v200, v200, v84
    v_mul_f32 v201, v201, v85
    v_mul_f32 v202, v202, v86
    v_mul_f32 v203, v203, v87
    v_cvt_pk_bf16_f32 v200, v200, v201
    v_cvt_pk_bf16_f32 v201, v202, v203
    v_fma_f32 v204, v204, v33, v56
    v_fma_f32 v205, v205, v33, v57
    v_fma_f32 v206, v206, v33, v58
    v_fma_f32 v207, v207, v33, v59
    v_mul_f32 v88, v204, v204
    v_mul_f32 v89, v205, v205
    v_mul_f32 v90, v206, v206
    v_mul_f32 v91, v207, v207
    v_fma_f32 v88, v88, s43, v25
    v_fma_f32 v89, v89, s43, v25
    v_fma_f32 v90, v90, s43, v25
    v_fma_f32 v91, v91, s43, v25
    v_mul_f32 v88, v88, v204
    v_mul_f32 v89, v89, v205
    v_mul_f32 v90, v90, v206
    v_mul_f32 v91, v91, v207
    v_exp_f32 v88, v88
    v_exp_f32 v89, v89
    v_exp_f32 v90, v90
    v_exp_f32 v91, v91
    v_add_f32 v88, 1.0, v88
    v_add_f32 v89, 1.0, v89
    v_add_f32 v90, 1.0, v90
    v_add_f32 v91, 1.0, v91
    v_rcp_f32 v88, v88
    v_rcp_f32 v89, v89
    v_rcp_f32 v90, v90
    v_rcp_f32 v91, v91
    v_mul_f32 v204, v204, v88
    v_mul_f32 v205, v205, v89
    v_mul_f32 v206, v206, v90
    v_mul_f32 v207, v207, v91
    v_cvt_pk_bf16_f32 v202, v204, v205
    v_cvt_pk_bf16_f32 v203, v206, v207
    buffer_store_dwordx4 v[200:203], v17, s[4:7], s34 offen offset:0 sc1
    v_fma_f32 v208, v208, v34, v52
    v_fma_f32 v209, v209, v34, v53
    v_fma_f32 v210, v210, v34, v54
    v_fma_f32 v211, v211, v34, v55
    v_mul_f32 v84, v208, v208
    v_mul_f32 v85, v209, v209
    v_mul_f32 v86, v210, v210
    v_mul_f32 v87, v211, v211
    v_fma_f32 v84, v84, s43, v25
    v_fma_f32 v85, v85, s43, v25
    v_fma_f32 v86, v86, s43, v25
    v_fma_f32 v87, v87, s43, v25
    v_mul_f32 v84, v84, v208
    v_mul_f32 v85, v85, v209
    v_mul_f32 v86, v86, v210
    v_mul_f32 v87, v87, v211
    v_exp_f32 v84, v84
    v_exp_f32 v85, v85
    v_exp_f32 v86, v86
    v_exp_f32 v87, v87
    v_add_f32 v84, 1.0, v84
    v_add_f32 v85, 1.0, v85
    v_add_f32 v86, 1.0, v86
    v_add_f32 v87, 1.0, v87
    v_rcp_f32 v84, v84
    v_rcp_f32 v85, v85
    v_rcp_f32 v86, v86
    v_rcp_f32 v87, v87
    v_mul_f32 v208, v208, v84
    v_mul_f32 v209, v209, v85
    v_mul_f32 v210, v210, v86
    v_mul_f32 v211, v211, v87
    v_cvt_pk_bf16_f32 v208, v208, v209
    v_cvt_pk_bf16_f32 v209, v210, v211
    v_fma_f32 v212, v212, v34, v56
    v_fma_f32 v213, v213, v34, v57
    v_fma_f32 v214, v214, v34, v58
    v_fma_f32 v215, v215, v34, v59
    v_mul_f32 v88, v212, v212
    v_mul_f32 v89, v213, v213
    v_mul_f32 v90, v214, v214
    v_mul_f32 v91, v215, v215
    v_fma_f32 v88, v88, s43, v25
    v_fma_f32 v89, v89, s43, v25
    v_fma_f32 v90, v90, s43, v25
    v_fma_f32 v91, v91, s43, v25
    v_mul_f32 v88, v88, v212
    v_mul_f32 v89, v89, v213
    v_mul_f32 v90, v90, v214
    v_mul_f32 v91, v91, v215
    v_exp_f32 v88, v88
    v_exp_f32 v89, v89
    v_exp_f32 v90, v90
    v_exp_f32 v91, v91
    v_add_f32 v88, 1.0, v88
    v_add_f32 v89, 1.0, v89
    v_add_f32 v90, 1.0, v90
    v_add_f32 v91, 1.0, v91
    v_rcp_f32 v88, v88
    v_rcp_f32 v89, v89
    v_rcp_f32 v90, v90
    v_rcp_f32 v91, v91
    v_mul_f32 v212, v212, v88
    v_mul_f32 v213, v213, v89
    v_mul_f32 v214, v214, v90
    v_mul_f32 v215, v215, v91
    v_cvt_pk_bf16_f32 v210, v212, v213
    v_cvt_pk_bf16_f32 v211, v214, v215
    buffer_store_dwordx4 v[208:211], v18, s[4:7], s34 offen offset:0 sc1
    v_fma_f32 v216, v216, v35, v52
    v_fma_f32 v217, v217, v35, v53
    v_fma_f32 v218, v218, v35, v54
    v_fma_f32 v219, v219, v35, v55
    v_mul_f32 v84, v216, v216
    v_mul_f32 v85, v217, v217
    v_mul_f32 v86, v218, v218
    v_mul_f32 v87, v219, v219
    v_fma_f32 v84, v84, s43, v25
    v_fma_f32 v85, v85, s43, v25
    v_fma_f32 v86, v86, s43, v25
    v_fma_f32 v87, v87, s43, v25
    v_mul_f32 v84, v84, v216
    v_mul_f32 v85, v85, v217
    v_mul_f32 v86, v86, v218
    v_mul_f32 v87, v87, v219
    v_exp_f32 v84, v84
    v_exp_f32 v85, v85
    v_exp_f32 v86, v86
    v_exp_f32 v87, v87
    v_add_f32 v84, 1.0, v84
    v_add_f32 v85, 1.0, v85
    v_add_f32 v86, 1.0, v86
    v_add_f32 v87, 1.0, v87
    v_rcp_f32 v84, v84
    v_rcp_f32 v85, v85
    v_rcp_f32 v86, v86
    v_rcp_f32 v87, v87
    v_mul_f32 v216, v216, v84
    v_mul_f32 v217, v217, v85
    v_mul_f32 v218, v218, v86
    v_mul_f32 v219, v219, v87
    v_cvt_pk_bf16_f32 v216, v216, v217
    v_cvt_pk_bf16_f32 v217, v218, v219
    v_fma_f32 v220, v220, v35, v56
    v_fma_f32 v221, v221, v35, v57
    v_fma_f32 v222, v222, v35, v58
    v_fma_f32 v223, v223, v35, v59
    v_mul_f32 v88, v220, v220
    v_mul_f32 v89, v221, v221
    v_mul_f32 v90, v222, v222
    v_mul_f32 v91, v223, v223
    v_fma_f32 v88, v88, s43, v25
    v_fma_f32 v89, v89, s43, v25
    v_fma_f32 v90, v90, s43, v25
    v_fma_f32 v91, v91, s43, v25
    v_mul_f32 v88, v88, v220
    v_mul_f32 v89, v89, v221
    v_mul_f32 v90, v90, v222
    v_mul_f32 v91, v91, v223
    v_exp_f32 v88, v88
    v_exp_f32 v89, v89
    v_exp_f32 v90, v90
    v_exp_f32 v91, v91
    v_add_f32 v88, 1.0, v88
    v_add_f32 v89, 1.0, v89
    v_add_f32 v90, 1.0, v90
    v_add_f32 v91, 1.0, v91
    v_rcp_f32 v88, v88
    v_rcp_f32 v89, v89
    v_rcp_f32 v90, v90
    v_rcp_f32 v91, v91
    v_mul_f32 v220, v220, v88
    v_mul_f32 v221, v221, v89
    v_mul_f32 v222, v222, v90
    v_mul_f32 v223, v223, v91
    v_cvt_pk_bf16_f32 v218, v220, v221
    v_cvt_pk_bf16_f32 v219, v222, v223
    buffer_store_dwordx4 v[216:219], v19, s[4:7], s34 offen offset:0 sc1
    v_fma_f32 v224, v224, v32, v60
    v_fma_f32 v225, v225, v32, v61
    v_fma_f32 v226, v226, v32, v62
    v_fma_f32 v227, v227, v32, v63
    v_mul_f32 v84, v224, v224
    v_mul_f32 v85, v225, v225
    v_mul_f32 v86, v226, v226
    v_mul_f32 v87, v227, v227
    v_fma_f32 v84, v84, s43, v25
    v_fma_f32 v85, v85, s43, v25
    v_fma_f32 v86, v86, s43, v25
    v_fma_f32 v87, v87, s43, v25
    v_mul_f32 v84, v84, v224
    v_mul_f32 v85, v85, v225
    v_mul_f32 v86, v86, v226
    v_mul_f32 v87, v87, v227
    v_exp_f32 v84, v84
    v_exp_f32 v85, v85
    v_exp_f32 v86, v86
    v_exp_f32 v87, v87
    v_add_f32 v84, 1.0, v84
    v_add_f32 v85, 1.0, v85
    v_add_f32 v86, 1.0, v86
    v_add_f32 v87, 1.0, v87
    v_rcp_f32 v84, v84
    v_rcp_f32 v85, v85
    v_rcp_f32 v86, v86
    v_rcp_f32 v87, v87
    v_mul_f32 v224, v224, v84
    v_mul_f32 v225, v225, v85
    v_mul_f32 v226, v226, v86
    v_mul_f32 v227, v227, v87
    v_cvt_pk_bf16_f32 v224, v224, v225
    v_cvt_pk_bf16_f32 v225, v226, v227
    v_fma_f32 v228, v228, v32, v64
    v_fma_f32 v229, v229, v32, v65
    v_fma_f32 v230, v230, v32, v66
    v_fma_f32 v231, v231, v32, v67
    v_mul_f32 v88, v228, v228
    v_mul_f32 v89, v229, v229
    v_mul_f32 v90, v230, v230
    v_mul_f32 v91, v231, v231
    v_fma_f32 v88, v88, s43, v25
    v_fma_f32 v89, v89, s43, v25
    v_fma_f32 v90, v90, s43, v25
    v_fma_f32 v91, v91, s43, v25
    v_mul_f32 v88, v88, v228
    v_mul_f32 v89, v89, v229
    v_mul_f32 v90, v90, v230
    v_mul_f32 v91, v91, v231
    v_exp_f32 v88, v88
    v_exp_f32 v89, v89
    v_exp_f32 v90, v90
    v_exp_f32 v91, v91
    v_add_f32 v88, 1.0, v88
    v_add_f32 v89, 1.0, v89
    v_add_f32 v90, 1.0, v90
    v_add_f32 v91, 1.0, v91
    v_rcp_f32 v88, v88
    v_rcp_f32 v89, v89
    v_rcp_f32 v90, v90
    v_rcp_f32 v91, v91
    v_mul_f32 v228, v228, v88
    v_mul_f32 v229, v229, v89
    v_mul_f32 v230, v230, v90
    v_mul_f32 v231, v231, v91
    v_cvt_pk_bf16_f32 v226, v228, v229
    v_cvt_pk_bf16_f32 v227, v230, v231
    buffer_store_dwordx4 v[224:227], v16, s[4:7], s59 offen offset:0 sc1
    v_fma_f32 v232, v232, v33, v60
    v_fma_f32 v233, v233, v33, v61
    v_fma_f32 v234, v234, v33, v62
    v_fma_f32 v235, v235, v33, v63
    v_mul_f32 v84, v232, v232
    v_mul_f32 v85, v233, v233
    v_mul_f32 v86, v234, v234
    v_mul_f32 v87, v235, v235
    v_fma_f32 v84, v84, s43, v25
    v_fma_f32 v85, v85, s43, v25
    v_fma_f32 v86, v86, s43, v25
    v_fma_f32 v87, v87, s43, v25
    v_mul_f32 v84, v84, v232
    v_mul_f32 v85, v85, v233
    v_mul_f32 v86, v86, v234
    v_mul_f32 v87, v87, v235
    v_exp_f32 v84, v84
    v_exp_f32 v85, v85
    v_exp_f32 v86, v86
    v_exp_f32 v87, v87
    v_add_f32 v84, 1.0, v84
    v_add_f32 v85, 1.0, v85
    v_add_f32 v86, 1.0, v86
    v_add_f32 v87, 1.0, v87
    v_rcp_f32 v84, v84
    v_rcp_f32 v85, v85
    v_rcp_f32 v86, v86
    v_rcp_f32 v87, v87
    v_mul_f32 v232, v232, v84
    v_mul_f32 v233, v233, v85
    v_mul_f32 v234, v234, v86
    v_mul_f32 v235, v235, v87
    v_cvt_pk_bf16_f32 v232, v232, v233
    v_cvt_pk_bf16_f32 v233, v234, v235
    v_fma_f32 v236, v236, v33, v64
    v_fma_f32 v237, v237, v33, v65
    v_fma_f32 v238, v238, v33, v66
    v_fma_f32 v239, v239, v33, v67
    v_mul_f32 v88, v236, v236
    v_mul_f32 v89, v237, v237
    v_mul_f32 v90, v238, v238
    v_mul_f32 v91, v239, v239
    v_fma_f32 v88, v88, s43, v25
    v_fma_f32 v89, v89, s43, v25
    v_fma_f32 v90, v90, s43, v25
    v_fma_f32 v91, v91, s43, v25
    v_mul_f32 v88, v88, v236
    v_mul_f32 v89, v89, v237
    v_mul_f32 v90, v90, v238
    v_mul_f32 v91, v91, v239
    v_exp_f32 v88, v88
    v_exp_f32 v89, v89
    v_exp_f32 v90, v90
    v_exp_f32 v91, v91
    v_add_f32 v88, 1.0, v88
    v_add_f32 v89, 1.0, v89
    v_add_f32 v90, 1.0, v90
    v_add_f32 v91, 1.0, v91
    v_rcp_f32 v88, v88
    v_rcp_f32 v89, v89
    v_rcp_f32 v90, v90
    v_rcp_f32 v91, v91
    v_mul_f32 v236, v236, v88
    v_mul_f32 v237, v237, v89
    v_mul_f32 v238, v238, v90
    v_mul_f32 v239, v239, v91
    v_cvt_pk_bf16_f32 v234, v236, v237
    v_cvt_pk_bf16_f32 v235, v238, v239
    buffer_store_dwordx4 v[232:235], v17, s[4:7], s59 offen offset:0 sc1
    v_fma_f32 v240, v240, v34, v60
    v_fma_f32 v241, v241, v34, v61
    v_fma_f32 v242, v242, v34, v62
    v_fma_f32 v243, v243, v34, v63
    v_mul_f32 v84, v240, v240
    v_mul_f32 v85, v241, v241
    v_mul_f32 v86, v242, v242
    v_mul_f32 v87, v243, v243
    v_fma_f32 v84, v84, s43, v25
    v_fma_f32 v85, v85, s43, v25
    v_fma_f32 v86, v86, s43, v25
    v_fma_f32 v87, v87, s43, v25
    v_mul_f32 v84, v84, v240
    v_mul_f32 v85, v85, v241
    v_mul_f32 v86, v86, v242
    v_mul_f32 v87, v87, v243
    v_exp_f32 v84, v84
    v_exp_f32 v85, v85
    v_exp_f32 v86, v86
    v_exp_f32 v87, v87
    v_add_f32 v84, 1.0, v84
    v_add_f32 v85, 1.0, v85
    v_add_f32 v86, 1.0, v86
    v_add_f32 v87, 1.0, v87
    v_rcp_f32 v84, v84
    v_rcp_f32 v85, v85
    v_rcp_f32 v86, v86
    v_rcp_f32 v87, v87
    v_mul_f32 v240, v240, v84
    v_mul_f32 v241, v241, v85
    v_mul_f32 v242, v242, v86
    v_mul_f32 v243, v243, v87
    v_cvt_pk_bf16_f32 v240, v240, v241
    v_cvt_pk_bf16_f32 v241, v242, v243
    v_fma_f32 v244, v244, v34, v64
    v_fma_f32 v245, v245, v34, v65
    v_fma_f32 v246, v246, v34, v66
    v_fma_f32 v247, v247, v34, v67
    v_mul_f32 v88, v244, v244
    v_mul_f32 v89, v245, v245
    v_mul_f32 v90, v246, v246
    v_mul_f32 v91, v247, v247
    v_fma_f32 v88, v88, s43, v25
    v_fma_f32 v89, v89, s43, v25
    v_fma_f32 v90, v90, s43, v25
    v_fma_f32 v91, v91, s43, v25
    v_mul_f32 v88, v88, v244
    v_mul_f32 v89, v89, v245
    v_mul_f32 v90, v90, v246
    v_mul_f32 v91, v91, v247
    v_exp_f32 v88, v88
    v_exp_f32 v89, v89
    v_exp_f32 v90, v90
    v_exp_f32 v91, v91
    v_add_f32 v88, 1.0, v88
    v_add_f32 v89, 1.0, v89
    v_add_f32 v90, 1.0, v90
    v_add_f32 v91, 1.0, v91
    v_rcp_f32 v88, v88
    v_rcp_f32 v89, v89
    v_rcp_f32 v90, v90
    v_rcp_f32 v91, v91
    v_mul_f32 v244, v244, v88
    v_mul_f32 v245, v245, v89
    v_mul_f32 v246, v246, v90
    v_mul_f32 v247, v247, v91
    v_cvt_pk_bf16_f32 v242, v244, v245
    v_cvt_pk_bf16_f32 v243, v246, v247
    buffer_store_dwordx4 v[240:243], v18, s[4:7], s59 offen offset:0 sc1
    v_fma_f32 v248, v248, v35, v60
    v_fma_f32 v249, v249, v35, v61
    v_fma_f32 v250, v250, v35, v62
    v_fma_f32 v251, v251, v35, v63
    v_mul_f32 v84, v248, v248
    v_mul_f32 v85, v249, v249
    v_mul_f32 v86, v250, v250
    v_mul_f32 v87, v251, v251
    v_fma_f32 v84, v84, s43, v25
    v_fma_f32 v85, v85, s43, v25
    v_fma_f32 v86, v86, s43, v25
    v_fma_f32 v87, v87, s43, v25
    v_mul_f32 v84, v84, v248
    v_mul_f32 v85, v85, v249
    v_mul_f32 v86, v86, v250
    v_mul_f32 v87, v87, v251
    v_exp_f32 v84, v84
    v_exp_f32 v85, v85
    v_exp_f32 v86, v86
    v_exp_f32 v87, v87
    v_add_f32 v84, 1.0, v84
    v_add_f32 v85, 1.0, v85
    v_add_f32 v86, 1.0, v86
    v_add_f32 v87, 1.0, v87
    v_rcp_f32 v84, v84
    v_rcp_f32 v85, v85
    v_rcp_f32 v86, v86
    v_rcp_f32 v87, v87
    v_mul_f32 v248, v248, v84
    v_mul_f32 v249, v249, v85
    v_mul_f32 v250, v250, v86
    v_mul_f32 v251, v251, v87
    v_cvt_pk_bf16_f32 v248, v248, v249
    v_cvt_pk_bf16_f32 v249, v250, v251
    v_fma_f32 v252, v252, v35, v64
    v_fma_f32 v253, v253, v35, v65
    v_fma_f32 v254, v254, v35, v66
    v_fma_f32 v255, v255, v35, v67
    v_mul_f32 v88, v252, v252
    v_mul_f32 v89, v253, v253
    v_mul_f32 v90, v254, v254
    v_mul_f32 v91, v255, v255
    v_fma_f32 v88, v88, s43, v25
    v_fma_f32 v89, v89, s43, v25
    v_fma_f32 v90, v90, s43, v25
    v_fma_f32 v91, v91, s43, v25
    v_mul_f32 v88, v88, v252
    v_mul_f32 v89, v89, v253
    v_mul_f32 v90, v90, v254
    v_mul_f32 v91, v91, v255
    v_exp_f32 v88, v88
    v_exp_f32 v89, v89
    v_exp_f32 v90, v90
    v_exp_f32 v91, v91
    v_add_f32 v88, 1.0, v88
    v_add_f32 v89, 1.0, v89
    v_add_f32 v90, 1.0, v90
    v_add_f32 v91, 1.0, v91
    v_rcp_f32 v88, v88
    v_rcp_f32 v89, v89
    v_rcp_f32 v90, v90
    v_rcp_f32 v91, v91
    v_mul_f32 v252, v252, v88
    v_mul_f32 v253, v253, v89
    v_mul_f32 v254, v254, v90
    v_mul_f32 v255, v255, v91
    v_cvt_pk_bf16_f32 v250, v252, v253
    v_cvt_pk_bf16_f32 v251, v254, v255
    buffer_store_dwordx4 v[248:251], v19, s[4:7], s59 offen offset:0 sc1
p1_kernel_done:
    s_getpc_b64 s[96:97]
p1_kernel_ct_p2:
    s_add_u32 s96, s96, p2_kernel-p1_kernel_ct_p2
    s_addc_u32 s97, s97, 0
    s_lshr_b32 s98, s2, 3
    s_lshl_b32 s98, s98, 2
    s_add_u32 s98, s98, s35
    s_lshl_b32 s98, s98, 6
    v_add_u32 v29, s98, v20
    s_mov_b32 s98, (p2_kernel_end-p2_kernel)/128-1
    v_min_u32 v29, s98, v29
    v_lshlrev_b32 v29, 7, v29
    global_load_dword v28, v29, s[96:97]
    s_waitcnt vmcnt(0)
p1_kernel_end:
    s_endpgm

    .globl p2_kernel
    .p2align 8
    .type p2_kernel,@function
p2_kernel:
    s_cmp_ge_u32 s2, 256
    s_cbranch_scc1 p2_kernel_end
    s_load_dwordx2 s[4:5], s[0:1], 112
    s_load_dwordx2 s[52:53], s[0:1], 40
    s_load_dwordx2 s[56:57], s[0:1], 72
    v_lshrrev_b32 v20, 6, v0
    v_and_b32 v21, 63, v0
    v_readfirstlane_b32 s38, v20
    s_getpc_b64 s[96:97]
p2_kernel_ct0:
    s_sub_u32 s96, s96, p2_kernel_ct0-p2_kernel
    s_subb_u32 s97, s97, 0
    s_lshr_b32 s98, s2, 3
    s_lshl_b32 s98, s98, 3
    s_add_u32 s98, s98, s38
    s_lshl_b32 s98, s98, 6
    v_add_u32 v25, s98, v21
    s_mov_b32 s98, (p2_kernel_end-p2_kernel)/128-1
    v_min_u32 v25, s98, v25
    v_lshlrev_b32 v25, 7, v25
    global_load_dword v24, v25, s[96:97]
    v_lshlrev_b32 v1, 4, v21
    s_and_b32 s30, s2, 7
    s_lshr_b32 s31, s2, 3
    s_and_b32 s32, s31, 3
    s_lshl_b32 s12, s30, 2
    s_add_u32 s12, s12, s32
    s_lshr_b32 s33, s2, 5
    s_lshr_b32 s11, s38, 2
    s_and_b32 s17, s38, 3
    s_sub_u32 s34, 15, s33
    s_sub_u32 s35, 3, s17
    s_cmp_eq_u32 s11, 0
    s_cselect_b32 s34, s34, s33
    s_cselect_b32 s35, s17, s35
    s_lshl_b32 s18, s34, 2
    s_add_u32 s18, s18, s35
    s_lshr_b32 s36, s35, 1
    s_lshl_b32 s9, s34, 1
    s_add_u32 s9, s9, s36
    s_lshl_b32 s36, s33, 1
    s_sub_u32 s10, 30, s36
    s_mov_b32 s19, 0x41000000
    s_mov_b32 s39, 0
    s_waitcnt lgkmcnt(0)
    s_and_b32 s5, s5, 0xffff
    s_mov_b32 s6, 0x10000000
    s_mov_b32 s7, 0x00020000
    s_lshl_b32 s13, s12, 20
    s_add_u32 s13, s13, 0x1000000
    s_lshl_b32 s36, s17, 13
    s_add_u32 s13, s13, s36
p2_kernel_restart:
    s_lshl_b32 s36, s12, 6
    s_add_u32 s36, s36, s18
    s_lshl_b32 s36, s36, 13
    s_cmp_eq_u32 s11, 0
    s_cbranch_scc1 p2_kernel_pro_q
    s_mov_b32 s8, -3
    s_add_u32 s15, s8, 3
    s_min_u32 s28, s15, 31
    s_lshl_b32 s28, s28, 15
    s_add_u32 s28, s28, s13
    s_and_b32 s15, s15, 3
    s_lshl_b32 s15, s15, 15
    s_lshl_b32 s16, s17, 13
    s_add_u32 m0, s15, s16
    s_nop 0
    buffer_load_dwordx4 v1, s[4:7], s28 offen offset:0 lds
    buffer_load_dwordx4 v1, s[4:7], s28 offen offset:1024 lds
    buffer_load_dwordx4 v1, s[4:7], s28 offen offset:2048 lds
    buffer_load_dwordx4 v1, s[4:7], s28 offen offset:3072 lds
    s_add_u32 m0, m0, 4096
    s_add_u32 s28, s28, 4096
    buffer_load_dwordx4 v1, s[4:7], s28 offen offset:0 lds
    buffer_load_dwordx4 v1, s[4:7], s28 offen offset:1024 lds
    buffer_load_dwordx4 v1, s[4:7], s28 offen offset:2048 lds
    buffer_load_dwordx4 v1, s[4:7], s28 offen offset:3072 lds
p2_kernel_pro_q:
    buffer_load_dwordx4 v[32:35], v1, s[4:7], s36 offen offset:0
    buffer_load_dwordx4 v[36:39], v1, s[4:7], s36 offen offset:1024
    buffer_load_dwordx4 v[40:43], v1, s[4:7], s36 offen offset:2048
    buffer_load_dwordx4 v[44:47], v1, s[4:7], s36 offen offset:3072
    s_add_u32 s36, s36, 4096
    buffer_load_dwordx4 v[48:51], v1, s[4:7], s36 offen offset:0
    buffer_load_dwordx4 v[52:55], v1, s[4:7], s36 offen offset:1024
    buffer_load_dwordx4 v[56:59], v1, s[4:7], s36 offen offset:2048
    buffer_load_dwordx4 v[60:63], v1, s[4:7], s36 offen offset:3072
    s_cmp_eq_u32 s11, 0
    s_cbranch_scc1 p2_kernel_pro_init
    s_mov_b32 s8, -2
    s_add_u32 s15, s8, 3
    s_min_u32 s28, s15, 31
    s_lshl_b32 s28, s28, 15
    s_add_u32 s28, s28, s13
    s_and_b32 s15, s15, 3
    s_lshl_b32 s15, s15, 15
    s_lshl_b32 s16, s17, 13
    s_add_u32 m0, s15, s16
    s_nop 0
    buffer_load_dwordx4 v1, s[4:7], s28 offen offset:0 lds
    buffer_load_dwordx4 v1, s[4:7], s28 offen offset:1024 lds
    buffer_load_dwordx4 v1, s[4:7], s28 offen offset:2048 lds
    buffer_load_dwordx4 v1, s[4:7], s28 offen offset:3072 lds
    s_add_u32 m0, m0, 4096
    s_add_u32 s28, s28, 4096
    buffer_load_dwordx4 v1, s[4:7], s28 offen offset:0 lds
    buffer_load_dwordx4 v1, s[4:7], s28 offen offset:1024 lds
    buffer_load_dwordx4 v1, s[4:7], s28 offen offset:2048 lds
    buffer_load_dwordx4 v1, s[4:7], s28 offen offset:3072 lds
p2_kernel_pro_init:
    v_and_b32 v21, 63, v0
    v_and_b32 v22, 15, v21
    s_lshl_b32 s36, s18, 5
    s_lshl_b32 s37, s9, 6
    s_sub_u32 s36, s36, s37
    v_lshrrev_b32 v23, 4, v21
    v_lshlrev_b32 v23, 2, v23
    v_sub_u32 v22, v22, v23
    v_add_u32 v18, s36, v22
    v_mov_b32 v19, 0xf149f2ca
    v_mov_b32 v64, 0
    v_mov_b32 v65, 0
    v_mov_b32 v66, 0
    v_mov_b32 v67, 0
    v_mov_b32 v68, 0
    v_mov_b32 v69, 0
    v_mov_b32 v70, 0
    v_mov_b32 v71, 0
    v_mov_b32 v72, 0
    v_mov_b32 v73, 0
    v_mov_b32 v74, 0
    v_mov_b32 v75, 0
    v_mov_b32 v76, 0
    v_mov_b32 v77, 0
    v_mov_b32 v78, 0
    v_mov_b32 v79, 0
    v_mov_b32 v80, 0
    v_mov_b32 v81, 0
    v_mov_b32 v82, 0
    v_mov_b32 v83, 0
    v_mov_b32 v84, 0
    v_mov_b32 v85, 0
    v_mov_b32 v86, 0
    v_mov_b32 v87, 0
    v_mov_b32 v88, 0
    v_mov_b32 v89, 0
    v_mov_b32 v90, 0
    v_mov_b32 v91, 0
    v_mov_b32 v92, 0
    v_mov_b32 v93, 0
    v_mov_b32 v94, 0
    v_mov_b32 v95, 0
    v_mov_b32 v96, 0
    v_mov_b32 v97, 0
    v_mov_b32 v98, 0
    v_mov_b32 v99, 0
    v_mov_b32 v100, 0
    v_mov_b32 v101, 0
    v_mov_b32 v102, 0
    v_mov_b32 v103, 0
    v_mov_b32 v104, 0
    v_mov_b32 v105, 0
    v_mov_b32 v106, 0
    v_mov_b32 v107, 0
    v_mov_b32 v108, 0
    v_mov_b32 v109, 0
    v_mov_b32 v110, 0
    v_mov_b32 v111, 0
    v_mov_b32 v112, 0
    v_mov_b32 v113, 0
    v_mov_b32 v114, 0
    v_mov_b32 v115, 0
    v_mov_b32 v116, 0
    v_mov_b32 v117, 0
    v_mov_b32 v118, 0
    v_mov_b32 v119, 0
    v_mov_b32 v120, 0
    v_mov_b32 v121, 0
    v_mov_b32 v122, 0
    v_mov_b32 v123, 0
    v_mov_b32 v124, 0
    v_mov_b32 v125, 0
    v_mov_b32 v126, 0
    v_mov_b32 v127, 0
    v_mov_b32 v160, 0
    v_mov_b32 v161, 0
    v_mov_b32 v162, 0
    v_mov_b32 v163, 0
    v_mov_b32 v164, 0
    v_mov_b32 v165, 0
    v_mov_b32 v166, 0
    v_mov_b32 v167, 0
    v_mov_b32 v168, 0
    v_mov_b32 v169, 0
    v_mov_b32 v170, 0
    v_mov_b32 v171, 0
    v_mov_b32 v172, 0
    v_mov_b32 v173, 0
    v_mov_b32 v174, 0
    v_mov_b32 v175, 0
    v_mov_b32 v176, 0
    v_mov_b32 v177, 0
    v_mov_b32 v178, 0
    v_mov_b32 v179, 0
    v_mov_b32 v180, 0
    v_mov_b32 v181, 0
    v_mov_b32 v182, 0
    v_mov_b32 v183, 0
    v_mov_b32 v184, 0
    v_mov_b32 v185, 0
    v_mov_b32 v186, 0
    v_mov_b32 v187, 0
    v_mov_b32 v188, 0
    v_mov_b32 v189, 0
    v_mov_b32 v190, 0
    v_mov_b32 v191, 0
    v_mov_b32 v240, 0
    v_mov_b32 v241, 0
    v_mov_b32 v242, 0
    v_mov_b32 v243, 0
    v_mov_b32 v244, 0
    v_mov_b32 v245, 0
    v_mov_b32 v246, 0
    v_mov_b32 v247, 0
    v_mov_b32 v248, 0x3f803f80
    v_mov_b32 v249, 0x3f803f80
    v_mov_b32 v250, 0x3f803f80
    v_mov_b32 v251, 0x3f803f80
    v_mov_b32 v2, v1
    v_add_u32 v3, 0x8000, v1
    s_cmp_eq_u32 s11, 0
    s_cbranch_scc1 p2_kernel_pro_hi
    s_waitcnt vmcnt(8) lgkmcnt(0)
    s_barrier
    s_mov_b32 s8, -1
    s_add_u32 s15, s8, 3
    s_min_u32 s28, s15, 31
    s_lshl_b32 s28, s28, 15
    s_add_u32 s28, s28, s13
    s_and_b32 s15, s15, 3
    s_lshl_b32 s15, s15, 15
    s_lshl_b32 s16, s17, 13
    s_add_u32 m0, s15, s16
    s_nop 0
    buffer_load_dwordx4 v1, s[4:7], s28 offen offset:0 lds
    buffer_load_dwordx4 v1, s[4:7], s28 offen offset:1024 lds
    buffer_load_dwordx4 v1, s[4:7], s28 offen offset:2048 lds
    buffer_load_dwordx4 v1, s[4:7], s28 offen offset:3072 lds
    s_add_u32 m0, m0, 4096
    s_add_u32 s28, s28, 4096
    buffer_load_dwordx4 v1, s[4:7], s28 offen offset:0 lds
    buffer_load_dwordx4 v1, s[4:7], s28 offen offset:1024 lds
    buffer_load_dwordx4 v1, s[4:7], s28 offen offset:2048 lds
    buffer_load_dwordx4 v1, s[4:7], s28 offen offset:3072 lds
    s_branch p2_kernel_pro_j
p2_kernel_pro_hi:
    s_waitcnt vmcnt(0) lgkmcnt(0)
    s_barrier
    s_and_b32 s53, s53, 0xffff
    s_mov_b32 s54, 0x400000
    s_mov_b32 s55, 0x00020000
    s_and_b32 s57, s57, 0xffff
    s_mov_b32 s58, 1409024
    s_mov_b32 s59, 0x00020000
    s_lshl_b32 s36, s2, 14
    s_lshl_b32 s37, s17, 12
    s_add_u32 s36, s36, s37
    buffer_load_dwordx4 v[24:27], v1, s[52:55], s36 offen offset:0
    buffer_load_dwordx4 v[24:27], v1, s[52:55], s36 offen offset:1024
    buffer_load_dwordx4 v[24:27], v1, s[52:55], s36 offen offset:2048
    buffer_load_dwordx4 v[24:27], v1, s[52:55], s36 offen offset:3072
    s_lshl_b32 s36, s2, 13
    s_lshl_b32 s37, s17, 11
    s_add_u32 s36, s36, s37
    buffer_load_dwordx4 v[28:31], v1, s[56:59], s36 offen offset:0
    buffer_load_dwordx4 v[28:31], v1, s[56:59], s36 offen offset:1024
p2_kernel_pro_j:
    s_mov_b32 s8, 0
    s_mov_b32 s40, 0x8000
    s_mov_b32 s41, 0x18000
    s_mov_b32 s43, 3
    s_mov_b32 s42, 0
    s_cmp_lg_u32 s9, 0
    s_cbranch_scc1 p2_kernel_pro_nomask
    v_cmp_le_i32 s[20:21], 0, v18
    v_cmp_le_i32 s[22:23], 1, v18
    v_cmp_le_i32 s[24:25], 2, v18
    v_cmp_le_i32 s[26:27], 3, v18
    v_cndmask_b32 v160, v19, v160, s[20:21]
    v_cndmask_b32 v161, v19, v161, s[22:23]
    v_cndmask_b32 v162, v19, v162, s[24:25]
    v_cndmask_b32 v163, v19, v163, s[26:27]
    v_cmp_le_i32 s[20:21], -16, v18
    v_cmp_le_i32 s[22:23], -15, v18
    v_cmp_le_i32 s[24:25], -14, v18
    v_cmp_le_i32 s[26:27], -13, v18
    v_cndmask_b32 v164, v19, v164, s[20:21]
    v_cndmask_b32 v165, v19, v165, s[22:23]
    v_cndmask_b32 v166, v19, v166, s[24:25]
    v_cndmask_b32 v167, v19, v167, s[26:27]
    v_cmp_le_i32 s[20:21], 16, v18
    v_cmp_le_i32 s[22:23], 17, v18
    v_cmp_le_i32 s[24:25], 18, v18
    v_cmp_le_i32 s[26:27], 19, v18
    v_cndmask_b32 v168, v19, v168, s[20:21]
    v_cndmask_b32 v169, v19, v169, s[22:23]
    v_cndmask_b32 v170, v19, v170, s[24:25]
    v_cndmask_b32 v171, v19, v171, s[26:27]
    v_cmp_le_i32 s[20:21], 0, v18
    v_cmp_le_i32 s[22:23], 1, v18
    v_cmp_le_i32 s[24:25], 2, v18
    v_cmp_le_i32 s[26:27], 3, v18
    v_cndmask_b32 v172, v19, v172, s[20:21]
    v_cndmask_b32 v173, v19, v173, s[22:23]
    v_cndmask_b32 v174, v19, v174, s[24:25]
    v_cndmask_b32 v175, v19, v175, s[26:27]
    s_nop 1
p2_kernel_pro_nomask:
    ds_read_b128 v[192:195], v2 offset:0
    ds_read_b128 v[196:199], v2 offset:1024
    ds_read_b128 v[200:203], v2 offset:2048
    ds_read_b128 v[204:207], v2 offset:3072
    ds_read_b128 v[208:211], v2 offset:4096
    ds_read_b128 v[212:215], v2 offset:5120
    ds_read_b128 v[216:219], v2 offset:6144
    ds_read_b128 v[220:223], v2 offset:7168
    s_waitcnt lgkmcnt(0)
    v_mfma_f32_16x16x32_bf16 v[128:131], v[192:195], v[32:35], v[160:163]
    v_mfma_f32_16x16x32_bf16 v[128:131], v[196:199], v[36:39], v[128:131]
    v_mfma_f32_16x16x32_bf16 v[128:131], v[200:203], v[40:43], v[128:131]
    v_mfma_f32_16x16x32_bf16 v[128:131], v[204:207], v[44:47], v[128:131]
    v_mfma_f32_16x16x32_bf16 v[132:135], v[192:195], v[48:51], v[164:167]
    v_mfma_f32_16x16x32_bf16 v[132:135], v[196:199], v[52:55], v[132:135]
    v_mfma_f32_16x16x32_bf16 v[132:135], v[200:203], v[56:59], v[132:135]
    v_mfma_f32_16x16x32_bf16 v[132:135], v[204:207], v[60:63], v[132:135]
    v_mfma_f32_16x16x32_bf16 v[136:139], v[208:211], v[32:35], v[168:171]
    v_mfma_f32_16x16x32_bf16 v[136:139], v[212:215], v[36:39], v[136:139]
    v_mfma_f32_16x16x32_bf16 v[136:139], v[216:219], v[40:43], v[136:139]
    v_mfma_f32_16x16x32_bf16 v[136:139], v[220:223], v[44:47], v[136:139]
    v_mfma_f32_16x16x32_bf16 v[140:143], v[208:211], v[48:51], v[172:175]
    v_mfma_f32_16x16x32_bf16 v[140:143], v[212:215], v[52:55], v[140:143]
    v_mfma_f32_16x16x32_bf16 v[140:143], v[216:219], v[56:59], v[140:143]
    v_mfma_f32_16x16x32_bf16 v[140:143], v[220:223], v[60:63], v[140:143]
    ds_read_b128 v[192:195], v2 offset:16384
    ds_read_b128 v[196:199], v2 offset:17408
    ds_read_b128 v[200:203], v2 offset:18432
    ds_read_b128 v[204:207], v2 offset:19456
    s_nop 7
    v_max3_f32 v8, v128, v129, v130
    v_max3_f32 v10, v131, v136, v137
    v_max3_f32 v8, v8, v138, v139
    v_max_f32 v8, v8, v10
    v_mov_b32 v12, v8
    s_nop 1
    v_permlane32_swap_b32 v8, v12
    s_nop 1
    v_max_f32 v8, v8, v12
    v_mov_b32 v12, v8
    s_nop 1
    v_permlane16_swap_b32 v8, v12
    s_nop 1
    v_max_f32 v8, v8, v12
    v_max3_f32 v9, v132, v133, v134
    v_max3_f32 v10, v135, v140, v141
    v_max3_f32 v9, v9, v142, v143
    v_max_f32 v9, v9, v10
    v_mov_b32 v12, v9
    s_nop 1
    v_permlane32_swap_b32 v9, v12
    s_nop 1
    v_max_f32 v9, v9, v12
    v_mov_b32 v12, v9
    s_nop 1
    v_permlane16_swap_b32 v9, v12
    s_nop 1
    v_max_f32 v9, v9, v12
    v_sub_f32 v128, v128, v8
    v_sub_f32 v160, v160, v8
    v_sub_f32 v176, v176, v8
    v_sub_f32 v129, v129, v8
    v_sub_f32 v161, v161, v8
    v_sub_f32 v177, v177, v8
    v_sub_f32 v130, v130, v8
    v_sub_f32 v162, v162, v8
    v_sub_f32 v178, v178, v8
    v_sub_f32 v131, v131, v8
    v_sub_f32 v163, v163, v8
    v_sub_f32 v179, v179, v8
    v_sub_f32 v132, v132, v9
    v_sub_f32 v164, v164, v9
    v_sub_f32 v180, v180, v9
    v_sub_f32 v133, v133, v9
    v_sub_f32 v165, v165, v9
    v_sub_f32 v181, v181, v9
    v_sub_f32 v134, v134, v9
    v_sub_f32 v166, v166, v9
    v_sub_f32 v182, v182, v9
    v_sub_f32 v135, v135, v9
    v_sub_f32 v167, v167, v9
    v_sub_f32 v183, v183, v9
    v_sub_f32 v136, v136, v8
    v_sub_f32 v168, v168, v8
    v_sub_f32 v184, v184, v8
    v_sub_f32 v137, v137, v8
    v_sub_f32 v169, v169, v8
    v_sub_f32 v185, v185, v8
    v_sub_f32 v138, v138, v8
    v_sub_f32 v170, v170, v8
    v_sub_f32 v186, v186, v8
    v_sub_f32 v139, v139, v8
    v_sub_f32 v171, v171, v8
    v_sub_f32 v187, v187, v8
    v_sub_f32 v140, v140, v9
    v_sub_f32 v172, v172, v9
    v_sub_f32 v188, v188, v9
    v_sub_f32 v141, v141, v9
    v_sub_f32 v173, v173, v9
    v_sub_f32 v189, v189, v9
    v_sub_f32 v142, v142, v9
    v_sub_f32 v174, v174, v9
    v_sub_f32 v190, v190, v9
    v_sub_f32 v143, v143, v9
    v_sub_f32 v175, v175, v9
    v_sub_f32 v191, v191, v9
    s_nop 1
    s_cmp_eq_u32 s39, 0
    s_cbranch_scc0 p2_kernel_safe_main
    s_cmp_eq_u32 s11, 0
    s_cbranch_scc0 p2_kernel_lofast_main
    ds_read_b128 v[208:211], v2 offset:20480
    ds_read_b128 v[212:215], v2 offset:21504
    ds_read_b128 v[216:219], v2 offset:22528
    ds_read_b128 v[220:223], v2 offset:23552
    s_waitcnt lgkmcnt(4)
    v_exp_f32 v128, v128
    v_exp_f32 v129, v129
    v_exp_f32 v130, v130
    v_cvt_pk_bf16_f32 v224, v128, v129
    v_exp_f32 v131, v131
    v_exp_f32 v136, v136
    v_cvt_pk_bf16_f32 v225, v130, v131
    v_exp_f32 v137, v137
    v_exp_f32 v138, v138
    v_cvt_pk_bf16_f32 v226, v136, v137
    v_exp_f32 v139, v139
    s_nop 0
    v_cvt_pk_bf16_f32 v227, v138, v139
    s_cmp_eq_u32 s9, 0
    s_cbranch_scc1 p2_kernel_hifast_finalE
    s_lshr_b32 s29, s9, 1
    s_bitcmp1_b32 s9, 0
    s_cbranch_scc1 p2_kernel_hifast_lp
    s_sub_u32 s29, s29, 1
p2_kernel_hifast_lp:
    s_lshl_b32 s29, s29, 1
    s_cmp_lt_u32 s8, s29
    s_cbranch_scc0 p2_kernel_hifast_lpend
p2_kernel_hifast_loop:
    s_barrier
    v_mfma_f32_16x16x32_bf16 v[144:147], v[192:195], v[32:35], v[176:179]
    v_exp_f32 v132, v132
    v_mfma_f32_16x16x32_bf16 v[144:147], v[196:199], v[36:39], v[144:147]
    v_exp_f32 v133, v133
    v_mfma_f32_16x16x32_bf16 v[144:147], v[200:203], v[40:43], v[144:147]
    v_exp_f32 v134, v134
    v_mfma_f32_16x16x32_bf16 v[144:147], v[204:207], v[44:47], v[144:147]
    v_exp_f32 v135, v135
    v_mfma_f32_16x16x32_bf16 v[148:151], v[192:195], v[48:51], v[180:183]
    v_exp_f32 v140, v140
    v_mfma_f32_16x16x32_bf16 v[148:151], v[196:199], v[52:55], v[148:151]
    ds_read_b128 v[192:195], v2 offset:8192
    v_cvt_pk_bf16_f32 v228, v132, v133
    v_mfma_f32_16x16x32_bf16 v[148:151], v[200:203], v[56:59], v[148:151]
    ds_read_b128 v[196:199], v2 offset:9216
    v_cvt_pk_bf16_f32 v229, v134, v135
    v_mfma_f32_16x16x32_bf16 v[148:151], v[204:207], v[60:63], v[148:151]
    ds_read_b128 v[200:203], v2 offset:10240
    s_waitcnt lgkmcnt(3)
    v_mfma_f32_16x16x32_bf16 v[152:155], v[208:211], v[32:35], v[184:187]
    ds_read_b128 v[204:207], v2 offset:11264
    v_mfma_f32_16x16x32_bf16 v[152:155], v[212:215], v[36:39], v[152:155]
    v_exp_f32 v141, v141
    v_mfma_f32_16x16x32_bf16 v[152:155], v[216:219], v[40:43], v[152:155]
    v_exp_f32 v142, v142
    v_mfma_f32_16x16x32_bf16 v[152:155], v[220:223], v[44:47], v[152:155]
    v_exp_f32 v143, v143
    v_mfma_f32_16x16x32_bf16 v[156:159], v[208:211], v[48:51], v[188:191]
    v_mfma_f32_16x16x32_bf16 v[156:159], v[212:215], v[52:55], v[156:159]
    ds_read_b128 v[208:211], v2 offset:12288
    v_cvt_pk_bf16_f32 v230, v140, v141
    v_mfma_f32_16x16x32_bf16 v[156:159], v[216:219], v[56:59], v[156:159]
    ds_read_b128 v[212:215], v2 offset:13312
    v_cvt_pk_bf16_f32 v231, v142, v143
    v_mfma_f32_16x16x32_bf16 v[156:159], v[220:223], v[60:63], v[156:159]
    ds_read_b128 v[216:219], v2 offset:14336
    s_waitcnt lgkmcnt(3)
    v_mfma_f32_16x16x32_bf16 v[64:67], v[192:195], v[224:227], v[64:67]
    ds_read_b128 v[220:223], v2 offset:15360
    v_mfma_f32_16x16x32_bf16 v[68:71], v[192:195], v[228:231], v[68:71]
    v_exp_f32 v144, v144
    v_mfma_f32_16x16x32_bf16 v[72:75], v[196:199], v[224:227], v[72:75]
    ds_read_b128 v[192:195], v3 offset:0
    v_mfma_f32_16x16x32_bf16 v[76:79], v[196:199], v[228:231], v[76:79]
    v_exp_f32 v145, v145
    v_mfma_f32_16x16x32_bf16 v[80:83], v[200:203], v[224:227], v[80:83]
    ds_read_b128 v[196:199], v3 offset:1024
    v_cvt_pk_bf16_f32 v232, v144, v145
    v_mfma_f32_16x16x32_bf16 v[84:87], v[200:203], v[228:231], v[84:87]
    v_exp_f32 v146, v146
    v_mfma_f32_16x16x32_bf16 v[88:91], v[204:207], v[224:227], v[88:91]
    ds_read_b128 v[200:203], v3 offset:2048
    s_waitcnt lgkmcnt(3)
    v_mfma_f32_16x16x32_bf16 v[92:95], v[204:207], v[228:231], v[92:95]
    v_exp_f32 v147, v147
    v_mfma_f32_16x16x32_bf16 v[96:99], v[208:211], v[224:227], v[96:99]
    ds_read_b128 v[204:207], v3 offset:3072
    v_cvt_pk_bf16_f32 v233, v146, v147
    v_mfma_f32_16x16x32_bf16 v[100:103], v[208:211], v[228:231], v[100:103]
    v_exp_f32 v152, v152
    v_mfma_f32_16x16x32_bf16 v[104:107], v[212:215], v[224:227], v[104:107]
    ds_read_b128 v[208:211], v3 offset:4096
    v_mfma_f32_16x16x32_bf16 v[108:111], v[212:215], v[228:231], v[108:111]
    v_exp_f32 v153, v153
    v_mfma_f32_16x16x32_bf16 v[112:115], v[216:219], v[224:227], v[112:115]
    ds_read_b128 v[212:215], v3 offset:5120
    v_cvt_pk_bf16_f32 v234, v152, v153
    v_mfma_f32_16x16x32_bf16 v[116:119], v[216:219], v[228:231], v[116:119]
    v_exp_f32 v154, v154
    v_mfma_f32_16x16x32_bf16 v[120:123], v[220:223], v[224:227], v[120:123]
    ds_read_b128 v[216:219], v3 offset:6144
    v_mfma_f32_16x16x32_bf16 v[124:127], v[220:223], v[228:231], v[124:127]
    v_exp_f32 v155, v155
    v_mfma_f32_16x16x32_bf16 v[240:243], v[248:251], v[224:227], v[240:243]
    ds_read_b128 v[220:223], v3 offset:7168
    v_cvt_pk_bf16_f32 v235, v154, v155
    v_mfma_f32_16x16x32_bf16 v[244:247], v[248:251], v[228:231], v[244:247]
    s_waitcnt lgkmcnt(4)
    v_mfma_f32_16x16x32_bf16 v[128:131], v[192:195], v[32:35], v[160:163]
    v_exp_f32 v148, v148
    v_mfma_f32_16x16x32_bf16 v[128:131], v[196:199], v[36:39], v[128:131]
    v_exp_f32 v149, v149
    v_mfma_f32_16x16x32_bf16 v[128:131], v[200:203], v[40:43], v[128:131]
    v_exp_f32 v150, v150
    v_mfma_f32_16x16x32_bf16 v[128:131], v[204:207], v[44:47], v[128:131]
    v_exp_f32 v151, v151
    v_mfma_f32_16x16x32_bf16 v[132:135], v[192:195], v[48:51], v[164:167]
    v_exp_f32 v156, v156
    v_mfma_f32_16x16x32_bf16 v[132:135], v[196:199], v[52:55], v[132:135]
    ds_read_b128 v[192:195], v2 offset:24576
    v_cvt_pk_bf16_f32 v236, v148, v149
    v_mfma_f32_16x16x32_bf16 v[132:135], v[200:203], v[56:59], v[132:135]
    ds_read_b128 v[196:199], v2 offset:25600
    v_cvt_pk_bf16_f32 v237, v150, v151
    v_mfma_f32_16x16x32_bf16 v[132:135], v[204:207], v[60:63], v[132:135]
    ds_read_b128 v[200:203], v2 offset:26624
    s_waitcnt lgkmcnt(3)
    v_mfma_f32_16x16x32_bf16 v[136:139], v[208:211], v[32:35], v[168:171]
    ds_read_b128 v[204:207], v2 offset:27648
    s_add_u32 s8, s8, 1
    v_mfma_f32_16x16x32_bf16 v[136:139], v[212:215], v[36:39], v[136:139]
    v_exp_f32 v157, v157
    v_mfma_f32_16x16x32_bf16 v[136:139], v[216:219], v[40:43], v[136:139]
    v_exp_f32 v158, v158
    v_mfma_f32_16x16x32_bf16 v[136:139], v[220:223], v[44:47], v[136:139]
    v_exp_f32 v159, v159
    v_mfma_f32_16x16x32_bf16 v[140:143], v[208:211], v[48:51], v[172:175]
    s_add_u32 s40, s40, 0x8000
    s_cmp_eq_u32 s40, 0x28000
    v_mfma_f32_16x16x32_bf16 v[140:143], v[212:215], v[52:55], v[140:143]
    ds_read_b128 v[208:211], v2 offset:28672
    v_cvt_pk_bf16_f32 v238, v156, v157
    v_mfma_f32_16x16x32_bf16 v[140:143], v[216:219], v[56:59], v[140:143]
    ds_read_b128 v[212:215], v2 offset:29696
    v_cvt_pk_bf16_f32 v239, v158, v159
    v_mfma_f32_16x16x32_bf16 v[140:143], v[220:223], v[60:63], v[140:143]
    ds_read_b128 v[216:219], v2 offset:30720
    s_waitcnt lgkmcnt(3)
    v_mfma_f32_16x16x32_bf16 v[64:67], v[192:195], v[232:235], v[64:67]
    ds_read_b128 v[220:223], v2 offset:31744
    s_cselect_b32 s40, 0, s40
    v_mfma_f32_16x16x32_bf16 v[68:71], v[192:195], v[236:239], v[68:71]
    v_exp_f32 v128, v128
    v_mfma_f32_16x16x32_bf16 v[72:75], v[196:199], v[232:235], v[72:75]
    ds_read_b128 v[192:195], v3 offset:16384
    v_mfma_f32_16x16x32_bf16 v[76:79], v[196:199], v[236:239], v[76:79]
    v_exp_f32 v129, v129
    v_mfma_f32_16x16x32_bf16 v[80:83], v[200:203], v[232:235], v[80:83]
    ds_read_b128 v[196:199], v3 offset:17408
    v_cvt_pk_bf16_f32 v224, v128, v129
    v_mfma_f32_16x16x32_bf16 v[84:87], v[200:203], v[236:239], v[84:87]
    v_exp_f32 v130, v130
    v_mfma_f32_16x16x32_bf16 v[88:91], v[204:207], v[232:235], v[88:91]
    ds_read_b128 v[200:203], v3 offset:18432
    s_waitcnt lgkmcnt(3)
    v_mfma_f32_16x16x32_bf16 v[92:95], v[204:207], v[236:239], v[92:95]
    v_exp_f32 v131, v131
    v_mfma_f32_16x16x32_bf16 v[96:99], v[208:211], v[232:235], v[96:99]
    ds_read_b128 v[204:207], v3 offset:19456
    v_cvt_pk_bf16_f32 v225, v130, v131
    v_mfma_f32_16x16x32_bf16 v[100:103], v[208:211], v[236:239], v[100:103]
    v_exp_f32 v136, v136
    v_mfma_f32_16x16x32_bf16 v[104:107], v[212:215], v[232:235], v[104:107]
    ds_read_b128 v[208:211], v3 offset:20480
    v_mfma_f32_16x16x32_bf16 v[108:111], v[212:215], v[236:239], v[108:111]
    v_exp_f32 v137, v137
    v_mfma_f32_16x16x32_bf16 v[112:115], v[216:219], v[232:235], v[112:115]
    ds_read_b128 v[212:215], v3 offset:21504
    v_cvt_pk_bf16_f32 v226, v136, v137
    v_mfma_f32_16x16x32_bf16 v[116:119], v[216:219], v[236:239], v[116:119]
    v_exp_f32 v138, v138
    v_mfma_f32_16x16x32_bf16 v[120:123], v[220:223], v[232:235], v[120:123]
    ds_read_b128 v[216:219], v3 offset:22528
    v_mfma_f32_16x16x32_bf16 v[124:127], v[220:223], v[236:239], v[124:127]
    v_exp_f32 v139, v139
    v_mfma_f32_16x16x32_bf16 v[240:243], v[248:251], v[232:235], v[240:243]
    ds_read_b128 v[220:223], v3 offset:23552
    v_cvt_pk_bf16_f32 v227, v138, v139
    v_mfma_f32_16x16x32_bf16 v[244:247], v[248:251], v[236:239], v[244:247]
    s_waitcnt lgkmcnt(4)
    v_mov_b32 v2, v3
    v_add_u32 v3, s40, v1
    v_mfma_f32_16x16x32_bf16 v[144:147], v[192:195], v[32:35], v[176:179]
    v_exp_f32 v132, v132
    v_mfma_f32_16x16x32_bf16 v[144:147], v[196:199], v[36:39], v[144:147]
    v_exp_f32 v133, v133
    v_mfma_f32_16x16x32_bf16 v[144:147], v[200:203], v[40:43], v[144:147]
    v_exp_f32 v134, v134
    v_mfma_f32_16x16x32_bf16 v[144:147], v[204:207], v[44:47], v[144:147]
    v_exp_f32 v135, v135
    v_mfma_f32_16x16x32_bf16 v[148:151], v[192:195], v[48:51], v[180:183]
    v_exp_f32 v140, v140
    v_mfma_f32_16x16x32_bf16 v[148:151], v[196:199], v[52:55], v[148:151]
    ds_read_b128 v[192:195], v2 offset:8192
    v_cvt_pk_bf16_f32 v228, v132, v133
    v_mfma_f32_16x16x32_bf16 v[148:151], v[200:203], v[56:59], v[148:151]
    ds_read_b128 v[196:199], v2 offset:9216
    v_cvt_pk_bf16_f32 v229, v134, v135
    v_mfma_f32_16x16x32_bf16 v[148:151], v[204:207], v[60:63], v[148:151]
    ds_read_b128 v[200:203], v2 offset:10240
    s_waitcnt lgkmcnt(3)
    v_mfma_f32_16x16x32_bf16 v[152:155], v[208:211], v[32:35], v[184:187]
    ds_read_b128 v[204:207], v2 offset:11264
    v_mfma_f32_16x16x32_bf16 v[152:155], v[212:215], v[36:39], v[152:155]
    v_exp_f32 v141, v141
    v_mfma_f32_16x16x32_bf16 v[152:155], v[216:219], v[40:43], v[152:155]
    v_exp_f32 v142, v142
    v_mfma_f32_16x16x32_bf16 v[152:155], v[220:223], v[44:47], v[152:155]
    v_exp_f32 v143, v143
    v_mfma_f32_16x16x32_bf16 v[156:159], v[208:211], v[48:51], v[188:191]
    v_mfma_f32_16x16x32_bf16 v[156:159], v[212:215], v[52:55], v[156:159]
    ds_read_b128 v[208:211], v2 offset:12288
    v_cvt_pk_bf16_f32 v230, v140, v141
    v_mfma_f32_16x16x32_bf16 v[156:159], v[216:219], v[56:59], v[156:159]
    ds_read_b128 v[212:215], v2 offset:13312
    v_cvt_pk_bf16_f32 v231, v142, v143
    v_mfma_f32_16x16x32_bf16 v[156:159], v[220:223], v[60:63], v[156:159]
    ds_read_b128 v[216:219], v2 offset:14336
    s_waitcnt lgkmcnt(3)
    v_mfma_f32_16x16x32_bf16 v[64:67], v[192:195], v[224:227], v[64:67]
    ds_read_b128 v[220:223], v2 offset:15360
    v_mfma_f32_16x16x32_bf16 v[68:71], v[192:195], v[228:231], v[68:71]
    v_exp_f32 v144, v144
    v_mfma_f32_16x16x32_bf16 v[72:75], v[196:199], v[224:227], v[72:75]
    ds_read_b128 v[192:195], v3 offset:0
    v_mfma_f32_16x16x32_bf16 v[76:79], v[196:199], v[228:231], v[76:79]
    v_exp_f32 v145, v145
    v_mfma_f32_16x16x32_bf16 v[80:83], v[200:203], v[224:227], v[80:83]
    ds_read_b128 v[196:199], v3 offset:1024
    v_cvt_pk_bf16_f32 v232, v144, v145
    v_mfma_f32_16x16x32_bf16 v[84:87], v[200:203], v[228:231], v[84:87]
    v_exp_f32 v146, v146
    v_mfma_f32_16x16x32_bf16 v[88:91], v[204:207], v[224:227], v[88:91]
    ds_read_b128 v[200:203], v3 offset:2048
    s_waitcnt lgkmcnt(3)
    v_mfma_f32_16x16x32_bf16 v[92:95], v[204:207], v[228:231], v[92:95]
    v_exp_f32 v147, v147
    v_mfma_f32_16x16x32_bf16 v[96:99], v[208:211], v[224:227], v[96:99]
    ds_read_b128 v[204:207], v3 offset:3072
    v_cvt_pk_bf16_f32 v233, v146, v147
    v_mfma_f32_16x16x32_bf16 v[100:103], v[208:211], v[228:231], v[100:103]
    v_exp_f32 v152, v152
    v_mfma_f32_16x16x32_bf16 v[104:107], v[212:215], v[224:227], v[104:107]
    ds_read_b128 v[208:211], v3 offset:4096
    v_mfma_f32_16x16x32_bf16 v[108:111], v[212:215], v[228:231], v[108:111]
    v_exp_f32 v153, v153
    v_mfma_f32_16x16x32_bf16 v[112:115], v[216:219], v[224:227], v[112:115]
    ds_read_b128 v[212:215], v3 offset:5120
    v_cvt_pk_bf16_f32 v234, v152, v153
    v_mfma_f32_16x16x32_bf16 v[116:119], v[216:219], v[228:231], v[116:119]
    v_exp_f32 v154, v154
    v_mfma_f32_16x16x32_bf16 v[120:123], v[220:223], v[224:227], v[120:123]
    ds_read_b128 v[216:219], v3 offset:6144
    v_mfma_f32_16x16x32_bf16 v[124:127], v[220:223], v[228:231], v[124:127]
    v_exp_f32 v155, v155
    v_mfma_f32_16x16x32_bf16 v[240:243], v[248:251], v[224:227], v[240:243]
    ds_read_b128 v[220:223], v3 offset:7168
    v_cvt_pk_bf16_f32 v235, v154, v155
    v_mfma_f32_16x16x32_bf16 v[244:247], v[248:251], v[228:231], v[244:247]
    s_waitcnt lgkmcnt(4)
    v_mfma_f32_16x16x32_bf16 v[128:131], v[192:195], v[32:35], v[160:163]
    v_exp_f32 v148, v148
    v_mfma_f32_16x16x32_bf16 v[128:131], v[196:199], v[36:39], v[128:131]
    v_exp_f32 v149, v149
    v_mfma_f32_16x16x32_bf16 v[128:131], v[200:203], v[40:43], v[128:131]
    v_exp_f32 v150, v150
    v_mfma_f32_16x16x32_bf16 v[128:131], v[204:207], v[44:47], v[128:131]
    v_exp_f32 v151, v151
    v_mfma_f32_16x16x32_bf16 v[132:135], v[192:195], v[48:51], v[164:167]
    v_exp_f32 v156, v156
    v_mfma_f32_16x16x32_bf16 v[132:135], v[196:199], v[52:55], v[132:135]
    ds_read_b128 v[192:195], v2 offset:24576
    v_cvt_pk_bf16_f32 v236, v148, v149
    v_mfma_f32_16x16x32_bf16 v[132:135], v[200:203], v[56:59], v[132:135]
    ds_read_b128 v[196:199], v2 offset:25600
    v_cvt_pk_bf16_f32 v237, v150, v151
    v_mfma_f32_16x16x32_bf16 v[132:135], v[204:207], v[60:63], v[132:135]
    ds_read_b128 v[200:203], v2 offset:26624
    s_waitcnt lgkmcnt(3)
    v_mfma_f32_16x16x32_bf16 v[136:139], v[208:211], v[32:35], v[168:171]
    ds_read_b128 v[204:207], v2 offset:27648
    s_add_u32 s8, s8, 1
    v_mfma_f32_16x16x32_bf16 v[136:139], v[212:215], v[36:39], v[136:139]
    v_exp_f32 v157, v157
    v_mfma_f32_16x16x32_bf16 v[136:139], v[216:219], v[40:43], v[136:139]
    v_exp_f32 v158, v158
    v_mfma_f32_16x16x32_bf16 v[136:139], v[220:223], v[44:47], v[136:139]
    v_exp_f32 v159, v159
    v_mfma_f32_16x16x32_bf16 v[140:143], v[208:211], v[48:51], v[172:175]
    s_add_u32 s40, s40, 0x8000
    s_cmp_eq_u32 s40, 0x28000
    v_mfma_f32_16x16x32_bf16 v[140:143], v[212:215], v[52:55], v[140:143]
    ds_read_b128 v[208:211], v2 offset:28672
    v_cvt_pk_bf16_f32 v238, v156, v157
    v_mfma_f32_16x16x32_bf16 v[140:143], v[216:219], v[56:59], v[140:143]
    ds_read_b128 v[212:215], v2 offset:29696
    v_cvt_pk_bf16_f32 v239, v158, v159
    v_mfma_f32_16x16x32_bf16 v[140:143], v[220:223], v[60:63], v[140:143]
    ds_read_b128 v[216:219], v2 offset:30720
    s_waitcnt lgkmcnt(3)
    v_mfma_f32_16x16x32_bf16 v[64:67], v[192:195], v[232:235], v[64:67]
    ds_read_b128 v[220:223], v2 offset:31744
    s_cselect_b32 s40, 0, s40
    v_mfma_f32_16x16x32_bf16 v[68:71], v[192:195], v[236:239], v[68:71]
    v_exp_f32 v128, v128
    v_mfma_f32_16x16x32_bf16 v[72:75], v[196:199], v[232:235], v[72:75]
    ds_read_b128 v[192:195], v3 offset:16384
    v_mfma_f32_16x16x32_bf16 v[76:79], v[196:199], v[236:239], v[76:79]
    v_exp_f32 v129, v129
    v_mfma_f32_16x16x32_bf16 v[80:83], v[200:203], v[232:235], v[80:83]
    ds_read_b128 v[196:199], v3 offset:17408
    v_cvt_pk_bf16_f32 v224, v128, v129
    v_mfma_f32_16x16x32_bf16 v[84:87], v[200:203], v[236:239], v[84:87]
    v_exp_f32 v130, v130
    v_mfma_f32_16x16x32_bf16 v[88:91], v[204:207], v[232:235], v[88:91]
    ds_read_b128 v[200:203], v3 offset:18432
    s_waitcnt lgkmcnt(3)
    v_mfma_f32_16x16x32_bf16 v[92:95], v[204:207], v[236:239], v[92:95]
    v_exp_f32 v131, v131
    v_mfma_f32_16x16x32_bf16 v[96:99], v[208:211], v[232:235], v[96:99]
    ds_read_b128 v[204:207], v3 offset:19456
    v_cvt_pk_bf16_f32 v225, v130, v131
    v_mfma_f32_16x16x32_bf16 v[100:103], v[208:211], v[236:239], v[100:103]
    v_exp_f32 v136, v136
    v_mfma_f32_16x16x32_bf16 v[104:107], v[212:215], v[232:235], v[104:107]
    ds_read_b128 v[208:211], v3 offset:20480
    v_mfma_f32_16x16x32_bf16 v[108:111], v[212:215], v[236:239], v[108:111]
    v_exp_f32 v137, v137
    v_mfma_f32_16x16x32_bf16 v[112:115], v[216:219], v[232:235], v[112:115]
    ds_read_b128 v[212:215], v3 offset:21504
    v_cvt_pk_bf16_f32 v226, v136, v137
    v_mfma_f32_16x16x32_bf16 v[116:119], v[216:219], v[236:239], v[116:119]
    v_exp_f32 v138, v138
    v_mfma_f32_16x16x32_bf16 v[120:123], v[220:223], v[232:235], v[120:123]
    ds_read_b128 v[216:219], v3 offset:22528
    v_mfma_f32_16x16x32_bf16 v[124:127], v[220:223], v[236:239], v[124:127]
    v_exp_f32 v139, v139
    v_mfma_f32_16x16x32_bf16 v[240:243], v[248:251], v[232:235], v[240:243]
    ds_read_b128 v[220:223], v3 offset:23552
    v_cvt_pk_bf16_f32 v227, v138, v139
    v_mfma_f32_16x16x32_bf16 v[244:247], v[248:251], v[236:239], v[244:247]
    s_waitcnt lgkmcnt(4)
    v_mov_b32 v2, v3
    v_add_u32 v3, s40, v1
    s_cmp_lt_u32 s8, s29
    s_cbranch_scc1 p2_kernel_hifast_loop
p2_kernel_hifast_lpend:
    v_and_b32 v26, 63, v0
    s_getpc_b64 s[96:97]
p2_kernel_hifast_ct4:
    s_add_u32 s96, s96, p2_kernel_fin-p2_kernel_hifast_ct4
    s_addc_u32 s97, s97, 0
    s_mov_b32 s98, 0
    s_lshl_b32 s98, s98, 6
    v_add_u32 v25, s98, v26
    s_mov_b32 s98, (p2_kernel_end-p2_kernel_fin)/128-1
    v_min_u32 v25, s98, v25
    v_lshlrev_b32 v25, 7, v25
    global_load_dword v24, v25, s[96:97]
    s_getpc_b64 s[96:97]
p2_kernel_hifast_ct5:
    s_add_u32 s96, s96, p2_kernel_hifast_finalE-p2_kernel_hifast_ct5
    s_addc_u32 s97, s97, 0
    s_mov_b32 s98, 0
    s_lshl_b32 s98, s98, 6
    v_add_u32 v25, s98, v26
    s_mov_b32 s98, (p2_kernel_hifast_tailend-p2_kernel_hifast_finalE)/128-1
    v_min_u32 v25, s98, v25
    v_lshlrev_b32 v25, 7, v25
    global_load_dword v27, v25, s[96:97]
    s_bitcmp1_b32 s9, 0
    s_cbranch_scc1 p2_kernel_hifast_peelO
    s_barrier
    v_mfma_f32_16x16x32_bf16 v[144:147], v[192:195], v[32:35], v[176:179]
    v_exp_f32 v132, v132
    v_mfma_f32_16x16x32_bf16 v[144:147], v[196:199], v[36:39], v[144:147]
    v_exp_f32 v133, v133
    v_mfma_f32_16x16x32_bf16 v[144:147], v[200:203], v[40:43], v[144:147]
    v_exp_f32 v134, v134
    v_mfma_f32_16x16x32_bf16 v[144:147], v[204:207], v[44:47], v[144:147]
    v_exp_f32 v135, v135
    v_mfma_f32_16x16x32_bf16 v[148:151], v[192:195], v[48:51], v[180:183]
    v_exp_f32 v140, v140
    v_mfma_f32_16x16x32_bf16 v[148:151], v[196:199], v[52:55], v[148:151]
    ds_read_b128 v[192:195], v2 offset:8192
    v_cvt_pk_bf16_f32 v228, v132, v133
    v_mfma_f32_16x16x32_bf16 v[148:151], v[200:203], v[56:59], v[148:151]
    ds_read_b128 v[196:199], v2 offset:9216
    v_cvt_pk_bf16_f32 v229, v134, v135
    v_mfma_f32_16x16x32_bf16 v[148:151], v[204:207], v[60:63], v[148:151]
    ds_read_b128 v[200:203], v2 offset:10240
    s_waitcnt lgkmcnt(3)
    v_mfma_f32_16x16x32_bf16 v[152:155], v[208:211], v[32:35], v[184:187]
    ds_read_b128 v[204:207], v2 offset:11264
    v_mfma_f32_16x16x32_bf16 v[152:155], v[212:215], v[36:39], v[152:155]
    v_exp_f32 v141, v141
    v_mfma_f32_16x16x32_bf16 v[152:155], v[216:219], v[40:43], v[152:155]
    v_exp_f32 v142, v142
    v_mfma_f32_16x16x32_bf16 v[152:155], v[220:223], v[44:47], v[152:155]
    v_exp_f32 v143, v143
    v_mfma_f32_16x16x32_bf16 v[156:159], v[208:211], v[48:51], v[188:191]
    v_mfma_f32_16x16x32_bf16 v[156:159], v[212:215], v[52:55], v[156:159]
    ds_read_b128 v[208:211], v2 offset:12288
    v_cvt_pk_bf16_f32 v230, v140, v141
    v_mfma_f32_16x16x32_bf16 v[156:159], v[216:219], v[56:59], v[156:159]
    ds_read_b128 v[212:215], v2 offset:13312
    v_cvt_pk_bf16_f32 v231, v142, v143
    v_mfma_f32_16x16x32_bf16 v[156:159], v[220:223], v[60:63], v[156:159]
    ds_read_b128 v[216:219], v2 offset:14336
    s_waitcnt lgkmcnt(3)
    v_mfma_f32_16x16x32_bf16 v[64:67], v[192:195], v[224:227], v[64:67]
    ds_read_b128 v[220:223], v2 offset:15360
    v_mfma_f32_16x16x32_bf16 v[68:71], v[192:195], v[228:231], v[68:71]
    v_exp_f32 v144, v144
    v_mfma_f32_16x16x32_bf16 v[72:75], v[196:199], v[224:227], v[72:75]
    ds_read_b128 v[192:195], v3 offset:0
    v_mfma_f32_16x16x32_bf16 v[76:79], v[196:199], v[228:231], v[76:79]
    v_exp_f32 v145, v145
    v_mfma_f32_16x16x32_bf16 v[80:83], v[200:203], v[224:227], v[80:83]
    ds_read_b128 v[196:199], v3 offset:1024
    v_cvt_pk_bf16_f32 v232, v144, v145
    v_mfma_f32_16x16x32_bf16 v[84:87], v[200:203], v[228:231], v[84:87]
    v_exp_f32 v146, v146
    v_mfma_f32_16x16x32_bf16 v[88:91], v[204:207], v[224:227], v[88:91]
    ds_read_b128 v[200:203], v3 offset:2048
    s_waitcnt lgkmcnt(3)
    v_mfma_f32_16x16x32_bf16 v[92:95], v[204:207], v[228:231], v[92:95]
    v_exp_f32 v147, v147
    v_mfma_f32_16x16x32_bf16 v[96:99], v[208:211], v[224:227], v[96:99]
    ds_read_b128 v[204:207], v3 offset:3072
    v_cvt_pk_bf16_f32 v233, v146, v147
    v_mfma_f32_16x16x32_bf16 v[100:103], v[208:211], v[228:231], v[100:103]
    v_exp_f32 v152, v152
    v_mfma_f32_16x16x32_bf16 v[104:107], v[212:215], v[224:227], v[104:107]
    ds_read_b128 v[208:211], v3 offset:4096
    v_mfma_f32_16x16x32_bf16 v[108:111], v[212:215], v[228:231], v[108:111]
    v_exp_f32 v153, v153
    v_mfma_f32_16x16x32_bf16 v[112:115], v[216:219], v[224:227], v[112:115]
    ds_read_b128 v[212:215], v3 offset:5120
    v_cvt_pk_bf16_f32 v234, v152, v153
    v_mfma_f32_16x16x32_bf16 v[116:119], v[216:219], v[228:231], v[116:119]
    v_exp_f32 v154, v154
    v_mfma_f32_16x16x32_bf16 v[120:123], v[220:223], v[224:227], v[120:123]
    ds_read_b128 v[216:219], v3 offset:6144
    v_mfma_f32_16x16x32_bf16 v[124:127], v[220:223], v[228:231], v[124:127]
    v_exp_f32 v155, v155
    v_mfma_f32_16x16x32_bf16 v[240:243], v[248:251], v[224:227], v[240:243]
    ds_read_b128 v[220:223], v3 offset:7168
    v_cvt_pk_bf16_f32 v235, v154, v155
    v_mfma_f32_16x16x32_bf16 v[244:247], v[248:251], v[228:231], v[244:247]
    s_waitcnt lgkmcnt(4)
    v_mfma_f32_16x16x32_bf16 v[128:131], v[192:195], v[32:35], v[160:163]
    v_exp_f32 v148, v148
    v_mfma_f32_16x16x32_bf16 v[128:131], v[196:199], v[36:39], v[128:131]
    v_exp_f32 v149, v149
    v_mfma_f32_16x16x32_bf16 v[128:131], v[200:203], v[40:43], v[128:131]
    v_exp_f32 v150, v150
    v_mfma_f32_16x16x32_bf16 v[128:131], v[204:207], v[44:47], v[128:131]
    v_exp_f32 v151, v151
    v_mfma_f32_16x16x32_bf16 v[132:135], v[192:195], v[48:51], v[164:167]
    v_exp_f32 v156, v156
    v_mfma_f32_16x16x32_bf16 v[132:135], v[196:199], v[52:55], v[132:135]
    ds_read_b128 v[192:195], v2 offset:24576
    v_cvt_pk_bf16_f32 v236, v148, v149
    v_mfma_f32_16x16x32_bf16 v[132:135], v[200:203], v[56:59], v[132:135]
    ds_read_b128 v[196:199], v2 offset:25600
    v_cvt_pk_bf16_f32 v237, v150, v151
    v_mfma_f32_16x16x32_bf16 v[132:135], v[204:207], v[60:63], v[132:135]
    ds_read_b128 v[200:203], v2 offset:26624
    s_waitcnt lgkmcnt(3)
    v_mfma_f32_16x16x32_bf16 v[136:139], v[208:211], v[32:35], v[168:171]
    ds_read_b128 v[204:207], v2 offset:27648
    s_add_u32 s8, s8, 1
    v_mfma_f32_16x16x32_bf16 v[136:139], v[212:215], v[36:39], v[136:139]
    v_exp_f32 v157, v157
    v_mfma_f32_16x16x32_bf16 v[136:139], v[216:219], v[40:43], v[136:139]
    v_exp_f32 v158, v158
    v_mfma_f32_16x16x32_bf16 v[136:139], v[220:223], v[44:47], v[136:139]
    v_exp_f32 v159, v159
    v_mfma_f32_16x16x32_bf16 v[140:143], v[208:211], v[48:51], v[172:175]
    s_add_u32 s40, s40, 0x8000
    s_cmp_eq_u32 s40, 0x28000
    v_mfma_f32_16x16x32_bf16 v[140:143], v[212:215], v[52:55], v[140:143]
    ds_read_b128 v[208:211], v2 offset:28672
    v_cvt_pk_bf16_f32 v238, v156, v157
    v_mfma_f32_16x16x32_bf16 v[140:143], v[216:219], v[56:59], v[140:143]
    ds_read_b128 v[212:215], v2 offset:29696
    v_cvt_pk_bf16_f32 v239, v158, v159
    v_mfma_f32_16x16x32_bf16 v[140:143], v[220:223], v[60:63], v[140:143]
    ds_read_b128 v[216:219], v2 offset:30720
    s_waitcnt lgkmcnt(3)
    v_mfma_f32_16x16x32_bf16 v[64:67], v[192:195], v[232:235], v[64:67]
    ds_read_b128 v[220:223], v2 offset:31744
    s_cselect_b32 s40, 0, s40
    v_mfma_f32_16x16x32_bf16 v[68:71], v[192:195], v[236:239], v[68:71]
    v_exp_f32 v128, v128
    v_mfma_f32_16x16x32_bf16 v[72:75], v[196:199], v[232:235], v[72:75]
    ds_read_b128 v[192:195], v3 offset:16384
    v_mfma_f32_16x16x32_bf16 v[76:79], v[196:199], v[236:239], v[76:79]
    v_exp_f32 v129, v129
    v_mfma_f32_16x16x32_bf16 v[80:83], v[200:203], v[232:235], v[80:83]
    ds_read_b128 v[196:199], v3 offset:17408
    v_cvt_pk_bf16_f32 v224, v128, v129
    v_mfma_f32_16x16x32_bf16 v[84:87], v[200:203], v[236:239], v[84:87]
    v_exp_f32 v130, v130
    v_mfma_f32_16x16x32_bf16 v[88:91], v[204:207], v[232:235], v[88:91]
    ds_read_b128 v[200:203], v3 offset:18432
    s_waitcnt lgkmcnt(3)
    v_mfma_f32_16x16x32_bf16 v[92:95], v[204:207], v[236:239], v[92:95]
    v_exp_f32 v131, v131
    v_mfma_f32_16x16x32_bf16 v[96:99], v[208:211], v[232:235], v[96:99]
    ds_read_b128 v[204:207], v3 offset:19456
    v_cvt_pk_bf16_f32 v225, v130, v131
    v_mfma_f32_16x16x32_bf16 v[100:103], v[208:211], v[236:239], v[100:103]
    v_exp_f32 v136, v136
    v_mfma_f32_16x16x32_bf16 v[104:107], v[212:215], v[232:235], v[104:107]
    ds_read_b128 v[208:211], v3 offset:20480
    v_mfma_f32_16x16x32_bf16 v[108:111], v[212:215], v[236:239], v[108:111]
    v_exp_f32 v137, v137
    v_mfma_f32_16x16x32_bf16 v[112:115], v[216:219], v[232:235], v[112:115]
    ds_read_b128 v[212:215], v3 offset:21504
    v_cvt_pk_bf16_f32 v226, v136, v137
    v_mfma_f32_16x16x32_bf16 v[116:119], v[216:219], v[236:239], v[116:119]
    v_exp_f32 v138, v138
    v_mfma_f32_16x16x32_bf16 v[120:123], v[220:223], v[232:235], v[120:123]
    ds_read_b128 v[216:219], v3 offset:22528
    v_mfma_f32_16x16x32_bf16 v[124:127], v[220:223], v[236:239], v[124:127]
    v_exp_f32 v139, v139
    v_mfma_f32_16x16x32_bf16 v[240:243], v[248:251], v[232:235], v[240:243]
    ds_read_b128 v[220:223], v3 offset:23552
    v_cvt_pk_bf16_f32 v227, v138, v139
    v_mfma_f32_16x16x32_bf16 v[244:247], v[248:251], v[236:239], v[244:247]
    s_waitcnt lgkmcnt(4)
    v_mov_b32 v2, v3
    v_add_u32 v3, s40, v1
    v_cmp_le_i32 s[20:21], 0, v18
    v_cmp_le_i32 s[22:23], 1, v18
    v_cmp_le_i32 s[24:25], 2, v18
    v_cmp_le_i32 s[26:27], 3, v18
    v_cndmask_b32 v160, v19, v160, s[20:21]
    v_cndmask_b32 v161, v19, v161, s[22:23]
    v_cndmask_b32 v162, v19, v162, s[24:25]
    v_cndmask_b32 v163, v19, v163, s[26:27]
    v_cmp_le_i32 s[20:21], -16, v18
    v_cmp_le_i32 s[22:23], -15, v18
    v_cmp_le_i32 s[24:25], -14, v18
    v_cmp_le_i32 s[26:27], -13, v18
    v_cndmask_b32 v164, v19, v164, s[20:21]
    v_cndmask_b32 v165, v19, v165, s[22:23]
    v_cndmask_b32 v166, v19, v166, s[24:25]
    v_cndmask_b32 v167, v19, v167, s[26:27]
    v_cmp_le_i32 s[20:21], 16, v18
    v_cmp_le_i32 s[22:23], 17, v18
    v_cmp_le_i32 s[24:25], 18, v18
    v_cmp_le_i32 s[26:27], 19, v18
    v_cndmask_b32 v168, v19, v168, s[20:21]
    v_cndmask_b32 v169, v19, v169, s[22:23]
    v_cndmask_b32 v170, v19, v170, s[24:25]
    v_cndmask_b32 v171, v19, v171, s[26:27]
    v_cmp_le_i32 s[20:21], 0, v18
    v_cmp_le_i32 s[22:23], 1, v18
    v_cmp_le_i32 s[24:25], 2, v18
    v_cmp_le_i32 s[26:27], 3, v18
    v_cndmask_b32 v172, v19, v172, s[20:21]
    v_cndmask_b32 v173, v19, v173, s[22:23]
    v_cndmask_b32 v174, v19, v174, s[24:25]
    v_cndmask_b32 v175, v19, v175, s[26:27]
    s_nop 1
    v_mfma_f32_16x16x32_bf16 v[144:147], v[192:195], v[32:35], v[176:179]
    v_exp_f32 v132, v132
    v_mfma_f32_16x16x32_bf16 v[144:147], v[196:199], v[36:39], v[144:147]
    v_exp_f32 v133, v133
    v_mfma_f32_16x16x32_bf16 v[144:147], v[200:203], v[40:43], v[144:147]
    v_exp_f32 v134, v134
    v_mfma_f32_16x16x32_bf16 v[144:147], v[204:207], v[44:47], v[144:147]
    v_exp_f32 v135, v135
    v_mfma_f32_16x16x32_bf16 v[148:151], v[192:195], v[48:51], v[180:183]
    v_exp_f32 v140, v140
    v_mfma_f32_16x16x32_bf16 v[148:151], v[196:199], v[52:55], v[148:151]
    ds_read_b128 v[192:195], v2 offset:8192
    v_cvt_pk_bf16_f32 v228, v132, v133
    v_mfma_f32_16x16x32_bf16 v[148:151], v[200:203], v[56:59], v[148:151]
    ds_read_b128 v[196:199], v2 offset:9216
    v_cvt_pk_bf16_f32 v229, v134, v135
    v_mfma_f32_16x16x32_bf16 v[148:151], v[204:207], v[60:63], v[148:151]
    ds_read_b128 v[200:203], v2 offset:10240
    s_waitcnt lgkmcnt(3)
    v_mfma_f32_16x16x32_bf16 v[152:155], v[208:211], v[32:35], v[184:187]
    ds_read_b128 v[204:207], v2 offset:11264
    v_mfma_f32_16x16x32_bf16 v[152:155], v[212:215], v[36:39], v[152:155]
    v_exp_f32 v141, v141
    v_mfma_f32_16x16x32_bf16 v[152:155], v[216:219], v[40:43], v[152:155]
    v_exp_f32 v142, v142
    v_mfma_f32_16x16x32_bf16 v[152:155], v[220:223], v[44:47], v[152:155]
    v_exp_f32 v143, v143
    v_mfma_f32_16x16x32_bf16 v[156:159], v[208:211], v[48:51], v[188:191]
    v_mfma_f32_16x16x32_bf16 v[156:159], v[212:215], v[52:55], v[156:159]
    ds_read_b128 v[208:211], v2 offset:12288
    v_cvt_pk_bf16_f32 v230, v140, v141
    v_mfma_f32_16x16x32_bf16 v[156:159], v[216:219], v[56:59], v[156:159]
    ds_read_b128 v[212:215], v2 offset:13312
    v_cvt_pk_bf16_f32 v231, v142, v143
    v_mfma_f32_16x16x32_bf16 v[156:159], v[220:223], v[60:63], v[156:159]
    ds_read_b128 v[216:219], v2 offset:14336
    s_waitcnt lgkmcnt(3)
    v_mfma_f32_16x16x32_bf16 v[64:67], v[192:195], v[224:227], v[64:67]
    ds_read_b128 v[220:223], v2 offset:15360
    v_mfma_f32_16x16x32_bf16 v[68:71], v[192:195], v[228:231], v[68:71]
    v_exp_f32 v144, v144
    v_mfma_f32_16x16x32_bf16 v[72:75], v[196:199], v[224:227], v[72:75]
    ds_read_b128 v[192:195], v3 offset:0
    v_mfma_f32_16x16x32_bf16 v[76:79], v[196:199], v[228:231], v[76:79]
    v_exp_f32 v145, v145
    v_mfma_f32_16x16x32_bf16 v[80:83], v[200:203], v[224:227], v[80:83]
    ds_read_b128 v[196:199], v3 offset:1024
    v_cvt_pk_bf16_f32 v232, v144, v145
    v_mfma_f32_16x16x32_bf16 v[84:87], v[200:203], v[228:231], v[84:87]
    v_exp_f32 v146, v146
    v_mfma_f32_16x16x32_bf16 v[88:91], v[204:207], v[224:227], v[88:91]
    ds_read_b128 v[200:203], v3 offset:2048
    s_waitcnt lgkmcnt(3)
    v_mfma_f32_16x16x32_bf16 v[92:95], v[204:207], v[228:231], v[92:95]
    v_exp_f32 v147, v147
    v_mfma_f32_16x16x32_bf16 v[96:99], v[208:211], v[224:227], v[96:99]
    ds_read_b128 v[204:207], v3 offset:3072
    v_cvt_pk_bf16_f32 v233, v146, v147
    v_mfma_f32_16x16x32_bf16 v[100:103], v[208:211], v[228:231], v[100:103]
    v_exp_f32 v152, v152
    v_mfma_f32_16x16x32_bf16 v[104:107], v[212:215], v[224:227], v[104:107]
    ds_read_b128 v[208:211], v3 offset:4096
    v_mfma_f32_16x16x32_bf16 v[108:111], v[212:215], v[228:231], v[108:111]
    v_exp_f32 v153, v153
    v_mfma_f32_16x16x32_bf16 v[112:115], v[216:219], v[224:227], v[112:115]
    ds_read_b128 v[212:215], v3 offset:5120
    v_cvt_pk_bf16_f32 v234, v152, v153
    v_mfma_f32_16x16x32_bf16 v[116:119], v[216:219], v[228:231], v[116:119]
    v_exp_f32 v154, v154
    v_mfma_f32_16x16x32_bf16 v[120:123], v[220:223], v[224:227], v[120:123]
    ds_read_b128 v[216:219], v3 offset:6144
    v_mfma_f32_16x16x32_bf16 v[124:127], v[220:223], v[228:231], v[124:127]
    v_exp_f32 v155, v155
    v_mfma_f32_16x16x32_bf16 v[240:243], v[248:251], v[224:227], v[240:243]
    ds_read_b128 v[220:223], v3 offset:7168
    v_cvt_pk_bf16_f32 v235, v154, v155
    v_mfma_f32_16x16x32_bf16 v[244:247], v[248:251], v[228:231], v[244:247]
    s_waitcnt lgkmcnt(4)
    v_mfma_f32_16x16x32_bf16 v[128:131], v[192:195], v[32:35], v[160:163]
    v_exp_f32 v148, v148
    v_mfma_f32_16x16x32_bf16 v[128:131], v[196:199], v[36:39], v[128:131]
    v_exp_f32 v149, v149
    v_mfma_f32_16x16x32_bf16 v[128:131], v[200:203], v[40:43], v[128:131]
    v_exp_f32 v150, v150
    v_mfma_f32_16x16x32_bf16 v[128:131], v[204:207], v[44:47], v[128:131]
    v_exp_f32 v151, v151
    v_mfma_f32_16x16x32_bf16 v[132:135], v[192:195], v[48:51], v[164:167]
    v_exp_f32 v156, v156
    v_mfma_f32_16x16x32_bf16 v[132:135], v[196:199], v[52:55], v[132:135]
    ds_read_b128 v[192:195], v2 offset:24576
    v_cvt_pk_bf16_f32 v236, v148, v149
    v_mfma_f32_16x16x32_bf16 v[132:135], v[200:203], v[56:59], v[132:135]
    ds_read_b128 v[196:199], v2 offset:25600
    v_cvt_pk_bf16_f32 v237, v150, v151
    v_mfma_f32_16x16x32_bf16 v[132:135], v[204:207], v[60:63], v[132:135]
    ds_read_b128 v[200:203], v2 offset:26624
    s_waitcnt lgkmcnt(3)
    v_mfma_f32_16x16x32_bf16 v[136:139], v[208:211], v[32:35], v[168:171]
    ds_read_b128 v[204:207], v2 offset:27648
    s_add_u32 s8, s8, 1
    v_mfma_f32_16x16x32_bf16 v[136:139], v[212:215], v[36:39], v[136:139]
    v_exp_f32 v157, v157
    v_mfma_f32_16x16x32_bf16 v[136:139], v[216:219], v[40:43], v[136:139]
    v_exp_f32 v158, v158
    v_mfma_f32_16x16x32_bf16 v[136:139], v[220:223], v[44:47], v[136:139]
    v_exp_f32 v159, v159
    v_mfma_f32_16x16x32_bf16 v[140:143], v[208:211], v[48:51], v[172:175]
    s_add_u32 s40, s40, 0x8000
    s_cmp_eq_u32 s40, 0x28000
    v_mfma_f32_16x16x32_bf16 v[140:143], v[212:215], v[52:55], v[140:143]
    ds_read_b128 v[208:211], v2 offset:28672
    v_cvt_pk_bf16_f32 v238, v156, v157
    v_mfma_f32_16x16x32_bf16 v[140:143], v[216:219], v[56:59], v[140:143]
    ds_read_b128 v[212:215], v2 offset:29696
    v_cvt_pk_bf16_f32 v239, v158, v159
    v_mfma_f32_16x16x32_bf16 v[140:143], v[220:223], v[60:63], v[140:143]
    ds_read_b128 v[216:219], v2 offset:30720
    s_waitcnt lgkmcnt(3)
    v_mfma_f32_16x16x32_bf16 v[64:67], v[192:195], v[232:235], v[64:67]
    ds_read_b128 v[220:223], v2 offset:31744
    s_cselect_b32 s40, 0, s40
    v_mfma_f32_16x16x32_bf16 v[68:71], v[192:195], v[236:239], v[68:71]
    v_exp_f32 v128, v128
    v_mfma_f32_16x16x32_bf16 v[72:75], v[196:199], v[232:235], v[72:75]
    ds_read_b128 v[192:195], v3 offset:16384
    v_mfma_f32_16x16x32_bf16 v[76:79], v[196:199], v[236:239], v[76:79]
    v_exp_f32 v129, v129
    v_mfma_f32_16x16x32_bf16 v[80:83], v[200:203], v[232:235], v[80:83]
    ds_read_b128 v[196:199], v3 offset:17408
    v_cvt_pk_bf16_f32 v224, v128, v129
    v_mfma_f32_16x16x32_bf16 v[84:87], v[200:203], v[236:239], v[84:87]
    v_exp_f32 v130, v130
    v_mfma_f32_16x16x32_bf16 v[88:91], v[204:207], v[232:235], v[88:91]
    ds_read_b128 v[200:203], v3 offset:18432
    s_waitcnt lgkmcnt(3)
    v_mfma_f32_16x16x32_bf16 v[92:95], v[204:207], v[236:239], v[92:95]
    v_exp_f32 v131, v131
    v_mfma_f32_16x16x32_bf16 v[96:99], v[208:211], v[232:235], v[96:99]
    ds_read_b128 v[204:207], v3 offset:19456
    v_cvt_pk_bf16_f32 v225, v130, v131
    v_mfma_f32_16x16x32_bf16 v[100:103], v[208:211], v[236:239], v[100:103]
    v_exp_f32 v136, v136
    v_mfma_f32_16x16x32_bf16 v[104:107], v[212:215], v[232:235], v[104:107]
    ds_read_b128 v[208:211], v3 offset:20480
    v_mfma_f32_16x16x32_bf16 v[108:111], v[212:215], v[236:239], v[108:111]
    v_exp_f32 v137, v137
    v_mfma_f32_16x16x32_bf16 v[112:115], v[216:219], v[232:235], v[112:115]
    ds_read_b128 v[212:215], v3 offset:21504
    v_cvt_pk_bf16_f32 v226, v136, v137
    v_mfma_f32_16x16x32_bf16 v[116:119], v[216:219], v[236:239], v[116:119]
    v_exp_f32 v138, v138
    v_mfma_f32_16x16x32_bf16 v[120:123], v[220:223], v[232:235], v[120:123]
    ds_read_b128 v[216:219], v3 offset:22528
    v_mfma_f32_16x16x32_bf16 v[124:127], v[220:223], v[236:239], v[124:127]
    v_exp_f32 v139, v139
    v_mfma_f32_16x16x32_bf16 v[240:243], v[248:251], v[232:235], v[240:243]
    ds_read_b128 v[220:223], v3 offset:23552
    v_cvt_pk_bf16_f32 v227, v138, v139
    v_mfma_f32_16x16x32_bf16 v[244:247], v[248:251], v[236:239], v[244:247]
    s_waitcnt lgkmcnt(4)
    v_mov_b32 v2, v3
    v_add_u32 v3, s40, v1
p2_kernel_hifast_finalE:
    s_barrier
    s_branch p2_kernel_hifast_final
p2_kernel_hifast_peelO:
    s_barrier
    v_cmp_le_i32 s[20:21], 0, v18
    v_cmp_le_i32 s[22:23], 1, v18
    v_cmp_le_i32 s[24:25], 2, v18
    v_cmp_le_i32 s[26:27], 3, v18
    v_cndmask_b32 v160, v19, v160, s[20:21]
    v_cndmask_b32 v161, v19, v161, s[22:23]
    v_cndmask_b32 v162, v19, v162, s[24:25]
    v_cndmask_b32 v163, v19, v163, s[26:27]
    v_cmp_le_i32 s[20:21], -16, v18
    v_cmp_le_i32 s[22:23], -15, v18
    v_cmp_le_i32 s[24:25], -14, v18
    v_cmp_le_i32 s[26:27], -13, v18
    v_cndmask_b32 v164, v19, v164, s[20:21]
    v_cndmask_b32 v165, v19, v165, s[22:23]
    v_cndmask_b32 v166, v19, v166, s[24:25]
    v_cndmask_b32 v167, v19, v167, s[26:27]
    v_cmp_le_i32 s[20:21], 16, v18
    v_cmp_le_i32 s[22:23], 17, v18
    v_cmp_le_i32 s[24:25], 18, v18
    v_cmp_le_i32 s[26:27], 19, v18
    v_cndmask_b32 v168, v19, v168, s[20:21]
    v_cndmask_b32 v169, v19, v169, s[22:23]
    v_cndmask_b32 v170, v19, v170, s[24:25]
    v_cndmask_b32 v171, v19, v171, s[26:27]
    v_cmp_le_i32 s[20:21], 0, v18
    v_cmp_le_i32 s[22:23], 1, v18
    v_cmp_le_i32 s[24:25], 2, v18
    v_cmp_le_i32 s[26:27], 3, v18
    v_cndmask_b32 v172, v19, v172, s[20:21]
    v_cndmask_b32 v173, v19, v173, s[22:23]
    v_cndmask_b32 v174, v19, v174, s[24:25]
    v_cndmask_b32 v175, v19, v175, s[26:27]
    s_nop 1
    v_mfma_f32_16x16x32_bf16 v[144:147], v[192:195], v[32:35], v[176:179]
    v_exp_f32 v132, v132
    v_mfma_f32_16x16x32_bf16 v[144:147], v[196:199], v[36:39], v[144:147]
    v_exp_f32 v133, v133
    v_mfma_f32_16x16x32_bf16 v[144:147], v[200:203], v[40:43], v[144:147]
    v_exp_f32 v134, v134
    v_mfma_f32_16x16x32_bf16 v[144:147], v[204:207], v[44:47], v[144:147]
    v_exp_f32 v135, v135
    v_mfma_f32_16x16x32_bf16 v[148:151], v[192:195], v[48:51], v[180:183]
    v_exp_f32 v140, v140
    v_mfma_f32_16x16x32_bf16 v[148:151], v[196:199], v[52:55], v[148:151]
    ds_read_b128 v[192:195], v2 offset:8192
    v_cvt_pk_bf16_f32 v228, v132, v133
    v_mfma_f32_16x16x32_bf16 v[148:151], v[200:203], v[56:59], v[148:151]
    ds_read_b128 v[196:199], v2 offset:9216
    v_cvt_pk_bf16_f32 v229, v134, v135
    v_mfma_f32_16x16x32_bf16 v[148:151], v[204:207], v[60:63], v[148:151]
    ds_read_b128 v[200:203], v2 offset:10240
    s_waitcnt lgkmcnt(3)
    v_mfma_f32_16x16x32_bf16 v[152:155], v[208:211], v[32:35], v[184:187]
    ds_read_b128 v[204:207], v2 offset:11264
    v_mfma_f32_16x16x32_bf16 v[152:155], v[212:215], v[36:39], v[152:155]
    v_exp_f32 v141, v141
    v_mfma_f32_16x16x32_bf16 v[152:155], v[216:219], v[40:43], v[152:155]
    v_exp_f32 v142, v142
    v_mfma_f32_16x16x32_bf16 v[152:155], v[220:223], v[44:47], v[152:155]
    v_exp_f32 v143, v143
    v_mfma_f32_16x16x32_bf16 v[156:159], v[208:211], v[48:51], v[188:191]
    v_mfma_f32_16x16x32_bf16 v[156:159], v[212:215], v[52:55], v[156:159]
    ds_read_b128 v[208:211], v2 offset:12288
    v_cvt_pk_bf16_f32 v230, v140, v141
    v_mfma_f32_16x16x32_bf16 v[156:159], v[216:219], v[56:59], v[156:159]
    ds_read_b128 v[212:215], v2 offset:13312
    v_cvt_pk_bf16_f32 v231, v142, v143
    v_mfma_f32_16x16x32_bf16 v[156:159], v[220:223], v[60:63], v[156:159]
    ds_read_b128 v[216:219], v2 offset:14336
    s_waitcnt lgkmcnt(3)
    v_mfma_f32_16x16x32_bf16 v[64:67], v[192:195], v[224:227], v[64:67]
    ds_read_b128 v[220:223], v2 offset:15360
    v_mfma_f32_16x16x32_bf16 v[68:71], v[192:195], v[228:231], v[68:71]
    v_exp_f32 v144, v144
    v_mfma_f32_16x16x32_bf16 v[72:75], v[196:199], v[224:227], v[72:75]
    ds_read_b128 v[192:195], v3 offset:0
    v_mfma_f32_16x16x32_bf16 v[76:79], v[196:199], v[228:231], v[76:79]
    v_exp_f32 v145, v145
    v_mfma_f32_16x16x32_bf16 v[80:83], v[200:203], v[224:227], v[80:83]
    ds_read_b128 v[196:199], v3 offset:1024
    v_cvt_pk_bf16_f32 v232, v144, v145
    v_mfma_f32_16x16x32_bf16 v[84:87], v[200:203], v[228:231], v[84:87]
    v_exp_f32 v146, v146
    v_mfma_f32_16x16x32_bf16 v[88:91], v[204:207], v[224:227], v[88:91]
    ds_read_b128 v[200:203], v3 offset:2048
    s_waitcnt lgkmcnt(3)
    v_mfma_f32_16x16x32_bf16 v[92:95], v[204:207], v[228:231], v[92:95]
    v_exp_f32 v147, v147
    v_mfma_f32_16x16x32_bf16 v[96:99], v[208:211], v[224:227], v[96:99]
    ds_read_b128 v[204:207], v3 offset:3072
    v_cvt_pk_bf16_f32 v233, v146, v147
    v_mfma_f32_16x16x32_bf16 v[100:103], v[208:211], v[228:231], v[100:103]
    v_exp_f32 v152, v152
    v_mfma_f32_16x16x32_bf16 v[104:107], v[212:215], v[224:227], v[104:107]
    ds_read_b128 v[208:211], v3 offset:4096
    v_mfma_f32_16x16x32_bf16 v[108:111], v[212:215], v[228:231], v[108:111]
    v_exp_f32 v153, v153
    v_mfma_f32_16x16x32_bf16 v[112:115], v[216:219], v[224:227], v[112:115]
    ds_read_b128 v[212:215], v3 offset:5120
    v_cvt_pk_bf16_f32 v234, v152, v153
    v_mfma_f32_16x16x32_bf16 v[116:119], v[216:219], v[228:231], v[116:119]
    v_exp_f32 v154, v154
    v_mfma_f32_16x16x32_bf16 v[120:123], v[220:223], v[224:227], v[120:123]
    ds_read_b128 v[216:219], v3 offset:6144
    v_mfma_f32_16x16x32_bf16 v[124:127], v[220:223], v[228:231], v[124:127]
    v_exp_f32 v155, v155
    v_mfma_f32_16x16x32_bf16 v[240:243], v[248:251], v[224:227], v[240:243]
    ds_read_b128 v[220:223], v3 offset:7168
    v_cvt_pk_bf16_f32 v235, v154, v155
    v_mfma_f32_16x16x32_bf16 v[244:247], v[248:251], v[228:231], v[244:247]
    s_waitcnt lgkmcnt(4)
    v_mfma_f32_16x16x32_bf16 v[128:131], v[192:195], v[32:35], v[160:163]
    v_exp_f32 v148, v148
    v_mfma_f32_16x16x32_bf16 v[128:131], v[196:199], v[36:39], v[128:131]
    v_exp_f32 v149, v149
    v_mfma_f32_16x16x32_bf16 v[128:131], v[200:203], v[40:43], v[128:131]
    v_exp_f32 v150, v150
    v_mfma_f32_16x16x32_bf16 v[128:131], v[204:207], v[44:47], v[128:131]
    v_exp_f32 v151, v151
    v_mfma_f32_16x16x32_bf16 v[132:135], v[192:195], v[48:51], v[164:167]
    v_exp_f32 v156, v156
    v_mfma_f32_16x16x32_bf16 v[132:135], v[196:199], v[52:55], v[132:135]
    ds_read_b128 v[192:195], v2 offset:24576
    v_cvt_pk_bf16_f32 v236, v148, v149
    v_mfma_f32_16x16x32_bf16 v[132:135], v[200:203], v[56:59], v[132:135]
    ds_read_b128 v[196:199], v2 offset:25600
    v_cvt_pk_bf16_f32 v237, v150, v151
    v_mfma_f32_16x16x32_bf16 v[132:135], v[204:207], v[60:63], v[132:135]
    ds_read_b128 v[200:203], v2 offset:26624
    s_waitcnt lgkmcnt(3)
    v_mfma_f32_16x16x32_bf16 v[136:139], v[208:211], v[32:35], v[168:171]
    ds_read_b128 v[204:207], v2 offset:27648
    s_add_u32 s8, s8, 1
    v_mfma_f32_16x16x32_bf16 v[136:139], v[212:215], v[36:39], v[136:139]
    v_exp_f32 v157, v157
    v_mfma_f32_16x16x32_bf16 v[136:139], v[216:219], v[40:43], v[136:139]
    v_exp_f32 v158, v158
    v_mfma_f32_16x16x32_bf16 v[136:139], v[220:223], v[44:47], v[136:139]
    v_exp_f32 v159, v159
    v_mfma_f32_16x16x32_bf16 v[140:143], v[208:211], v[48:51], v[172:175]
    s_add_u32 s40, s40, 0x8000
    s_cmp_eq_u32 s40, 0x28000
    v_mfma_f32_16x16x32_bf16 v[140:143], v[212:215], v[52:55], v[140:143]
    ds_read_b128 v[208:211], v2 offset:28672
    v_cvt_pk_bf16_f32 v238, v156, v157
    v_mfma_f32_16x16x32_bf16 v[140:143], v[216:219], v[56:59], v[140:143]
    ds_read_b128 v[212:215], v2 offset:29696
    v_cvt_pk_bf16_f32 v239, v158, v159
    v_mfma_f32_16x16x32_bf16 v[140:143], v[220:223], v[60:63], v[140:143]
    ds_read_b128 v[216:219], v2 offset:30720
    s_waitcnt lgkmcnt(3)
    v_mfma_f32_16x16x32_bf16 v[64:67], v[192:195], v[232:235], v[64:67]
    ds_read_b128 v[220:223], v2 offset:31744
    s_cselect_b32 s40, 0, s40
    v_mfma_f32_16x16x32_bf16 v[68:71], v[192:195], v[236:239], v[68:71]
    v_exp_f32 v128, v128
    v_mfma_f32_16x16x32_bf16 v[72:75], v[196:199], v[232:235], v[72:75]
    ds_read_b128 v[192:195], v3 offset:16384
    v_mfma_f32_16x16x32_bf16 v[76:79], v[196:199], v[236:239], v[76:79]
    v_exp_f32 v129, v129
    v_mfma_f32_16x16x32_bf16 v[80:83], v[200:203], v[232:235], v[80:83]
    ds_read_b128 v[196:199], v3 offset:17408
    v_cvt_pk_bf16_f32 v224, v128, v129
    v_mfma_f32_16x16x32_bf16 v[84:87], v[200:203], v[236:239], v[84:87]
    v_exp_f32 v130, v130
    v_mfma_f32_16x16x32_bf16 v[88:91], v[204:207], v[232:235], v[88:91]
    ds_read_b128 v[200:203], v3 offset:18432
    s_waitcnt lgkmcnt(3)
    v_mfma_f32_16x16x32_bf16 v[92:95], v[204:207], v[236:239], v[92:95]
    v_exp_f32 v131, v131
    v_mfma_f32_16x16x32_bf16 v[96:99], v[208:211], v[232:235], v[96:99]
    ds_read_b128 v[204:207], v3 offset:19456
    v_cvt_pk_bf16_f32 v225, v130, v131
    v_mfma_f32_16x16x32_bf16 v[100:103], v[208:211], v[236:239], v[100:103]
    v_exp_f32 v136, v136
    v_mfma_f32_16x16x32_bf16 v[104:107], v[212:215], v[232:235], v[104:107]
    ds_read_b128 v[208:211], v3 offset:20480
    v_mfma_f32_16x16x32_bf16 v[108:111], v[212:215], v[236:239], v[108:111]
    v_exp_f32 v137, v137
    v_mfma_f32_16x16x32_bf16 v[112:115], v[216:219], v[232:235], v[112:115]
    ds_read_b128 v[212:215], v3 offset:21504
    v_cvt_pk_bf16_f32 v226, v136, v137
    v_mfma_f32_16x16x32_bf16 v[116:119], v[216:219], v[236:239], v[116:119]
    v_exp_f32 v138, v138
    v_mfma_f32_16x16x32_bf16 v[120:123], v[220:223], v[232:235], v[120:123]
    ds_read_b128 v[216:219], v3 offset:22528
    v_mfma_f32_16x16x32_bf16 v[124:127], v[220:223], v[236:239], v[124:127]
    v_exp_f32 v139, v139
    v_mfma_f32_16x16x32_bf16 v[240:243], v[248:251], v[232:235], v[240:243]
    ds_read_b128 v[220:223], v3 offset:23552
    v_cvt_pk_bf16_f32 v227, v138, v139
    v_mfma_f32_16x16x32_bf16 v[244:247], v[248:251], v[236:239], v[244:247]
    s_waitcnt lgkmcnt(4)
    v_mov_b32 v2, v3
    v_add_u32 v3, s40, v1
p2_kernel_hifast_final:
    s_bitcmp1_b32 s18, 0
    s_cbranch_scc0 p2_kernel_hifast_fshort
    v_cmp_le_i32 s[20:21], 32, v18
    v_cmp_le_i32 s[22:23], 33, v18
    v_cmp_le_i32 s[24:25], 34, v18
    v_cmp_le_i32 s[26:27], 35, v18
    v_cndmask_b32 v176, v19, v176, s[20:21]
    v_cndmask_b32 v177, v19, v177, s[22:23]
    v_cndmask_b32 v178, v19, v178, s[24:25]
    v_cndmask_b32 v179, v19, v179, s[26:27]
    v_cmp_le_i32 s[20:21], 16, v18
    v_cmp_le_i32 s[22:23], 17, v18
    v_cmp_le_i32 s[24:25], 18, v18
    v_cmp_le_i32 s[26:27], 19, v18
    v_cndmask_b32 v180, v19, v180, s[20:21]
    v_cndmask_b32 v181, v19, v181, s[22:23]
    v_cndmask_b32 v182, v19, v182, s[24:25]
    v_cndmask_b32 v183, v19, v183, s[26:27]
    v_cmp_le_i32 s[20:21], 48, v18
    v_cmp_le_i32 s[22:23], 49, v18
    v_cmp_le_i32 s[24:25], 50, v18
    v_cmp_le_i32 s[26:27], 51, v18
    v_cndmask_b32 v184, v19, v184, s[20:21]
    v_cndmask_b32 v185, v19, v185, s[22:23]
    v_cndmask_b32 v186, v19, v186, s[24:25]
    v_cndmask_b32 v187, v19, v187, s[26:27]
    v_cmp_le_i32 s[20:21], 32, v18
    v_cmp_le_i32 s[22:23], 33, v18
    v_cmp_le_i32 s[24:25], 34, v18
    v_cmp_le_i32 s[26:27], 35, v18
    v_cndmask_b32 v188, v19, v188, s[20:21]
    v_cndmask_b32 v189, v19, v189, s[22:23]
    v_cndmask_b32 v190, v19, v190, s[24:25]
    v_cndmask_b32 v191, v19, v191, s[26:27]
    s_nop 1
    v_mfma_f32_16x16x32_bf16 v[144:147], v[192:195], v[32:35], v[176:179]
    v_exp_f32 v132, v132
    v_mfma_f32_16x16x32_bf16 v[144:147], v[196:199], v[36:39], v[144:147]
    v_exp_f32 v133, v133
    v_mfma_f32_16x16x32_bf16 v[144:147], v[200:203], v[40:43], v[144:147]
    v_exp_f32 v134, v134
    v_mfma_f32_16x16x32_bf16 v[144:147], v[204:207], v[44:47], v[144:147]
    v_exp_f32 v135, v135
    v_mfma_f32_16x16x32_bf16 v[148:151], v[192:195], v[48:51], v[180:183]
    v_exp_f32 v140, v140
    v_mfma_f32_16x16x32_bf16 v[148:151], v[196:199], v[52:55], v[148:151]
    ds_read_b128 v[192:195], v2 offset:8192
    v_cvt_pk_bf16_f32 v228, v132, v133
    v_mfma_f32_16x16x32_bf16 v[148:151], v[200:203], v[56:59], v[148:151]
    ds_read_b128 v[196:199], v2 offset:9216
    v_cvt_pk_bf16_f32 v229, v134, v135
    v_mfma_f32_16x16x32_bf16 v[148:151], v[204:207], v[60:63], v[148:151]
    ds_read_b128 v[200:203], v2 offset:10240
    s_waitcnt lgkmcnt(3)
    v_mfma_f32_16x16x32_bf16 v[152:155], v[208:211], v[32:35], v[184:187]
    ds_read_b128 v[204:207], v2 offset:11264
    v_mfma_f32_16x16x32_bf16 v[152:155], v[212:215], v[36:39], v[152:155]
    v_exp_f32 v141, v141
    v_mfma_f32_16x16x32_bf16 v[152:155], v[216:219], v[40:43], v[152:155]
    v_exp_f32 v142, v142
    v_mfma_f32_16x16x32_bf16 v[152:155], v[220:223], v[44:47], v[152:155]
    v_exp_f32 v143, v143
    v_mfma_f32_16x16x32_bf16 v[156:159], v[208:211], v[48:51], v[188:191]
    v_mfma_f32_16x16x32_bf16 v[156:159], v[212:215], v[52:55], v[156:159]
    ds_read_b128 v[208:211], v2 offset:12288
    v_cvt_pk_bf16_f32 v230, v140, v141
    v_mfma_f32_16x16x32_bf16 v[156:159], v[216:219], v[56:59], v[156:159]
    ds_read_b128 v[212:215], v2 offset:13312
    v_cvt_pk_bf16_f32 v231, v142, v143
    v_mfma_f32_16x16x32_bf16 v[156:159], v[220:223], v[60:63], v[156:159]
    ds_read_b128 v[216:219], v2 offset:14336
    s_waitcnt lgkmcnt(3)
    v_mfma_f32_16x16x32_bf16 v[64:67], v[192:195], v[224:227], v[64:67]
    ds_read_b128 v[220:223], v2 offset:15360
    v_mfma_f32_16x16x32_bf16 v[68:71], v[192:195], v[228:231], v[68:71]
    v_exp_f32 v144, v144
    v_mfma_f32_16x16x32_bf16 v[72:75], v[196:199], v[224:227], v[72:75]
    v_mfma_f32_16x16x32_bf16 v[76:79], v[196:199], v[228:231], v[76:79]
    v_exp_f32 v145, v145
    v_mfma_f32_16x16x32_bf16 v[80:83], v[200:203], v[224:227], v[80:83]
    v_cvt_pk_bf16_f32 v232, v144, v145
    v_mfma_f32_16x16x32_bf16 v[84:87], v[200:203], v[228:231], v[84:87]
    v_exp_f32 v146, v146
    v_mfma_f32_16x16x32_bf16 v[88:91], v[204:207], v[224:227], v[88:91]
    s_waitcnt lgkmcnt(0)
    v_mfma_f32_16x16x32_bf16 v[92:95], v[204:207], v[228:231], v[92:95]
    v_exp_f32 v147, v147
    v_mfma_f32_16x16x32_bf16 v[96:99], v[208:211], v[224:227], v[96:99]
    v_cvt_pk_bf16_f32 v233, v146, v147
    v_mfma_f32_16x16x32_bf16 v[100:103], v[208:211], v[228:231], v[100:103]
    v_exp_f32 v152, v152
    v_mfma_f32_16x16x32_bf16 v[104:107], v[212:215], v[224:227], v[104:107]
    v_mfma_f32_16x16x32_bf16 v[108:111], v[212:215], v[228:231], v[108:111]
    v_exp_f32 v153, v153
    v_mfma_f32_16x16x32_bf16 v[112:115], v[216:219], v[224:227], v[112:115]
    v_cvt_pk_bf16_f32 v234, v152, v153
    v_mfma_f32_16x16x32_bf16 v[116:119], v[216:219], v[228:231], v[116:119]
    v_exp_f32 v154, v154
    v_mfma_f32_16x16x32_bf16 v[120:123], v[220:223], v[224:227], v[120:123]
    v_mfma_f32_16x16x32_bf16 v[124:127], v[220:223], v[228:231], v[124:127]
    v_exp_f32 v155, v155
    v_mfma_f32_16x16x32_bf16 v[240:243], v[248:251], v[224:227], v[240:243]
    v_cvt_pk_bf16_f32 v235, v154, v155
    v_mfma_f32_16x16x32_bf16 v[244:247], v[248:251], v[228:231], v[244:247]
    v_exp_f32 v148, v148
    v_exp_f32 v149, v149
    v_exp_f32 v150, v150
    v_exp_f32 v151, v151
    v_exp_f32 v156, v156
    s_nop 0
    ds_read_b128 v[192:195], v2 offset:24576
    v_cvt_pk_bf16_f32 v236, v148, v149
    ds_read_b128 v[196:199], v2 offset:25600
    v_cvt_pk_bf16_f32 v237, v150, v151
    ds_read_b128 v[200:203], v2 offset:26624
    ds_read_b128 v[204:207], v2 offset:27648
    v_exp_f32 v157, v157
    v_exp_f32 v158, v158
    v_exp_f32 v159, v159
    s_nop 0
    s_nop 0
    ds_read_b128 v[208:211], v2 offset:28672
    v_cvt_pk_bf16_f32 v238, v156, v157
    ds_read_b128 v[212:215], v2 offset:29696
    v_cvt_pk_bf16_f32 v239, v158, v159
    ds_read_b128 v[216:219], v2 offset:30720
    s_waitcnt lgkmcnt(3)
    v_mfma_f32_16x16x32_bf16 v[64:67], v[192:195], v[232:235], v[64:67]
    ds_read_b128 v[220:223], v2 offset:31744
    v_mfma_f32_16x16x32_bf16 v[68:71], v[192:195], v[236:239], v[68:71]
    v_mfma_f32_16x16x32_bf16 v[72:75], v[196:199], v[232:235], v[72:75]
    v_mfma_f32_16x16x32_bf16 v[76:79], v[196:199], v[236:239], v[76:79]
    v_mfma_f32_16x16x32_bf16 v[80:83], v[200:203], v[232:235], v[80:83]
    v_mfma_f32_16x16x32_bf16 v[84:87], v[200:203], v[236:239], v[84:87]
    v_mfma_f32_16x16x32_bf16 v[88:91], v[204:207], v[232:235], v[88:91]
    s_waitcnt lgkmcnt(0)
    v_mfma_f32_16x16x32_bf16 v[92:95], v[204:207], v[236:239], v[92:95]
    v_mfma_f32_16x16x32_bf16 v[96:99], v[208:211], v[232:235], v[96:99]
    v_mfma_f32_16x16x32_bf16 v[100:103], v[208:211], v[236:239], v[100:103]
    v_mfma_f32_16x16x32_bf16 v[104:107], v[212:215], v[232:235], v[104:107]
    v_mfma_f32_16x16x32_bf16 v[108:111], v[212:215], v[236:239], v[108:111]
    v_mfma_f32_16x16x32_bf16 v[112:115], v[216:219], v[232:235], v[112:115]
    v_mfma_f32_16x16x32_bf16 v[116:119], v[216:219], v[236:239], v[116:119]
    v_mfma_f32_16x16x32_bf16 v[120:123], v[220:223], v[232:235], v[120:123]
    v_mfma_f32_16x16x32_bf16 v[124:127], v[220:223], v[236:239], v[124:127]
    v_mfma_f32_16x16x32_bf16 v[240:243], v[248:251], v[232:235], v[240:243]
    v_mfma_f32_16x16x32_bf16 v[244:247], v[248:251], v[236:239], v[244:247]
    s_branch p2_kernel_hifast_fdone
p2_kernel_hifast_fshort:
    s_waitcnt lgkmcnt(0)
    v_exp_f32 v132, v132
    v_exp_f32 v133, v133
    v_exp_f32 v134, v134
    v_exp_f32 v135, v135
    v_exp_f32 v140, v140
    s_nop 0
    ds_read_b128 v[192:195], v2 offset:8192
    v_cvt_pk_bf16_f32 v228, v132, v133
    ds_read_b128 v[196:199], v2 offset:9216
    v_cvt_pk_bf16_f32 v229, v134, v135
    ds_read_b128 v[200:203], v2 offset:10240
    ds_read_b128 v[204:207], v2 offset:11264
    v_exp_f32 v141, v141
    v_exp_f32 v142, v142
    v_exp_f32 v143, v143
    s_nop 0
    s_nop 0
    ds_read_b128 v[208:211], v2 offset:12288
    v_cvt_pk_bf16_f32 v230, v140, v141
    ds_read_b128 v[212:215], v2 offset:13312
    v_cvt_pk_bf16_f32 v231, v142, v143
    ds_read_b128 v[216:219], v2 offset:14336
    s_waitcnt lgkmcnt(3)
    v_mfma_f32_16x16x32_bf16 v[64:67], v[192:195], v[224:227], v[64:67]
    ds_read_b128 v[220:223], v2 offset:15360
    v_mfma_f32_16x16x32_bf16 v[68:71], v[192:195], v[228:231], v[68:71]
    v_mfma_f32_16x16x32_bf16 v[72:75], v[196:199], v[224:227], v[72:75]
    v_mfma_f32_16x16x32_bf16 v[76:79], v[196:199], v[228:231], v[76:79]
    v_mfma_f32_16x16x32_bf16 v[80:83], v[200:203], v[224:227], v[80:83]
    v_mfma_f32_16x16x32_bf16 v[84:87], v[200:203], v[228:231], v[84:87]
    v_mfma_f32_16x16x32_bf16 v[88:91], v[204:207], v[224:227], v[88:91]
    s_waitcnt lgkmcnt(0)
    v_mfma_f32_16x16x32_bf16 v[92:95], v[204:207], v[228:231], v[92:95]
    v_mfma_f32_16x16x32_bf16 v[96:99], v[208:211], v[224:227], v[96:99]
    v_mfma_f32_16x16x32_bf16 v[100:103], v[208:211], v[228:231], v[100:103]
    v_mfma_f32_16x16x32_bf16 v[104:107], v[212:215], v[224:227], v[104:107]
    v_mfma_f32_16x16x32_bf16 v[108:111], v[212:215], v[228:231], v[108:111]
    v_mfma_f32_16x16x32_bf16 v[112:115], v[216:219], v[224:227], v[112:115]
    v_mfma_f32_16x16x32_bf16 v[116:119], v[216:219], v[228:231], v[116:119]
    v_mfma_f32_16x16x32_bf16 v[120:123], v[220:223], v[224:227], v[120:123]
    v_mfma_f32_16x16x32_bf16 v[124:127], v[220:223], v[228:231], v[124:127]
    v_mfma_f32_16x16x32_bf16 v[240:243], v[248:251], v[224:227], v[240:243]
    v_mfma_f32_16x16x32_bf16 v[244:247], v[248:251], v[228:231], v[244:247]
p2_kernel_hifast_fdone:
    s_nop 7
    v_rcp_f32 v8, v240
    v_rcp_f32 v9, v244
    v_mul_f32 v10, 0, v240
    v_mul_f32 v11, 0, v244
    s_mov_b32 s36, 0x71800000
    v_cmp_nge_f32 s[20:21], s36, v240
    v_cmp_nge_f32 s[22:23], s36, v244
    s_nop 0
    s_lshl_b32 s36, s18, 1
    s_mul_i32 s36, s36, 171
    s_lshl_b32 s37, s12, 2
    s_add_u32 s36, s36, s37
    s_lshl_b32 s36, s36, 10
    s_add_u32 s36, s36, 0x3000000
    v_mul_f32 v64, v64, v8
    v_mul_f32 v65, v65, v8
    v_mul_f32 v66, v66, v8
    v_mul_f32 v67, v67, v8
    v_fma_f32 v10, v64, 0, v10
    v_fma_f32 v11, v65, 0, v11
    v_fma_f32 v10, v66, 0, v10
    v_fma_f32 v11, v67, 0, v11
    v_cvt_pk_bf16_f32 v192, v64, v65
    v_cvt_pk_bf16_f32 v193, v66, v67
    v_mul_f32 v72, v72, v8
    v_mul_f32 v73, v73, v8
    v_mul_f32 v74, v74, v8
    v_mul_f32 v75, v75, v8
    v_fma_f32 v10, v72, 0, v10
    v_fma_f32 v11, v73, 0, v11
    v_fma_f32 v10, v74, 0, v10
    v_fma_f32 v11, v75, 0, v11
    v_cvt_pk_bf16_f32 v194, v72, v73
    v_cvt_pk_bf16_f32 v195, v74, v75
    buffer_store_dwordx4 v[192:195], v1, s[4:7], s36 offen offset:0 sc1
    v_mul_f32 v80, v80, v8
    v_mul_f32 v81, v81, v8
    v_mul_f32 v82, v82, v8
    v_mul_f32 v83, v83, v8
    v_fma_f32 v10, v80, 0, v10
    v_fma_f32 v11, v81, 0, v11
    v_fma_f32 v10, v82, 0, v10
    v_fma_f32 v11, v83, 0, v11
    v_cvt_pk_bf16_f32 v196, v80, v81
    v_cvt_pk_bf16_f32 v197, v82, v83
    v_mul_f32 v88, v88, v8
    v_mul_f32 v89, v89, v8
    v_mul_f32 v90, v90, v8
    v_mul_f32 v91, v91, v8
    v_fma_f32 v10, v88, 0, v10
    v_fma_f32 v11, v89, 0, v11
    v_fma_f32 v10, v90, 0, v10
    v_fma_f32 v11, v91, 0, v11
    v_cvt_pk_bf16_f32 v198, v88, v89
    v_cvt_pk_bf16_f32 v199, v90, v91
    buffer_store_dwordx4 v[196:199], v1, s[4:7], s36 offen offset:1024 sc1
    v_mul_f32 v96, v96, v8
    v_mul_f32 v97, v97, v8
    v_mul_f32 v98, v98, v8
    v_mul_f32 v99, v99, v8
    v_fma_f32 v10, v96, 0, v10
    v_fma_f32 v11, v97, 0, v11
    v_fma_f32 v10, v98, 0, v10
    v_fma_f32 v11, v99, 0, v11
    v_cvt_pk_bf16_f32 v200, v96, v97
    v_cvt_pk_bf16_f32 v201, v98, v99
    v_mul_f32 v104, v104, v8
    v_mul_f32 v105, v105, v8
    v_mul_f32 v106, v106, v8
    v_mul_f32 v107, v107, v8
    v_fma_f32 v10, v104, 0, v10
    v_fma_f32 v11, v105, 0, v11
    v_fma_f32 v10, v106, 0, v10
    v_fma_f32 v11, v107, 0, v11
    v_cvt_pk_bf16_f32 v202, v104, v105
    v_cvt_pk_bf16_f32 v203, v106, v107
    buffer_store_dwordx4 v[200:203], v1, s[4:7], s36 offen offset:2048 sc1
    v_mul_f32 v112, v112, v8
    v_mul_f32 v113, v113, v8
    v_mul_f32 v114, v114, v8
    v_mul_f32 v115, v115, v8
    v_fma_f32 v10, v112, 0, v10
    v_fma_f32 v11, v113, 0, v11
    v_fma_f32 v10, v114, 0, v10
    v_fma_f32 v11, v115, 0, v11
    v_cvt_pk_bf16_f32 v204, v112, v113
    v_cvt_pk_bf16_f32 v205, v114, v115
    v_mul_f32 v120, v120, v8
    v_mul_f32 v121, v121, v8
    v_mul_f32 v122, v122, v8
    v_mul_f32 v123, v123, v8
    v_fma_f32 v10, v120, 0, v10
    v_fma_f32 v11, v121, 0, v11
    v_fma_f32 v10, v122, 0, v10
    v_fma_f32 v11, v123, 0, v11
    v_cvt_pk_bf16_f32 v206, v120, v121
    v_cvt_pk_bf16_f32 v207, v122, v123
    buffer_store_dwordx4 v[204:207], v1, s[4:7], s36 offen offset:3072 sc1
    s_lshl_b32 s36, s18, 1
    s_add_u32 s36, s36, 1
    s_mul_i32 s36, s36, 171
    s_lshl_b32 s37, s12, 2
    s_add_u32 s36, s36, s37
    s_lshl_b32 s36, s36, 10
    s_add_u32 s36, s36, 0x3000000
    v_mul_f32 v68, v68, v9
    v_mul_f32 v69, v69, v9
    v_mul_f32 v70, v70, v9
    v_mul_f32 v71, v71, v9
    v_fma_f32 v10, v68, 0, v10
    v_fma_f32 v11, v69, 0, v11
    v_fma_f32 v10, v70, 0, v10
    v_fma_f32 v11, v71, 0, v11
    v_cvt_pk_bf16_f32 v208, v68, v69
    v_cvt_pk_bf16_f32 v209, v70, v71
    v_mul_f32 v76, v76, v9
    v_mul_f32 v77, v77, v9
    v_mul_f32 v78, v78, v9
    v_mul_f32 v79, v79, v9
    v_fma_f32 v10, v76, 0, v10
    v_fma_f32 v11, v77, 0, v11
    v_fma_f32 v10, v78, 0, v10
    v_fma_f32 v11, v79, 0, v11
    v_cvt_pk_bf16_f32 v210, v76, v77
    v_cvt_pk_bf16_f32 v211, v78, v79
    buffer_store_dwordx4 v[208:211], v1, s[4:7], s36 offen offset:0 sc1
    v_mul_f32 v84, v84, v9
    v_mul_f32 v85, v85, v9
    v_mul_f32 v86, v86, v9
    v_mul_f32 v87, v87, v9
    v_fma_f32 v10, v84, 0, v10
    v_fma_f32 v11, v85, 0, v11
    v_fma_f32 v10, v86, 0, v10
    v_fma_f32 v11, v87, 0, v11
    v_cvt_pk_bf16_f32 v212, v84, v85
    v_cvt_pk_bf16_f32 v213, v86, v87
    v_mul_f32 v92, v92, v9
    v_mul_f32 v93, v93, v9
    v_mul_f32 v94, v94, v9
    v_mul_f32 v95, v95, v9
    v_fma_f32 v10, v92, 0, v10
    v_fma_f32 v11, v93, 0, v11
    v_fma_f32 v10, v94, 0, v10
    v_fma_f32 v11, v95, 0, v11
    v_cvt_pk_bf16_f32 v214, v92, v93
    v_cvt_pk_bf16_f32 v215, v94, v95
    buffer_store_dwordx4 v[212:215], v1, s[4:7], s36 offen offset:1024 sc1
    v_mul_f32 v100, v100, v9
    v_mul_f32 v101, v101, v9
    v_mul_f32 v102, v102, v9
    v_mul_f32 v103, v103, v9
    v_fma_f32 v10, v100, 0, v10
    v_fma_f32 v11, v101, 0, v11
    v_fma_f32 v10, v102, 0, v10
    v_fma_f32 v11, v103, 0, v11
    v_cvt_pk_bf16_f32 v216, v100, v101
    v_cvt_pk_bf16_f32 v217, v102, v103
    v_mul_f32 v108, v108, v9
    v_mul_f32 v109, v109, v9
    v_mul_f32 v110, v110, v9
    v_mul_f32 v111, v111, v9
    v_fma_f32 v10, v108, 0, v10
    v_fma_f32 v11, v109, 0, v11
    v_fma_f32 v10, v110, 0, v10
    v_fma_f32 v11, v111, 0, v11
    v_cvt_pk_bf16_f32 v218, v108, v109
    v_cvt_pk_bf16_f32 v219, v110, v111
    buffer_store_dwordx4 v[216:219], v1, s[4:7], s36 offen offset:2048 sc1
    v_mul_f32 v116, v116, v9
    v_mul_f32 v117, v117, v9
    v_mul_f32 v118, v118, v9
    v_mul_f32 v119, v119, v9
    v_fma_f32 v10, v116, 0, v10
    v_fma_f32 v11, v117, 0, v11
    v_fma_f32 v10, v118, 0, v10
    v_fma_f32 v11, v119, 0, v11
    v_cvt_pk_bf16_f32 v220, v116, v117
    v_cvt_pk_bf16_f32 v221, v118, v119
    v_mul_f32 v124, v124, v9
    v_mul_f32 v125, v125, v9
    v_mul_f32 v126, v126, v9
    v_mul_f32 v127, v127, v9
    v_fma_f32 v10, v124, 0, v10
    v_fma_f32 v11, v125, 0, v11
    v_fma_f32 v10, v126, 0, v10
    v_fma_f32 v11, v127, 0, v11
    v_cvt_pk_bf16_f32 v222, v124, v125
    v_cvt_pk_bf16_f32 v223, v126, v127
    buffer_store_dwordx4 v[220:223], v1, s[4:7], s36 offen offset:3072 sc1
    v_add_f32 v10, v10, v11
    v_cmp_u_f32 vcc, v10, v10
    s_nop 4
    s_or_b64 vcc, vcc, s[20:21]
    s_or_b64 vcc, vcc, s[22:23]
    s_cmp_lg_u64 vcc, 0
    s_cselect_b32 s42, 1, 0
    s_branch p2_kernel_fin
p2_kernel_hifast_tailend:
p2_kernel_lofast_main:
    ds_read_b128 v[208:211], v2 offset:20480
    ds_read_b128 v[212:215], v2 offset:21504
    ds_read_b128 v[216:219], v2 offset:22528
    ds_read_b128 v[220:223], v2 offset:23552
    s_waitcnt lgkmcnt(4)
    v_exp_f32 v128, v128
    v_exp_f32 v129, v129
    v_exp_f32 v130, v130
    v_cvt_pk_bf16_f32 v224, v128, v129
    v_exp_f32 v131, v131
    v_exp_f32 v136, v136
    v_cvt_pk_bf16_f32 v225, v130, v131
    v_exp_f32 v137, v137
    v_exp_f32 v138, v138
    v_cvt_pk_bf16_f32 v226, v136, v137
    v_exp_f32 v139, v139
    s_nop 0
    v_cvt_pk_bf16_f32 v227, v138, v139
    s_cmp_eq_u32 s9, 0
    s_cbranch_scc1 p2_kernel_lofast_finalE
    s_lshr_b32 s29, s9, 1
    s_bitcmp1_b32 s9, 0
    s_cbranch_scc1 p2_kernel_lofast_lp
    s_sub_u32 s29, s29, 1
p2_kernel_lofast_lp:
    s_lshl_b32 s29, s29, 1
    s_cmp_lt_u32 s8, s29
    s_cbranch_scc0 p2_kernel_lofast_lpend
p2_kernel_lofast_loop:
    s_waitcnt vmcnt(0)
    s_barrier
    s_min_u32 s28, s43, 31
    s_lshl_b32 s28, s28, 15
    s_add_u32 s28, s28, s13
    s_lshl_b32 s16, s17, 13
    s_add_u32 m0, s41, s16
    s_add_u32 s43, s43, 1
    buffer_load_dwordx4 v1, s[4:7], s28 offen offset:0 lds
    buffer_load_dwordx4 v1, s[4:7], s28 offen offset:1024 lds
    buffer_load_dwordx4 v1, s[4:7], s28 offen offset:2048 lds
    buffer_load_dwordx4 v1, s[4:7], s28 offen offset:3072 lds
    s_add_u32 m0, m0, 4096
    s_add_u32 s28, s28, 4096
    buffer_load_dwordx4 v1, s[4:7], s28 offen offset:0 lds
    buffer_load_dwordx4 v1, s[4:7], s28 offen offset:1024 lds
    buffer_load_dwordx4 v1, s[4:7], s28 offen offset:2048 lds
    buffer_load_dwordx4 v1, s[4:7], s28 offen offset:3072 lds
    s_add_u32 s41, s41, 0x8000
    s_cmp_eq_u32 s41, 0x28000
    s_cselect_b32 s41, 0, s41
    s_min_u32 s28, s43, 31
    s_lshl_b32 s28, s28, 15
    s_add_u32 s28, s28, s13
    s_lshl_b32 s16, s17, 13
    s_add_u32 m0, s41, s16
    s_add_u32 s43, s43, 1
    buffer_load_dwordx4 v1, s[4:7], s28 offen offset:0 lds
    buffer_load_dwordx4 v1, s[4:7], s28 offen offset:1024 lds
    buffer_load_dwordx4 v1, s[4:7], s28 offen offset:2048 lds
    buffer_load_dwordx4 v1, s[4:7], s28 offen offset:3072 lds
    s_add_u32 m0, m0, 4096
    s_add_u32 s28, s28, 4096
    buffer_load_dwordx4 v1, s[4:7], s28 offen offset:0 lds
    buffer_load_dwordx4 v1, s[4:7], s28 offen offset:1024 lds
    buffer_load_dwordx4 v1, s[4:7], s28 offen offset:2048 lds
    buffer_load_dwordx4 v1, s[4:7], s28 offen offset:3072 lds
    s_add_u32 s41, s41, 0x8000
    s_cmp_eq_u32 s41, 0x28000
    s_cselect_b32 s41, 0, s41
    v_mfma_f32_16x16x32_bf16 v[144:147], v[192:195], v[32:35], v[176:179]
    v_exp_f32 v132, v132
    v_mfma_f32_16x16x32_bf16 v[144:147], v[196:199], v[36:39], v[144:147]
    v_exp_f32 v133, v133
    v_mfma_f32_16x16x32_bf16 v[144:147], v[200:203], v[40:43], v[144:147]
    v_exp_f32 v134, v134
    v_mfma_f32_16x16x32_bf16 v[144:147], v[204:207], v[44:47], v[144:147]
    v_exp_f32 v135, v135
    v_mfma_f32_16x16x32_bf16 v[148:151], v[192:195], v[48:51], v[180:183]
    v_exp_f32 v140, v140
    v_mfma_f32_16x16x32_bf16 v[148:151], v[196:199], v[52:55], v[148:151]
    ds_read_b128 v[192:195], v2 offset:8192
    v_cvt_pk_bf16_f32 v228, v132, v133
    v_mfma_f32_16x16x32_bf16 v[148:151], v[200:203], v[56:59], v[148:151]
    ds_read_b128 v[196:199], v2 offset:9216
    v_cvt_pk_bf16_f32 v229, v134, v135
    v_mfma_f32_16x16x32_bf16 v[148:151], v[204:207], v[60:63], v[148:151]
    ds_read_b128 v[200:203], v2 offset:10240
    s_waitcnt lgkmcnt(3)
    v_mfma_f32_16x16x32_bf16 v[152:155], v[208:211], v[32:35], v[184:187]
    ds_read_b128 v[204:207], v2 offset:11264
    v_mfma_f32_16x16x32_bf16 v[152:155], v[212:215], v[36:39], v[152:155]
    v_exp_f32 v141, v141
    v_mfma_f32_16x16x32_bf16 v[152:155], v[216:219], v[40:43], v[152:155]
    v_exp_f32 v142, v142
    v_mfma_f32_16x16x32_bf16 v[152:155], v[220:223], v[44:47], v[152:155]
    v_exp_f32 v143, v143
    v_mfma_f32_16x16x32_bf16 v[156:159], v[208:211], v[48:51], v[188:191]
    v_mfma_f32_16x16x32_bf16 v[156:159], v[212:215], v[52:55], v[156:159]
    ds_read_b128 v[208:211], v2 offset:12288
    v_cvt_pk_bf16_f32 v230, v140, v141
    v_mfma_f32_16x16x32_bf16 v[156:159], v[216:219], v[56:59], v[156:159]
    ds_read_b128 v[212:215], v2 offset:13312
    v_cvt_pk_bf16_f32 v231, v142, v143
    v_mfma_f32_16x16x32_bf16 v[156:159], v[220:223], v[60:63], v[156:159]
    ds_read_b128 v[216:219], v2 offset:14336
    s_waitcnt lgkmcnt(3)
    v_mfma_f32_16x16x32_bf16 v[64:67], v[192:195], v[224:227], v[64:67]
    ds_read_b128 v[220:223], v2 offset:15360
    v_mfma_f32_16x16x32_bf16 v[68:71], v[192:195], v[228:231], v[68:71]
    v_exp_f32 v144, v144
    v_mfma_f32_16x16x32_bf16 v[72:75], v[196:199], v[224:227], v[72:75]
    ds_read_b128 v[192:195], v3 offset:0
    v_mfma_f32_16x16x32_bf16 v[76:79], v[196:199], v[228:231], v[76:79]
    v_exp_f32 v145, v145
    v_mfma_f32_16x16x32_bf16 v[80:83], v[200:203], v[224:227], v[80:83]
    ds_read_b128 v[196:199], v3 offset:1024
    v_cvt_pk_bf16_f32 v232, v144, v145
    v_mfma_f32_16x16x32_bf16 v[84:87], v[200:203], v[228:231], v[84:87]
    v_exp_f32 v146, v146
    v_mfma_f32_16x16x32_bf16 v[88:91], v[204:207], v[224:227], v[88:91]
    ds_read_b128 v[200:203], v3 offset:2048
    s_waitcnt lgkmcnt(3)
    v_mfma_f32_16x16x32_bf16 v[92:95], v[204:207], v[228:231], v[92:95]
    v_exp_f32 v147, v147
    v_mfma_f32_16x16x32_bf16 v[96:99], v[208:211], v[224:227], v[96:99]
    ds_read_b128 v[204:207], v3 offset:3072
    v_cvt_pk_bf16_f32 v233, v146, v147
    v_mfma_f32_16x16x32_bf16 v[100:103], v[208:211], v[228:231], v[100:103]
    v_exp_f32 v152, v152
    v_mfma_f32_16x16x32_bf16 v[104:107], v[212:215], v[224:227], v[104:107]
    ds_read_b128 v[208:211], v3 offset:4096
    v_mfma_f32_16x16x32_bf16 v[108:111], v[212:215], v[228:231], v[108:111]
    v_exp_f32 v153, v153
    v_mfma_f32_16x16x32_bf16 v[112:115], v[216:219], v[224:227], v[112:115]
    ds_read_b128 v[212:215], v3 offset:5120
    v_cvt_pk_bf16_f32 v234, v152, v153
    v_mfma_f32_16x16x32_bf16 v[116:119], v[216:219], v[228:231], v[116:119]
    v_exp_f32 v154, v154
    v_mfma_f32_16x16x32_bf16 v[120:123], v[220:223], v[224:227], v[120:123]
    ds_read_b128 v[216:219], v3 offset:6144
    v_mfma_f32_16x16x32_bf16 v[124:127], v[220:223], v[228:231], v[124:127]
    v_exp_f32 v155, v155
    v_mfma_f32_16x16x32_bf16 v[240:243], v[248:251], v[224:227], v[240:243]
    ds_read_b128 v[220:223], v3 offset:7168
    v_cvt_pk_bf16_f32 v235, v154, v155
    v_mfma_f32_16x16x32_bf16 v[244:247], v[248:251], v[228:231], v[244:247]
    s_waitcnt lgkmcnt(4)
    v_mfma_f32_16x16x32_bf16 v[128:131], v[192:195], v[32:35], v[160:163]
    v_exp_f32 v148, v148
    v_mfma_f32_16x16x32_bf16 v[128:131], v[196:199], v[36:39], v[128:131]
    v_exp_f32 v149, v149
    v_mfma_f32_16x16x32_bf16 v[128:131], v[200:203], v[40:43], v[128:131]
    v_exp_f32 v150, v150
    v_mfma_f32_16x16x32_bf16 v[128:131], v[204:207], v[44:47], v[128:131]
    v_exp_f32 v151, v151
    v_mfma_f32_16x16x32_bf16 v[132:135], v[192:195], v[48:51], v[164:167]
    v_exp_f32 v156, v156
    v_mfma_f32_16x16x32_bf16 v[132:135], v[196:199], v[52:55], v[132:135]
    ds_read_b128 v[192:195], v2 offset:24576
    v_cvt_pk_bf16_f32 v236, v148, v149
    v_mfma_f32_16x16x32_bf16 v[132:135], v[200:203], v[56:59], v[132:135]
    ds_read_b128 v[196:199], v2 offset:25600
    v_cvt_pk_bf16_f32 v237, v150, v151
    v_mfma_f32_16x16x32_bf16 v[132:135], v[204:207], v[60:63], v[132:135]
    ds_read_b128 v[200:203], v2 offset:26624
    s_waitcnt lgkmcnt(3)
    v_mfma_f32_16x16x32_bf16 v[136:139], v[208:211], v[32:35], v[168:171]
    ds_read_b128 v[204:207], v2 offset:27648
    s_add_u32 s8, s8, 1
    v_mfma_f32_16x16x32_bf16 v[136:139], v[212:215], v[36:39], v[136:139]
    v_exp_f32 v157, v157
    v_mfma_f32_16x16x32_bf16 v[136:139], v[216:219], v[40:43], v[136:139]
    v_exp_f32 v158, v158
    v_mfma_f32_16x16x32_bf16 v[136:139], v[220:223], v[44:47], v[136:139]
    v_exp_f32 v159, v159
    v_mfma_f32_16x16x32_bf16 v[140:143], v[208:211], v[48:51], v[172:175]
    s_add_u32 s40, s40, 0x8000
    s_cmp_eq_u32 s40, 0x28000
    v_mfma_f32_16x16x32_bf16 v[140:143], v[212:215], v[52:55], v[140:143]
    ds_read_b128 v[208:211], v2 offset:28672
    v_cvt_pk_bf16_f32 v238, v156, v157
    v_mfma_f32_16x16x32_bf16 v[140:143], v[216:219], v[56:59], v[140:143]
    ds_read_b128 v[212:215], v2 offset:29696
    v_cvt_pk_bf16_f32 v239, v158, v159
    v_mfma_f32_16x16x32_bf16 v[140:143], v[220:223], v[60:63], v[140:143]
    ds_read_b128 v[216:219], v2 offset:30720
    s_waitcnt lgkmcnt(3)
    v_mfma_f32_16x16x32_bf16 v[64:67], v[192:195], v[232:235], v[64:67]
    ds_read_b128 v[220:223], v2 offset:31744
    s_cselect_b32 s40, 0, s40
    v_mfma_f32_16x16x32_bf16 v[68:71], v[192:195], v[236:239], v[68:71]
    v_exp_f32 v128, v128
    v_mfma_f32_16x16x32_bf16 v[72:75], v[196:199], v[232:235], v[72:75]
    ds_read_b128 v[192:195], v3 offset:16384
    v_mfma_f32_16x16x32_bf16 v[76:79], v[196:199], v[236:239], v[76:79]
    v_exp_f32 v129, v129
    v_mfma_f32_16x16x32_bf16 v[80:83], v[200:203], v[232:235], v[80:83]
    ds_read_b128 v[196:199], v3 offset:17408
    v_cvt_pk_bf16_f32 v224, v128, v129
    v_mfma_f32_16x16x32_bf16 v[84:87], v[200:203], v[236:239], v[84:87]
    v_exp_f32 v130, v130
    v_mfma_f32_16x16x32_bf16 v[88:91], v[204:207], v[232:235], v[88:91]
    ds_read_b128 v[200:203], v3 offset:18432
    s_waitcnt lgkmcnt(3)
    v_mfma_f32_16x16x32_bf16 v[92:95], v[204:207], v[236:239], v[92:95]
    v_exp_f32 v131, v131
    v_mfma_f32_16x16x32_bf16 v[96:99], v[208:211], v[232:235], v[96:99]
    ds_read_b128 v[204:207], v3 offset:19456
    v_cvt_pk_bf16_f32 v225, v130, v131
    v_mfma_f32_16x16x32_bf16 v[100:103], v[208:211], v[236:239], v[100:103]
    v_exp_f32 v136, v136
    v_mfma_f32_16x16x32_bf16 v[104:107], v[212:215], v[232:235], v[104:107]
    ds_read_b128 v[208:211], v3 offset:20480
    v_mfma_f32_16x16x32_bf16 v[108:111], v[212:215], v[236:239], v[108:111]
    v_exp_f32 v137, v137
    v_mfma_f32_16x16x32_bf16 v[112:115], v[216:219], v[232:235], v[112:115]
    ds_read_b128 v[212:215], v3 offset:21504
    v_cvt_pk_bf16_f32 v226, v136, v137
    v_mfma_f32_16x16x32_bf16 v[116:119], v[216:219], v[236:239], v[116:119]
    v_exp_f32 v138, v138
    v_mfma_f32_16x16x32_bf16 v[120:123], v[220:223], v[232:235], v[120:123]
    ds_read_b128 v[216:219], v3 offset:22528
    v_mfma_f32_16x16x32_bf16 v[124:127], v[220:223], v[236:239], v[124:127]
    v_exp_f32 v139, v139
    v_mfma_f32_16x16x32_bf16 v[240:243], v[248:251], v[232:235], v[240:243]
    ds_read_b128 v[220:223], v3 offset:23552
    v_cvt_pk_bf16_f32 v227, v138, v139
    v_mfma_f32_16x16x32_bf16 v[244:247], v[248:251], v[236:239], v[244:247]
    s_waitcnt lgkmcnt(4)
    v_mov_b32 v2, v3
    v_add_u32 v3, s40, v1
    v_mfma_f32_16x16x32_bf16 v[144:147], v[192:195], v[32:35], v[176:179]
    v_exp_f32 v132, v132
    v_mfma_f32_16x16x32_bf16 v[144:147], v[196:199], v[36:39], v[144:147]
    v_exp_f32 v133, v133
    v_mfma_f32_16x16x32_bf16 v[144:147], v[200:203], v[40:43], v[144:147]
    v_exp_f32 v134, v134
    v_mfma_f32_16x16x32_bf16 v[144:147], v[204:207], v[44:47], v[144:147]
    v_exp_f32 v135, v135
    v_mfma_f32_16x16x32_bf16 v[148:151], v[192:195], v[48:51], v[180:183]
    v_exp_f32 v140, v140
    v_mfma_f32_16x16x32_bf16 v[148:151], v[196:199], v[52:55], v[148:151]
    ds_read_b128 v[192:195], v2 offset:8192
    v_cvt_pk_bf16_f32 v228, v132, v133
    v_mfma_f32_16x16x32_bf16 v[148:151], v[200:203], v[56:59], v[148:151]
    ds_read_b128 v[196:199], v2 offset:9216
    v_cvt_pk_bf16_f32 v229, v134, v135
    v_mfma_f32_16x16x32_bf16 v[148:151], v[204:207], v[60:63], v[148:151]
    ds_read_b128 v[200:203], v2 offset:10240
    s_waitcnt lgkmcnt(3)
    v_mfma_f32_16x16x32_bf16 v[152:155], v[208:211], v[32:35], v[184:187]
    ds_read_b128 v[204:207], v2 offset:11264
    v_mfma_f32_16x16x32_bf16 v[152:155], v[212:215], v[36:39], v[152:155]
    v_exp_f32 v141, v141
    v_mfma_f32_16x16x32_bf16 v[152:155], v[216:219], v[40:43], v[152:155]
    v_exp_f32 v142, v142
    v_mfma_f32_16x16x32_bf16 v[152:155], v[220:223], v[44:47], v[152:155]
    v_exp_f32 v143, v143
    v_mfma_f32_16x16x32_bf16 v[156:159], v[208:211], v[48:51], v[188:191]
    v_mfma_f32_16x16x32_bf16 v[156:159], v[212:215], v[52:55], v[156:159]
    ds_read_b128 v[208:211], v2 offset:12288
    v_cvt_pk_bf16_f32 v230, v140, v141
    v_mfma_f32_16x16x32_bf16 v[156:159], v[216:219], v[56:59], v[156:159]
    ds_read_b128 v[212:215], v2 offset:13312
    v_cvt_pk_bf16_f32 v231, v142, v143
    v_mfma_f32_16x16x32_bf16 v[156:159], v[220:223], v[60:63], v[156:159]
    ds_read_b128 v[216:219], v2 offset:14336
    s_waitcnt lgkmcnt(3)
    v_mfma_f32_16x16x32_bf16 v[64:67], v[192:195], v[224:227], v[64:67]
    ds_read_b128 v[220:223], v2 offset:15360
    v_mfma_f32_16x16x32_bf16 v[68:71], v[192:195], v[228:231], v[68:71]
    v_exp_f32 v144, v144
    v_mfma_f32_16x16x32_bf16 v[72:75], v[196:199], v[224:227], v[72:75]
    ds_read_b128 v[192:195], v3 offset:0
    v_mfma_f32_16x16x32_bf16 v[76:79], v[196:199], v[228:231], v[76:79]
    v_exp_f32 v145, v145
    v_mfma_f32_16x16x32_bf16 v[80:83], v[200:203], v[224:227], v[80:83]
    ds_read_b128 v[196:199], v3 offset:1024
    v_cvt_pk_bf16_f32 v232, v144, v145
    v_mfma_f32_16x16x32_bf16 v[84:87], v[200:203], v[228:231], v[84:87]
    v_exp_f32 v146, v146
    v_mfma_f32_16x16x32_bf16 v[88:91], v[204:207], v[224:227], v[88:91]
    ds_read_b128 v[200:203], v3 offset:2048
    s_waitcnt lgkmcnt(3)
    v_mfma_f32_16x16x32_bf16 v[92:95], v[204:207], v[228:231], v[92:95]
    v_exp_f32 v147, v147
    v_mfma_f32_16x16x32_bf16 v[96:99], v[208:211], v[224:227], v[96:99]
    ds_read_b128 v[204:207], v3 offset:3072
    v_cvt_pk_bf16_f32 v233, v146, v147
    v_mfma_f32_16x16x32_bf16 v[100:103], v[208:211], v[228:231], v[100:103]
    v_exp_f32 v152, v152
    v_mfma_f32_16x16x32_bf16 v[104:107], v[212:215], v[224:227], v[104:107]
    ds_read_b128 v[208:211], v3 offset:4096
    v_mfma_f32_16x16x32_bf16 v[108:111], v[212:215], v[228:231], v[108:111]
    v_exp_f32 v153, v153
    v_mfma_f32_16x16x32_bf16 v[112:115], v[216:219], v[224:227], v[112:115]
    ds_read_b128 v[212:215], v3 offset:5120
    v_cvt_pk_bf16_f32 v234, v152, v153
    v_mfma_f32_16x16x32_bf16 v[116:119], v[216:219], v[228:231], v[116:119]
    v_exp_f32 v154, v154
    v_mfma_f32_16x16x32_bf16 v[120:123], v[220:223], v[224:227], v[120:123]
    ds_read_b128 v[216:219], v3 offset:6144
    v_mfma_f32_16x16x32_bf16 v[124:127], v[220:223], v[228:231], v[124:127]
    v_exp_f32 v155, v155
    v_mfma_f32_16x16x32_bf16 v[240:243], v[248:251], v[224:227], v[240:243]
    ds_read_b128 v[220:223], v3 offset:7168
    v_cvt_pk_bf16_f32 v235, v154, v155
    v_mfma_f32_16x16x32_bf16 v[244:247], v[248:251], v[228:231], v[244:247]
    s_waitcnt lgkmcnt(4)
    v_mfma_f32_16x16x32_bf16 v[128:131], v[192:195], v[32:35], v[160:163]
    v_exp_f32 v148, v148
    v_mfma_f32_16x16x32_bf16 v[128:131], v[196:199], v[36:39], v[128:131]
    v_exp_f32 v149, v149
    v_mfma_f32_16x16x32_bf16 v[128:131], v[200:203], v[40:43], v[128:131]
    v_exp_f32 v150, v150
    v_mfma_f32_16x16x32_bf16 v[128:131], v[204:207], v[44:47], v[128:131]
    v_exp_f32 v151, v151
    v_mfma_f32_16x16x32_bf16 v[132:135], v[192:195], v[48:51], v[164:167]
    v_exp_f32 v156, v156
    v_mfma_f32_16x16x32_bf16 v[132:135], v[196:199], v[52:55], v[132:135]
    ds_read_b128 v[192:195], v2 offset:24576
    v_cvt_pk_bf16_f32 v236, v148, v149
    v_mfma_f32_16x16x32_bf16 v[132:135], v[200:203], v[56:59], v[132:135]
    ds_read_b128 v[196:199], v2 offset:25600
    v_cvt_pk_bf16_f32 v237, v150, v151
    v_mfma_f32_16x16x32_bf16 v[132:135], v[204:207], v[60:63], v[132:135]
    ds_read_b128 v[200:203], v2 offset:26624
    s_waitcnt lgkmcnt(3)
    v_mfma_f32_16x16x32_bf16 v[136:139], v[208:211], v[32:35], v[168:171]
    ds_read_b128 v[204:207], v2 offset:27648
    s_add_u32 s8, s8, 1
    v_mfma_f32_16x16x32_bf16 v[136:139], v[212:215], v[36:39], v[136:139]
    v_exp_f32 v157, v157
    v_mfma_f32_16x16x32_bf16 v[136:139], v[216:219], v[40:43], v[136:139]
    v_exp_f32 v158, v158
    v_mfma_f32_16x16x32_bf16 v[136:139], v[220:223], v[44:47], v[136:139]
    v_exp_f32 v159, v159
    v_mfma_f32_16x16x32_bf16 v[140:143], v[208:211], v[48:51], v[172:175]
    s_add_u32 s40, s40, 0x8000
    s_cmp_eq_u32 s40, 0x28000
    v_mfma_f32_16x16x32_bf16 v[140:143], v[212:215], v[52:55], v[140:143]
    ds_read_b128 v[208:211], v2 offset:28672
    v_cvt_pk_bf16_f32 v238, v156, v157
    v_mfma_f32_16x16x32_bf16 v[140:143], v[216:219], v[56:59], v[140:143]
    ds_read_b128 v[212:215], v2 offset:29696
    v_cvt_pk_bf16_f32 v239, v158, v159
    v_mfma_f32_16x16x32_bf16 v[140:143], v[220:223], v[60:63], v[140:143]
    ds_read_b128 v[216:219], v2 offset:30720
    s_waitcnt lgkmcnt(3)
    v_mfma_f32_16x16x32_bf16 v[64:67], v[192:195], v[232:235], v[64:67]
    ds_read_b128 v[220:223], v2 offset:31744
    s_cselect_b32 s40, 0, s40
    v_mfma_f32_16x16x32_bf16 v[68:71], v[192:195], v[236:239], v[68:71]
    v_exp_f32 v128, v128
    v_mfma_f32_16x16x32_bf16 v[72:75], v[196:199], v[232:235], v[72:75]
    ds_read_b128 v[192:195], v3 offset:16384
    v_mfma_f32_16x16x32_bf16 v[76:79], v[196:199], v[236:239], v[76:79]
    v_exp_f32 v129, v129
    v_mfma_f32_16x16x32_bf16 v[80:83], v[200:203], v[232:235], v[80:83]
    ds_read_b128 v[196:199], v3 offset:17408
    v_cvt_pk_bf16_f32 v224, v128, v129
    v_mfma_f32_16x16x32_bf16 v[84:87], v[200:203], v[236:239], v[84:87]
    v_exp_f32 v130, v130
    v_mfma_f32_16x16x32_bf16 v[88:91], v[204:207], v[232:235], v[88:91]
    ds_read_b128 v[200:203], v3 offset:18432
    s_waitcnt lgkmcnt(3)
    v_mfma_f32_16x16x32_bf16 v[92:95], v[204:207], v[236:239], v[92:95]
    v_exp_f32 v131, v131
    v_mfma_f32_16x16x32_bf16 v[96:99], v[208:211], v[232:235], v[96:99]
    ds_read_b128 v[204:207], v3 offset:19456
    v_cvt_pk_bf16_f32 v225, v130, v131
    v_mfma_f32_16x16x32_bf16 v[100:103], v[208:211], v[236:239], v[100:103]
    v_exp_f32 v136, v136
    v_mfma_f32_16x16x32_bf16 v[104:107], v[212:215], v[232:235], v[104:107]
    ds_read_b128 v[208:211], v3 offset:20480
    v_mfma_f32_16x16x32_bf16 v[108:111], v[212:215], v[236:239], v[108:111]
    v_exp_f32 v137, v137
    v_mfma_f32_16x16x32_bf16 v[112:115], v[216:219], v[232:235], v[112:115]
    ds_read_b128 v[212:215], v3 offset:21504
    v_cvt_pk_bf16_f32 v226, v136, v137
    v_mfma_f32_16x16x32_bf16 v[116:119], v[216:219], v[236:239], v[116:119]
    v_exp_f32 v138, v138
    v_mfma_f32_16x16x32_bf16 v[120:123], v[220:223], v[232:235], v[120:123]
    ds_read_b128 v[216:219], v3 offset:22528
    v_mfma_f32_16x16x32_bf16 v[124:127], v[220:223], v[236:239], v[124:127]
    v_exp_f32 v139, v139
    v_mfma_f32_16x16x32_bf16 v[240:243], v[248:251], v[232:235], v[240:243]
    ds_read_b128 v[220:223], v3 offset:23552
    v_cvt_pk_bf16_f32 v227, v138, v139
    v_mfma_f32_16x16x32_bf16 v[244:247], v[248:251], v[236:239], v[244:247]
    s_waitcnt lgkmcnt(4)
    v_mov_b32 v2, v3
    v_add_u32 v3, s40, v1
    s_cmp_lt_u32 s8, s29
    s_cbranch_scc1 p2_kernel_lofast_loop
p2_kernel_lofast_lpend:
    s_bitcmp1_b32 s9, 0
    s_cbranch_scc1 p2_kernel_lofast_peelO
    s_waitcnt vmcnt(0)
    s_barrier
    s_min_u32 s28, s43, 31
    s_lshl_b32 s28, s28, 15
    s_add_u32 s28, s28, s13
    s_lshl_b32 s16, s17, 13
    s_add_u32 m0, s41, s16
    s_add_u32 s43, s43, 1
    buffer_load_dwordx4 v1, s[4:7], s28 offen offset:0 lds
    buffer_load_dwordx4 v1, s[4:7], s28 offen offset:1024 lds
    buffer_load_dwordx4 v1, s[4:7], s28 offen offset:2048 lds
    buffer_load_dwordx4 v1, s[4:7], s28 offen offset:3072 lds
    s_add_u32 m0, m0, 4096
    s_add_u32 s28, s28, 4096
    buffer_load_dwordx4 v1, s[4:7], s28 offen offset:0 lds
    buffer_load_dwordx4 v1, s[4:7], s28 offen offset:1024 lds
    buffer_load_dwordx4 v1, s[4:7], s28 offen offset:2048 lds
    buffer_load_dwordx4 v1, s[4:7], s28 offen offset:3072 lds
    s_add_u32 s41, s41, 0x8000
    s_cmp_eq_u32 s41, 0x28000
    s_cselect_b32 s41, 0, s41
    s_min_u32 s28, s43, 31
    s_lshl_b32 s28, s28, 15
    s_add_u32 s28, s28, s13
    s_lshl_b32 s16, s17, 13
    s_add_u32 m0, s41, s16
    s_add_u32 s43, s43, 1
    buffer_load_dwordx4 v1, s[4:7], s28 offen offset:0 lds
    buffer_load_dwordx4 v1, s[4:7], s28 offen offset:1024 lds
    buffer_load_dwordx4 v1, s[4:7], s28 offen offset:2048 lds
    buffer_load_dwordx4 v1, s[4:7], s28 offen offset:3072 lds
    s_add_u32 m0, m0, 4096
    s_add_u32 s28, s28, 4096
    buffer_load_dwordx4 v1, s[4:7], s28 offen offset:0 lds
    buffer_load_dwordx4 v1, s[4:7], s28 offen offset:1024 lds
    buffer_load_dwordx4 v1, s[4:7], s28 offen offset:2048 lds
    buffer_load_dwordx4 v1, s[4:7], s28 offen offset:3072 lds
    s_add_u32 s41, s41, 0x8000
    s_cmp_eq_u32 s41, 0x28000
    s_cselect_b32 s41, 0, s41
    v_mfma_f32_16x16x32_bf16 v[144:147], v[192:195], v[32:35], v[176:179]
    v_exp_f32 v132, v132
    v_mfma_f32_16x16x32_bf16 v[144:147], v[196:199], v[36:39], v[144:147]
    v_exp_f32 v133, v133
    v_mfma_f32_16x16x32_bf16 v[144:147], v[200:203], v[40:43], v[144:147]
    v_exp_f32 v134, v134
    v_mfma_f32_16x16x32_bf16 v[144:147], v[204:207], v[44:47], v[144:147]
    v_exp_f32 v135, v135
    v_mfma_f32_16x16x32_bf16 v[148:151], v[192:195], v[48:51], v[180:183]
    v_exp_f32 v140, v140
    v_mfma_f32_16x16x32_bf16 v[148:151], v[196:199], v[52:55], v[148:151]
    ds_read_b128 v[192:195], v2 offset:8192
    v_cvt_pk_bf16_f32 v228, v132, v133
    v_mfma_f32_16x16x32_bf16 v[148:151], v[200:203], v[56:59], v[148:151]
    ds_read_b128 v[196:199], v2 offset:9216
    v_cvt_pk_bf16_f32 v229, v134, v135
    v_mfma_f32_16x16x32_bf16 v[148:151], v[204:207], v[60:63], v[148:151]
    ds_read_b128 v[200:203], v2 offset:10240
    s_waitcnt lgkmcnt(3)
    v_mfma_f32_16x16x32_bf16 v[152:155], v[208:211], v[32:35], v[184:187]
    ds_read_b128 v[204:207], v2 offset:11264
    v_mfma_f32_16x16x32_bf16 v[152:155], v[212:215], v[36:39], v[152:155]
    v_exp_f32 v141, v141
    v_mfma_f32_16x16x32_bf16 v[152:155], v[216:219], v[40:43], v[152:155]
    v_exp_f32 v142, v142
    v_mfma_f32_16x16x32_bf16 v[152:155], v[220:223], v[44:47], v[152:155]
    v_exp_f32 v143, v143
    v_mfma_f32_16x16x32_bf16 v[156:159], v[208:211], v[48:51], v[188:191]
    v_mfma_f32_16x16x32_bf16 v[156:159], v[212:215], v[52:55], v[156:159]
    ds_read_b128 v[208:211], v2 offset:12288
    v_cvt_pk_bf16_f32 v230, v140, v141
    v_mfma_f32_16x16x32_bf16 v[156:159], v[216:219], v[56:59], v[156:159]
    ds_read_b128 v[212:215], v2 offset:13312
    v_cvt_pk_bf16_f32 v231, v142, v143
    v_mfma_f32_16x16x32_bf16 v[156:159], v[220:223], v[60:63], v[156:159]
    ds_read_b128 v[216:219], v2 offset:14336
    s_waitcnt lgkmcnt(3)
    v_mfma_f32_16x16x32_bf16 v[64:67], v[192:195], v[224:227], v[64:67]
    ds_read_b128 v[220:223], v2 offset:15360
    v_mfma_f32_16x16x32_bf16 v[68:71], v[192:195], v[228:231], v[68:71]
    v_exp_f32 v144, v144
    v_mfma_f32_16x16x32_bf16 v[72:75], v[196:199], v[224:227], v[72:75]
    ds_read_b128 v[192:195], v3 offset:0
    v_mfma_f32_16x16x32_bf16 v[76:79], v[196:199], v[228:231], v[76:79]
    v_exp_f32 v145, v145
    v_mfma_f32_16x16x32_bf16 v[80:83], v[200:203], v[224:227], v[80:83]
    ds_read_b128 v[196:199], v3 offset:1024
    v_cvt_pk_bf16_f32 v232, v144, v145
    v_mfma_f32_16x16x32_bf16 v[84:87], v[200:203], v[228:231], v[84:87]
    v_exp_f32 v146, v146
    v_mfma_f32_16x16x32_bf16 v[88:91], v[204:207], v[224:227], v[88:91]
    ds_read_b128 v[200:203], v3 offset:2048
    s_waitcnt lgkmcnt(3)
    v_mfma_f32_16x16x32_bf16 v[92:95], v[204:207], v[228:231], v[92:95]
    v_exp_f32 v147, v147
    v_mfma_f32_16x16x32_bf16 v[96:99], v[208:211], v[224:227], v[96:99]
    ds_read_b128 v[204:207], v3 offset:3072
    v_cvt_pk_bf16_f32 v233, v146, v147
    v_mfma_f32_16x16x32_bf16 v[100:103], v[208:211], v[228:231], v[100:103]
    v_exp_f32 v152, v152
    v_mfma_f32_16x16x32_bf16 v[104:107], v[212:215], v[224:227], v[104:107]
    ds_read_b128 v[208:211], v3 offset:4096
    v_mfma_f32_16x16x32_bf16 v[108:111], v[212:215], v[228:231], v[108:111]
    v_exp_f32 v153, v153
    v_mfma_f32_16x16x32_bf16 v[112:115], v[216:219], v[224:227], v[112:115]
    ds_read_b128 v[212:215], v3 offset:5120
    v_cvt_pk_bf16_f32 v234, v152, v153
    v_mfma_f32_16x16x32_bf16 v[116:119], v[216:219], v[228:231], v[116:119]
    v_exp_f32 v154, v154
    v_mfma_f32_16x16x32_bf16 v[120:123], v[220:223], v[224:227], v[120:123]
    ds_read_b128 v[216:219], v3 offset:6144
    v_mfma_f32_16x16x32_bf16 v[124:127], v[220:223], v[228:231], v[124:127]
    v_exp_f32 v155, v155
    v_mfma_f32_16x16x32_bf16 v[240:243], v[248:251], v[224:227], v[240:243]
    ds_read_b128 v[220:223], v3 offset:7168
    v_cvt_pk_bf16_f32 v235, v154, v155
    v_mfma_f32_16x16x32_bf16 v[244:247], v[248:251], v[228:231], v[244:247]
    s_waitcnt lgkmcnt(4)
    v_mfma_f32_16x16x32_bf16 v[128:131], v[192:195], v[32:35], v[160:163]
    v_exp_f32 v148, v148
    v_mfma_f32_16x16x32_bf16 v[128:131], v[196:199], v[36:39], v[128:131]
    v_exp_f32 v149, v149
    v_mfma_f32_16x16x32_bf16 v[128:131], v[200:203], v[40:43], v[128:131]
    v_exp_f32 v150, v150
    v_mfma_f32_16x16x32_bf16 v[128:131], v[204:207], v[44:47], v[128:131]
    v_exp_f32 v151, v151
    v_mfma_f32_16x16x32_bf16 v[132:135], v[192:195], v[48:51], v[164:167]
    v_exp_f32 v156, v156
    v_mfma_f32_16x16x32_bf16 v[132:135], v[196:199], v[52:55], v[132:135]
    ds_read_b128 v[192:195], v2 offset:24576
    v_cvt_pk_bf16_f32 v236, v148, v149
    v_mfma_f32_16x16x32_bf16 v[132:135], v[200:203], v[56:59], v[132:135]
    ds_read_b128 v[196:199], v2 offset:25600
    v_cvt_pk_bf16_f32 v237, v150, v151
    v_mfma_f32_16x16x32_bf16 v[132:135], v[204:207], v[60:63], v[132:135]
    ds_read_b128 v[200:203], v2 offset:26624
    s_waitcnt lgkmcnt(3)
    v_mfma_f32_16x16x32_bf16 v[136:139], v[208:211], v[32:35], v[168:171]
    ds_read_b128 v[204:207], v2 offset:27648
    s_add_u32 s8, s8, 1
    v_mfma_f32_16x16x32_bf16 v[136:139], v[212:215], v[36:39], v[136:139]
    v_exp_f32 v157, v157
    v_mfma_f32_16x16x32_bf16 v[136:139], v[216:219], v[40:43], v[136:139]
    v_exp_f32 v158, v158
    v_mfma_f32_16x16x32_bf16 v[136:139], v[220:223], v[44:47], v[136:139]
    v_exp_f32 v159, v159
    v_mfma_f32_16x16x32_bf16 v[140:143], v[208:211], v[48:51], v[172:175]
    s_add_u32 s40, s40, 0x8000
    s_cmp_eq_u32 s40, 0x28000
    v_mfma_f32_16x16x32_bf16 v[140:143], v[212:215], v[52:55], v[140:143]
    ds_read_b128 v[208:211], v2 offset:28672
    v_cvt_pk_bf16_f32 v238, v156, v157
    v_mfma_f32_16x16x32_bf16 v[140:143], v[216:219], v[56:59], v[140:143]
    ds_read_b128 v[212:215], v2 offset:29696
    v_cvt_pk_bf16_f32 v239, v158, v159
    v_mfma_f32_16x16x32_bf16 v[140:143], v[220:223], v[60:63], v[140:143]
    ds_read_b128 v[216:219], v2 offset:30720
    s_waitcnt lgkmcnt(3)
    v_mfma_f32_16x16x32_bf16 v[64:67], v[192:195], v[232:235], v[64:67]
    ds_read_b128 v[220:223], v2 offset:31744
    s_cselect_b32 s40, 0, s40
    v_mfma_f32_16x16x32_bf16 v[68:71], v[192:195], v[236:239], v[68:71]
    v_exp_f32 v128, v128
    v_mfma_f32_16x16x32_bf16 v[72:75], v[196:199], v[232:235], v[72:75]
    ds_read_b128 v[192:195], v3 offset:16384
    v_mfma_f32_16x16x32_bf16 v[76:79], v[196:199], v[236:239], v[76:79]
    v_exp_f32 v129, v129
    v_mfma_f32_16x16x32_bf16 v[80:83], v[200:203], v[232:235], v[80:83]
    ds_read_b128 v[196:199], v3 offset:17408
    v_cvt_pk_bf16_f32 v224, v128, v129
    v_mfma_f32_16x16x32_bf16 v[84:87], v[200:203], v[236:239], v[84:87]
    v_exp_f32 v130, v130
    v_mfma_f32_16x16x32_bf16 v[88:91], v[204:207], v[232:235], v[88:91]
    ds_read_b128 v[200:203], v3 offset:18432
    s_waitcnt lgkmcnt(3)
    v_mfma_f32_16x16x32_bf16 v[92:95], v[204:207], v[236:239], v[92:95]
    v_exp_f32 v131, v131
    v_mfma_f32_16x16x32_bf16 v[96:99], v[208:211], v[232:235], v[96:99]
    ds_read_b128 v[204:207], v3 offset:19456
    v_cvt_pk_bf16_f32 v225, v130, v131
    v_mfma_f32_16x16x32_bf16 v[100:103], v[208:211], v[236:239], v[100:103]
    v_exp_f32 v136, v136
    v_mfma_f32_16x16x32_bf16 v[104:107], v[212:215], v[232:235], v[104:107]
    ds_read_b128 v[208:211], v3 offset:20480
    v_mfma_f32_16x16x32_bf16 v[108:111], v[212:215], v[236:239], v[108:111]
    v_exp_f32 v137, v137
    v_mfma_f32_16x16x32_bf16 v[112:115], v[216:219], v[232:235], v[112:115]
    ds_read_b128 v[212:215], v3 offset:21504
    v_cvt_pk_bf16_f32 v226, v136, v137
    v_mfma_f32_16x16x32_bf16 v[116:119], v[216:219], v[236:239], v[116:119]
    v_exp_f32 v138, v138
    v_mfma_f32_16x16x32_bf16 v[120:123], v[220:223], v[232:235], v[120:123]
    ds_read_b128 v[216:219], v3 offset:22528
    v_mfma_f32_16x16x32_bf16 v[124:127], v[220:223], v[236:239], v[124:127]
    v_exp_f32 v139, v139
    v_mfma_f32_16x16x32_bf16 v[240:243], v[248:251], v[232:235], v[240:243]
    ds_read_b128 v[220:223], v3 offset:23552
    v_cvt_pk_bf16_f32 v227, v138, v139
    v_mfma_f32_16x16x32_bf16 v[244:247], v[248:251], v[236:239], v[244:247]
    s_waitcnt lgkmcnt(4)
    v_mov_b32 v2, v3
    v_add_u32 v3, s40, v1
    v_cmp_le_i32 s[20:21], 0, v18
    v_cmp_le_i32 s[22:23], 1, v18
    v_cmp_le_i32 s[24:25], 2, v18
    v_cmp_le_i32 s[26:27], 3, v18
    v_cndmask_b32 v160, v19, v160, s[20:21]
    v_cndmask_b32 v161, v19, v161, s[22:23]
    v_cndmask_b32 v162, v19, v162, s[24:25]
    v_cndmask_b32 v163, v19, v163, s[26:27]
    v_cmp_le_i32 s[20:21], -16, v18
    v_cmp_le_i32 s[22:23], -15, v18
    v_cmp_le_i32 s[24:25], -14, v18
    v_cmp_le_i32 s[26:27], -13, v18
    v_cndmask_b32 v164, v19, v164, s[20:21]
    v_cndmask_b32 v165, v19, v165, s[22:23]
    v_cndmask_b32 v166, v19, v166, s[24:25]
    v_cndmask_b32 v167, v19, v167, s[26:27]
    v_cmp_le_i32 s[20:21], 16, v18
    v_cmp_le_i32 s[22:23], 17, v18
    v_cmp_le_i32 s[24:25], 18, v18
    v_cmp_le_i32 s[26:27], 19, v18
    v_cndmask_b32 v168, v19, v168, s[20:21]
    v_cndmask_b32 v169, v19, v169, s[22:23]
    v_cndmask_b32 v170, v19, v170, s[24:25]
    v_cndmask_b32 v171, v19, v171, s[26:27]
    v_cmp_le_i32 s[20:21], 0, v18
    v_cmp_le_i32 s[22:23], 1, v18
    v_cmp_le_i32 s[24:25], 2, v18
    v_cmp_le_i32 s[26:27], 3, v18
    v_cndmask_b32 v172, v19, v172, s[20:21]
    v_cndmask_b32 v173, v19, v173, s[22:23]
    v_cndmask_b32 v174, v19, v174, s[24:25]
    v_cndmask_b32 v175, v19, v175, s[26:27]
    s_nop 1
    v_mfma_f32_16x16x32_bf16 v[144:147], v[192:195], v[32:35], v[176:179]
    v_exp_f32 v132, v132
    v_mfma_f32_16x16x32_bf16 v[144:147], v[196:199], v[36:39], v[144:147]
    v_exp_f32 v133, v133
    v_mfma_f32_16x16x32_bf16 v[144:147], v[200:203], v[40:43], v[144:147]
    v_exp_f32 v134, v134
    v_mfma_f32_16x16x32_bf16 v[144:147], v[204:207], v[44:47], v[144:147]
    v_exp_f32 v135, v135
    v_mfma_f32_16x16x32_bf16 v[148:151], v[192:195], v[48:51], v[180:183]
    v_exp_f32 v140, v140
    v_mfma_f32_16x16x32_bf16 v[148:151], v[196:199], v[52:55], v[148:151]
    ds_read_b128 v[192:195], v2 offset:8192
    v_cvt_pk_bf16_f32 v228, v132, v133
    v_mfma_f32_16x16x32_bf16 v[148:151], v[200:203], v[56:59], v[148:151]
    ds_read_b128 v[196:199], v2 offset:9216
    v_cvt_pk_bf16_f32 v229, v134, v135
    v_mfma_f32_16x16x32_bf16 v[148:151], v[204:207], v[60:63], v[148:151]
    ds_read_b128 v[200:203], v2 offset:10240
    s_waitcnt lgkmcnt(3)
    v_mfma_f32_16x16x32_bf16 v[152:155], v[208:211], v[32:35], v[184:187]
    ds_read_b128 v[204:207], v2 offset:11264
    v_mfma_f32_16x16x32_bf16 v[152:155], v[212:215], v[36:39], v[152:155]
    v_exp_f32 v141, v141
    v_mfma_f32_16x16x32_bf16 v[152:155], v[216:219], v[40:43], v[152:155]
    v_exp_f32 v142, v142
    v_mfma_f32_16x16x32_bf16 v[152:155], v[220:223], v[44:47], v[152:155]
    v_exp_f32 v143, v143
    v_mfma_f32_16x16x32_bf16 v[156:159], v[208:211], v[48:51], v[188:191]
    v_mfma_f32_16x16x32_bf16 v[156:159], v[212:215], v[52:55], v[156:159]
    ds_read_b128 v[208:211], v2 offset:12288
    v_cvt_pk_bf16_f32 v230, v140, v141
    v_mfma_f32_16x16x32_bf16 v[156:159], v[216:219], v[56:59], v[156:159]
    ds_read_b128 v[212:215], v2 offset:13312
    v_cvt_pk_bf16_f32 v231, v142, v143
    v_mfma_f32_16x16x32_bf16 v[156:159], v[220:223], v[60:63], v[156:159]
    ds_read_b128 v[216:219], v2 offset:14336
    s_waitcnt lgkmcnt(3)
    v_mfma_f32_16x16x32_bf16 v[64:67], v[192:195], v[224:227], v[64:67]
    ds_read_b128 v[220:223], v2 offset:15360
    v_mfma_f32_16x16x32_bf16 v[68:71], v[192:195], v[228:231], v[68:71]
    v_exp_f32 v144, v144
    v_mfma_f32_16x16x32_bf16 v[72:75], v[196:199], v[224:227], v[72:75]
    ds_read_b128 v[192:195], v3 offset:0
    v_mfma_f32_16x16x32_bf16 v[76:79], v[196:199], v[228:231], v[76:79]
    v_exp_f32 v145, v145
    v_mfma_f32_16x16x32_bf16 v[80:83], v[200:203], v[224:227], v[80:83]
    ds_read_b128 v[196:199], v3 offset:1024
    v_cvt_pk_bf16_f32 v232, v144, v145
    v_mfma_f32_16x16x32_bf16 v[84:87], v[200:203], v[228:231], v[84:87]
    v_exp_f32 v146, v146
    v_mfma_f32_16x16x32_bf16 v[88:91], v[204:207], v[224:227], v[88:91]
    ds_read_b128 v[200:203], v3 offset:2048
    s_waitcnt lgkmcnt(3)
    v_mfma_f32_16x16x32_bf16 v[92:95], v[204:207], v[228:231], v[92:95]
    v_exp_f32 v147, v147
    v_mfma_f32_16x16x32_bf16 v[96:99], v[208:211], v[224:227], v[96:99]
    ds_read_b128 v[204:207], v3 offset:3072
    v_cvt_pk_bf16_f32 v233, v146, v147
    v_mfma_f32_16x16x32_bf16 v[100:103], v[208:211], v[228:231], v[100:103]
    v_exp_f32 v152, v152
    v_mfma_f32_16x16x32_bf16 v[104:107], v[212:215], v[224:227], v[104:107]
    ds_read_b128 v[208:211], v3 offset:4096
    v_mfma_f32_16x16x32_bf16 v[108:111], v[212:215], v[228:231], v[108:111]
    v_exp_f32 v153, v153
    v_mfma_f32_16x16x32_bf16 v[112:115], v[216:219], v[224:227], v[112:115]
    ds_read_b128 v[212:215], v3 offset:5120
    v_cvt_pk_bf16_f32 v234, v152, v153
    v_mfma_f32_16x16x32_bf16 v[116:119], v[216:219], v[228:231], v[116:119]
    v_exp_f32 v154, v154
    v_mfma_f32_16x16x32_bf16 v[120:123], v[220:223], v[224:227], v[120:123]
    ds_read_b128 v[216:219], v3 offset:6144
    v_mfma_f32_16x16x32_bf16 v[124:127], v[220:223], v[228:231], v[124:127]
    v_exp_f32 v155, v155
    v_mfma_f32_16x16x32_bf16 v[240:243], v[248:251], v[224:227], v[240:243]
    ds_read_b128 v[220:223], v3 offset:7168
    v_cvt_pk_bf16_f32 v235, v154, v155
    v_mfma_f32_16x16x32_bf16 v[244:247], v[248:251], v[228:231], v[244:247]
    s_waitcnt lgkmcnt(4)
    v_mfma_f32_16x16x32_bf16 v[128:131], v[192:195], v[32:35], v[160:163]
    v_exp_f32 v148, v148
    v_mfma_f32_16x16x32_bf16 v[128:131], v[196:199], v[36:39], v[128:131]
    v_exp_f32 v149, v149
    v_mfma_f32_16x16x32_bf16 v[128:131], v[200:203], v[40:43], v[128:131]
    v_exp_f32 v150, v150
    v_mfma_f32_16x16x32_bf16 v[128:131], v[204:207], v[44:47], v[128:131]
    v_exp_f32 v151, v151
    v_mfma_f32_16x16x32_bf16 v[132:135], v[192:195], v[48:51], v[164:167]
    v_exp_f32 v156, v156
    v_mfma_f32_16x16x32_bf16 v[132:135], v[196:199], v[52:55], v[132:135]
    ds_read_b128 v[192:195], v2 offset:24576
    v_cvt_pk_bf16_f32 v236, v148, v149
    v_mfma_f32_16x16x32_bf16 v[132:135], v[200:203], v[56:59], v[132:135]
    ds_read_b128 v[196:199], v2 offset:25600
    v_cvt_pk_bf16_f32 v237, v150, v151
    v_mfma_f32_16x16x32_bf16 v[132:135], v[204:207], v[60:63], v[132:135]
    ds_read_b128 v[200:203], v2 offset:26624
    s_waitcnt lgkmcnt(3)
    v_mfma_f32_16x16x32_bf16 v[136:139], v[208:211], v[32:35], v[168:171]
    ds_read_b128 v[204:207], v2 offset:27648
    s_add_u32 s8, s8, 1
    v_mfma_f32_16x16x32_bf16 v[136:139], v[212:215], v[36:39], v[136:139]
    v_exp_f32 v157, v157
    v_mfma_f32_16x16x32_bf16 v[136:139], v[216:219], v[40:43], v[136:139]
    v_exp_f32 v158, v158
    v_mfma_f32_16x16x32_bf16 v[136:139], v[220:223], v[44:47], v[136:139]
    v_exp_f32 v159, v159
    v_mfma_f32_16x16x32_bf16 v[140:143], v[208:211], v[48:51], v[172:175]
    s_add_u32 s40, s40, 0x8000
    s_cmp_eq_u32 s40, 0x28000
    v_mfma_f32_16x16x32_bf16 v[140:143], v[212:215], v[52:55], v[140:143]
    ds_read_b128 v[208:211], v2 offset:28672
    v_cvt_pk_bf16_f32 v238, v156, v157
    v_mfma_f32_16x16x32_bf16 v[140:143], v[216:219], v[56:59], v[140:143]
    ds_read_b128 v[212:215], v2 offset:29696
    v_cvt_pk_bf16_f32 v239, v158, v159
    v_mfma_f32_16x16x32_bf16 v[140:143], v[220:223], v[60:63], v[140:143]
    ds_read_b128 v[216:219], v2 offset:30720
    s_waitcnt lgkmcnt(3)
    v_mfma_f32_16x16x32_bf16 v[64:67], v[192:195], v[232:235], v[64:67]
    ds_read_b128 v[220:223], v2 offset:31744
    s_cselect_b32 s40, 0, s40
    v_mfma_f32_16x16x32_bf16 v[68:71], v[192:195], v[236:239], v[68:71]
    v_exp_f32 v128, v128
    v_mfma_f32_16x16x32_bf16 v[72:75], v[196:199], v[232:235], v[72:75]
    ds_read_b128 v[192:195], v3 offset:16384
    v_mfma_f32_16x16x32_bf16 v[76:79], v[196:199], v[236:239], v[76:79]
    v_exp_f32 v129, v129
    v_mfma_f32_16x16x32_bf16 v[80:83], v[200:203], v[232:235], v[80:83]
    ds_read_b128 v[196:199], v3 offset:17408
    v_cvt_pk_bf16_f32 v224, v128, v129
    v_mfma_f32_16x16x32_bf16 v[84:87], v[200:203], v[236:239], v[84:87]
    v_exp_f32 v130, v130
    v_mfma_f32_16x16x32_bf16 v[88:91], v[204:207], v[232:235], v[88:91]
    ds_read_b128 v[200:203], v3 offset:18432
    s_waitcnt lgkmcnt(3)
    v_mfma_f32_16x16x32_bf16 v[92:95], v[204:207], v[236:239], v[92:95]
    v_exp_f32 v131, v131
    v_mfma_f32_16x16x32_bf16 v[96:99], v[208:211], v[232:235], v[96:99]
    ds_read_b128 v[204:207], v3 offset:19456
    v_cvt_pk_bf16_f32 v225, v130, v131
    v_mfma_f32_16x16x32_bf16 v[100:103], v[208:211], v[236:239], v[100:103]
    v_exp_f32 v136, v136
    v_mfma_f32_16x16x32_bf16 v[104:107], v[212:215], v[232:235], v[104:107]
    ds_read_b128 v[208:211], v3 offset:20480
    v_mfma_f32_16x16x32_bf16 v[108:111], v[212:215], v[236:239], v[108:111]
    v_exp_f32 v137, v137
    v_mfma_f32_16x16x32_bf16 v[112:115], v[216:219], v[232:235], v[112:115]
    ds_read_b128 v[212:215], v3 offset:21504
    v_cvt_pk_bf16_f32 v226, v136, v137
    v_mfma_f32_16x16x32_bf16 v[116:119], v[216:219], v[236:239], v[116:119]
    v_exp_f32 v138, v138
    v_mfma_f32_16x16x32_bf16 v[120:123], v[220:223], v[232:235], v[120:123]
    ds_read_b128 v[216:219], v3 offset:22528
    v_mfma_f32_16x16x32_bf16 v[124:127], v[220:223], v[236:239], v[124:127]
    v_exp_f32 v139, v139
    v_mfma_f32_16x16x32_bf16 v[240:243], v[248:251], v[232:235], v[240:243]
    ds_read_b128 v[220:223], v3 offset:23552
    v_cvt_pk_bf16_f32 v227, v138, v139
    v_mfma_f32_16x16x32_bf16 v[244:247], v[248:251], v[236:239], v[244:247]
    s_waitcnt lgkmcnt(4)
    v_mov_b32 v2, v3
    v_add_u32 v3, s40, v1
p2_kernel_lofast_finalE:
    s_waitcnt vmcnt(0)
    s_barrier
    s_min_u32 s28, s43, 31
    s_lshl_b32 s28, s28, 15
    s_add_u32 s28, s28, s13
    s_lshl_b32 s16, s17, 13
    s_add_u32 m0, s41, s16
    s_add_u32 s43, s43, 1
    buffer_load_dwordx4 v1, s[4:7], s28 offen offset:0 lds
    buffer_load_dwordx4 v1, s[4:7], s28 offen offset:1024 lds
    buffer_load_dwordx4 v1, s[4:7], s28 offen offset:2048 lds
    buffer_load_dwordx4 v1, s[4:7], s28 offen offset:3072 lds
    s_add_u32 m0, m0, 4096
    s_add_u32 s28, s28, 4096
    buffer_load_dwordx4 v1, s[4:7], s28 offen offset:0 lds
    buffer_load_dwordx4 v1, s[4:7], s28 offen offset:1024 lds
    buffer_load_dwordx4 v1, s[4:7], s28 offen offset:2048 lds
    buffer_load_dwordx4 v1, s[4:7], s28 offen offset:3072 lds
    s_add_u32 s41, s41, 0x8000
    s_cmp_eq_u32 s41, 0x28000
    s_cselect_b32 s41, 0, s41
    s_min_u32 s28, s43, 31
    s_lshl_b32 s28, s28, 15
    s_add_u32 s28, s28, s13
    s_lshl_b32 s16, s17, 13
    s_add_u32 m0, s41, s16
    s_add_u32 s43, s43, 1
    buffer_load_dwordx4 v1, s[4:7], s28 offen offset:0 lds
    buffer_load_dwordx4 v1, s[4:7], s28 offen offset:1024 lds
    buffer_load_dwordx4 v1, s[4:7], s28 offen offset:2048 lds
    buffer_load_dwordx4 v1, s[4:7], s28 offen offset:3072 lds
    s_add_u32 m0, m0, 4096
    s_add_u32 s28, s28, 4096
    buffer_load_dwordx4 v1, s[4:7], s28 offen offset:0 lds
    buffer_load_dwordx4 v1, s[4:7], s28 offen offset:1024 lds
    buffer_load_dwordx4 v1, s[4:7], s28 offen offset:2048 lds
    buffer_load_dwordx4 v1, s[4:7], s28 offen offset:3072 lds
    s_add_u32 s41, s41, 0x8000
    s_cmp_eq_u32 s41, 0x28000
    s_cselect_b32 s41, 0, s41
    s_branch p2_kernel_lofast_final
p2_kernel_lofast_peelO:
    s_waitcnt vmcnt(0)
    s_barrier
    s_min_u32 s28, s43, 31
    s_lshl_b32 s28, s28, 15
    s_add_u32 s28, s28, s13
    s_lshl_b32 s16, s17, 13
    s_add_u32 m0, s41, s16
    s_add_u32 s43, s43, 1
    buffer_load_dwordx4 v1, s[4:7], s28 offen offset:0 lds
    buffer_load_dwordx4 v1, s[4:7], s28 offen offset:1024 lds
    buffer_load_dwordx4 v1, s[4:7], s28 offen offset:2048 lds
    buffer_load_dwordx4 v1, s[4:7], s28 offen offset:3072 lds
    s_add_u32 m0, m0, 4096
    s_add_u32 s28, s28, 4096
    buffer_load_dwordx4 v1, s[4:7], s28 offen offset:0 lds
    buffer_load_dwordx4 v1, s[4:7], s28 offen offset:1024 lds
    buffer_load_dwordx4 v1, s[4:7], s28 offen offset:2048 lds
    buffer_load_dwordx4 v1, s[4:7], s28 offen offset:3072 lds
    s_add_u32 s41, s41, 0x8000
    s_cmp_eq_u32 s41, 0x28000
    s_cselect_b32 s41, 0, s41
    s_min_u32 s28, s43, 31
    s_lshl_b32 s28, s28, 15
    s_add_u32 s28, s28, s13
    s_lshl_b32 s16, s17, 13
    s_add_u32 m0, s41, s16
    s_add_u32 s43, s43, 1
    buffer_load_dwordx4 v1, s[4:7], s28 offen offset:0 lds
    buffer_load_dwordx4 v1, s[4:7], s28 offen offset:1024 lds
    buffer_load_dwordx4 v1, s[4:7], s28 offen offset:2048 lds
    buffer_load_dwordx4 v1, s[4:7], s28 offen offset:3072 lds
    s_add_u32 m0, m0, 4096
    s_add_u32 s28, s28, 4096
    buffer_load_dwordx4 v1, s[4:7], s28 offen offset:0 lds
    buffer_load_dwordx4 v1, s[4:7], s28 offen offset:1024 lds
    buffer_load_dwordx4 v1, s[4:7], s28 offen offset:2048 lds
    buffer_load_dwordx4 v1, s[4:7], s28 offen offset:3072 lds
    s_add_u32 s41, s41, 0x8000
    s_cmp_eq_u32 s41, 0x28000
    s_cselect_b32 s41, 0, s41
    v_cmp_le_i32 s[20:21], 0, v18
    v_cmp_le_i32 s[22:23], 1, v18
    v_cmp_le_i32 s[24:25], 2, v18
    v_cmp_le_i32 s[26:27], 3, v18
    v_cndmask_b32 v160, v19, v160, s[20:21]
    v_cndmask_b32 v161, v19, v161, s[22:23]
    v_cndmask_b32 v162, v19, v162, s[24:25]
    v_cndmask_b32 v163, v19, v163, s[26:27]
    v_cmp_le_i32 s[20:21], -16, v18
    v_cmp_le_i32 s[22:23], -15, v18
    v_cmp_le_i32 s[24:25], -14, v18
    v_cmp_le_i32 s[26:27], -13, v18
    v_cndmask_b32 v164, v19, v164, s[20:21]
    v_cndmask_b32 v165, v19, v165, s[22:23]
    v_cndmask_b32 v166, v19, v166, s[24:25]
    v_cndmask_b32 v167, v19, v167, s[26:27]
    v_cmp_le_i32 s[20:21], 16, v18
    v_cmp_le_i32 s[22:23], 17, v18
    v_cmp_le_i32 s[24:25], 18, v18
    v_cmp_le_i32 s[26:27], 19, v18
    v_cndmask_b32 v168, v19, v168, s[20:21]
    v_cndmask_b32 v169, v19, v169, s[22:23]
    v_cndmask_b32 v170, v19, v170, s[24:25]
    v_cndmask_b32 v171, v19, v171, s[26:27]
    v_cmp_le_i32 s[20:21], 0, v18
    v_cmp_le_i32 s[22:23], 1, v18
    v_cmp_le_i32 s[24:25], 2, v18
    v_cmp_le_i32 s[26:27], 3, v18
    v_cndmask_b32 v172, v19, v172, s[20:21]
    v_cndmask_b32 v173, v19, v173, s[22:23]
    v_cndmask_b32 v174, v19, v174, s[24:25]
    v_cndmask_b32 v175, v19, v175, s[26:27]
    s_nop 1
    v_mfma_f32_16x16x32_bf16 v[144:147], v[192:195], v[32:35], v[176:179]
    v_exp_f32 v132, v132
    v_mfma_f32_16x16x32_bf16 v[144:147], v[196:199], v[36:39], v[144:147]
    v_exp_f32 v133, v133
    v_mfma_f32_16x16x32_bf16 v[144:147], v[200:203], v[40:43], v[144:147]
    v_exp_f32 v134, v134
    v_mfma_f32_16x16x32_bf16 v[144:147], v[204:207], v[44:47], v[144:147]
    v_exp_f32 v135, v135
    v_mfma_f32_16x16x32_bf16 v[148:151], v[192:195], v[48:51], v[180:183]
    v_exp_f32 v140, v140
    v_mfma_f32_16x16x32_bf16 v[148:151], v[196:199], v[52:55], v[148:151]
    ds_read_b128 v[192:195], v2 offset:8192
    v_cvt_pk_bf16_f32 v228, v132, v133
    v_mfma_f32_16x16x32_bf16 v[148:151], v[200:203], v[56:59], v[148:151]
    ds_read_b128 v[196:199], v2 offset:9216
    v_cvt_pk_bf16_f32 v229, v134, v135
    v_mfma_f32_16x16x32_bf16 v[148:151], v[204:207], v[60:63], v[148:151]
    ds_read_b128 v[200:203], v2 offset:10240
    s_waitcnt lgkmcnt(3)
    v_mfma_f32_16x16x32_bf16 v[152:155], v[208:211], v[32:35], v[184:187]
    ds_read_b128 v[204:207], v2 offset:11264
    v_mfma_f32_16x16x32_bf16 v[152:155], v[212:215], v[36:39], v[152:155]
    v_exp_f32 v141, v141
    v_mfma_f32_16x16x32_bf16 v[152:155], v[216:219], v[40:43], v[152:155]
    v_exp_f32 v142, v142
    v_mfma_f32_16x16x32_bf16 v[152:155], v[220:223], v[44:47], v[152:155]
    v_exp_f32 v143, v143
    v_mfma_f32_16x16x32_bf16 v[156:159], v[208:211], v[48:51], v[188:191]
    v_mfma_f32_16x16x32_bf16 v[156:159], v[212:215], v[52:55], v[156:159]
    ds_read_b128 v[208:211], v2 offset:12288
    v_cvt_pk_bf16_f32 v230, v140, v141
    v_mfma_f32_16x16x32_bf16 v[156:159], v[216:219], v[56:59], v[156:159]
    ds_read_b128 v[212:215], v2 offset:13312
    v_cvt_pk_bf16_f32 v231, v142, v143
    v_mfma_f32_16x16x32_bf16 v[156:159], v[220:223], v[60:63], v[156:159]
    ds_read_b128 v[216:219], v2 offset:14336
    s_waitcnt lgkmcnt(3)
    v_mfma_f32_16x16x32_bf16 v[64:67], v[192:195], v[224:227], v[64:67]
    ds_read_b128 v[220:223], v2 offset:15360
    v_mfma_f32_16x16x32_bf16 v[68:71], v[192:195], v[228:231], v[68:71]
    v_exp_f32 v144, v144
    v_mfma_f32_16x16x32_bf16 v[72:75], v[196:199], v[224:227], v[72:75]
    ds_read_b128 v[192:195], v3 offset:0
    v_mfma_f32_16x16x32_bf16 v[76:79], v[196:199], v[228:231], v[76:79]
    v_exp_f32 v145, v145
    v_mfma_f32_16x16x32_bf16 v[80:83], v[200:203], v[224:227], v[80:83]
    ds_read_b128 v[196:199], v3 offset:1024
    v_cvt_pk_bf16_f32 v232, v144, v145
    v_mfma_f32_16x16x32_bf16 v[84:87], v[200:203], v[228:231], v[84:87]
    v_exp_f32 v146, v146
    v_mfma_f32_16x16x32_bf16 v[88:91], v[204:207], v[224:227], v[88:91]
    ds_read_b128 v[200:203], v3 offset:2048
    s_waitcnt lgkmcnt(3)
    v_mfma_f32_16x16x32_bf16 v[92:95], v[204:207], v[228:231], v[92:95]
    v_exp_f32 v147, v147
    v_mfma_f32_16x16x32_bf16 v[96:99], v[208:211], v[224:227], v[96:99]
    ds_read_b128 v[204:207], v3 offset:3072
    v_cvt_pk_bf16_f32 v233, v146, v147
    v_mfma_f32_16x16x32_bf16 v[100:103], v[208:211], v[228:231], v[100:103]
    v_exp_f32 v152, v152
    v_mfma_f32_16x16x32_bf16 v[104:107], v[212:215], v[224:227], v[104:107]
    ds_read_b128 v[208:211], v3 offset:4096
    v_mfma_f32_16x16x32_bf16 v[108:111], v[212:215], v[228:231], v[108:111]
    v_exp_f32 v153, v153
    v_mfma_f32_16x16x32_bf16 v[112:115], v[216:219], v[224:227], v[112:115]
    ds_read_b128 v[212:215], v3 offset:5120
    v_cvt_pk_bf16_f32 v234, v152, v153
    v_mfma_f32_16x16x32_bf16 v[116:119], v[216:219], v[228:231], v[116:119]
    v_exp_f32 v154, v154
    v_mfma_f32_16x16x32_bf16 v[120:123], v[220:223], v[224:227], v[120:123]
    ds_read_b128 v[216:219], v3 offset:6144
    v_mfma_f32_16x16x32_bf16 v[124:127], v[220:223], v[228:231], v[124:127]
    v_exp_f32 v155, v155
    v_mfma_f32_16x16x32_bf16 v[240:243], v[248:251], v[224:227], v[240:243]
    ds_read_b128 v[220:223], v3 offset:7168
    v_cvt_pk_bf16_f32 v235, v154, v155
    v_mfma_f32_16x16x32_bf16 v[244:247], v[248:251], v[228:231], v[244:247]
    s_waitcnt lgkmcnt(4)
    v_mfma_f32_16x16x32_bf16 v[128:131], v[192:195], v[32:35], v[160:163]
    v_exp_f32 v148, v148
    v_mfma_f32_16x16x32_bf16 v[128:131], v[196:199], v[36:39], v[128:131]
    v_exp_f32 v149, v149
    v_mfma_f32_16x16x32_bf16 v[128:131], v[200:203], v[40:43], v[128:131]
    v_exp_f32 v150, v150
    v_mfma_f32_16x16x32_bf16 v[128:131], v[204:207], v[44:47], v[128:131]
    v_exp_f32 v151, v151
    v_mfma_f32_16x16x32_bf16 v[132:135], v[192:195], v[48:51], v[164:167]
    v_exp_f32 v156, v156
    v_mfma_f32_16x16x32_bf16 v[132:135], v[196:199], v[52:55], v[132:135]
    ds_read_b128 v[192:195], v2 offset:24576
    v_cvt_pk_bf16_f32 v236, v148, v149
    v_mfma_f32_16x16x32_bf16 v[132:135], v[200:203], v[56:59], v[132:135]
    ds_read_b128 v[196:199], v2 offset:25600
    v_cvt_pk_bf16_f32 v237, v150, v151
    v_mfma_f32_16x16x32_bf16 v[132:135], v[204:207], v[60:63], v[132:135]
    ds_read_b128 v[200:203], v2 offset:26624
    s_waitcnt lgkmcnt(3)
    v_mfma_f32_16x16x32_bf16 v[136:139], v[208:211], v[32:35], v[168:171]
    ds_read_b128 v[204:207], v2 offset:27648
    s_add_u32 s8, s8, 1
    v_mfma_f32_16x16x32_bf16 v[136:139], v[212:215], v[36:39], v[136:139]
    v_exp_f32 v157, v157
    v_mfma_f32_16x16x32_bf16 v[136:139], v[216:219], v[40:43], v[136:139]
    v_exp_f32 v158, v158
    v_mfma_f32_16x16x32_bf16 v[136:139], v[220:223], v[44:47], v[136:139]
    v_exp_f32 v159, v159
    v_mfma_f32_16x16x32_bf16 v[140:143], v[208:211], v[48:51], v[172:175]
    s_add_u32 s40, s40, 0x8000
    s_cmp_eq_u32 s40, 0x28000
    v_mfma_f32_16x16x32_bf16 v[140:143], v[212:215], v[52:55], v[140:143]
    ds_read_b128 v[208:211], v2 offset:28672
    v_cvt_pk_bf16_f32 v238, v156, v157
    v_mfma_f32_16x16x32_bf16 v[140:143], v[216:219], v[56:59], v[140:143]
    ds_read_b128 v[212:215], v2 offset:29696
    v_cvt_pk_bf16_f32 v239, v158, v159
    v_mfma_f32_16x16x32_bf16 v[140:143], v[220:223], v[60:63], v[140:143]
    ds_read_b128 v[216:219], v2 offset:30720
    s_waitcnt lgkmcnt(3)
    v_mfma_f32_16x16x32_bf16 v[64:67], v[192:195], v[232:235], v[64:67]
    ds_read_b128 v[220:223], v2 offset:31744
    s_cselect_b32 s40, 0, s40
    v_mfma_f32_16x16x32_bf16 v[68:71], v[192:195], v[236:239], v[68:71]
    v_exp_f32 v128, v128
    v_mfma_f32_16x16x32_bf16 v[72:75], v[196:199], v[232:235], v[72:75]
    ds_read_b128 v[192:195], v3 offset:16384
    v_mfma_f32_16x16x32_bf16 v[76:79], v[196:199], v[236:239], v[76:79]
    v_exp_f32 v129, v129
    v_mfma_f32_16x16x32_bf16 v[80:83], v[200:203], v[232:235], v[80:83]
    ds_read_b128 v[196:199], v3 offset:17408
    v_cvt_pk_bf16_f32 v224, v128, v129
    v_mfma_f32_16x16x32_bf16 v[84:87], v[200:203], v[236:239], v[84:87]
    v_exp_f32 v130, v130
    v_mfma_f32_16x16x32_bf16 v[88:91], v[204:207], v[232:235], v[88:91]
    ds_read_b128 v[200:203], v3 offset:18432
    s_waitcnt lgkmcnt(3)
    v_mfma_f32_16x16x32_bf16 v[92:95], v[204:207], v[236:239], v[92:95]
    v_exp_f32 v131, v131
    v_mfma_f32_16x16x32_bf16 v[96:99], v[208:211], v[232:235], v[96:99]
    ds_read_b128 v[204:207], v3 offset:19456
    v_cvt_pk_bf16_f32 v225, v130, v131
    v_mfma_f32_16x16x32_bf16 v[100:103], v[208:211], v[236:239], v[100:103]
    v_exp_f32 v136, v136
    v_mfma_f32_16x16x32_bf16 v[104:107], v[212:215], v[232:235], v[104:107]
    ds_read_b128 v[208:211], v3 offset:20480
    v_mfma_f32_16x16x32_bf16 v[108:111], v[212:215], v[236:239], v[108:111]
    v_exp_f32 v137, v137
    v_mfma_f32_16x16x32_bf16 v[112:115], v[216:219], v[232:235], v[112:115]
    ds_read_b128 v[212:215], v3 offset:21504
    v_cvt_pk_bf16_f32 v226, v136, v137
    v_mfma_f32_16x16x32_bf16 v[116:119], v[216:219], v[236:239], v[116:119]
    v_exp_f32 v138, v138
    v_mfma_f32_16x16x32_bf16 v[120:123], v[220:223], v[232:235], v[120:123]
    ds_read_b128 v[216:219], v3 offset:22528
    v_mfma_f32_16x16x32_bf16 v[124:127], v[220:223], v[236:239], v[124:127]
    v_exp_f32 v139, v139
    v_mfma_f32_16x16x32_bf16 v[240:243], v[248:251], v[232:235], v[240:243]
    ds_read_b128 v[220:223], v3 offset:23552
    v_cvt_pk_bf16_f32 v227, v138, v139
    v_mfma_f32_16x16x32_bf16 v[244:247], v[248:251], v[236:239], v[244:247]
    s_waitcnt lgkmcnt(4)
    v_mov_b32 v2, v3
    v_add_u32 v3, s40, v1
p2_kernel_lofast_final:
    s_bitcmp1_b32 s18, 0
    s_cbranch_scc0 p2_kernel_lofast_fshort
    v_cmp_le_i32 s[20:21], 32, v18
    v_cmp_le_i32 s[22:23], 33, v18
    v_cmp_le_i32 s[24:25], 34, v18
    v_cmp_le_i32 s[26:27], 35, v18
    v_cndmask_b32 v176, v19, v176, s[20:21]
    v_cndmask_b32 v177, v19, v177, s[22:23]
    v_cndmask_b32 v178, v19, v178, s[24:25]
    v_cndmask_b32 v179, v19, v179, s[26:27]
    v_cmp_le_i32 s[20:21], 16, v18
    v_cmp_le_i32 s[22:23], 17, v18
    v_cmp_le_i32 s[24:25], 18, v18
    v_cmp_le_i32 s[26:27], 19, v18
    v_cndmask_b32 v180, v19, v180, s[20:21]
    v_cndmask_b32 v181, v19, v181, s[22:23]
    v_cndmask_b32 v182, v19, v182, s[24:25]
    v_cndmask_b32 v183, v19, v183, s[26:27]
    v_cmp_le_i32 s[20:21], 48, v18
    v_cmp_le_i32 s[22:23], 49, v18
    v_cmp_le_i32 s[24:25], 50, v18
    v_cmp_le_i32 s[26:27], 51, v18
    v_cndmask_b32 v184, v19, v184, s[20:21]
    v_cndmask_b32 v185, v19, v185, s[22:23]
    v_cndmask_b32 v186, v19, v186, s[24:25]
    v_cndmask_b32 v187, v19, v187, s[26:27]
    v_cmp_le_i32 s[20:21], 32, v18
    v_cmp_le_i32 s[22:23], 33, v18
    v_cmp_le_i32 s[24:25], 34, v18
    v_cmp_le_i32 s[26:27], 35, v18
    v_cndmask_b32 v188, v19, v188, s[20:21]
    v_cndmask_b32 v189, v19, v189, s[22:23]
    v_cndmask_b32 v190, v19, v190, s[24:25]
    v_cndmask_b32 v191, v19, v191, s[26:27]
    s_nop 1
    v_mfma_f32_16x16x32_bf16 v[144:147], v[192:195], v[32:35], v[176:179]
    v_exp_f32 v132, v132
    v_mfma_f32_16x16x32_bf16 v[144:147], v[196:199], v[36:39], v[144:147]
    v_exp_f32 v133, v133
    v_mfma_f32_16x16x32_bf16 v[144:147], v[200:203], v[40:43], v[144:147]
    v_exp_f32 v134, v134
    v_mfma_f32_16x16x32_bf16 v[144:147], v[204:207], v[44:47], v[144:147]
    v_exp_f32 v135, v135
    v_mfma_f32_16x16x32_bf16 v[148:151], v[192:195], v[48:51], v[180:183]
    v_exp_f32 v140, v140
    v_mfma_f32_16x16x32_bf16 v[148:151], v[196:199], v[52:55], v[148:151]
    ds_read_b128 v[192:195], v2 offset:8192
    v_cvt_pk_bf16_f32 v228, v132, v133
    v_mfma_f32_16x16x32_bf16 v[148:151], v[200:203], v[56:59], v[148:151]
    ds_read_b128 v[196:199], v2 offset:9216
    v_cvt_pk_bf16_f32 v229, v134, v135
    v_mfma_f32_16x16x32_bf16 v[148:151], v[204:207], v[60:63], v[148:151]
    ds_read_b128 v[200:203], v2 offset:10240
    s_waitcnt lgkmcnt(3)
    v_mfma_f32_16x16x32_bf16 v[152:155], v[208:211], v[32:35], v[184:187]
    ds_read_b128 v[204:207], v2 offset:11264
    v_mfma_f32_16x16x32_bf16 v[152:155], v[212:215], v[36:39], v[152:155]
    v_exp_f32 v141, v141
    v_mfma_f32_16x16x32_bf16 v[152:155], v[216:219], v[40:43], v[152:155]
    v_exp_f32 v142, v142
    v_mfma_f32_16x16x32_bf16 v[152:155], v[220:223], v[44:47], v[152:155]
    v_exp_f32 v143, v143
    v_mfma_f32_16x16x32_bf16 v[156:159], v[208:211], v[48:51], v[188:191]
    v_mfma_f32_16x16x32_bf16 v[156:159], v[212:215], v[52:55], v[156:159]
    ds_read_b128 v[208:211], v2 offset:12288
    v_cvt_pk_bf16_f32 v230, v140, v141
    v_mfma_f32_16x16x32_bf16 v[156:159], v[216:219], v[56:59], v[156:159]
    ds_read_b128 v[212:215], v2 offset:13312
    v_cvt_pk_bf16_f32 v231, v142, v143
    v_mfma_f32_16x16x32_bf16 v[156:159], v[220:223], v[60:63], v[156:159]
    ds_read_b128 v[216:219], v2 offset:14336
    s_waitcnt lgkmcnt(3)
    v_mfma_f32_16x16x32_bf16 v[64:67], v[192:195], v[224:227], v[64:67]
    ds_read_b128 v[220:223], v2 offset:15360
    v_mfma_f32_16x16x32_bf16 v[68:71], v[192:195], v[228:231], v[68:71]
    v_exp_f32 v144, v144
    v_mfma_f32_16x16x32_bf16 v[72:75], v[196:199], v[224:227], v[72:75]
    v_mfma_f32_16x16x32_bf16 v[76:79], v[196:199], v[228:231], v[76:79]
    v_exp_f32 v145, v145
    v_mfma_f32_16x16x32_bf16 v[80:83], v[200:203], v[224:227], v[80:83]
    v_cvt_pk_bf16_f32 v232, v144, v145
    v_mfma_f32_16x16x32_bf16 v[84:87], v[200:203], v[228:231], v[84:87]
    v_exp_f32 v146, v146
    v_mfma_f32_16x16x32_bf16 v[88:91], v[204:207], v[224:227], v[88:91]
    s_waitcnt lgkmcnt(0)
    v_mfma_f32_16x16x32_bf16 v[92:95], v[204:207], v[228:231], v[92:95]
    v_exp_f32 v147, v147
    v_mfma_f32_16x16x32_bf16 v[96:99], v[208:211], v[224:227], v[96:99]
    v_cvt_pk_bf16_f32 v233, v146, v147
    v_mfma_f32_16x16x32_bf16 v[100:103], v[208:211], v[228:231], v[100:103]
    v_exp_f32 v152, v152
    v_mfma_f32_16x16x32_bf16 v[104:107], v[212:215], v[224:227], v[104:107]
    v_mfma_f32_16x16x32_bf16 v[108:111], v[212:215], v[228:231], v[108:111]
    v_exp_f32 v153, v153
    v_mfma_f32_16x16x32_bf16 v[112:115], v[216:219], v[224:227], v[112:115]
    v_cvt_pk_bf16_f32 v234, v152, v153
    v_mfma_f32_16x16x32_bf16 v[116:119], v[216:219], v[228:231], v[116:119]
    v_exp_f32 v154, v154
    v_mfma_f32_16x16x32_bf16 v[120:123], v[220:223], v[224:227], v[120:123]
    v_mfma_f32_16x16x32_bf16 v[124:127], v[220:223], v[228:231], v[124:127]
    v_exp_f32 v155, v155
    v_mfma_f32_16x16x32_bf16 v[240:243], v[248:251], v[224:227], v[240:243]
    v_cvt_pk_bf16_f32 v235, v154, v155
    v_mfma_f32_16x16x32_bf16 v[244:247], v[248:251], v[228:231], v[244:247]
    v_exp_f32 v148, v148
    v_exp_f32 v149, v149
    v_exp_f32 v150, v150
    v_exp_f32 v151, v151
    v_exp_f32 v156, v156
    s_nop 0
    ds_read_b128 v[192:195], v2 offset:24576
    v_cvt_pk_bf16_f32 v236, v148, v149
    ds_read_b128 v[196:199], v2 offset:25600
    v_cvt_pk_bf16_f32 v237, v150, v151
    ds_read_b128 v[200:203], v2 offset:26624
    ds_read_b128 v[204:207], v2 offset:27648
    v_exp_f32 v157, v157
    v_exp_f32 v158, v158
    v_exp_f32 v159, v159
    s_nop 0
    s_nop 0
    ds_read_b128 v[208:211], v2 offset:28672
    v_cvt_pk_bf16_f32 v238, v156, v157
    ds_read_b128 v[212:215], v2 offset:29696
    v_cvt_pk_bf16_f32 v239, v158, v159
    ds_read_b128 v[216:219], v2 offset:30720
    s_waitcnt lgkmcnt(3)
    v_mfma_f32_16x16x32_bf16 v[64:67], v[192:195], v[232:235], v[64:67]
    ds_read_b128 v[220:223], v2 offset:31744
    v_mfma_f32_16x16x32_bf16 v[68:71], v[192:195], v[236:239], v[68:71]
    v_mfma_f32_16x16x32_bf16 v[72:75], v[196:199], v[232:235], v[72:75]
    v_mfma_f32_16x16x32_bf16 v[76:79], v[196:199], v[236:239], v[76:79]
    v_mfma_f32_16x16x32_bf16 v[80:83], v[200:203], v[232:235], v[80:83]
    v_mfma_f32_16x16x32_bf16 v[84:87], v[200:203], v[236:239], v[84:87]
    v_mfma_f32_16x16x32_bf16 v[88:91], v[204:207], v[232:235], v[88:91]
    s_waitcnt lgkmcnt(0)
    v_mfma_f32_16x16x32_bf16 v[92:95], v[204:207], v[236:239], v[92:95]
    v_mfma_f32_16x16x32_bf16 v[96:99], v[208:211], v[232:235], v[96:99]
    v_mfma_f32_16x16x32_bf16 v[100:103], v[208:211], v[236:239], v[100:103]
    v_mfma_f32_16x16x32_bf16 v[104:107], v[212:215], v[232:235], v[104:107]
    v_mfma_f32_16x16x32_bf16 v[108:111], v[212:215], v[236:239], v[108:111]
    v_mfma_f32_16x16x32_bf16 v[112:115], v[216:219], v[232:235], v[112:115]
    v_mfma_f32_16x16x32_bf16 v[116:119], v[216:219], v[236:239], v[116:119]
    v_mfma_f32_16x16x32_bf16 v[120:123], v[220:223], v[232:235], v[120:123]
    v_mfma_f32_16x16x32_bf16 v[124:127], v[220:223], v[236:239], v[124:127]
    v_mfma_f32_16x16x32_bf16 v[240:243], v[248:251], v[232:235], v[240:243]
    v_mfma_f32_16x16x32_bf16 v[244:247], v[248:251], v[236:239], v[244:247]
    s_branch p2_kernel_lofast_fdone
p2_kernel_lofast_fshort:
    s_waitcnt lgkmcnt(0)
    v_exp_f32 v132, v132
    v_exp_f32 v133, v133
    v_exp_f32 v134, v134
    v_exp_f32 v135, v135
    v_exp_f32 v140, v140
    s_nop 0
    ds_read_b128 v[192:195], v2 offset:8192
    v_cvt_pk_bf16_f32 v228, v132, v133
    ds_read_b128 v[196:199], v2 offset:9216
    v_cvt_pk_bf16_f32 v229, v134, v135
    ds_read_b128 v[200:203], v2 offset:10240
    ds_read_b128 v[204:207], v2 offset:11264
    v_exp_f32 v141, v141
    v_exp_f32 v142, v142
    v_exp_f32 v143, v143
    s_nop 0
    s_nop 0
    ds_read_b128 v[208:211], v2 offset:12288
    v_cvt_pk_bf16_f32 v230, v140, v141
    ds_read_b128 v[212:215], v2 offset:13312
    v_cvt_pk_bf16_f32 v231, v142, v143
    ds_read_b128 v[216:219], v2 offset:14336
    s_waitcnt lgkmcnt(3)
    v_mfma_f32_16x16x32_bf16 v[64:67], v[192:195], v[224:227], v[64:67]
    ds_read_b128 v[220:223], v2 offset:15360
    v_mfma_f32_16x16x32_bf16 v[68:71], v[192:195], v[228:231], v[68:71]
    v_mfma_f32_16x16x32_bf16 v[72:75], v[196:199], v[224:227], v[72:75]
    v_mfma_f32_16x16x32_bf16 v[76:79], v[196:199], v[228:231], v[76:79]
    v_mfma_f32_16x16x32_bf16 v[80:83], v[200:203], v[224:227], v[80:83]
    v_mfma_f32_16x16x32_bf16 v[84:87], v[200:203], v[228:231], v[84:87]
    v_mfma_f32_16x16x32_bf16 v[88:91], v[204:207], v[224:227], v[88:91]
    s_waitcnt lgkmcnt(0)
    v_mfma_f32_16x16x32_bf16 v[92:95], v[204:207], v[228:231], v[92:95]
    v_mfma_f32_16x16x32_bf16 v[96:99], v[208:211], v[224:227], v[96:99]
    v_mfma_f32_16x16x32_bf16 v[100:103], v[208:211], v[228:231], v[100:103]
    v_mfma_f32_16x16x32_bf16 v[104:107], v[212:215], v[224:227], v[104:107]
    v_mfma_f32_16x16x32_bf16 v[108:111], v[212:215], v[228:231], v[108:111]
    v_mfma_f32_16x16x32_bf16 v[112:115], v[216:219], v[224:227], v[112:115]
    v_mfma_f32_16x16x32_bf16 v[116:119], v[216:219], v[228:231], v[116:119]
    v_mfma_f32_16x16x32_bf16 v[120:123], v[220:223], v[224:227], v[120:123]
    v_mfma_f32_16x16x32_bf16 v[124:127], v[220:223], v[228:231], v[124:127]
    v_mfma_f32_16x16x32_bf16 v[240:243], v[248:251], v[224:227], v[240:243]
    v_mfma_f32_16x16x32_bf16 v[244:247], v[248:251], v[228:231], v[244:247]
p2_kernel_lofast_fdone:
    s_nop 7
    v_rcp_f32 v8, v240
    v_rcp_f32 v9, v244
    v_mul_f32 v10, 0, v240
    v_mul_f32 v11, 0, v244
    s_mov_b32 s36, 0x71800000
    v_cmp_nge_f32 s[20:21], s36, v240
    v_cmp_nge_f32 s[22:23], s36, v244
    s_nop 0
    s_lshl_b32 s36, s18, 1
    s_mul_i32 s36, s36, 171
    s_lshl_b32 s37, s12, 2
    s_add_u32 s36, s36, s37
    s_lshl_b32 s36, s36, 10
    s_add_u32 s36, s36, 0x3000000
    v_mul_f32 v64, v64, v8
    v_mul_f32 v65, v65, v8
    v_mul_f32 v66, v66, v8
    v_mul_f32 v67, v67, v8
    v_fma_f32 v10, v64, 0, v10
    v_fma_f32 v11, v65, 0, v11
    v_fma_f32 v10, v66, 0, v10
    v_fma_f32 v11, v67, 0, v11
    v_cvt_pk_bf16_f32 v192, v64, v65
    v_cvt_pk_bf16_f32 v193, v66, v67
    v_mul_f32 v72, v72, v8
    v_mul_f32 v73, v73, v8
    v_mul_f32 v74, v74, v8
    v_mul_f32 v75, v75, v8
    v_fma_f32 v10, v72, 0, v10
    v_fma_f32 v11, v73, 0, v11
    v_fma_f32 v10, v74, 0, v10
    v_fma_f32 v11, v75, 0, v11
    v_cvt_pk_bf16_f32 v194, v72, v73
    v_cvt_pk_bf16_f32 v195, v74, v75
    buffer_store_dwordx4 v[192:195], v1, s[4:7], s36 offen offset:0 sc1
    v_mul_f32 v80, v80, v8
    v_mul_f32 v81, v81, v8
    v_mul_f32 v82, v82, v8
    v_mul_f32 v83, v83, v8
    v_fma_f32 v10, v80, 0, v10
    v_fma_f32 v11, v81, 0, v11
    v_fma_f32 v10, v82, 0, v10
    v_fma_f32 v11, v83, 0, v11
    v_cvt_pk_bf16_f32 v196, v80, v81
    v_cvt_pk_bf16_f32 v197, v82, v83
    v_mul_f32 v88, v88, v8
    v_mul_f32 v89, v89, v8
    v_mul_f32 v90, v90, v8
    v_mul_f32 v91, v91, v8
    v_fma_f32 v10, v88, 0, v10
    v_fma_f32 v11, v89, 0, v11
    v_fma_f32 v10, v90, 0, v10
    v_fma_f32 v11, v91, 0, v11
    v_cvt_pk_bf16_f32 v198, v88, v89
    v_cvt_pk_bf16_f32 v199, v90, v91
    buffer_store_dwordx4 v[196:199], v1, s[4:7], s36 offen offset:1024 sc1
    v_mul_f32 v96, v96, v8
    v_mul_f32 v97, v97, v8
    v_mul_f32 v98, v98, v8
    v_mul_f32 v99, v99, v8
    v_fma_f32 v10, v96, 0, v10
    v_fma_f32 v11, v97, 0, v11
    v_fma_f32 v10, v98, 0, v10
    v_fma_f32 v11, v99, 0, v11
    v_cvt_pk_bf16_f32 v200, v96, v97
    v_cvt_pk_bf16_f32 v201, v98, v99
    v_mul_f32 v104, v104, v8
    v_mul_f32 v105, v105, v8
    v_mul_f32 v106, v106, v8
    v_mul_f32 v107, v107, v8
    v_fma_f32 v10, v104, 0, v10
    v_fma_f32 v11, v105, 0, v11
    v_fma_f32 v10, v106, 0, v10
    v_fma_f32 v11, v107, 0, v11
    v_cvt_pk_bf16_f32 v202, v104, v105
    v_cvt_pk_bf16_f32 v203, v106, v107
    buffer_store_dwordx4 v[200:203], v1, s[4:7], s36 offen offset:2048 sc1
    v_mul_f32 v112, v112, v8
    v_mul_f32 v113, v113, v8
    v_mul_f32 v114, v114, v8
    v_mul_f32 v115, v115, v8
    v_fma_f32 v10, v112, 0, v10
    v_fma_f32 v11, v113, 0, v11
    v_fma_f32 v10, v114, 0, v10
    v_fma_f32 v11, v115, 0, v11
    v_cvt_pk_bf16_f32 v204, v112, v113
    v_cvt_pk_bf16_f32 v205, v114, v115
    v_mul_f32 v120, v120, v8
    v_mul_f32 v121, v121, v8
    v_mul_f32 v122, v122, v8
    v_mul_f32 v123, v123, v8
    v_fma_f32 v10, v120, 0, v10
    v_fma_f32 v11, v121, 0, v11
    v_fma_f32 v10, v122, 0, v10
    v_fma_f32 v11, v123, 0, v11
    v_cvt_pk_bf16_f32 v206, v120, v121
    v_cvt_pk_bf16_f32 v207, v122, v123
    buffer_store_dwordx4 v[204:207], v1, s[4:7], s36 offen offset:3072 sc1
    s_lshl_b32 s36, s18, 1
    s_add_u32 s36, s36, 1
    s_mul_i32 s36, s36, 171
    s_lshl_b32 s37, s12, 2
    s_add_u32 s36, s36, s37
    s_lshl_b32 s36, s36, 10
    s_add_u32 s36, s36, 0x3000000
    v_mul_f32 v68, v68, v9
    v_mul_f32 v69, v69, v9
    v_mul_f32 v70, v70, v9
    v_mul_f32 v71, v71, v9
    v_fma_f32 v10, v68, 0, v10
    v_fma_f32 v11, v69, 0, v11
    v_fma_f32 v10, v70, 0, v10
    v_fma_f32 v11, v71, 0, v11
    v_cvt_pk_bf16_f32 v208, v68, v69
    v_cvt_pk_bf16_f32 v209, v70, v71
    v_mul_f32 v76, v76, v9
    v_mul_f32 v77, v77, v9
    v_mul_f32 v78, v78, v9
    v_mul_f32 v79, v79, v9
    v_fma_f32 v10, v76, 0, v10
    v_fma_f32 v11, v77, 0, v11
    v_fma_f32 v10, v78, 0, v10
    v_fma_f32 v11, v79, 0, v11
    v_cvt_pk_bf16_f32 v210, v76, v77
    v_cvt_pk_bf16_f32 v211, v78, v79
    buffer_store_dwordx4 v[208:211], v1, s[4:7], s36 offen offset:0 sc1
    v_mul_f32 v84, v84, v9
    v_mul_f32 v85, v85, v9
    v_mul_f32 v86, v86, v9
    v_mul_f32 v87, v87, v9
    v_fma_f32 v10, v84, 0, v10
    v_fma_f32 v11, v85, 0, v11
    v_fma_f32 v10, v86, 0, v10
    v_fma_f32 v11, v87, 0, v11
    v_cvt_pk_bf16_f32 v212, v84, v85
    v_cvt_pk_bf16_f32 v213, v86, v87
    v_mul_f32 v92, v92, v9
    v_mul_f32 v93, v93, v9
    v_mul_f32 v94, v94, v9
    v_mul_f32 v95, v95, v9
    v_fma_f32 v10, v92, 0, v10
    v_fma_f32 v11, v93, 0, v11
    v_fma_f32 v10, v94, 0, v10
    v_fma_f32 v11, v95, 0, v11
    v_cvt_pk_bf16_f32 v214, v92, v93
    v_cvt_pk_bf16_f32 v215, v94, v95
    buffer_store_dwordx4 v[212:215], v1, s[4:7], s36 offen offset:1024 sc1
    v_mul_f32 v100, v100, v9
    v_mul_f32 v101, v101, v9
    v_mul_f32 v102, v102, v9
    v_mul_f32 v103, v103, v9
    v_fma_f32 v10, v100, 0, v10
    v_fma_f32 v11, v101, 0, v11
    v_fma_f32 v10, v102, 0, v10
    v_fma_f32 v11, v103, 0, v11
    v_cvt_pk_bf16_f32 v216, v100, v101
    v_cvt_pk_bf16_f32 v217, v102, v103
    v_mul_f32 v108, v108, v9
    v_mul_f32 v109, v109, v9
    v_mul_f32 v110, v110, v9
    v_mul_f32 v111, v111, v9
    v_fma_f32 v10, v108, 0, v10
    v_fma_f32 v11, v109, 0, v11
    v_fma_f32 v10, v110, 0, v10
    v_fma_f32 v11, v111, 0, v11
    v_cvt_pk_bf16_f32 v218, v108, v109
    v_cvt_pk_bf16_f32 v219, v110, v111
    buffer_store_dwordx4 v[216:219], v1, s[4:7], s36 offen offset:2048 sc1
    v_mul_f32 v116, v116, v9
    v_mul_f32 v117, v117, v9
    v_mul_f32 v118, v118, v9
    v_mul_f32 v119, v119, v9
    v_fma_f32 v10, v116, 0, v10
    v_fma_f32 v11, v117, 0, v11
    v_fma_f32 v10, v118, 0, v10
    v_fma_f32 v11, v119, 0, v11
    v_cvt_pk_bf16_f32 v220, v116, v117
    v_cvt_pk_bf16_f32 v221, v118, v119
    v_mul_f32 v124, v124, v9
    v_mul_f32 v125, v125, v9
    v_mul_f32 v126, v126, v9
    v_mul_f32 v127, v127, v9
    v_fma_f32 v10, v124, 0, v10
    v_fma_f32 v11, v125, 0, v11
    v_fma_f32 v10, v126, 0, v10
    v_fma_f32 v11, v127, 0, v11
    v_cvt_pk_bf16_f32 v222, v124, v125
    v_cvt_pk_bf16_f32 v223, v126, v127
    buffer_store_dwordx4 v[220:223], v1, s[4:7], s36 offen offset:3072 sc1
    v_add_f32 v10, v10, v11
    v_cmp_u_f32 vcc, v10, v10
    s_nop 4
    s_or_b64 vcc, vcc, s[20:21]
    s_or_b64 vcc, vcc, s[22:23]
    s_cmp_lg_u64 vcc, 0
    s_cselect_b32 s42, 1, 0
    s_add_u32 s8, s9, 2
    s_and_b32 s8, s8, -2
p2_kernel_lofast_ldloop:
    s_cmp_gt_u32 s8, s10
    s_cbranch_scc1 p2_kernel_fin
    s_waitcnt vmcnt(0)
    s_barrier
    s_min_u32 s28, s43, 31
    s_lshl_b32 s28, s28, 15
    s_add_u32 s28, s28, s13
    s_lshl_b32 s16, s17, 13
    s_add_u32 m0, s41, s16
    s_add_u32 s43, s43, 1
    buffer_load_dwordx4 v1, s[4:7], s28 offen offset:0 lds
    buffer_load_dwordx4 v1, s[4:7], s28 offen offset:1024 lds
    buffer_load_dwordx4 v1, s[4:7], s28 offen offset:2048 lds
    buffer_load_dwordx4 v1, s[4:7], s28 offen offset:3072 lds
    s_add_u32 m0, m0, 4096
    s_add_u32 s28, s28, 4096
    buffer_load_dwordx4 v1, s[4:7], s28 offen offset:0 lds
    buffer_load_dwordx4 v1, s[4:7], s28 offen offset:1024 lds
    buffer_load_dwordx4 v1, s[4:7], s28 offen offset:2048 lds
    buffer_load_dwordx4 v1, s[4:7], s28 offen offset:3072 lds
    s_add_u32 s41, s41, 0x8000
    s_cmp_eq_u32 s41, 0x28000
    s_cselect_b32 s41, 0, s41
    s_min_u32 s28, s43, 31
    s_lshl_b32 s28, s28, 15
    s_add_u32 s28, s28, s13
    s_lshl_b32 s16, s17, 13
    s_add_u32 m0, s41, s16
    s_add_u32 s43, s43, 1
    buffer_load_dwordx4 v1, s[4:7], s28 offen offset:0 lds
    buffer_load_dwordx4 v1, s[4:7], s28 offen offset:1024 lds
    buffer_load_dwordx4 v1, s[4:7], s28 offen offset:2048 lds
    buffer_load_dwordx4 v1, s[4:7], s28 offen offset:3072 lds
    s_add_u32 m0, m0, 4096
    s_add_u32 s28, s28, 4096
    buffer_load_dwordx4 v1, s[4:7], s28 offen offset:0 lds
    buffer_load_dwordx4 v1, s[4:7], s28 offen offset:1024 lds
    buffer_load_dwordx4 v1, s[4:7], s28 offen offset:2048 lds
    buffer_load_dwordx4 v1, s[4:7], s28 offen offset:3072 lds
    s_add_u32 s41, s41, 0x8000
    s_cmp_eq_u32 s41, 0x28000
    s_cselect_b32 s41, 0, s41
    s_add_u32 s8, s8, 2
    s_branch p2_kernel_lofast_ldloop
p2_kernel_lofast_tailend:
p2_kernel_safe_main:
    s_cmp_eq_u32 s11, 0
    s_cbranch_scc0 p2_kernel_losafe_main
    s_cmp_eq_u32 s9, 0
    s_cbranch_scc1 p2_kernel_hisafe_final
    s_cmp_eq_u32 s9, 1
    s_cbranch_scc1 p2_kernel_hisafe_peel
    s_sub_u32 s29, s9, 1
p2_kernel_hisafe_loop:
    s_barrier
    s_waitcnt lgkmcnt(0)
    v_mfma_f32_16x16x32_bf16 v[144:147], v[192:195], v[32:35], v[176:179]
    ds_read_b128 v[208:211], v2 offset:20480
    v_exp_f32 v128, v128
    v_exp_f32 v129, v129
    v_mfma_f32_16x16x32_bf16 v[144:147], v[196:199], v[36:39], v[144:147]
    v_exp_f32 v130, v130
    v_cvt_pk_bf16_f32 v224, v128, v129
    v_mfma_f32_16x16x32_bf16 v[144:147], v[200:203], v[40:43], v[144:147]
    ds_read_b128 v[212:215], v2 offset:21504
    v_exp_f32 v131, v131
    v_mfma_f32_16x16x32_bf16 v[144:147], v[204:207], v[44:47], v[144:147]
    v_exp_f32 v136, v136
    v_cvt_pk_bf16_f32 v225, v130, v131
    v_mfma_f32_16x16x32_bf16 v[148:151], v[192:195], v[48:51], v[180:183]
    ds_read_b128 v[216:219], v2 offset:22528
    v_exp_f32 v137, v137
    v_exp_f32 v138, v138
    v_mfma_f32_16x16x32_bf16 v[148:151], v[196:199], v[52:55], v[148:151]
    v_cvt_pk_bf16_f32 v226, v136, v137
    v_mfma_f32_16x16x32_bf16 v[148:151], v[200:203], v[56:59], v[148:151]
    ds_read_b128 v[220:223], v2 offset:23552
    v_exp_f32 v139, v139
    s_nop 0
    v_mfma_f32_16x16x32_bf16 v[148:151], v[204:207], v[60:63], v[148:151]
    v_cvt_pk_bf16_f32 v227, v138, v139
    s_waitcnt lgkmcnt(0)
    v_mfma_f32_16x16x32_bf16 v[152:155], v[208:211], v[32:35], v[184:187]
    ds_read_b128 v[192:195], v2 offset:8192
    v_exp_f32 v132, v132
    v_exp_f32 v133, v133
    v_mfma_f32_16x16x32_bf16 v[152:155], v[212:215], v[36:39], v[152:155]
    v_exp_f32 v134, v134
    v_cvt_pk_bf16_f32 v228, v132, v133
    v_mfma_f32_16x16x32_bf16 v[152:155], v[216:219], v[40:43], v[152:155]
    ds_read_b128 v[196:199], v2 offset:9216
    v_exp_f32 v135, v135
    v_mfma_f32_16x16x32_bf16 v[152:155], v[220:223], v[44:47], v[152:155]
    v_exp_f32 v140, v140
    v_cvt_pk_bf16_f32 v229, v134, v135
    v_mfma_f32_16x16x32_bf16 v[156:159], v[208:211], v[48:51], v[188:191]
    ds_read_b128 v[200:203], v2 offset:10240
    v_exp_f32 v141, v141
    v_exp_f32 v142, v142
    v_mfma_f32_16x16x32_bf16 v[156:159], v[212:215], v[52:55], v[156:159]
    v_cvt_pk_bf16_f32 v230, v140, v141
    v_mfma_f32_16x16x32_bf16 v[156:159], v[216:219], v[56:59], v[156:159]
    ds_read_b128 v[204:207], v2 offset:11264
    v_exp_f32 v143, v143
    s_nop 0
    v_mfma_f32_16x16x32_bf16 v[156:159], v[220:223], v[60:63], v[156:159]
    v_cvt_pk_bf16_f32 v231, v142, v143
    s_waitcnt lgkmcnt(2)
    v_mfma_f32_16x16x32_bf16 v[64:67], v[192:195], v[224:227], v[64:67]
    ds_read_b128 v[208:211], v2 offset:12288
    v_mfma_f32_16x16x32_bf16 v[68:71], v[192:195], v[228:231], v[68:71]
    v_mfma_f32_16x16x32_bf16 v[72:75], v[196:199], v[224:227], v[72:75]
    ds_read_b128 v[212:215], v2 offset:13312
    v_mfma_f32_16x16x32_bf16 v[76:79], v[196:199], v[228:231], v[76:79]
    s_waitcnt lgkmcnt(2)
    v_mfma_f32_16x16x32_bf16 v[80:83], v[200:203], v[224:227], v[80:83]
    ds_read_b128 v[216:219], v2 offset:14336
    v_mfma_f32_16x16x32_bf16 v[84:87], v[200:203], v[228:231], v[84:87]
    v_max3_f32 v8, v144, v145, v146
    v_mfma_f32_16x16x32_bf16 v[88:91], v[204:207], v[224:227], v[88:91]
    ds_read_b128 v[220:223], v2 offset:15360
    v_max3_f32 v9, v148, v149, v150
    v_mfma_f32_16x16x32_bf16 v[92:95], v[204:207], v[228:231], v[92:95]
    v_max3_f32 v10, v147, v152, v153
    s_waitcnt lgkmcnt(2)
    v_mfma_f32_16x16x32_bf16 v[96:99], v[208:211], v[224:227], v[96:99]
    ds_read_b128 v[192:195], v3 offset:0
    v_max3_f32 v11, v151, v156, v157
    v_mfma_f32_16x16x32_bf16 v[100:103], v[208:211], v[228:231], v[100:103]
    v_max3_f32 v8, v8, v154, v155
    v_mfma_f32_16x16x32_bf16 v[104:107], v[212:215], v[224:227], v[104:107]
    ds_read_b128 v[196:199], v3 offset:1024
    v_max3_f32 v9, v9, v158, v159
    v_mfma_f32_16x16x32_bf16 v[108:111], v[212:215], v[228:231], v[108:111]
    v_max_f32 v8, v8, v10
    s_waitcnt lgkmcnt(2)
    v_mfma_f32_16x16x32_bf16 v[112:115], v[216:219], v[224:227], v[112:115]
    ds_read_b128 v[200:203], v3 offset:2048
    v_max_f32 v9, v9, v11
    v_mfma_f32_16x16x32_bf16 v[116:119], v[216:219], v[228:231], v[116:119]
    v_max_f32 v10, v8, v9
    v_mfma_f32_16x16x32_bf16 v[120:123], v[220:223], v[224:227], v[120:123]
    ds_read_b128 v[204:207], v3 offset:3072
    v_cmp_lt_f32 vcc, s19, v10
    v_mfma_f32_16x16x32_bf16 v[124:127], v[220:223], v[228:231], v[124:127]
    v_mfma_f32_16x16x32_bf16 v[240:243], v[248:251], v[224:227], v[240:243]
    v_mfma_f32_16x16x32_bf16 v[244:247], v[248:251], v[228:231], v[244:247]
    s_cbranch_vccnz p2_kernel_hisafe_l_sA
p2_kernel_hisafe_l_sA_ret:
    s_waitcnt lgkmcnt(0)
    v_mfma_f32_16x16x32_bf16 v[128:131], v[192:195], v[32:35], v[160:163]
    ds_read_b128 v[208:211], v3 offset:4096
    v_exp_f32 v144, v144
    v_exp_f32 v145, v145
    v_mfma_f32_16x16x32_bf16 v[128:131], v[196:199], v[36:39], v[128:131]
    v_exp_f32 v146, v146
    v_cvt_pk_bf16_f32 v232, v144, v145
    v_mfma_f32_16x16x32_bf16 v[128:131], v[200:203], v[40:43], v[128:131]
    ds_read_b128 v[212:215], v3 offset:5120
    v_exp_f32 v147, v147
    v_mfma_f32_16x16x32_bf16 v[128:131], v[204:207], v[44:47], v[128:131]
    v_exp_f32 v152, v152
    v_cvt_pk_bf16_f32 v233, v146, v147
    v_mfma_f32_16x16x32_bf16 v[132:135], v[192:195], v[48:51], v[164:167]
    ds_read_b128 v[216:219], v3 offset:6144
    v_exp_f32 v153, v153
    v_exp_f32 v154, v154
    v_mfma_f32_16x16x32_bf16 v[132:135], v[196:199], v[52:55], v[132:135]
    v_cvt_pk_bf16_f32 v234, v152, v153
    v_mfma_f32_16x16x32_bf16 v[132:135], v[200:203], v[56:59], v[132:135]
    ds_read_b128 v[220:223], v3 offset:7168
    v_exp_f32 v155, v155
    s_nop 0
    v_mfma_f32_16x16x32_bf16 v[132:135], v[204:207], v[60:63], v[132:135]
    v_cvt_pk_bf16_f32 v235, v154, v155
    s_waitcnt lgkmcnt(0)
    v_mfma_f32_16x16x32_bf16 v[136:139], v[208:211], v[32:35], v[168:171]
    ds_read_b128 v[192:195], v2 offset:24576
    v_exp_f32 v148, v148
    v_exp_f32 v149, v149
    v_mfma_f32_16x16x32_bf16 v[136:139], v[212:215], v[36:39], v[136:139]
    v_exp_f32 v150, v150
    v_cvt_pk_bf16_f32 v236, v148, v149
    v_mfma_f32_16x16x32_bf16 v[136:139], v[216:219], v[40:43], v[136:139]
    ds_read_b128 v[196:199], v2 offset:25600
    v_exp_f32 v151, v151
    v_mfma_f32_16x16x32_bf16 v[136:139], v[220:223], v[44:47], v[136:139]
    v_exp_f32 v156, v156
    v_cvt_pk_bf16_f32 v237, v150, v151
    v_mfma_f32_16x16x32_bf16 v[140:143], v[208:211], v[48:51], v[172:175]
    ds_read_b128 v[200:203], v2 offset:26624
    v_exp_f32 v157, v157
    v_exp_f32 v158, v158
    v_mfma_f32_16x16x32_bf16 v[140:143], v[212:215], v[52:55], v[140:143]
    v_cvt_pk_bf16_f32 v238, v156, v157
    v_mfma_f32_16x16x32_bf16 v[140:143], v[216:219], v[56:59], v[140:143]
    ds_read_b128 v[204:207], v2 offset:27648
    v_exp_f32 v159, v159
    s_nop 0
    v_mfma_f32_16x16x32_bf16 v[140:143], v[220:223], v[60:63], v[140:143]
    v_cvt_pk_bf16_f32 v239, v158, v159
    s_waitcnt lgkmcnt(2)
    v_mfma_f32_16x16x32_bf16 v[64:67], v[192:195], v[232:235], v[64:67]
    ds_read_b128 v[208:211], v2 offset:28672
    v_mfma_f32_16x16x32_bf16 v[68:71], v[192:195], v[236:239], v[68:71]
    v_mfma_f32_16x16x32_bf16 v[72:75], v[196:199], v[232:235], v[72:75]
    ds_read_b128 v[212:215], v2 offset:29696
    v_mfma_f32_16x16x32_bf16 v[76:79], v[196:199], v[236:239], v[76:79]
    s_waitcnt lgkmcnt(2)
    v_mfma_f32_16x16x32_bf16 v[80:83], v[200:203], v[232:235], v[80:83]
    ds_read_b128 v[216:219], v2 offset:30720
    v_mfma_f32_16x16x32_bf16 v[84:87], v[200:203], v[236:239], v[84:87]
    v_max3_f32 v8, v128, v129, v130
    v_mfma_f32_16x16x32_bf16 v[88:91], v[204:207], v[232:235], v[88:91]
    ds_read_b128 v[220:223], v2 offset:31744
    v_max3_f32 v9, v132, v133, v134
    v_mfma_f32_16x16x32_bf16 v[92:95], v[204:207], v[236:239], v[92:95]
    v_max3_f32 v10, v131, v136, v137
    s_waitcnt lgkmcnt(2)
    v_mfma_f32_16x16x32_bf16 v[96:99], v[208:211], v[232:235], v[96:99]
    ds_read_b128 v[192:195], v3 offset:16384
    v_max3_f32 v11, v135, v140, v141
    v_mfma_f32_16x16x32_bf16 v[100:103], v[208:211], v[236:239], v[100:103]
    v_max3_f32 v8, v8, v138, v139
    v_mfma_f32_16x16x32_bf16 v[104:107], v[212:215], v[232:235], v[104:107]
    ds_read_b128 v[196:199], v3 offset:17408
    v_max3_f32 v9, v9, v142, v143
    s_add_u32 s8, s8, 1
    v_mfma_f32_16x16x32_bf16 v[108:111], v[212:215], v[236:239], v[108:111]
    v_max_f32 v8, v8, v10
    s_add_u32 s15, s8, 1
    s_waitcnt lgkmcnt(2)
    v_mfma_f32_16x16x32_bf16 v[112:115], v[216:219], v[232:235], v[112:115]
    ds_read_b128 v[200:203], v3 offset:18432
    v_max_f32 v9, v9, v11
    s_and_b32 s15, s15, 3
    v_mfma_f32_16x16x32_bf16 v[116:119], v[216:219], v[236:239], v[116:119]
    v_max_f32 v10, v8, v9
    s_lshl_b32 s15, s15, 15
    v_mfma_f32_16x16x32_bf16 v[120:123], v[220:223], v[232:235], v[120:123]
    ds_read_b128 v[204:207], v3 offset:19456
    v_cmp_lt_f32 vcc, s19, v10
    v_mfma_f32_16x16x32_bf16 v[124:127], v[220:223], v[236:239], v[124:127]
    v_mfma_f32_16x16x32_bf16 v[240:243], v[248:251], v[232:235], v[240:243]
    v_mfma_f32_16x16x32_bf16 v[244:247], v[248:251], v[236:239], v[244:247]
    s_cbranch_vccnz p2_kernel_hisafe_l_sB
p2_kernel_hisafe_l_sB_ret:
    v_mov_b32 v2, v3
    v_add_u32 v3, s15, v1
    s_cmp_lt_u32 s8, s29
    s_cbranch_scc1 p2_kernel_hisafe_loop
p2_kernel_hisafe_peel:
    s_barrier
    v_cmp_le_i32 s[20:21], 0, v18
    v_cmp_le_i32 s[22:23], 1, v18
    v_cmp_le_i32 s[24:25], 2, v18
    v_cmp_le_i32 s[26:27], 3, v18
    v_cndmask_b32 v160, v19, v160, s[20:21]
    v_cndmask_b32 v161, v19, v161, s[22:23]
    v_cndmask_b32 v162, v19, v162, s[24:25]
    v_cndmask_b32 v163, v19, v163, s[26:27]
    v_cmp_le_i32 s[20:21], -16, v18
    v_cmp_le_i32 s[22:23], -15, v18
    v_cmp_le_i32 s[24:25], -14, v18
    v_cmp_le_i32 s[26:27], -13, v18
    v_cndmask_b32 v164, v19, v164, s[20:21]
    v_cndmask_b32 v165, v19, v165, s[22:23]
    v_cndmask_b32 v166, v19, v166, s[24:25]
    v_cndmask_b32 v167, v19, v167, s[26:27]
    v_cmp_le_i32 s[20:21], 16, v18
    v_cmp_le_i32 s[22:23], 17, v18
    v_cmp_le_i32 s[24:25], 18, v18
    v_cmp_le_i32 s[26:27], 19, v18
    v_cndmask_b32 v168, v19, v168, s[20:21]
    v_cndmask_b32 v169, v19, v169, s[22:23]
    v_cndmask_b32 v170, v19, v170, s[24:25]
    v_cndmask_b32 v171, v19, v171, s[26:27]
    v_cmp_le_i32 s[20:21], 0, v18
    v_cmp_le_i32 s[22:23], 1, v18
    v_cmp_le_i32 s[24:25], 2, v18
    v_cmp_le_i32 s[26:27], 3, v18
    v_cndmask_b32 v172, v19, v172, s[20:21]
    v_cndmask_b32 v173, v19, v173, s[22:23]
    v_cndmask_b32 v174, v19, v174, s[24:25]
    v_cndmask_b32 v175, v19, v175, s[26:27]
    s_nop 1
    s_waitcnt lgkmcnt(0)
    v_mfma_f32_16x16x32_bf16 v[144:147], v[192:195], v[32:35], v[176:179]
    ds_read_b128 v[208:211], v2 offset:20480
    v_exp_f32 v128, v128
    v_exp_f32 v129, v129
    v_mfma_f32_16x16x32_bf16 v[144:147], v[196:199], v[36:39], v[144:147]
    v_exp_f32 v130, v130
    v_cvt_pk_bf16_f32 v224, v128, v129
    v_mfma_f32_16x16x32_bf16 v[144:147], v[200:203], v[40:43], v[144:147]
    ds_read_b128 v[212:215], v2 offset:21504
    v_exp_f32 v131, v131
    v_mfma_f32_16x16x32_bf16 v[144:147], v[204:207], v[44:47], v[144:147]
    v_exp_f32 v136, v136
    v_cvt_pk_bf16_f32 v225, v130, v131
    v_mfma_f32_16x16x32_bf16 v[148:151], v[192:195], v[48:51], v[180:183]
    ds_read_b128 v[216:219], v2 offset:22528
    v_exp_f32 v137, v137
    v_exp_f32 v138, v138
    v_mfma_f32_16x16x32_bf16 v[148:151], v[196:199], v[52:55], v[148:151]
    v_cvt_pk_bf16_f32 v226, v136, v137
    v_mfma_f32_16x16x32_bf16 v[148:151], v[200:203], v[56:59], v[148:151]
    ds_read_b128 v[220:223], v2 offset:23552
    v_exp_f32 v139, v139
    s_nop 0
    v_mfma_f32_16x16x32_bf16 v[148:151], v[204:207], v[60:63], v[148:151]
    v_cvt_pk_bf16_f32 v227, v138, v139
    s_waitcnt lgkmcnt(0)
    v_mfma_f32_16x16x32_bf16 v[152:155], v[208:211], v[32:35], v[184:187]
    ds_read_b128 v[192:195], v2 offset:8192
    v_exp_f32 v132, v132
    v_exp_f32 v133, v133
    v_mfma_f32_16x16x32_bf16 v[152:155], v[212:215], v[36:39], v[152:155]
    v_exp_f32 v134, v134
    v_cvt_pk_bf16_f32 v228, v132, v133
    v_mfma_f32_16x16x32_bf16 v[152:155], v[216:219], v[40:43], v[152:155]
    ds_read_b128 v[196:199], v2 offset:9216
    v_exp_f32 v135, v135
    v_mfma_f32_16x16x32_bf16 v[152:155], v[220:223], v[44:47], v[152:155]
    v_exp_f32 v140, v140
    v_cvt_pk_bf16_f32 v229, v134, v135
    v_mfma_f32_16x16x32_bf16 v[156:159], v[208:211], v[48:51], v[188:191]
    ds_read_b128 v[200:203], v2 offset:10240
    v_exp_f32 v141, v141
    v_exp_f32 v142, v142
    v_mfma_f32_16x16x32_bf16 v[156:159], v[212:215], v[52:55], v[156:159]
    v_cvt_pk_bf16_f32 v230, v140, v141
    v_mfma_f32_16x16x32_bf16 v[156:159], v[216:219], v[56:59], v[156:159]
    ds_read_b128 v[204:207], v2 offset:11264
    v_exp_f32 v143, v143
    s_nop 0
    v_mfma_f32_16x16x32_bf16 v[156:159], v[220:223], v[60:63], v[156:159]
    v_cvt_pk_bf16_f32 v231, v142, v143
    s_waitcnt lgkmcnt(2)
    v_mfma_f32_16x16x32_bf16 v[64:67], v[192:195], v[224:227], v[64:67]
    ds_read_b128 v[208:211], v2 offset:12288
    v_mfma_f32_16x16x32_bf16 v[68:71], v[192:195], v[228:231], v[68:71]
    v_mfma_f32_16x16x32_bf16 v[72:75], v[196:199], v[224:227], v[72:75]
    ds_read_b128 v[212:215], v2 offset:13312
    v_mfma_f32_16x16x32_bf16 v[76:79], v[196:199], v[228:231], v[76:79]
    s_waitcnt lgkmcnt(2)
    v_mfma_f32_16x16x32_bf16 v[80:83], v[200:203], v[224:227], v[80:83]
    ds_read_b128 v[216:219], v2 offset:14336
    v_mfma_f32_16x16x32_bf16 v[84:87], v[200:203], v[228:231], v[84:87]
    v_max3_f32 v8, v144, v145, v146
    v_mfma_f32_16x16x32_bf16 v[88:91], v[204:207], v[224:227], v[88:91]
    ds_read_b128 v[220:223], v2 offset:15360
    v_max3_f32 v9, v148, v149, v150
    v_mfma_f32_16x16x32_bf16 v[92:95], v[204:207], v[228:231], v[92:95]
    v_max3_f32 v10, v147, v152, v153
    s_waitcnt lgkmcnt(2)
    v_mfma_f32_16x16x32_bf16 v[96:99], v[208:211], v[224:227], v[96:99]
    ds_read_b128 v[192:195], v3 offset:0
    v_max3_f32 v11, v151, v156, v157
    v_mfma_f32_16x16x32_bf16 v[100:103], v[208:211], v[228:231], v[100:103]
    v_max3_f32 v8, v8, v154, v155
    v_mfma_f32_16x16x32_bf16 v[104:107], v[212:215], v[224:227], v[104:107]
    ds_read_b128 v[196:199], v3 offset:1024
    v_max3_f32 v9, v9, v158, v159
    v_mfma_f32_16x16x32_bf16 v[108:111], v[212:215], v[228:231], v[108:111]
    v_max_f32 v8, v8, v10
    s_waitcnt lgkmcnt(2)
    v_mfma_f32_16x16x32_bf16 v[112:115], v[216:219], v[224:227], v[112:115]
    ds_read_b128 v[200:203], v3 offset:2048
    v_max_f32 v9, v9, v11
    v_mfma_f32_16x16x32_bf16 v[116:119], v[216:219], v[228:231], v[116:119]
    v_max_f32 v10, v8, v9
    v_mfma_f32_16x16x32_bf16 v[120:123], v[220:223], v[224:227], v[120:123]
    ds_read_b128 v[204:207], v3 offset:3072
    v_cmp_lt_f32 vcc, s19, v10
    v_mfma_f32_16x16x32_bf16 v[124:127], v[220:223], v[228:231], v[124:127]
    v_mfma_f32_16x16x32_bf16 v[240:243], v[248:251], v[224:227], v[240:243]
    v_mfma_f32_16x16x32_bf16 v[244:247], v[248:251], v[228:231], v[244:247]
    s_cbranch_vccnz p2_kernel_hisafe_p_sA
p2_kernel_hisafe_p_sA_ret:
    s_waitcnt lgkmcnt(0)
    v_mfma_f32_16x16x32_bf16 v[128:131], v[192:195], v[32:35], v[160:163]
    ds_read_b128 v[208:211], v3 offset:4096
    v_exp_f32 v144, v144
    v_exp_f32 v145, v145
    v_mfma_f32_16x16x32_bf16 v[128:131], v[196:199], v[36:39], v[128:131]
    v_exp_f32 v146, v146
    v_cvt_pk_bf16_f32 v232, v144, v145
    v_mfma_f32_16x16x32_bf16 v[128:131], v[200:203], v[40:43], v[128:131]
    ds_read_b128 v[212:215], v3 offset:5120
    v_exp_f32 v147, v147
    v_mfma_f32_16x16x32_bf16 v[128:131], v[204:207], v[44:47], v[128:131]
    v_exp_f32 v152, v152
    v_cvt_pk_bf16_f32 v233, v146, v147
    v_mfma_f32_16x16x32_bf16 v[132:135], v[192:195], v[48:51], v[164:167]
    ds_read_b128 v[216:219], v3 offset:6144
    v_exp_f32 v153, v153
    v_exp_f32 v154, v154
    v_mfma_f32_16x16x32_bf16 v[132:135], v[196:199], v[52:55], v[132:135]
    v_cvt_pk_bf16_f32 v234, v152, v153
    v_mfma_f32_16x16x32_bf16 v[132:135], v[200:203], v[56:59], v[132:135]
    ds_read_b128 v[220:223], v3 offset:7168
    v_exp_f32 v155, v155
    s_nop 0
    v_mfma_f32_16x16x32_bf16 v[132:135], v[204:207], v[60:63], v[132:135]
    v_cvt_pk_bf16_f32 v235, v154, v155
    s_waitcnt lgkmcnt(0)
    v_mfma_f32_16x16x32_bf16 v[136:139], v[208:211], v[32:35], v[168:171]
    ds_read_b128 v[192:195], v2 offset:24576
    v_exp_f32 v148, v148
    v_exp_f32 v149, v149
    v_mfma_f32_16x16x32_bf16 v[136:139], v[212:215], v[36:39], v[136:139]
    v_exp_f32 v150, v150
    v_cvt_pk_bf16_f32 v236, v148, v149
    v_mfma_f32_16x16x32_bf16 v[136:139], v[216:219], v[40:43], v[136:139]
    ds_read_b128 v[196:199], v2 offset:25600
    v_exp_f32 v151, v151
    v_mfma_f32_16x16x32_bf16 v[136:139], v[220:223], v[44:47], v[136:139]
    v_exp_f32 v156, v156
    v_cvt_pk_bf16_f32 v237, v150, v151
    v_mfma_f32_16x16x32_bf16 v[140:143], v[208:211], v[48:51], v[172:175]
    ds_read_b128 v[200:203], v2 offset:26624
    v_exp_f32 v157, v157
    v_exp_f32 v158, v158
    v_mfma_f32_16x16x32_bf16 v[140:143], v[212:215], v[52:55], v[140:143]
    v_cvt_pk_bf16_f32 v238, v156, v157
    v_mfma_f32_16x16x32_bf16 v[140:143], v[216:219], v[56:59], v[140:143]
    ds_read_b128 v[204:207], v2 offset:27648
    v_exp_f32 v159, v159
    s_nop 0
    v_mfma_f32_16x16x32_bf16 v[140:143], v[220:223], v[60:63], v[140:143]
    v_cvt_pk_bf16_f32 v239, v158, v159
    s_waitcnt lgkmcnt(2)
    v_mfma_f32_16x16x32_bf16 v[64:67], v[192:195], v[232:235], v[64:67]
    ds_read_b128 v[208:211], v2 offset:28672
    v_mfma_f32_16x16x32_bf16 v[68:71], v[192:195], v[236:239], v[68:71]
    v_mfma_f32_16x16x32_bf16 v[72:75], v[196:199], v[232:235], v[72:75]
    ds_read_b128 v[212:215], v2 offset:29696
    v_mfma_f32_16x16x32_bf16 v[76:79], v[196:199], v[236:239], v[76:79]
    s_waitcnt lgkmcnt(2)
    v_mfma_f32_16x16x32_bf16 v[80:83], v[200:203], v[232:235], v[80:83]
    ds_read_b128 v[216:219], v2 offset:30720
    v_mfma_f32_16x16x32_bf16 v[84:87], v[200:203], v[236:239], v[84:87]
    v_max3_f32 v8, v128, v129, v130
    v_mfma_f32_16x16x32_bf16 v[88:91], v[204:207], v[232:235], v[88:91]
    ds_read_b128 v[220:223], v2 offset:31744
    v_max3_f32 v9, v132, v133, v134
    v_mfma_f32_16x16x32_bf16 v[92:95], v[204:207], v[236:239], v[92:95]
    v_max3_f32 v10, v131, v136, v137
    s_waitcnt lgkmcnt(2)
    v_mfma_f32_16x16x32_bf16 v[96:99], v[208:211], v[232:235], v[96:99]
    ds_read_b128 v[192:195], v3 offset:16384
    v_max3_f32 v11, v135, v140, v141
    v_mfma_f32_16x16x32_bf16 v[100:103], v[208:211], v[236:239], v[100:103]
    v_max3_f32 v8, v8, v138, v139
    v_mfma_f32_16x16x32_bf16 v[104:107], v[212:215], v[232:235], v[104:107]
    ds_read_b128 v[196:199], v3 offset:17408
    v_max3_f32 v9, v9, v142, v143
    s_add_u32 s8, s8, 1
    v_mfma_f32_16x16x32_bf16 v[108:111], v[212:215], v[236:239], v[108:111]
    v_max_f32 v8, v8, v10
    s_add_u32 s15, s8, 1
    s_waitcnt lgkmcnt(2)
    v_mfma_f32_16x16x32_bf16 v[112:115], v[216:219], v[232:235], v[112:115]
    ds_read_b128 v[200:203], v3 offset:18432
    v_max_f32 v9, v9, v11
    s_and_b32 s15, s15, 3
    v_mfma_f32_16x16x32_bf16 v[116:119], v[216:219], v[236:239], v[116:119]
    v_max_f32 v10, v8, v9
    s_lshl_b32 s15, s15, 15
    v_mfma_f32_16x16x32_bf16 v[120:123], v[220:223], v[232:235], v[120:123]
    ds_read_b128 v[204:207], v3 offset:19456
    v_cmp_lt_f32 vcc, s19, v10
    v_mfma_f32_16x16x32_bf16 v[124:127], v[220:223], v[236:239], v[124:127]
    v_mfma_f32_16x16x32_bf16 v[240:243], v[248:251], v[232:235], v[240:243]
    v_mfma_f32_16x16x32_bf16 v[244:247], v[248:251], v[236:239], v[244:247]
    s_cbranch_vccnz p2_kernel_hisafe_p_sB
p2_kernel_hisafe_p_sB_ret:
    v_mov_b32 v2, v3
    v_add_u32 v3, s15, v1
p2_kernel_hisafe_final:
    s_cmp_gt_u32 s8, s10
    s_cbranch_scc1 p2_kernel_hisafe_final_nobar
    s_barrier
p2_kernel_hisafe_final_nobar:
    v_cmp_le_i32 s[20:21], 32, v18
    v_cmp_le_i32 s[22:23], 33, v18
    v_cmp_le_i32 s[24:25], 34, v18
    v_cmp_le_i32 s[26:27], 35, v18
    v_cndmask_b32 v176, v19, v176, s[20:21]
    v_cndmask_b32 v177, v19, v177, s[22:23]
    v_cndmask_b32 v178, v19, v178, s[24:25]
    v_cndmask_b32 v179, v19, v179, s[26:27]
    v_cmp_le_i32 s[20:21], 16, v18
    v_cmp_le_i32 s[22:23], 17, v18
    v_cmp_le_i32 s[24:25], 18, v18
    v_cmp_le_i32 s[26:27], 19, v18
    v_cndmask_b32 v180, v19, v180, s[20:21]
    v_cndmask_b32 v181, v19, v181, s[22:23]
    v_cndmask_b32 v182, v19, v182, s[24:25]
    v_cndmask_b32 v183, v19, v183, s[26:27]
    v_cmp_le_i32 s[20:21], 48, v18
    v_cmp_le_i32 s[22:23], 49, v18
    v_cmp_le_i32 s[24:25], 50, v18
    v_cmp_le_i32 s[26:27], 51, v18
    v_cndmask_b32 v184, v19, v184, s[20:21]
    v_cndmask_b32 v185, v19, v185, s[22:23]
    v_cndmask_b32 v186, v19, v186, s[24:25]
    v_cndmask_b32 v187, v19, v187, s[26:27]
    v_cmp_le_i32 s[20:21], 32, v18
    v_cmp_le_i32 s[22:23], 33, v18
    v_cmp_le_i32 s[24:25], 34, v18
    v_cmp_le_i32 s[26:27], 35, v18
    v_cndmask_b32 v188, v19, v188, s[20:21]
    v_cndmask_b32 v189, v19, v189, s[22:23]
    v_cndmask_b32 v190, v19, v190, s[24:25]
    v_cndmask_b32 v191, v19, v191, s[26:27]
    s_nop 1
    s_waitcnt lgkmcnt(2)
    v_mfma_f32_16x16x32_bf16 v[144:147], v[192:195], v[32:35], v[176:179]
    ds_read_b128 v[208:211], v2 offset:20480
    v_exp_f32 v128, v128
    v_exp_f32 v129, v129
    v_mfma_f32_16x16x32_bf16 v[144:147], v[196:199], v[36:39], v[144:147]
    v_exp_f32 v130, v130
    v_cvt_pk_bf16_f32 v224, v128, v129
    s_waitcnt lgkmcnt(1)
    v_mfma_f32_16x16x32_bf16 v[144:147], v[200:203], v[40:43], v[144:147]
    ds_read_b128 v[212:215], v2 offset:21504
    v_exp_f32 v131, v131
    v_mfma_f32_16x16x32_bf16 v[144:147], v[204:207], v[44:47], v[144:147]
    v_exp_f32 v136, v136
    v_cvt_pk_bf16_f32 v225, v130, v131
    v_mfma_f32_16x16x32_bf16 v[148:151], v[192:195], v[48:51], v[180:183]
    ds_read_b128 v[216:219], v2 offset:22528
    v_exp_f32 v137, v137
    v_exp_f32 v138, v138
    v_mfma_f32_16x16x32_bf16 v[148:151], v[196:199], v[52:55], v[148:151]
    v_cvt_pk_bf16_f32 v226, v136, v137
    v_mfma_f32_16x16x32_bf16 v[148:151], v[200:203], v[56:59], v[148:151]
    ds_read_b128 v[220:223], v2 offset:23552
    v_exp_f32 v139, v139
    s_nop 0
    v_mfma_f32_16x16x32_bf16 v[148:151], v[204:207], v[60:63], v[148:151]
    v_cvt_pk_bf16_f32 v227, v138, v139
    s_waitcnt lgkmcnt(2)
    v_mfma_f32_16x16x32_bf16 v[152:155], v[208:211], v[32:35], v[184:187]
    ds_read_b128 v[192:195], v2 offset:8192
    v_exp_f32 v132, v132
    v_exp_f32 v133, v133
    v_mfma_f32_16x16x32_bf16 v[152:155], v[212:215], v[36:39], v[152:155]
    v_exp_f32 v134, v134
    v_cvt_pk_bf16_f32 v228, v132, v133
    s_waitcnt lgkmcnt(1)
    v_mfma_f32_16x16x32_bf16 v[152:155], v[216:219], v[40:43], v[152:155]
    ds_read_b128 v[196:199], v2 offset:9216
    v_exp_f32 v135, v135
    v_mfma_f32_16x16x32_bf16 v[152:155], v[220:223], v[44:47], v[152:155]
    v_exp_f32 v140, v140
    v_cvt_pk_bf16_f32 v229, v134, v135
    v_mfma_f32_16x16x32_bf16 v[156:159], v[208:211], v[48:51], v[188:191]
    ds_read_b128 v[200:203], v2 offset:10240
    v_exp_f32 v141, v141
    v_exp_f32 v142, v142
    v_mfma_f32_16x16x32_bf16 v[156:159], v[212:215], v[52:55], v[156:159]
    v_cvt_pk_bf16_f32 v230, v140, v141
    v_mfma_f32_16x16x32_bf16 v[156:159], v[216:219], v[56:59], v[156:159]
    ds_read_b128 v[204:207], v2 offset:11264
    v_exp_f32 v143, v143
    s_nop 0
    v_mfma_f32_16x16x32_bf16 v[156:159], v[220:223], v[60:63], v[156:159]
    v_cvt_pk_bf16_f32 v231, v142, v143
    s_waitcnt lgkmcnt(3)
    v_mfma_f32_16x16x32_bf16 v[64:67], v[192:195], v[224:227], v[64:67]
    ds_read_b128 v[208:211], v2 offset:12288
    v_mfma_f32_16x16x32_bf16 v[68:71], v[192:195], v[228:231], v[68:71]
    s_waitcnt lgkmcnt(3)
    v_mfma_f32_16x16x32_bf16 v[72:75], v[196:199], v[224:227], v[72:75]
    ds_read_b128 v[212:215], v2 offset:13312
    v_mfma_f32_16x16x32_bf16 v[76:79], v[196:199], v[228:231], v[76:79]
    s_waitcnt lgkmcnt(3)
    v_mfma_f32_16x16x32_bf16 v[80:83], v[200:203], v[224:227], v[80:83]
    ds_read_b128 v[216:219], v2 offset:14336
    v_mfma_f32_16x16x32_bf16 v[84:87], v[200:203], v[228:231], v[84:87]
    v_max3_f32 v8, v144, v145, v146
    s_waitcnt lgkmcnt(3)
    v_mfma_f32_16x16x32_bf16 v[88:91], v[204:207], v[224:227], v[88:91]
    ds_read_b128 v[220:223], v2 offset:15360
    v_max3_f32 v9, v148, v149, v150
    v_mfma_f32_16x16x32_bf16 v[92:95], v[204:207], v[228:231], v[92:95]
    v_max3_f32 v10, v147, v152, v153
    s_waitcnt lgkmcnt(3)
    v_mfma_f32_16x16x32_bf16 v[96:99], v[208:211], v[224:227], v[96:99]
    v_max3_f32 v11, v151, v156, v157
    v_mfma_f32_16x16x32_bf16 v[100:103], v[208:211], v[228:231], v[100:103]
    v_max3_f32 v8, v8, v154, v155
    s_waitcnt lgkmcnt(2)
    v_mfma_f32_16x16x32_bf16 v[104:107], v[212:215], v[224:227], v[104:107]
    v_max3_f32 v9, v9, v158, v159
    v_mfma_f32_16x16x32_bf16 v[108:111], v[212:215], v[228:231], v[108:111]
    v_max_f32 v8, v8, v10
    s_waitcnt lgkmcnt(1)
    v_mfma_f32_16x16x32_bf16 v[112:115], v[216:219], v[224:227], v[112:115]
    v_max_f32 v9, v9, v11
    v_mfma_f32_16x16x32_bf16 v[116:119], v[216:219], v[228:231], v[116:119]
    v_max_f32 v10, v8, v9
    s_waitcnt lgkmcnt(0)
    v_mfma_f32_16x16x32_bf16 v[120:123], v[220:223], v[224:227], v[120:123]
    v_cmp_lt_f32 vcc, s19, v10
    v_mfma_f32_16x16x32_bf16 v[124:127], v[220:223], v[228:231], v[124:127]
    v_mfma_f32_16x16x32_bf16 v[240:243], v[248:251], v[224:227], v[240:243]
    v_mfma_f32_16x16x32_bf16 v[244:247], v[248:251], v[228:231], v[244:247]
    s_cbranch_vccnz p2_kernel_hisafe_f_sA
p2_kernel_hisafe_f_sA_ret:
    v_exp_f32 v144, v144
    v_exp_f32 v145, v145
    v_exp_f32 v146, v146
    v_cvt_pk_bf16_f32 v232, v144, v145
    v_exp_f32 v147, v147
    v_exp_f32 v152, v152
    v_cvt_pk_bf16_f32 v233, v146, v147
    v_exp_f32 v153, v153
    v_exp_f32 v154, v154
    v_cvt_pk_bf16_f32 v234, v152, v153
    v_exp_f32 v155, v155
    s_nop 0
    v_cvt_pk_bf16_f32 v235, v154, v155
    ds_read_b128 v[192:195], v2 offset:24576
    v_exp_f32 v148, v148
    v_exp_f32 v149, v149
    v_exp_f32 v150, v150
    v_cvt_pk_bf16_f32 v236, v148, v149
    ds_read_b128 v[196:199], v2 offset:25600
    v_exp_f32 v151, v151
    v_exp_f32 v156, v156
    v_cvt_pk_bf16_f32 v237, v150, v151
    ds_read_b128 v[200:203], v2 offset:26624
    v_exp_f32 v157, v157
    v_exp_f32 v158, v158
    v_cvt_pk_bf16_f32 v238, v156, v157
    ds_read_b128 v[204:207], v2 offset:27648
    v_exp_f32 v159, v159
    s_nop 0
    v_cvt_pk_bf16_f32 v239, v158, v159
    s_waitcnt lgkmcnt(3)
    v_mfma_f32_16x16x32_bf16 v[64:67], v[192:195], v[232:235], v[64:67]
    ds_read_b128 v[208:211], v2 offset:28672
    v_mfma_f32_16x16x32_bf16 v[68:71], v[192:195], v[236:239], v[68:71]
    s_waitcnt lgkmcnt(3)
    v_mfma_f32_16x16x32_bf16 v[72:75], v[196:199], v[232:235], v[72:75]
    ds_read_b128 v[212:215], v2 offset:29696
    v_mfma_f32_16x16x32_bf16 v[76:79], v[196:199], v[236:239], v[76:79]
    s_waitcnt lgkmcnt(3)
    v_mfma_f32_16x16x32_bf16 v[80:83], v[200:203], v[232:235], v[80:83]
    ds_read_b128 v[216:219], v2 offset:30720
    v_mfma_f32_16x16x32_bf16 v[84:87], v[200:203], v[236:239], v[84:87]
    s_waitcnt lgkmcnt(3)
    v_mfma_f32_16x16x32_bf16 v[88:91], v[204:207], v[232:235], v[88:91]
    ds_read_b128 v[220:223], v2 offset:31744
    v_mfma_f32_16x16x32_bf16 v[92:95], v[204:207], v[236:239], v[92:95]
    s_waitcnt lgkmcnt(3)
    v_mfma_f32_16x16x32_bf16 v[96:99], v[208:211], v[232:235], v[96:99]
    v_mfma_f32_16x16x32_bf16 v[100:103], v[208:211], v[236:239], v[100:103]
    s_waitcnt lgkmcnt(2)
    v_mfma_f32_16x16x32_bf16 v[104:107], v[212:215], v[232:235], v[104:107]
    v_mfma_f32_16x16x32_bf16 v[108:111], v[212:215], v[236:239], v[108:111]
    s_waitcnt lgkmcnt(1)
    v_mfma_f32_16x16x32_bf16 v[112:115], v[216:219], v[232:235], v[112:115]
    v_mfma_f32_16x16x32_bf16 v[116:119], v[216:219], v[236:239], v[116:119]
    s_waitcnt lgkmcnt(0)
    v_mfma_f32_16x16x32_bf16 v[120:123], v[220:223], v[232:235], v[120:123]
    v_mfma_f32_16x16x32_bf16 v[124:127], v[220:223], v[236:239], v[124:127]
    v_mfma_f32_16x16x32_bf16 v[240:243], v[248:251], v[232:235], v[240:243]
    v_mfma_f32_16x16x32_bf16 v[244:247], v[248:251], v[236:239], v[244:247]
    s_nop 7
    v_rcp_f32 v8, v240
    v_rcp_f32 v9, v244
    s_nop 0
    s_lshl_b32 s36, s18, 1
    s_mul_i32 s36, s36, 171
    s_lshl_b32 s37, s12, 2
    s_add_u32 s36, s36, s37
    s_lshl_b32 s36, s36, 10
    s_add_u32 s36, s36, 0x3000000
    v_mul_f32 v64, v64, v8
    v_mul_f32 v65, v65, v8
    v_mul_f32 v66, v66, v8
    v_mul_f32 v67, v67, v8
    v_cvt_pk_bf16_f32 v192, v64, v65
    v_cvt_pk_bf16_f32 v193, v66, v67
    v_mul_f32 v72, v72, v8
    v_mul_f32 v73, v73, v8
    v_mul_f32 v74, v74, v8
    v_mul_f32 v75, v75, v8
    v_cvt_pk_bf16_f32 v194, v72, v73
    v_cvt_pk_bf16_f32 v195, v74, v75
    buffer_store_dwordx4 v[192:195], v1, s[4:7], s36 offen offset:0 sc1
    v_mul_f32 v80, v80, v8
    v_mul_f32 v81, v81, v8
    v_mul_f32 v82, v82, v8
    v_mul_f32 v83, v83, v8
    v_cvt_pk_bf16_f32 v196, v80, v81
    v_cvt_pk_bf16_f32 v197, v82, v83
    v_mul_f32 v88, v88, v8
    v_mul_f32 v89, v89, v8
    v_mul_f32 v90, v90, v8
    v_mul_f32 v91, v91, v8
    v_cvt_pk_bf16_f32 v198, v88, v89
    v_cvt_pk_bf16_f32 v199, v90, v91
    buffer_store_dwordx4 v[196:199], v1, s[4:7], s36 offen offset:1024 sc1
    v_mul_f32 v96, v96, v8
    v_mul_f32 v97, v97, v8
    v_mul_f32 v98, v98, v8
    v_mul_f32 v99, v99, v8
    v_cvt_pk_bf16_f32 v200, v96, v97
    v_cvt_pk_bf16_f32 v201, v98, v99
    v_mul_f32 v104, v104, v8
    v_mul_f32 v105, v105, v8
    v_mul_f32 v106, v106, v8
    v_mul_f32 v107, v107, v8
    v_cvt_pk_bf16_f32 v202, v104, v105
    v_cvt_pk_bf16_f32 v203, v106, v107
    buffer_store_dwordx4 v[200:203], v1, s[4:7], s36 offen offset:2048 sc1
    v_mul_f32 v112, v112, v8
    v_mul_f32 v113, v113, v8
    v_mul_f32 v114, v114, v8
    v_mul_f32 v115, v115, v8
    v_cvt_pk_bf16_f32 v204, v112, v113
    v_cvt_pk_bf16_f32 v205, v114, v115
    v_mul_f32 v120, v120, v8
    v_mul_f32 v121, v121, v8
    v_mul_f32 v122, v122, v8
    v_mul_f32 v123, v123, v8
    v_cvt_pk_bf16_f32 v206, v120, v121
    v_cvt_pk_bf16_f32 v207, v122, v123
    buffer_store_dwordx4 v[204:207], v1, s[4:7], s36 offen offset:3072 sc1
    s_lshl_b32 s36, s18, 1
    s_add_u32 s36, s36, 1
    s_mul_i32 s36, s36, 171
    s_lshl_b32 s37, s12, 2
    s_add_u32 s36, s36, s37
    s_lshl_b32 s36, s36, 10
    s_add_u32 s36, s36, 0x3000000
    v_mul_f32 v68, v68, v9
    v_mul_f32 v69, v69, v9
    v_mul_f32 v70, v70, v9
    v_mul_f32 v71, v71, v9
    v_cvt_pk_bf16_f32 v208, v68, v69
    v_cvt_pk_bf16_f32 v209, v70, v71
    v_mul_f32 v76, v76, v9
    v_mul_f32 v77, v77, v9
    v_mul_f32 v78, v78, v9
    v_mul_f32 v79, v79, v9
    v_cvt_pk_bf16_f32 v210, v76, v77
    v_cvt_pk_bf16_f32 v211, v78, v79
    buffer_store_dwordx4 v[208:211], v1, s[4:7], s36 offen offset:0 sc1
    v_mul_f32 v84, v84, v9
    v_mul_f32 v85, v85, v9
    v_mul_f32 v86, v86, v9
    v_mul_f32 v87, v87, v9
    v_cvt_pk_bf16_f32 v212, v84, v85
    v_cvt_pk_bf16_f32 v213, v86, v87
    v_mul_f32 v92, v92, v9
    v_mul_f32 v93, v93, v9
    v_mul_f32 v94, v94, v9
    v_mul_f32 v95, v95, v9
    v_cvt_pk_bf16_f32 v214, v92, v93
    v_cvt_pk_bf16_f32 v215, v94, v95
    buffer_store_dwordx4 v[212:215], v1, s[4:7], s36 offen offset:1024 sc1
    v_mul_f32 v100, v100, v9
    v_mul_f32 v101, v101, v9
    v_mul_f32 v102, v102, v9
    v_mul_f32 v103, v103, v9
    v_cvt_pk_bf16_f32 v216, v100, v101
    v_cvt_pk_bf16_f32 v217, v102, v103
    v_mul_f32 v108, v108, v9
    v_mul_f32 v109, v109, v9
    v_mul_f32 v110, v110, v9
    v_mul_f32 v111, v111, v9
    v_cvt_pk_bf16_f32 v218, v108, v109
    v_cvt_pk_bf16_f32 v219, v110, v111
    buffer_store_dwordx4 v[216:219], v1, s[4:7], s36 offen offset:2048 sc1
    v_mul_f32 v116, v116, v9
    v_mul_f32 v117, v117, v9
    v_mul_f32 v118, v118, v9
    v_mul_f32 v119, v119, v9
    v_cvt_pk_bf16_f32 v220, v116, v117
    v_cvt_pk_bf16_f32 v221, v118, v119
    v_mul_f32 v124, v124, v9
    v_mul_f32 v125, v125, v9
    v_mul_f32 v126, v126, v9
    v_mul_f32 v127, v127, v9
    v_cvt_pk_bf16_f32 v222, v124, v125
    v_cvt_pk_bf16_f32 v223, v126, v127
    buffer_store_dwordx4 v[220:223], v1, s[4:7], s36 offen offset:3072 sc1
    s_branch p2_kernel_fin
p2_kernel_hisafe_tailend:
p2_kernel_losafe_main:
    s_cmp_eq_u32 s9, 0
    s_cbranch_scc1 p2_kernel_losafe_final
    s_cmp_eq_u32 s9, 1
    s_cbranch_scc1 p2_kernel_losafe_peel
    s_sub_u32 s29, s9, 1
p2_kernel_losafe_loop:
    s_waitcnt vmcnt(8)
    s_barrier
    s_add_u32 s15, s8, 3
    s_min_u32 s28, s15, 31
    s_lshl_b32 s28, s28, 15
    s_add_u32 s28, s28, s13
    s_and_b32 s15, s15, 3
    s_lshl_b32 s15, s15, 15
    s_lshl_b32 s16, s17, 13
    s_add_u32 m0, s15, s16
    s_nop 0
    buffer_load_dwordx4 v1, s[4:7], s28 offen offset:0 lds
    buffer_load_dwordx4 v1, s[4:7], s28 offen offset:1024 lds
    buffer_load_dwordx4 v1, s[4:7], s28 offen offset:2048 lds
    buffer_load_dwordx4 v1, s[4:7], s28 offen offset:3072 lds
    s_add_u32 m0, m0, 4096
    s_add_u32 s28, s28, 4096
    buffer_load_dwordx4 v1, s[4:7], s28 offen offset:0 lds
    buffer_load_dwordx4 v1, s[4:7], s28 offen offset:1024 lds
    buffer_load_dwordx4 v1, s[4:7], s28 offen offset:2048 lds
    buffer_load_dwordx4 v1, s[4:7], s28 offen offset:3072 lds
    s_waitcnt lgkmcnt(0)
    v_mfma_f32_16x16x32_bf16 v[144:147], v[192:195], v[32:35], v[176:179]
    ds_read_b128 v[208:211], v2 offset:20480
    v_exp_f32 v128, v128
    v_exp_f32 v129, v129
    v_mfma_f32_16x16x32_bf16 v[144:147], v[196:199], v[36:39], v[144:147]
    v_exp_f32 v130, v130
    v_cvt_pk_bf16_f32 v224, v128, v129
    v_mfma_f32_16x16x32_bf16 v[144:147], v[200:203], v[40:43], v[144:147]
    ds_read_b128 v[212:215], v2 offset:21504
    v_exp_f32 v131, v131
    v_mfma_f32_16x16x32_bf16 v[144:147], v[204:207], v[44:47], v[144:147]
    v_exp_f32 v136, v136
    v_cvt_pk_bf16_f32 v225, v130, v131
    v_mfma_f32_16x16x32_bf16 v[148:151], v[192:195], v[48:51], v[180:183]
    ds_read_b128 v[216:219], v2 offset:22528
    v_exp_f32 v137, v137
    v_exp_f32 v138, v138
    v_mfma_f32_16x16x32_bf16 v[148:151], v[196:199], v[52:55], v[148:151]
    v_cvt_pk_bf16_f32 v226, v136, v137
    v_mfma_f32_16x16x32_bf16 v[148:151], v[200:203], v[56:59], v[148:151]
    ds_read_b128 v[220:223], v2 offset:23552
    v_exp_f32 v139, v139
    s_nop 0
    v_mfma_f32_16x16x32_bf16 v[148:151], v[204:207], v[60:63], v[148:151]
    v_cvt_pk_bf16_f32 v227, v138, v139
    s_waitcnt lgkmcnt(0)
    v_mfma_f32_16x16x32_bf16 v[152:155], v[208:211], v[32:35], v[184:187]
    ds_read_b128 v[192:195], v2 offset:8192
    v_exp_f32 v132, v132
    v_exp_f32 v133, v133
    v_mfma_f32_16x16x32_bf16 v[152:155], v[212:215], v[36:39], v[152:155]
    v_exp_f32 v134, v134
    v_cvt_pk_bf16_f32 v228, v132, v133
    v_mfma_f32_16x16x32_bf16 v[152:155], v[216:219], v[40:43], v[152:155]
    ds_read_b128 v[196:199], v2 offset:9216
    v_exp_f32 v135, v135
    v_mfma_f32_16x16x32_bf16 v[152:155], v[220:223], v[44:47], v[152:155]
    v_exp_f32 v140, v140
    v_cvt_pk_bf16_f32 v229, v134, v135
    v_mfma_f32_16x16x32_bf16 v[156:159], v[208:211], v[48:51], v[188:191]
    ds_read_b128 v[200:203], v2 offset:10240
    v_exp_f32 v141, v141
    v_exp_f32 v142, v142
    v_mfma_f32_16x16x32_bf16 v[156:159], v[212:215], v[52:55], v[156:159]
    v_cvt_pk_bf16_f32 v230, v140, v141
    v_mfma_f32_16x16x32_bf16 v[156:159], v[216:219], v[56:59], v[156:159]
    ds_read_b128 v[204:207], v2 offset:11264
    v_exp_f32 v143, v143
    s_nop 0
    v_mfma_f32_16x16x32_bf16 v[156:159], v[220:223], v[60:63], v[156:159]
    v_cvt_pk_bf16_f32 v231, v142, v143
    s_waitcnt lgkmcnt(2)
    v_mfma_f32_16x16x32_bf16 v[64:67], v[192:195], v[224:227], v[64:67]
    ds_read_b128 v[208:211], v2 offset:12288
    v_mfma_f32_16x16x32_bf16 v[68:71], v[192:195], v[228:231], v[68:71]
    v_mfma_f32_16x16x32_bf16 v[72:75], v[196:199], v[224:227], v[72:75]
    ds_read_b128 v[212:215], v2 offset:13312
    v_mfma_f32_16x16x32_bf16 v[76:79], v[196:199], v[228:231], v[76:79]
    s_waitcnt lgkmcnt(2)
    v_mfma_f32_16x16x32_bf16 v[80:83], v[200:203], v[224:227], v[80:83]
    ds_read_b128 v[216:219], v2 offset:14336
    v_mfma_f32_16x16x32_bf16 v[84:87], v[200:203], v[228:231], v[84:87]
    v_max3_f32 v8, v144, v145, v146
    v_mfma_f32_16x16x32_bf16 v[88:91], v[204:207], v[224:227], v[88:91]
    ds_read_b128 v[220:223], v2 offset:15360
    v_max3_f32 v9, v148, v149, v150
    v_mfma_f32_16x16x32_bf16 v[92:95], v[204:207], v[228:231], v[92:95]
    v_max3_f32 v10, v147, v152, v153
    s_waitcnt lgkmcnt(2)
    v_mfma_f32_16x16x32_bf16 v[96:99], v[208:211], v[224:227], v[96:99]
    ds_read_b128 v[192:195], v3 offset:0
    v_max3_f32 v11, v151, v156, v157
    v_mfma_f32_16x16x32_bf16 v[100:103], v[208:211], v[228:231], v[100:103]
    v_max3_f32 v8, v8, v154, v155
    v_mfma_f32_16x16x32_bf16 v[104:107], v[212:215], v[224:227], v[104:107]
    ds_read_b128 v[196:199], v3 offset:1024
    v_max3_f32 v9, v9, v158, v159
    v_mfma_f32_16x16x32_bf16 v[108:111], v[212:215], v[228:231], v[108:111]
    v_max_f32 v8, v8, v10
    s_waitcnt lgkmcnt(2)
    v_mfma_f32_16x16x32_bf16 v[112:115], v[216:219], v[224:227], v[112:115]
    ds_read_b128 v[200:203], v3 offset:2048
    v_max_f32 v9, v9, v11
    v_mfma_f32_16x16x32_bf16 v[116:119], v[216:219], v[228:231], v[116:119]
    v_max_f32 v10, v8, v9
    v_mfma_f32_16x16x32_bf16 v[120:123], v[220:223], v[224:227], v[120:123]
    ds_read_b128 v[204:207], v3 offset:3072
    v_cmp_lt_f32 vcc, s19, v10
    v_mfma_f32_16x16x32_bf16 v[124:127], v[220:223], v[228:231], v[124:127]
    v_mfma_f32_16x16x32_bf16 v[240:243], v[248:251], v[224:227], v[240:243]
    v_mfma_f32_16x16x32_bf16 v[244:247], v[248:251], v[228:231], v[244:247]
    s_cbranch_vccnz p2_kernel_losafe_l_sA
p2_kernel_losafe_l_sA_ret:
    s_waitcnt lgkmcnt(0)
    v_mfma_f32_16x16x32_bf16 v[128:131], v[192:195], v[32:35], v[160:163]
    ds_read_b128 v[208:211], v3 offset:4096
    v_exp_f32 v144, v144
    v_exp_f32 v145, v145
    v_mfma_f32_16x16x32_bf16 v[128:131], v[196:199], v[36:39], v[128:131]
    v_exp_f32 v146, v146
    v_cvt_pk_bf16_f32 v232, v144, v145
    v_mfma_f32_16x16x32_bf16 v[128:131], v[200:203], v[40:43], v[128:131]
    ds_read_b128 v[212:215], v3 offset:5120
    v_exp_f32 v147, v147
    v_mfma_f32_16x16x32_bf16 v[128:131], v[204:207], v[44:47], v[128:131]
    v_exp_f32 v152, v152
    v_cvt_pk_bf16_f32 v233, v146, v147
    v_mfma_f32_16x16x32_bf16 v[132:135], v[192:195], v[48:51], v[164:167]
    ds_read_b128 v[216:219], v3 offset:6144
    v_exp_f32 v153, v153
    v_exp_f32 v154, v154
    v_mfma_f32_16x16x32_bf16 v[132:135], v[196:199], v[52:55], v[132:135]
    v_cvt_pk_bf16_f32 v234, v152, v153
    v_mfma_f32_16x16x32_bf16 v[132:135], v[200:203], v[56:59], v[132:135]
    ds_read_b128 v[220:223], v3 offset:7168
    v_exp_f32 v155, v155
    s_nop 0
    v_mfma_f32_16x16x32_bf16 v[132:135], v[204:207], v[60:63], v[132:135]
    v_cvt_pk_bf16_f32 v235, v154, v155
    s_waitcnt lgkmcnt(0)
    v_mfma_f32_16x16x32_bf16 v[136:139], v[208:211], v[32:35], v[168:171]
    ds_read_b128 v[192:195], v2 offset:24576
    v_exp_f32 v148, v148
    v_exp_f32 v149, v149
    v_mfma_f32_16x16x32_bf16 v[136:139], v[212:215], v[36:39], v[136:139]
    v_exp_f32 v150, v150
    v_cvt_pk_bf16_f32 v236, v148, v149
    v_mfma_f32_16x16x32_bf16 v[136:139], v[216:219], v[40:43], v[136:139]
    ds_read_b128 v[196:199], v2 offset:25600
    v_exp_f32 v151, v151
    v_mfma_f32_16x16x32_bf16 v[136:139], v[220:223], v[44:47], v[136:139]
    v_exp_f32 v156, v156
    v_cvt_pk_bf16_f32 v237, v150, v151
    v_mfma_f32_16x16x32_bf16 v[140:143], v[208:211], v[48:51], v[172:175]
    ds_read_b128 v[200:203], v2 offset:26624
    v_exp_f32 v157, v157
    v_exp_f32 v158, v158
    v_mfma_f32_16x16x32_bf16 v[140:143], v[212:215], v[52:55], v[140:143]
    v_cvt_pk_bf16_f32 v238, v156, v157
    v_mfma_f32_16x16x32_bf16 v[140:143], v[216:219], v[56:59], v[140:143]
    ds_read_b128 v[204:207], v2 offset:27648
    v_exp_f32 v159, v159
    s_nop 0
    v_mfma_f32_16x16x32_bf16 v[140:143], v[220:223], v[60:63], v[140:143]
    v_cvt_pk_bf16_f32 v239, v158, v159
    s_waitcnt lgkmcnt(2)
    v_mfma_f32_16x16x32_bf16 v[64:67], v[192:195], v[232:235], v[64:67]
    ds_read_b128 v[208:211], v2 offset:28672
    v_mfma_f32_16x16x32_bf16 v[68:71], v[192:195], v[236:239], v[68:71]
    v_mfma_f32_16x16x32_bf16 v[72:75], v[196:199], v[232:235], v[72:75]
    ds_read_b128 v[212:215], v2 offset:29696
    v_mfma_f32_16x16x32_bf16 v[76:79], v[196:199], v[236:239], v[76:79]
    s_waitcnt lgkmcnt(2)
    v_mfma_f32_16x16x32_bf16 v[80:83], v[200:203], v[232:235], v[80:83]
    ds_read_b128 v[216:219], v2 offset:30720
    v_mfma_f32_16x16x32_bf16 v[84:87], v[200:203], v[236:239], v[84:87]
    v_max3_f32 v8, v128, v129, v130
    v_mfma_f32_16x16x32_bf16 v[88:91], v[204:207], v[232:235], v[88:91]
    ds_read_b128 v[220:223], v2 offset:31744
    v_max3_f32 v9, v132, v133, v134
    v_mfma_f32_16x16x32_bf16 v[92:95], v[204:207], v[236:239], v[92:95]
    v_max3_f32 v10, v131, v136, v137
    s_waitcnt lgkmcnt(2)
    v_mfma_f32_16x16x32_bf16 v[96:99], v[208:211], v[232:235], v[96:99]
    ds_read_b128 v[192:195], v3 offset:16384
    v_max3_f32 v11, v135, v140, v141
    v_mfma_f32_16x16x32_bf16 v[100:103], v[208:211], v[236:239], v[100:103]
    v_max3_f32 v8, v8, v138, v139
    v_mfma_f32_16x16x32_bf16 v[104:107], v[212:215], v[232:235], v[104:107]
    ds_read_b128 v[196:199], v3 offset:17408
    v_max3_f32 v9, v9, v142, v143
    s_add_u32 s8, s8, 1
    v_mfma_f32_16x16x32_bf16 v[108:111], v[212:215], v[236:239], v[108:111]
    v_max_f32 v8, v8, v10
    s_add_u32 s15, s8, 1
    s_waitcnt lgkmcnt(2)
    v_mfma_f32_16x16x32_bf16 v[112:115], v[216:219], v[232:235], v[112:115]
    ds_read_b128 v[200:203], v3 offset:18432
    v_max_f32 v9, v9, v11
    s_and_b32 s15, s15, 3
    v_mfma_f32_16x16x32_bf16 v[116:119], v[216:219], v[236:239], v[116:119]
    v_max_f32 v10, v8, v9
    s_lshl_b32 s15, s15, 15
    v_mfma_f32_16x16x32_bf16 v[120:123], v[220:223], v[232:235], v[120:123]
    ds_read_b128 v[204:207], v3 offset:19456
    v_cmp_lt_f32 vcc, s19, v10
    v_mfma_f32_16x16x32_bf16 v[124:127], v[220:223], v[236:239], v[124:127]
    v_mfma_f32_16x16x32_bf16 v[240:243], v[248:251], v[232:235], v[240:243]
    v_mfma_f32_16x16x32_bf16 v[244:247], v[248:251], v[236:239], v[244:247]
    s_cbranch_vccnz p2_kernel_losafe_l_sB
p2_kernel_losafe_l_sB_ret:
    v_mov_b32 v2, v3
    v_add_u32 v3, s15, v1
    s_cmp_lt_u32 s8, s29
    s_cbranch_scc1 p2_kernel_losafe_loop
p2_kernel_losafe_peel:
    s_waitcnt vmcnt(8)
    s_barrier
    s_add_u32 s15, s8, 3
    s_min_u32 s28, s15, 31
    s_lshl_b32 s28, s28, 15
    s_add_u32 s28, s28, s13
    s_and_b32 s15, s15, 3
    s_lshl_b32 s15, s15, 15
    s_lshl_b32 s16, s17, 13
    s_add_u32 m0, s15, s16
    s_nop 0
    buffer_load_dwordx4 v1, s[4:7], s28 offen offset:0 lds
    buffer_load_dwordx4 v1, s[4:7], s28 offen offset:1024 lds
    buffer_load_dwordx4 v1, s[4:7], s28 offen offset:2048 lds
    buffer_load_dwordx4 v1, s[4:7], s28 offen offset:3072 lds
    s_add_u32 m0, m0, 4096
    s_add_u32 s28, s28, 4096
    buffer_load_dwordx4 v1, s[4:7], s28 offen offset:0 lds
    buffer_load_dwordx4 v1, s[4:7], s28 offen offset:1024 lds
    buffer_load_dwordx4 v1, s[4:7], s28 offen offset:2048 lds
    buffer_load_dwordx4 v1, s[4:7], s28 offen offset:3072 lds
    v_cmp_le_i32 s[20:21], 0, v18
    v_cmp_le_i32 s[22:23], 1, v18
    v_cmp_le_i32 s[24:25], 2, v18
    v_cmp_le_i32 s[26:27], 3, v18
    v_cndmask_b32 v160, v19, v160, s[20:21]
    v_cndmask_b32 v161, v19, v161, s[22:23]
    v_cndmask_b32 v162, v19, v162, s[24:25]
    v_cndmask_b32 v163, v19, v163, s[26:27]
    v_cmp_le_i32 s[20:21], -16, v18
    v_cmp_le_i32 s[22:23], -15, v18
    v_cmp_le_i32 s[24:25], -14, v18
    v_cmp_le_i32 s[26:27], -13, v18
    v_cndmask_b32 v164, v19, v164, s[20:21]
    v_cndmask_b32 v165, v19, v165, s[22:23]
    v_cndmask_b32 v166, v19, v166, s[24:25]
    v_cndmask_b32 v167, v19, v167, s[26:27]
    v_cmp_le_i32 s[20:21], 16, v18
    v_cmp_le_i32 s[22:23], 17, v18
    v_cmp_le_i32 s[24:25], 18, v18
    v_cmp_le_i32 s[26:27], 19, v18
    v_cndmask_b32 v168, v19, v168, s[20:21]
    v_cndmask_b32 v169, v19, v169, s[22:23]
    v_cndmask_b32 v170, v19, v170, s[24:25]
    v_cndmask_b32 v171, v19, v171, s[26:27]
    v_cmp_le_i32 s[20:21], 0, v18
    v_cmp_le_i32 s[22:23], 1, v18
    v_cmp_le_i32 s[24:25], 2, v18
    v_cmp_le_i32 s[26:27], 3, v18
    v_cndmask_b32 v172, v19, v172, s[20:21]
    v_cndmask_b32 v173, v19, v173, s[22:23]
    v_cndmask_b32 v174, v19, v174, s[24:25]
    v_cndmask_b32 v175, v19, v175, s[26:27]
    s_nop 1
    s_waitcnt lgkmcnt(0)
    v_mfma_f32_16x16x32_bf16 v[144:147], v[192:195], v[32:35], v[176:179]
    ds_read_b128 v[208:211], v2 offset:20480
    v_exp_f32 v128, v128
    v_exp_f32 v129, v129
    v_mfma_f32_16x16x32_bf16 v[144:147], v[196:199], v[36:39], v[144:147]
    v_exp_f32 v130, v130
    v_cvt_pk_bf16_f32 v224, v128, v129
    v_mfma_f32_16x16x32_bf16 v[144:147], v[200:203], v[40:43], v[144:147]
    ds_read_b128 v[212:215], v2 offset:21504
    v_exp_f32 v131, v131
    v_mfma_f32_16x16x32_bf16 v[144:147], v[204:207], v[44:47], v[144:147]
    v_exp_f32 v136, v136
    v_cvt_pk_bf16_f32 v225, v130, v131
    v_mfma_f32_16x16x32_bf16 v[148:151], v[192:195], v[48:51], v[180:183]
    ds_read_b128 v[216:219], v2 offset:22528
    v_exp_f32 v137, v137
    v_exp_f32 v138, v138
    v_mfma_f32_16x16x32_bf16 v[148:151], v[196:199], v[52:55], v[148:151]
    v_cvt_pk_bf16_f32 v226, v136, v137
    v_mfma_f32_16x16x32_bf16 v[148:151], v[200:203], v[56:59], v[148:151]
    ds_read_b128 v[220:223], v2 offset:23552
    v_exp_f32 v139, v139
    s_nop 0
    v_mfma_f32_16x16x32_bf16 v[148:151], v[204:207], v[60:63], v[148:151]
    v_cvt_pk_bf16_f32 v227, v138, v139
    s_waitcnt lgkmcnt(0)
    v_mfma_f32_16x16x32_bf16 v[152:155], v[208:211], v[32:35], v[184:187]
    ds_read_b128 v[192:195], v2 offset:8192
    v_exp_f32 v132, v132
    v_exp_f32 v133, v133
    v_mfma_f32_16x16x32_bf16 v[152:155], v[212:215], v[36:39], v[152:155]
    v_exp_f32 v134, v134
    v_cvt_pk_bf16_f32 v228, v132, v133
    v_mfma_f32_16x16x32_bf16 v[152:155], v[216:219], v[40:43], v[152:155]
    ds_read_b128 v[196:199], v2 offset:9216
    v_exp_f32 v135, v135
    v_mfma_f32_16x16x32_bf16 v[152:155], v[220:223], v[44:47], v[152:155]
    v_exp_f32 v140, v140
    v_cvt_pk_bf16_f32 v229, v134, v135
    v_mfma_f32_16x16x32_bf16 v[156:159], v[208:211], v[48:51], v[188:191]
    ds_read_b128 v[200:203], v2 offset:10240
    v_exp_f32 v141, v141
    v_exp_f32 v142, v142
    v_mfma_f32_16x16x32_bf16 v[156:159], v[212:215], v[52:55], v[156:159]
    v_cvt_pk_bf16_f32 v230, v140, v141
    v_mfma_f32_16x16x32_bf16 v[156:159], v[216:219], v[56:59], v[156:159]
    ds_read_b128 v[204:207], v2 offset:11264
    v_exp_f32 v143, v143
    s_nop 0
    v_mfma_f32_16x16x32_bf16 v[156:159], v[220:223], v[60:63], v[156:159]
    v_cvt_pk_bf16_f32 v231, v142, v143
    s_waitcnt lgkmcnt(2)
    v_mfma_f32_16x16x32_bf16 v[64:67], v[192:195], v[224:227], v[64:67]
    ds_read_b128 v[208:211], v2 offset:12288
    v_mfma_f32_16x16x32_bf16 v[68:71], v[192:195], v[228:231], v[68:71]
    v_mfma_f32_16x16x32_bf16 v[72:75], v[196:199], v[224:227], v[72:75]
    ds_read_b128 v[212:215], v2 offset:13312
    v_mfma_f32_16x16x32_bf16 v[76:79], v[196:199], v[228:231], v[76:79]
    s_waitcnt lgkmcnt(2)
    v_mfma_f32_16x16x32_bf16 v[80:83], v[200:203], v[224:227], v[80:83]
    ds_read_b128 v[216:219], v2 offset:14336
    v_mfma_f32_16x16x32_bf16 v[84:87], v[200:203], v[228:231], v[84:87]
    v_max3_f32 v8, v144, v145, v146
    v_mfma_f32_16x16x32_bf16 v[88:91], v[204:207], v[224:227], v[88:91]
    ds_read_b128 v[220:223], v2 offset:15360
    v_max3_f32 v9, v148, v149, v150
    v_mfma_f32_16x16x32_bf16 v[92:95], v[204:207], v[228:231], v[92:95]
    v_max3_f32 v10, v147, v152, v153
    s_waitcnt lgkmcnt(2)
    v_mfma_f32_16x16x32_bf16 v[96:99], v[208:211], v[224:227], v[96:99]
    ds_read_b128 v[192:195], v3 offset:0
    v_max3_f32 v11, v151, v156, v157
    v_mfma_f32_16x16x32_bf16 v[100:103], v[208:211], v[228:231], v[100:103]
    v_max3_f32 v8, v8, v154, v155
    v_mfma_f32_16x16x32_bf16 v[104:107], v[212:215], v[224:227], v[104:107]
    ds_read_b128 v[196:199], v3 offset:1024
    v_max3_f32 v9, v9, v158, v159
    v_mfma_f32_16x16x32_bf16 v[108:111], v[212:215], v[228:231], v[108:111]
    v_max_f32 v8, v8, v10
    s_waitcnt lgkmcnt(2)
    v_mfma_f32_16x16x32_bf16 v[112:115], v[216:219], v[224:227], v[112:115]
    ds_read_b128 v[200:203], v3 offset:2048
    v_max_f32 v9, v9, v11
    v_mfma_f32_16x16x32_bf16 v[116:119], v[216:219], v[228:231], v[116:119]
    v_max_f32 v10, v8, v9
    v_mfma_f32_16x16x32_bf16 v[120:123], v[220:223], v[224:227], v[120:123]
    ds_read_b128 v[204:207], v3 offset:3072
    v_cmp_lt_f32 vcc, s19, v10
    v_mfma_f32_16x16x32_bf16 v[124:127], v[220:223], v[228:231], v[124:127]
    v_mfma_f32_16x16x32_bf16 v[240:243], v[248:251], v[224:227], v[240:243]
    v_mfma_f32_16x16x32_bf16 v[244:247], v[248:251], v[228:231], v[244:247]
    s_cbranch_vccnz p2_kernel_losafe_p_sA
p2_kernel_losafe_p_sA_ret:
    s_waitcnt lgkmcnt(0)
    v_mfma_f32_16x16x32_bf16 v[128:131], v[192:195], v[32:35], v[160:163]
    ds_read_b128 v[208:211], v3 offset:4096
    v_exp_f32 v144, v144
    v_exp_f32 v145, v145
    v_mfma_f32_16x16x32_bf16 v[128:131], v[196:199], v[36:39], v[128:131]
    v_exp_f32 v146, v146
    v_cvt_pk_bf16_f32 v232, v144, v145
    v_mfma_f32_16x16x32_bf16 v[128:131], v[200:203], v[40:43], v[128:131]
    ds_read_b128 v[212:215], v3 offset:5120
    v_exp_f32 v147, v147
    v_mfma_f32_16x16x32_bf16 v[128:131], v[204:207], v[44:47], v[128:131]
    v_exp_f32 v152, v152
    v_cvt_pk_bf16_f32 v233, v146, v147
    v_mfma_f32_16x16x32_bf16 v[132:135], v[192:195], v[48:51], v[164:167]
    ds_read_b128 v[216:219], v3 offset:6144
    v_exp_f32 v153, v153
    v_exp_f32 v154, v154
    v_mfma_f32_16x16x32_bf16 v[132:135], v[196:199], v[52:55], v[132:135]
    v_cvt_pk_bf16_f32 v234, v152, v153
    v_mfma_f32_16x16x32_bf16 v[132:135], v[200:203], v[56:59], v[132:135]
    ds_read_b128 v[220:223], v3 offset:7168
    v_exp_f32 v155, v155
    s_nop 0
    v_mfma_f32_16x16x32_bf16 v[132:135], v[204:207], v[60:63], v[132:135]
    v_cvt_pk_bf16_f32 v235, v154, v155
    s_waitcnt lgkmcnt(0)
    v_mfma_f32_16x16x32_bf16 v[136:139], v[208:211], v[32:35], v[168:171]
    ds_read_b128 v[192:195], v2 offset:24576
    v_exp_f32 v148, v148
    v_exp_f32 v149, v149
    v_mfma_f32_16x16x32_bf16 v[136:139], v[212:215], v[36:39], v[136:139]
    v_exp_f32 v150, v150
    v_cvt_pk_bf16_f32 v236, v148, v149
    v_mfma_f32_16x16x32_bf16 v[136:139], v[216:219], v[40:43], v[136:139]
    ds_read_b128 v[196:199], v2 offset:25600
    v_exp_f32 v151, v151
    v_mfma_f32_16x16x32_bf16 v[136:139], v[220:223], v[44:47], v[136:139]
    v_exp_f32 v156, v156
    v_cvt_pk_bf16_f32 v237, v150, v151
    v_mfma_f32_16x16x32_bf16 v[140:143], v[208:211], v[48:51], v[172:175]
    ds_read_b128 v[200:203], v2 offset:26624
    v_exp_f32 v157, v157
    v_exp_f32 v158, v158
    v_mfma_f32_16x16x32_bf16 v[140:143], v[212:215], v[52:55], v[140:143]
    v_cvt_pk_bf16_f32 v238, v156, v157
    v_mfma_f32_16x16x32_bf16 v[140:143], v[216:219], v[56:59], v[140:143]
    ds_read_b128 v[204:207], v2 offset:27648
    v_exp_f32 v159, v159
    s_nop 0
    v_mfma_f32_16x16x32_bf16 v[140:143], v[220:223], v[60:63], v[140:143]
    v_cvt_pk_bf16_f32 v239, v158, v159
    s_waitcnt lgkmcnt(2)
    v_mfma_f32_16x16x32_bf16 v[64:67], v[192:195], v[232:235], v[64:67]
    ds_read_b128 v[208:211], v2 offset:28672
    v_mfma_f32_16x16x32_bf16 v[68:71], v[192:195], v[236:239], v[68:71]
    v_mfma_f32_16x16x32_bf16 v[72:75], v[196:199], v[232:235], v[72:75]
    ds_read_b128 v[212:215], v2 offset:29696
    v_mfma_f32_16x16x32_bf16 v[76:79], v[196:199], v[236:239], v[76:79]
    s_waitcnt lgkmcnt(2)
    v_mfma_f32_16x16x32_bf16 v[80:83], v[200:203], v[232:235], v[80:83]
    ds_read_b128 v[216:219], v2 offset:30720
    v_mfma_f32_16x16x32_bf16 v[84:87], v[200:203], v[236:239], v[84:87]
    v_max3_f32 v8, v128, v129, v130
    v_mfma_f32_16x16x32_bf16 v[88:91], v[204:207], v[232:235], v[88:91]
    ds_read_b128 v[220:223], v2 offset:31744
    v_max3_f32 v9, v132, v133, v134
    v_mfma_f32_16x16x32_bf16 v[92:95], v[204:207], v[236:239], v[92:95]
    v_max3_f32 v10, v131, v136, v137
    s_waitcnt lgkmcnt(2)
    v_mfma_f32_16x16x32_bf16 v[96:99], v[208:211], v[232:235], v[96:99]
    ds_read_b128 v[192:195], v3 offset:16384
    v_max3_f32 v11, v135, v140, v141
    v_mfma_f32_16x16x32_bf16 v[100:103], v[208:211], v[236:239], v[100:103]
    v_max3_f32 v8, v8, v138, v139
    v_mfma_f32_16x16x32_bf16 v[104:107], v[212:215], v[232:235], v[104:107]
    ds_read_b128 v[196:199], v3 offset:17408
    v_max3_f32 v9, v9, v142, v143
    s_add_u32 s8, s8, 1
    v_mfma_f32_16x16x32_bf16 v[108:111], v[212:215], v[236:239], v[108:111]
    v_max_f32 v8, v8, v10
    s_add_u32 s15, s8, 1
    s_waitcnt lgkmcnt(2)
    v_mfma_f32_16x16x32_bf16 v[112:115], v[216:219], v[232:235], v[112:115]
    ds_read_b128 v[200:203], v3 offset:18432
    v_max_f32 v9, v9, v11
    s_and_b32 s15, s15, 3
    v_mfma_f32_16x16x32_bf16 v[116:119], v[216:219], v[236:239], v[116:119]
    v_max_f32 v10, v8, v9
    s_lshl_b32 s15, s15, 15
    v_mfma_f32_16x16x32_bf16 v[120:123], v[220:223], v[232:235], v[120:123]
    ds_read_b128 v[204:207], v3 offset:19456
    v_cmp_lt_f32 vcc, s19, v10
    v_mfma_f32_16x16x32_bf16 v[124:127], v[220:223], v[236:239], v[124:127]
    v_mfma_f32_16x16x32_bf16 v[240:243], v[248:251], v[232:235], v[240:243]
    v_mfma_f32_16x16x32_bf16 v[244:247], v[248:251], v[236:239], v[244:247]
    s_cbranch_vccnz p2_kernel_losafe_p_sB
p2_kernel_losafe_p_sB_ret:
    v_mov_b32 v2, v3
    v_add_u32 v3, s15, v1
p2_kernel_losafe_final:
    s_waitcnt vmcnt(8)
    s_barrier
    s_add_u32 s15, s8, 3
    s_min_u32 s28, s15, 31
    s_lshl_b32 s28, s28, 15
    s_add_u32 s28, s28, s13
    s_and_b32 s15, s15, 3
    s_lshl_b32 s15, s15, 15
    s_lshl_b32 s16, s17, 13
    s_add_u32 m0, s15, s16
    s_nop 0
    buffer_load_dwordx4 v1, s[4:7], s28 offen offset:0 lds
    buffer_load_dwordx4 v1, s[4:7], s28 offen offset:1024 lds
    buffer_load_dwordx4 v1, s[4:7], s28 offen offset:2048 lds
    buffer_load_dwordx4 v1, s[4:7], s28 offen offset:3072 lds
    s_add_u32 m0, m0, 4096
    s_add_u32 s28, s28, 4096
    buffer_load_dwordx4 v1, s[4:7], s28 offen offset:0 lds
    buffer_load_dwordx4 v1, s[4:7], s28 offen offset:1024 lds
    buffer_load_dwordx4 v1, s[4:7], s28 offen offset:2048 lds
    buffer_load_dwordx4 v1, s[4:7], s28 offen offset:3072 lds
    v_cmp_le_i32 s[20:21], 32, v18
    v_cmp_le_i32 s[22:23], 33, v18
    v_cmp_le_i32 s[24:25], 34, v18
    v_cmp_le_i32 s[26:27], 35, v18
    v_cndmask_b32 v176, v19, v176, s[20:21]
    v_cndmask_b32 v177, v19, v177, s[22:23]
    v_cndmask_b32 v178, v19, v178, s[24:25]
    v_cndmask_b32 v179, v19, v179, s[26:27]
    v_cmp_le_i32 s[20:21], 16, v18
    v_cmp_le_i32 s[22:23], 17, v18
    v_cmp_le_i32 s[24:25], 18, v18
    v_cmp_le_i32 s[26:27], 19, v18
    v_cndmask_b32 v180, v19, v180, s[20:21]
    v_cndmask_b32 v181, v19, v181, s[22:23]
    v_cndmask_b32 v182, v19, v182, s[24:25]
    v_cndmask_b32 v183, v19, v183, s[26:27]
    v_cmp_le_i32 s[20:21], 48, v18
    v_cmp_le_i32 s[22:23], 49, v18
    v_cmp_le_i32 s[24:25], 50, v18
    v_cmp_le_i32 s[26:27], 51, v18
    v_cndmask_b32 v184, v19, v184, s[20:21]
    v_cndmask_b32 v185, v19, v185, s[22:23]
    v_cndmask_b32 v186, v19, v186, s[24:25]
    v_cndmask_b32 v187, v19, v187, s[26:27]
    v_cmp_le_i32 s[20:21], 32, v18
    v_cmp_le_i32 s[22:23], 33, v18
    v_cmp_le_i32 s[24:25], 34, v18
    v_cmp_le_i32 s[26:27], 35, v18
    v_cndmask_b32 v188, v19, v188, s[20:21]
    v_cndmask_b32 v189, v19, v189, s[22:23]
    v_cndmask_b32 v190, v19, v190, s[24:25]
    v_cndmask_b32 v191, v19, v191, s[26:27]
    s_nop 1
    s_waitcnt lgkmcnt(2)
    v_mfma_f32_16x16x32_bf16 v[144:147], v[192:195], v[32:35], v[176:179]
    ds_read_b128 v[208:211], v2 offset:20480
    v_exp_f32 v128, v128
    v_exp_f32 v129, v129
    v_mfma_f32_16x16x32_bf16 v[144:147], v[196:199], v[36:39], v[144:147]
    v_exp_f32 v130, v130
    v_cvt_pk_bf16_f32 v224, v128, v129
    s_waitcnt lgkmcnt(1)
    v_mfma_f32_16x16x32_bf16 v[144:147], v[200:203], v[40:43], v[144:147]
    ds_read_b128 v[212:215], v2 offset:21504
    v_exp_f32 v131, v131
    v_mfma_f32_16x16x32_bf16 v[144:147], v[204:207], v[44:47], v[144:147]
    v_exp_f32 v136, v136
    v_cvt_pk_bf16_f32 v225, v130, v131
    v_mfma_f32_16x16x32_bf16 v[148:151], v[192:195], v[48:51], v[180:183]
    ds_read_b128 v[216:219], v2 offset:22528
    v_exp_f32 v137, v137
    v_exp_f32 v138, v138
    v_mfma_f32_16x16x32_bf16 v[148:151], v[196:199], v[52:55], v[148:151]
    v_cvt_pk_bf16_f32 v226, v136, v137
    v_mfma_f32_16x16x32_bf16 v[148:151], v[200:203], v[56:59], v[148:151]
    ds_read_b128 v[220:223], v2 offset:23552
    v_exp_f32 v139, v139
    s_nop 0
    v_mfma_f32_16x16x32_bf16 v[148:151], v[204:207], v[60:63], v[148:151]
    v_cvt_pk_bf16_f32 v227, v138, v139
    s_waitcnt lgkmcnt(2)
    v_mfma_f32_16x16x32_bf16 v[152:155], v[208:211], v[32:35], v[184:187]
    ds_read_b128 v[192:195], v2 offset:8192
    v_exp_f32 v132, v132
    v_exp_f32 v133, v133
    v_mfma_f32_16x16x32_bf16 v[152:155], v[212:215], v[36:39], v[152:155]
    v_exp_f32 v134, v134
    v_cvt_pk_bf16_f32 v228, v132, v133
    s_waitcnt lgkmcnt(1)
    v_mfma_f32_16x16x32_bf16 v[152:155], v[216:219], v[40:43], v[152:155]
    ds_read_b128 v[196:199], v2 offset:9216
    v_exp_f32 v135, v135
    v_mfma_f32_16x16x32_bf16 v[152:155], v[220:223], v[44:47], v[152:155]
    v_exp_f32 v140, v140
    v_cvt_pk_bf16_f32 v229, v134, v135
    v_mfma_f32_16x16x32_bf16 v[156:159], v[208:211], v[48:51], v[188:191]
    ds_read_b128 v[200:203], v2 offset:10240
    v_exp_f32 v141, v141
    v_exp_f32 v142, v142
    v_mfma_f32_16x16x32_bf16 v[156:159], v[212:215], v[52:55], v[156:159]
    v_cvt_pk_bf16_f32 v230, v140, v141
    v_mfma_f32_16x16x32_bf16 v[156:159], v[216:219], v[56:59], v[156:159]
    ds_read_b128 v[204:207], v2 offset:11264
    v_exp_f32 v143, v143
    s_nop 0
    v_mfma_f32_16x16x32_bf16 v[156:159], v[220:223], v[60:63], v[156:159]
    v_cvt_pk_bf16_f32 v231, v142, v143
    s_waitcnt lgkmcnt(3)
    v_mfma_f32_16x16x32_bf16 v[64:67], v[192:195], v[224:227], v[64:67]
    ds_read_b128 v[208:211], v2 offset:12288
    v_mfma_f32_16x16x32_bf16 v[68:71], v[192:195], v[228:231], v[68:71]
    s_waitcnt lgkmcnt(3)
    v_mfma_f32_16x16x32_bf16 v[72:75], v[196:199], v[224:227], v[72:75]
    ds_read_b128 v[212:215], v2 offset:13312
    v_mfma_f32_16x16x32_bf16 v[76:79], v[196:199], v[228:231], v[76:79]
    s_waitcnt lgkmcnt(3)
    v_mfma_f32_16x16x32_bf16 v[80:83], v[200:203], v[224:227], v[80:83]
    ds_read_b128 v[216:219], v2 offset:14336
    v_mfma_f32_16x16x32_bf16 v[84:87], v[200:203], v[228:231], v[84:87]
    v_max3_f32 v8, v144, v145, v146
    s_waitcnt lgkmcnt(3)
    v_mfma_f32_16x16x32_bf16 v[88:91], v[204:207], v[224:227], v[88:91]
    ds_read_b128 v[220:223], v2 offset:15360
    v_max3_f32 v9, v148, v149, v150
    v_mfma_f32_16x16x32_bf16 v[92:95], v[204:207], v[228:231], v[92:95]
    v_max3_f32 v10, v147, v152, v153
    s_waitcnt lgkmcnt(3)
    v_mfma_f32_16x16x32_bf16 v[96:99], v[208:211], v[224:227], v[96:99]
    v_max3_f32 v11, v151, v156, v157
    v_mfma_f32_16x16x32_bf16 v[100:103], v[208:211], v[228:231], v[100:103]
    v_max3_f32 v8, v8, v154, v155
    s_waitcnt lgkmcnt(2)
    v_mfma_f32_16x16x32_bf16 v[104:107], v[212:215], v[224:227], v[104:107]
    v_max3_f32 v9, v9, v158, v159
    v_mfma_f32_16x16x32_bf16 v[108:111], v[212:215], v[228:231], v[108:111]
    v_max_f32 v8, v8, v10
    s_waitcnt lgkmcnt(1)
    v_mfma_f32_16x16x32_bf16 v[112:115], v[216:219], v[224:227], v[112:115]
    v_max_f32 v9, v9, v11
    v_mfma_f32_16x16x32_bf16 v[116:119], v[216:219], v[228:231], v[116:119]
    v_max_f32 v10, v8, v9
    s_waitcnt lgkmcnt(0)
    v_mfma_f32_16x16x32_bf16 v[120:123], v[220:223], v[224:227], v[120:123]
    v_cmp_lt_f32 vcc, s19, v10
    v_mfma_f32_16x16x32_bf16 v[124:127], v[220:223], v[228:231], v[124:127]
    v_mfma_f32_16x16x32_bf16 v[240:243], v[248:251], v[224:227], v[240:243]
    v_mfma_f32_16x16x32_bf16 v[244:247], v[248:251], v[228:231], v[244:247]
    s_cbranch_vccnz p2_kernel_losafe_f_sA
p2_kernel_losafe_f_sA_ret:
    v_exp_f32 v144, v144
    v_exp_f32 v145, v145
    v_exp_f32 v146, v146
    v_cvt_pk_bf16_f32 v232, v144, v145
    v_exp_f32 v147, v147
    v_exp_f32 v152, v152
    v_cvt_pk_bf16_f32 v233, v146, v147
    v_exp_f32 v153, v153
    v_exp_f32 v154, v154
    v_cvt_pk_bf16_f32 v234, v152, v153
    v_exp_f32 v155, v155
    s_nop 0
    v_cvt_pk_bf16_f32 v235, v154, v155
    ds_read_b128 v[192:195], v2 offset:24576
    v_exp_f32 v148, v148
    v_exp_f32 v149, v149
    v_exp_f32 v150, v150
    v_cvt_pk_bf16_f32 v236, v148, v149
    ds_read_b128 v[196:199], v2 offset:25600
    v_exp_f32 v151, v151
    v_exp_f32 v156, v156
    v_cvt_pk_bf16_f32 v237, v150, v151
    ds_read_b128 v[200:203], v2 offset:26624
    v_exp_f32 v157, v157
    v_exp_f32 v158, v158
    v_cvt_pk_bf16_f32 v238, v156, v157
    ds_read_b128 v[204:207], v2 offset:27648
    v_exp_f32 v159, v159
    s_nop 0
    v_cvt_pk_bf16_f32 v239, v158, v159
    s_waitcnt lgkmcnt(3)
    v_mfma_f32_16x16x32_bf16 v[64:67], v[192:195], v[232:235], v[64:67]
    ds_read_b128 v[208:211], v2 offset:28672
    v_mfma_f32_16x16x32_bf16 v[68:71], v[192:195], v[236:239], v[68:71]
    s_waitcnt lgkmcnt(3)
    v_mfma_f32_16x16x32_bf16 v[72:75], v[196:199], v[232:235], v[72:75]
    ds_read_b128 v[212:215], v2 offset:29696
    v_mfma_f32_16x16x32_bf16 v[76:79], v[196:199], v[236:239], v[76:79]
    s_waitcnt lgkmcnt(3)
    v_mfma_f32_16x16x32_bf16 v[80:83], v[200:203], v[232:235], v[80:83]
    ds_read_b128 v[216:219], v2 offset:30720
    v_mfma_f32_16x16x32_bf16 v[84:87], v[200:203], v[236:239], v[84:87]
    s_waitcnt lgkmcnt(3)
    v_mfma_f32_16x16x32_bf16 v[88:91], v[204:207], v[232:235], v[88:91]
    ds_read_b128 v[220:223], v2 offset:31744
    v_mfma_f32_16x16x32_bf16 v[92:95], v[204:207], v[236:239], v[92:95]
    s_waitcnt lgkmcnt(3)
    v_mfma_f32_16x16x32_bf16 v[96:99], v[208:211], v[232:235], v[96:99]
    v_mfma_f32_16x16x32_bf16 v[100:103], v[208:211], v[236:239], v[100:103]
    s_waitcnt lgkmcnt(2)
    v_mfma_f32_16x16x32_bf16 v[104:107], v[212:215], v[232:235], v[104:107]
    v_mfma_f32_16x16x32_bf16 v[108:111], v[212:215], v[236:239], v[108:111]
    s_waitcnt lgkmcnt(1)
    v_mfma_f32_16x16x32_bf16 v[112:115], v[216:219], v[232:235], v[112:115]
    v_mfma_f32_16x16x32_bf16 v[116:119], v[216:219], v[236:239], v[116:119]
    s_waitcnt lgkmcnt(0)
    v_mfma_f32_16x16x32_bf16 v[120:123], v[220:223], v[232:235], v[120:123]
    v_mfma_f32_16x16x32_bf16 v[124:127], v[220:223], v[236:239], v[124:127]
    v_mfma_f32_16x16x32_bf16 v[240:243], v[248:251], v[232:235], v[240:243]
    v_mfma_f32_16x16x32_bf16 v[244:247], v[248:251], v[236:239], v[244:247]
    s_nop 7
    v_rcp_f32 v8, v240
    v_rcp_f32 v9, v244
    s_nop 0
    s_lshl_b32 s36, s18, 1
    s_mul_i32 s36, s36, 171
    s_lshl_b32 s37, s12, 2
    s_add_u32 s36, s36, s37
    s_lshl_b32 s36, s36, 10
    s_add_u32 s36, s36, 0x3000000
    v_mul_f32 v64, v64, v8
    v_mul_f32 v65, v65, v8
    v_mul_f32 v66, v66, v8
    v_mul_f32 v67, v67, v8
    v_cvt_pk_bf16_f32 v192, v64, v65
    v_cvt_pk_bf16_f32 v193, v66, v67
    v_mul_f32 v72, v72, v8
    v_mul_f32 v73, v73, v8
    v_mul_f32 v74, v74, v8
    v_mul_f32 v75, v75, v8
    v_cvt_pk_bf16_f32 v194, v72, v73
    v_cvt_pk_bf16_f32 v195, v74, v75
    buffer_store_dwordx4 v[192:195], v1, s[4:7], s36 offen offset:0 sc1
    v_mul_f32 v80, v80, v8
    v_mul_f32 v81, v81, v8
    v_mul_f32 v82, v82, v8
    v_mul_f32 v83, v83, v8
    v_cvt_pk_bf16_f32 v196, v80, v81
    v_cvt_pk_bf16_f32 v197, v82, v83
    v_mul_f32 v88, v88, v8
    v_mul_f32 v89, v89, v8
    v_mul_f32 v90, v90, v8
    v_mul_f32 v91, v91, v8
    v_cvt_pk_bf16_f32 v198, v88, v89
    v_cvt_pk_bf16_f32 v199, v90, v91
    buffer_store_dwordx4 v[196:199], v1, s[4:7], s36 offen offset:1024 sc1
    v_mul_f32 v96, v96, v8
    v_mul_f32 v97, v97, v8
    v_mul_f32 v98, v98, v8
    v_mul_f32 v99, v99, v8
    v_cvt_pk_bf16_f32 v200, v96, v97
    v_cvt_pk_bf16_f32 v201, v98, v99
    v_mul_f32 v104, v104, v8
    v_mul_f32 v105, v105, v8
    v_mul_f32 v106, v106, v8
    v_mul_f32 v107, v107, v8
    v_cvt_pk_bf16_f32 v202, v104, v105
    v_cvt_pk_bf16_f32 v203, v106, v107
    buffer_store_dwordx4 v[200:203], v1, s[4:7], s36 offen offset:2048 sc1
    v_mul_f32 v112, v112, v8
    v_mul_f32 v113, v113, v8
    v_mul_f32 v114, v114, v8
    v_mul_f32 v115, v115, v8
    v_cvt_pk_bf16_f32 v204, v112, v113
    v_cvt_pk_bf16_f32 v205, v114, v115
    v_mul_f32 v120, v120, v8
    v_mul_f32 v121, v121, v8
    v_mul_f32 v122, v122, v8
    v_mul_f32 v123, v123, v8
    v_cvt_pk_bf16_f32 v206, v120, v121
    v_cvt_pk_bf16_f32 v207, v122, v123
    buffer_store_dwordx4 v[204:207], v1, s[4:7], s36 offen offset:3072 sc1
    s_lshl_b32 s36, s18, 1
    s_add_u32 s36, s36, 1
    s_mul_i32 s36, s36, 171
    s_lshl_b32 s37, s12, 2
    s_add_u32 s36, s36, s37
    s_lshl_b32 s36, s36, 10
    s_add_u32 s36, s36, 0x3000000
    v_mul_f32 v68, v68, v9
    v_mul_f32 v69, v69, v9
    v_mul_f32 v70, v70, v9
    v_mul_f32 v71, v71, v9
    v_cvt_pk_bf16_f32 v208, v68, v69
    v_cvt_pk_bf16_f32 v209, v70, v71
    v_mul_f32 v76, v76, v9
    v_mul_f32 v77, v77, v9
    v_mul_f32 v78, v78, v9
    v_mul_f32 v79, v79, v9
    v_cvt_pk_bf16_f32 v210, v76, v77
    v_cvt_pk_bf16_f32 v211, v78, v79
    buffer_store_dwordx4 v[208:211], v1, s[4:7], s36 offen offset:0 sc1
    v_mul_f32 v84, v84, v9
    v_mul_f32 v85, v85, v9
    v_mul_f32 v86, v86, v9
    v_mul_f32 v87, v87, v9
    v_cvt_pk_bf16_f32 v212, v84, v85
    v_cvt_pk_bf16_f32 v213, v86, v87
    v_mul_f32 v92, v92, v9
    v_mul_f32 v93, v93, v9
    v_mul_f32 v94, v94, v9
    v_mul_f32 v95, v95, v9
    v_cvt_pk_bf16_f32 v214, v92, v93
    v_cvt_pk_bf16_f32 v215, v94, v95
    buffer_store_dwordx4 v[212:215], v1, s[4:7], s36 offen offset:1024 sc1
    v_mul_f32 v100, v100, v9
    v_mul_f32 v101, v101, v9
    v_mul_f32 v102, v102, v9
    v_mul_f32 v103, v103, v9
    v_cvt_pk_bf16_f32 v216, v100, v101
    v_cvt_pk_bf16_f32 v217, v102, v103
    v_mul_f32 v108, v108, v9
    v_mul_f32 v109, v109, v9
    v_mul_f32 v110, v110, v9
    v_mul_f32 v111, v111, v9
    v_cvt_pk_bf16_f32 v218, v108, v109
    v_cvt_pk_bf16_f32 v219, v110, v111
    buffer_store_dwordx4 v[216:219], v1, s[4:7], s36 offen offset:2048 sc1
    v_mul_f32 v116, v116, v9
    v_mul_f32 v117, v117, v9
    v_mul_f32 v118, v118, v9
    v_mul_f32 v119, v119, v9
    v_cvt_pk_bf16_f32 v220, v116, v117
    v_cvt_pk_bf16_f32 v221, v118, v119
    v_mul_f32 v124, v124, v9
    v_mul_f32 v125, v125, v9
    v_mul_f32 v126, v126, v9
    v_mul_f32 v127, v127, v9
    v_cvt_pk_bf16_f32 v222, v124, v125
    v_cvt_pk_bf16_f32 v223, v126, v127
    buffer_store_dwordx4 v[220:223], v1, s[4:7], s36 offen offset:3072 sc1
p2_kernel_losafe_ldloop:
    s_add_u32 s8, s8, 1
    s_cmp_gt_u32 s8, s10
    s_cbranch_scc1 p2_kernel_fin
    s_waitcnt vmcnt(8)
    s_barrier
    s_add_u32 s15, s8, 3
    s_min_u32 s28, s15, 31
    s_lshl_b32 s28, s28, 15
    s_add_u32 s28, s28, s13
    s_and_b32 s15, s15, 3
    s_lshl_b32 s15, s15, 15
    s_lshl_b32 s16, s17, 13
    s_add_u32 m0, s15, s16
    s_nop 0
    buffer_load_dwordx4 v1, s[4:7], s28 offen offset:0 lds
    buffer_load_dwordx4 v1, s[4:7], s28 offen offset:1024 lds
    buffer_load_dwordx4 v1, s[4:7], s28 offen offset:2048 lds
    buffer_load_dwordx4 v1, s[4:7], s28 offen offset:3072 lds
    s_add_u32 m0, m0, 4096
    s_add_u32 s28, s28, 4096
    buffer_load_dwordx4 v1, s[4:7], s28 offen offset:0 lds
    buffer_load_dwordx4 v1, s[4:7], s28 offen offset:1024 lds
    buffer_load_dwordx4 v1, s[4:7], s28 offen offset:2048 lds
    buffer_load_dwordx4 v1, s[4:7], s28 offen offset:3072 lds
    s_branch p2_kernel_losafe_ldloop
p2_kernel_losafe_tailend:
p2_kernel_fin:
    s_waitcnt vmcnt(0) lgkmcnt(0)
    s_barrier
    s_cmp_lg_u32 s39, 0
    s_cbranch_scc1 p2_kernel_done
    s_lshl_b32 s36, s38, 2
    s_add_u32 s36, s36, 0x20000
    v_mov_b32 v23, s36
    v_mov_b32 v22, s42
    ds_write_b32 v23, v22
    s_waitcnt lgkmcnt(0)
    s_barrier
    v_mov_b32 v23, 0x20000
    ds_read_b128 v[24:27], v23
    ds_read_b128 v[28:31], v23 offset:16
    s_waitcnt lgkmcnt(0)
    v_or_b32 v24, v24, v25
    v_or_b32 v26, v26, v27
    v_or_b32 v28, v28, v29
    v_or_b32 v30, v30, v31
    v_or_b32 v24, v24, v26
    v_or_b32 v28, v28, v30
    v_or_b32 v22, v24, v28
    s_nop 0
    v_readfirstlane_b32 s36, v22
    s_cmp_eq_u32 s36, 0
    s_cbranch_scc1 p2_kernel_done
    s_mov_b32 s39, 1
    s_branch p2_kernel_restart
p2_kernel_done:
    s_cmp_lg_u32 s38, 0
    s_cbranch_scc1 p2_kernel_nosig2
    v_mov_b32 v20, 0
    v_mov_b32 v21, 1
    s_lshr_b32 s33, s2, 5
    s_lshl_b32 s36, s33, 8
    s_add_u32 s36, s36, 0x5310000
    s_sub_u32 s37, 15, s33
    s_lshl_b32 s37, s37, 8
    s_add_u32 s37, s37, 0x5310000
    v_and_b32 v22, 63, v0
    v_cmp_eq_u32 vcc, 0, v22
    s_and_saveexec_b64 s[40:41], vcc
    buffer_atomic_add v21, v20, s[4:7], s37 offen
    buffer_atomic_add v21, v20, s[4:7], s36 offen
    s_mov_b64 exec, s[40:41]
p2_kernel_nosig2:
    s_load_dwordx2 s[4:5], s[0:1], 112
    s_load_dwordx2 s[40:41], s[0:1], 40
    s_load_dwordx4 s[44:47], s[0:1], 72
    s_load_dwordx4 s[48:51], s[0:1], 96
    v_lshrrev_b32 v15, 6, v0
    v_and_b32 v13, 63, v0
    v_readfirstlane_b32 s24, v15
    v_lshlrev_b32 v1, 4, v13
    v_lshrrev_b32 v14, 4, v13
    s_and_b32 s52, s2, 7
    s_lshr_b32 s53, s2, 3
    s_lshr_b32 s25, s52, 1
    s_and_b32 s26, s52, 1
    s_lshl_b32 s26, s26, 3
    s_and_b32 s54, s53, 7
    s_add_u32 s26, s26, s54
    s_lshr_b32 s27, s53, 3
    s_lshl_b32 s35, s26, 2
    s_add_u32 s35, s35, s27
    s_lshr_b32 s36, s24, 2
    s_and_b32 s37, s24, 3
    s_waitcnt lgkmcnt(0)
    s_and_b32 s5, s5, 0xffff
    s_mov_b32 s6, 0x10000000
    s_mov_b32 s7, 0x00020000
    s_mov_b32 s12, s48
    s_and_b32 s13, s49, 0xffff
    s_mov_b32 s14, 0x200000
    s_mov_b32 s15, 0x00020000
    s_mov_b32 s16, s46
    s_and_b32 s17, s47, 0xffff
    s_mov_b32 s18, 1024
    s_mov_b32 s19, 0x00020000
    s_mov_b32 s20, s50
    s_and_b32 s21, s51, 0xffff
    s_mov_b32 s22, 256
    s_mov_b32 s23, 0x00020000
    s_mov_b32 s11, 0x00020000
    s_cmp_eq_u32 s25, 3
    s_cbranch_scc1 p2_kernel_p3_kq3
    s_mul_i32 s54, s25, 42
    s_min_u32 s55, s25, 1
    s_lshl_b32 s55, s55, 1
    s_add_u32 s54, s54, s55
    s_cmp_eq_u32 s25, 0
    s_cselect_b32 s29, 22, 21
    s_mov_b32 s34, 0
    s_mov_b32 s8, s40
    s_and_b32 s9, s41, 0xffff
    s_mov_b32 s10, 0x400000
    s_lshl_b32 s31, s54, 15
    s_branch p2_kernel_p3_kqj
p2_kernel_p3_kq3:
    s_mov_b32 s54, 128
    s_mov_b32 s29, 21
    s_mov_b32 s34, 1
    s_mov_b32 s8, s44
    s_and_b32 s9, s45, 0xffff
    s_mov_b32 s10, 1409024
    s_mov_b32 s31, 0
p2_kernel_p3_kqj:
    s_lshl_b32 s55, s24, 12
    s_add_u32 s31, s31, s55
    s_lshl_b32 s55, s27, 8
    s_add_u32 s31, s31, s55
    s_lshl_b32 s55, s26, 3
    s_add_u32 s55, s55, s24
    s_mul_i32 s55, s55, 171
    s_add_u32 s55, s55, s54
    s_lshl_b32 s30, s55, 10
    s_add_u32 s30, s30, 0x3000000
    v_and_b32 v16, 15, v13
    s_and_b32 s55, s24, 1
    s_lshl_b32 s55, s55, 2
    v_add_u32 v17, s55, v14
    v_lshlrev_b32 v17, 1, v17
    v_xor_b32 v17, v17, v16
    v_lshlrev_b32 v17, 4, v17
    v_lshlrev_b32 v18, 10, v14
    v_add_u32 v2, v17, v18
    s_lshl_b32 s55, s36, 12
    v_add_u32 v4, s55, v1
    v_lshrrev_b32 v17, 2, v16
    v_lshlrev_b32 v18, 2, v14
    v_add_u32 v17, v17, v18
    v_and_b32 v18, 7, v17
    s_lshl_b32 s55, s37, 1
    v_xor_b32 v18, s55, v18
    v_lshlrev_b32 v18, 5, v18
    v_lshlrev_b32 v17, 8, v17
    v_add_u32 v17, v17, v18
    v_and_b32 v18, 3, v16
    v_lshlrev_b32 v18, 3, v18
    v_add_u32 v5, v17, v18
    v_xor_b32 v6, 32, v5
    v_mov_b32 v7, v4
    v_mov_b32 v8, v5
    v_mov_b32 v9, v6
    v_add_u32 v10, 0x8000, v4
    v_add_u32 v11, 0x8000, v5
    v_add_u32 v12, 0x8000, v6
    v_mov_b32 v32, 0
    v_mov_b32 v33, 0
    v_mov_b32 v34, 0
    v_mov_b32 v35, 0
    v_mov_b32 v36, 0
    v_mov_b32 v37, 0
    v_mov_b32 v38, 0
    v_mov_b32 v39, 0
    v_mov_b32 v40, 0
    v_mov_b32 v41, 0
    v_mov_b32 v42, 0
    v_mov_b32 v43, 0
    v_mov_b32 v44, 0
    v_mov_b32 v45, 0
    v_mov_b32 v46, 0
    v_mov_b32 v47, 0
    v_mov_b32 v48, 0
    v_mov_b32 v49, 0
    v_mov_b32 v50, 0
    v_mov_b32 v51, 0
    v_mov_b32 v52, 0
    v_mov_b32 v53, 0
    v_mov_b32 v54, 0
    v_mov_b32 v55, 0
    v_mov_b32 v56, 0
    v_mov_b32 v57, 0
    v_mov_b32 v58, 0
    v_mov_b32 v59, 0
    v_mov_b32 v60, 0
    v_mov_b32 v61, 0
    v_mov_b32 v62, 0
    v_mov_b32 v63, 0
    s_mov_b32 s39, 0x8000
    s_lshl_b32 s33, s24, 10
    s_mov_b32 s38, 0x18000
    s_add_u32 m0, s33, 8192
    s_nop 0
    buffer_load_dwordx4 v2, s[8:11], s31 offen lds
    s_add_u32 s31, s31, 32768
    s_add_u32 m0, s33, 24576
    s_nop 0
    buffer_load_dwordx4 v2, s[8:11], s31 offen lds
    s_add_u32 s31, s31, 32768
    s_add_u32 m0, s33, 40960
    s_nop 0
    buffer_load_dwordx4 v2, s[8:11], s31 offen lds
    s_add_u32 s31, s31, 32768
    s_add_u32 m0, s33, 57344
    s_nop 0
    buffer_load_dwordx4 v2, s[8:11], s31 offen lds
    s_add_u32 s31, s31, 32768
    s_add_u32 m0, s33, 73728
    s_nop 0
    buffer_load_dwordx4 v2, s[8:11], s31 offen lds
    s_add_u32 s31, s31, 32768
    s_add_u32 m0, s33, 90112
    s_nop 0
    buffer_load_dwordx4 v2, s[8:11], s31 offen lds
    s_add_u32 s31, s31, 32768
    s_cmp_eq_u32 s25, 3
    s_cbranch_scc1 p2_kernel_p3_dep_ok
    s_cmp_lg_u32 s24, 0
    s_cbranch_scc1 p2_kernel_p3_dep_bar
    v_mov_b32 v15, 0
    s_lshl_b32 s52, s26, 8
    s_add_u32 s52, s52, 0x5310000
    s_mov_b32 s53, 0
    buffer_load_dword v16, v15, s[4:7], s52 offen sc1
    s_sleep 4
    buffer_load_dword v17, v15, s[4:7], s52 offen sc1
    s_sleep 4
p2_kernel_p3_dep_poll:
    buffer_load_dword v18, v15, s[4:7], s52 offen sc1
    s_waitcnt vmcnt(2)
    v_readfirstlane_b32 s54, v16
    s_cmp_ge_u32 s54, 32
    s_cbranch_scc1 p2_kernel_p3_dep_end
    buffer_load_dword v16, v15, s[4:7], s52 offen sc1
    s_waitcnt vmcnt(2)
    v_readfirstlane_b32 s54, v17
    s_cmp_ge_u32 s54, 32
    s_cbranch_scc1 p2_kernel_p3_dep_end
    buffer_load_dword v17, v15, s[4:7], s52 offen sc1
    s_waitcnt vmcnt(2)
    v_readfirstlane_b32 s54, v18
    s_cmp_ge_u32 s54, 32
    s_cbranch_scc1 p2_kernel_p3_dep_end
    s_add_u32 s53, s53, 1
    s_cmp_lt_u32 s53, 0x200000
    s_cbranch_scc1 p2_kernel_p3_dep_poll
p2_kernel_p3_dep_end:
    s_waitcnt vmcnt(0)
p2_kernel_p3_dep_bar:
    s_barrier
p2_kernel_p3_dep_ok:
    s_add_u32 m0, s33, 0
    s_nop 0
    buffer_load_dwordx4 v1, s[4:7], s30 offen sc1 lds
    s_add_u32 s30, s30, 1024
    s_add_u32 m0, s33, 16384
    s_nop 0
    buffer_load_dwordx4 v1, s[4:7], s30 offen sc1 lds
    s_add_u32 s30, s30, 1024
    s_add_u32 m0, s33, 32768
    s_nop 0
    buffer_load_dwordx4 v1, s[4:7], s30 offen sc1 lds
    s_add_u32 s30, s30, 1024
    s_add_u32 m0, s33, 49152
    s_nop 0
    buffer_load_dwordx4 v1, s[4:7], s30 offen sc1 lds
    s_add_u32 s30, s30, 1024
    s_add_u32 m0, s33, 65536
    s_nop 0
    buffer_load_dwordx4 v1, s[4:7], s30 offen sc1 lds
    s_add_u32 s30, s30, 1024
    s_add_u32 m0, s33, 81920
    s_nop 0
    buffer_load_dwordx4 v1, s[4:7], s30 offen sc1 lds
    s_add_u32 s30, s30, 1024
    s_mov_b32 s28, 0
    s_waitcnt vmcnt(2)
    s_barrier
    ds_read_b128 v[64:67], v7 offset:0
    ds_read_b128 v[68:71], v7 offset:1024
    ds_read_b128 v[72:75], v7 offset:2048
    ds_read_b128 v[76:79], v7 offset:3072
    ds_read_b64_tr_b16 v[80:81], v8 offset:8192
    ds_read_b64_tr_b16 v[82:83], v8 offset:12288
    ds_read_b64_tr_b16 v[84:85], v9 offset:8192
    ds_read_b64_tr_b16 v[86:87], v9 offset:12288
p2_kernel_p3_loop:
    s_waitcnt vmcnt(4)
    s_barrier
    s_waitcnt lgkmcnt(0)
    v_mfma_f32_16x16x32_bf16 v[32:35], v[80:83], v[64:67], v[32:35]
    ds_read_b128 v[88:91], v7 offset:16384
    s_lshl_b32 s33, s24, 10
    v_mfma_f32_16x16x32_bf16 v[36:39], v[84:87], v[64:67], v[36:39]
    ds_read_b128 v[92:95], v7 offset:17408
    s_add_u32 s32, s38, s33
    v_mfma_f32_16x16x32_bf16 v[40:43], v[80:83], v[68:71], v[40:43]
    ds_read_b128 v[96:99], v7 offset:18432
    s_add_u32 s38, s38, 0x8000
    v_mfma_f32_16x16x32_bf16 v[44:47], v[84:87], v[68:71], v[44:47]
    ds_read_b128 v[100:103], v7 offset:19456
    s_cmp_eq_u32 s38, 0x20000
    v_mfma_f32_16x16x32_bf16 v[48:51], v[80:83], v[72:75], v[48:51]
    ds_read_b64_tr_b16 v[104:105], v8 offset:24576
    s_cselect_b32 s38, 0, s38
    v_mfma_f32_16x16x32_bf16 v[52:55], v[84:87], v[72:75], v[52:55]
    ds_read_b64_tr_b16 v[106:107], v8 offset:28672
    s_mov_b32 m0, s32
    s_nop 0
    buffer_load_dwordx4 v1, s[4:7], s30 offen sc1 lds
    v_mfma_f32_16x16x32_bf16 v[56:59], v[80:83], v[76:79], v[56:59]
    ds_read_b64_tr_b16 v[108:109], v9 offset:24576
    s_add_u32 m0, m0, 8192
    s_add_u32 s30, s30, 1024
    buffer_load_dwordx4 v2, s[8:11], s31 offen lds
    v_mfma_f32_16x16x32_bf16 v[60:63], v[84:87], v[76:79], v[60:63]
    ds_read_b64_tr_b16 v[110:111], v9 offset:28672
    s_add_u32 m0, m0, 8192
    s_add_u32 s31, s31, 32768
    buffer_load_dwordx4 v1, s[4:7], s30 offen sc1 lds
    s_waitcnt lgkmcnt(0)
    v_mfma_f32_16x16x32_bf16 v[32:35], v[104:107], v[88:91], v[32:35]
    ds_read_b128 v[64:67], v10 offset:0
    s_add_u32 m0, m0, 8192
    s_add_u32 s30, s30, 1024
    buffer_load_dwordx4 v2, s[8:11], s31 offen lds
    v_mfma_f32_16x16x32_bf16 v[36:39], v[108:111], v[88:91], v[36:39]
    ds_read_b128 v[68:71], v10 offset:1024
    s_add_u32 s31, s31, 32768
    v_mfma_f32_16x16x32_bf16 v[40:43], v[104:107], v[92:95], v[40:43]
    ds_read_b128 v[72:75], v10 offset:2048
    s_add_u32 s28, s28, 1
    v_mfma_f32_16x16x32_bf16 v[44:47], v[108:111], v[92:95], v[44:47]
    ds_read_b128 v[76:79], v10 offset:3072
    s_add_u32 s39, s39, 0x8000
    v_mfma_f32_16x16x32_bf16 v[48:51], v[104:107], v[96:99], v[48:51]
    ds_read_b64_tr_b16 v[80:81], v11 offset:8192
    s_cmp_eq_u32 s39, 0x20000
    v_mfma_f32_16x16x32_bf16 v[52:55], v[108:111], v[96:99], v[52:55]
    ds_read_b64_tr_b16 v[82:83], v11 offset:12288
    s_cselect_b32 s39, 0, s39
    v_mfma_f32_16x16x32_bf16 v[56:59], v[104:107], v[100:103], v[56:59]
    ds_read_b64_tr_b16 v[84:85], v12 offset:8192
    v_mfma_f32_16x16x32_bf16 v[60:63], v[108:111], v[100:103], v[60:63]
    ds_read_b64_tr_b16 v[86:87], v12 offset:12288
    v_mov_b32 v7, v10
    v_add_u32 v10, s39, v4
    v_mov_b32 v8, v11
    v_add_u32 v11, s39, v5
    v_mov_b32 v9, v12
    v_add_u32 v12, s39, v6
    s_cmp_lt_u32 s28, s29
    s_cbranch_scc1 p2_kernel_p3_loop
    s_cmp_eq_u32 s34, 0
    s_cbranch_scc1 p2_kernel_p3_notail
    s_waitcnt lgkmcnt(0)
    v_mfma_f32_16x16x32_bf16 v[32:35], v[80:83], v[64:67], v[32:35]
    v_mfma_f32_16x16x32_bf16 v[36:39], v[84:87], v[64:67], v[36:39]
    v_mfma_f32_16x16x32_bf16 v[40:43], v[80:83], v[68:71], v[40:43]
    v_mfma_f32_16x16x32_bf16 v[44:47], v[84:87], v[68:71], v[44:47]
    v_mfma_f32_16x16x32_bf16 v[48:51], v[80:83], v[72:75], v[48:51]
    v_mfma_f32_16x16x32_bf16 v[52:55], v[84:87], v[72:75], v[52:55]
    v_mfma_f32_16x16x32_bf16 v[56:59], v[80:83], v[76:79], v[56:59]
    v_mfma_f32_16x16x32_bf16 v[60:63], v[84:87], v[76:79], v[60:63]
p2_kernel_p3_notail:
    s_waitcnt vmcnt(0) lgkmcnt(0)
    s_nop 7
    s_lshl_b32 s52, s35, 2
    s_add_u32 s52, s52, s25
    s_lshl_b32 s52, s52, 15
    s_add_u32 s52, s52, 0x6400000
    s_lshl_b32 s53, s36, 14
    s_lshl_b32 s54, s37, 10
    s_add_u32 s53, s53, s54
    s_add_u32 s52, s52, s53
    s_lshl_b32 s54, s36, 1
    s_add_u32 s54, s54, 0
    s_cmp_eq_u32 s54, s25
    s_cbranch_scc1 p2_kernel_p3_skipst0
    v_cvt_pk_bf16_f32 v64, v32, v33
    v_cvt_pk_bf16_f32 v65, v34, v35
    v_cvt_pk_bf16_f32 v66, v36, v37
    v_cvt_pk_bf16_f32 v67, v38, v39
    s_add_u32 s55, s52, 0
    buffer_store_dwordx4 v[64:67], v1, s[4:7], s55 offen sc1
    v_cvt_pk_bf16_f32 v68, v40, v41
    v_cvt_pk_bf16_f32 v69, v42, v43
    v_cvt_pk_bf16_f32 v70, v44, v45
    v_cvt_pk_bf16_f32 v71, v46, v47
    s_add_u32 s55, s52, 4096
    buffer_store_dwordx4 v[68:71], v1, s[4:7], s55 offen sc1
p2_kernel_p3_skipst0:
    s_lshl_b32 s54, s36, 1
    s_add_u32 s54, s54, 1
    s_cmp_eq_u32 s54, s25
    s_cbranch_scc1 p2_kernel_p3_skipst1
    v_cvt_pk_bf16_f32 v72, v48, v49
    v_cvt_pk_bf16_f32 v73, v50, v51
    v_cvt_pk_bf16_f32 v74, v52, v53
    v_cvt_pk_bf16_f32 v75, v54, v55
    s_add_u32 s55, s52, 8192
    buffer_store_dwordx4 v[72:75], v1, s[4:7], s55 offen sc1
    v_cvt_pk_bf16_f32 v76, v56, v57
    v_cvt_pk_bf16_f32 v77, v58, v59
    v_cvt_pk_bf16_f32 v78, v60, v61
    v_cvt_pk_bf16_f32 v79, v62, v63
    s_add_u32 s55, s52, 12288
    buffer_store_dwordx4 v[76:79], v1, s[4:7], s55 offen sc1
p2_kernel_p3_skipst1:
    s_waitcnt vmcnt(0)
    s_barrier
    v_and_b32 v16, 15, v13
    v_lshlrev_b32 v17, 2, v16
    s_lshl_b32 s76, s26, 3
    s_lshl_b32 s77, s25, 1
    s_add_u32 s76, s76, s77
    s_lshl_b32 s77, s76, 6
    s_add_u32 s77, s77, 0x5000000
    buffer_load_dword v20, v17, s[4:7], s77 offen
    buffer_load_dword v21, v17, s[4:7], s77 offen offset:64
    v_lshlrev_b32 v19, 3, v14
    s_lshl_b32 s78, s27, 8
    s_lshl_b32 s79, s37, 6
    s_add_u32 s78, s78, s79
    buffer_load_dwordx2 v[22:23], v19, s[16:19], s78 offen
    buffer_load_dwordx2 v[24:25], v19, s[16:19], s78 offen offset:32
    s_cmp_lg_u32 s24, 0
    s_cbranch_scc1 p2_kernel_p3_nosig
    v_mov_b32 v15, 0
    v_mov_b32 v126, 1
    s_lshl_b32 s52, s35, 8
    s_add_u32 s52, s52, 0x5300000
    s_lshl_b32 s53, s25, 2
    s_add_u32 s53, s53, s52
    v_cmp_eq_u32 vcc, 0, v13
    s_and_saveexec_b64 s[56:57], vcc
    buffer_store_dword v126, v15, s[4:7], s53 offen sc1
    s_mov_b64 exec, s[56:57]
    s_mov_b32 s53, 0
    buffer_load_dwordx4 v[112:115], v15, s[4:7], s52 offen sc1
    s_sleep 4
    buffer_load_dwordx4 v[116:119], v15, s[4:7], s52 offen sc1
    s_sleep 4
p2_kernel_p3_poll:
    buffer_load_dwordx4 v[120:123], v15, s[4:7], s52 offen sc1
    s_waitcnt vmcnt(2)
    v_add_u32 v124, v112, v113
    v_add_u32 v125, v114, v115
    v_add_u32 v124, v124, v125
    s_nop 0
    v_readfirstlane_b32 s54, v124
    s_cmp_eq_u32 s54, 4
    s_cbranch_scc1 p2_kernel_p3_pollend
    buffer_load_dwordx4 v[112:115], v15, s[4:7], s52 offen sc1
    s_waitcnt vmcnt(2)
    v_add_u32 v124, v116, v117
    v_add_u32 v125, v118, v119
    v_add_u32 v124, v124, v125
    s_nop 0
    v_readfirstlane_b32 s54, v124
    s_cmp_eq_u32 s54, 4
    s_cbranch_scc1 p2_kernel_p3_pollend
    buffer_load_dwordx4 v[116:119], v15, s[4:7], s52 offen sc1
    s_waitcnt vmcnt(2)
    v_add_u32 v124, v120, v121
    v_add_u32 v125, v122, v123
    v_add_u32 v124, v124, v125
    s_nop 0
    v_readfirstlane_b32 s54, v124
    s_cmp_eq_u32 s54, 4
    s_cbranch_scc1 p2_kernel_p3_pollend
    s_add_u32 s53, s53, 1
    s_cmp_lt_u32 s53, 0x200000
    s_cbranch_scc1 p2_kernel_p3_poll
p2_kernel_p3_pollend:
    s_waitcnt vmcnt(0)
p2_kernel_p3_nosig:
    s_barrier
    s_lshr_b32 s52, s25, 1
    s_cmp_lg_u32 s52, s36
    s_cbranch_scc1 p2_kernel_p3_fin
    s_add_u32 s52, s25, 1
    s_and_b32 s52, s52, 3
    s_lshl_b32 s53, s35, 2
    s_add_u32 s53, s53, s52
    s_lshl_b32 s53, s53, 15
    s_add_u32 s53, s53, 0x6400000
    s_lshl_b32 s54, s25, 13
    s_add_u32 s53, s53, s54
    s_lshl_b32 s54, s37, 10
    s_add_u32 s53, s53, s54
    buffer_load_dwordx4 v[160:163], v1, s[4:7], s53 offen sc1
    s_add_u32 s53, s53, 4096
    buffer_load_dwordx4 v[164:167], v1, s[4:7], s53 offen sc1
    s_add_u32 s52, s25, 2
    s_and_b32 s52, s52, 3
    s_lshl_b32 s53, s35, 2
    s_add_u32 s53, s53, s52
    s_lshl_b32 s53, s53, 15
    s_add_u32 s53, s53, 0x6400000
    s_lshl_b32 s54, s25, 13
    s_add_u32 s53, s53, s54
    s_lshl_b32 s54, s37, 10
    s_add_u32 s53, s53, s54
    buffer_load_dwordx4 v[168:171], v1, s[4:7], s53 offen sc1
    s_add_u32 s53, s53, 4096
    buffer_load_dwordx4 v[172:175], v1, s[4:7], s53 offen sc1
    s_add_u32 s52, s25, 3
    s_and_b32 s52, s52, 3
    s_lshl_b32 s53, s35, 2
    s_add_u32 s53, s53, s52
    s_lshl_b32 s53, s53, 15
    s_add_u32 s53, s53, 0x6400000
    s_lshl_b32 s54, s25, 13
    s_add_u32 s53, s53, s54
    s_lshl_b32 s54, s37, 10
    s_add_u32 s53, s53, s54
    buffer_load_dwordx4 v[176:179], v1, s[4:7], s53 offen sc1
    s_add_u32 s53, s53, 4096
    buffer_load_dwordx4 v[180:183], v1, s[4:7], s53 offen sc1
    s_and_b32 s55, s25, 1
    s_cmp_eq_u32 s55, 0
    s_cbranch_scc1 p2_kernel_p3_own0
    v_mov_b32 v64, v48
    v_mov_b32 v65, v49
    v_mov_b32 v66, v50
    v_mov_b32 v67, v51
    v_mov_b32 v68, v52
    v_mov_b32 v69, v53
    v_mov_b32 v70, v54
    v_mov_b32 v71, v55
    v_mov_b32 v72, v56
    v_mov_b32 v73, v57
    v_mov_b32 v74, v58
    v_mov_b32 v75, v59
    v_mov_b32 v76, v60
    v_mov_b32 v77, v61
    v_mov_b32 v78, v62
    v_mov_b32 v79, v63
    s_branch p2_kernel_p3_ownj
p2_kernel_p3_own0:
    v_mov_b32 v64, v32
    v_mov_b32 v65, v33
    v_mov_b32 v66, v34
    v_mov_b32 v67, v35
    v_mov_b32 v68, v36
    v_mov_b32 v69, v37
    v_mov_b32 v70, v38
    v_mov_b32 v71, v39
    v_mov_b32 v72, v40
    v_mov_b32 v73, v41
    v_mov_b32 v74, v42
    v_mov_b32 v75, v43
    v_mov_b32 v76, v44
    v_mov_b32 v77, v45
    v_mov_b32 v78, v46
    v_mov_b32 v79, v47
p2_kernel_p3_ownj:
    s_waitcnt vmcnt(0)
    v_lshlrev_b32 v112, 16, v160
    v_and_b32 v113, 0xffff0000, v160
    v_lshlrev_b32 v114, 16, v161
    v_and_b32 v115, 0xffff0000, v161
    v_lshlrev_b32 v116, 16, v162
    v_and_b32 v117, 0xffff0000, v162
    v_lshlrev_b32 v118, 16, v163
    v_and_b32 v119, 0xffff0000, v163
    v_lshlrev_b32 v120, 16, v164
    v_and_b32 v121, 0xffff0000, v164
    v_lshlrev_b32 v122, 16, v165
    v_and_b32 v123, 0xffff0000, v165
    v_lshlrev_b32 v124, 16, v166
    v_and_b32 v125, 0xffff0000, v166
    v_lshlrev_b32 v126, 16, v167
    v_and_b32 v127, 0xffff0000, v167
    v_lshlrev_b32 v128, 16, v168
    v_and_b32 v129, 0xffff0000, v168
    v_lshlrev_b32 v130, 16, v169
    v_and_b32 v131, 0xffff0000, v169
    v_lshlrev_b32 v132, 16, v170
    v_and_b32 v133, 0xffff0000, v170
    v_lshlrev_b32 v134, 16, v171
    v_and_b32 v135, 0xffff0000, v171
    v_lshlrev_b32 v136, 16, v172
    v_and_b32 v137, 0xffff0000, v172
    v_lshlrev_b32 v138, 16, v173
    v_and_b32 v139, 0xffff0000, v173
    v_lshlrev_b32 v140, 16, v174
    v_and_b32 v141, 0xffff0000, v174
    v_lshlrev_b32 v142, 16, v175
    v_and_b32 v143, 0xffff0000, v175
    v_lshlrev_b32 v144, 16, v176
    v_and_b32 v145, 0xffff0000, v176
    v_lshlrev_b32 v146, 16, v177
    v_and_b32 v147, 0xffff0000, v177
    v_lshlrev_b32 v148, 16, v178
    v_and_b32 v149, 0xffff0000, v178
    v_lshlrev_b32 v150, 16, v179
    v_and_b32 v151, 0xffff0000, v179
    v_lshlrev_b32 v152, 16, v180
    v_and_b32 v153, 0xffff0000, v180
    v_lshlrev_b32 v154, 16, v181
    v_and_b32 v155, 0xffff0000, v181
    v_lshlrev_b32 v156, 16, v182
    v_and_b32 v157, 0xffff0000, v182
    v_lshlrev_b32 v158, 16, v183
    v_and_b32 v159, 0xffff0000, v183
    v_sub_f32 v26, 1.0, v20
    v_sub_f32 v27, 1.0, v21
    v_lshlrev_b32 v28, 10, v16
    v_add_u32 v28, v28, v19
    s_lshl_b32 s52, s76, 14
    s_add_u32 s52, s52, s78
    s_add_u32 s53, s25, 0
    s_and_b32 s53, s53, 3
    s_cmp_eq_u32 s53, 3
    s_cselect_b64 s[56:57], -1, 0
    v_cndmask_b32 v80, v20, v26, s[56:57]
    v_cndmask_b32 v81, v21, v27, s[56:57]
    s_add_u32 s53, s25, 1
    s_and_b32 s53, s53, 3
    s_cmp_eq_u32 s53, 3
    s_cselect_b64 s[56:57], -1, 0
    v_cndmask_b32 v82, v20, v26, s[56:57]
    v_cndmask_b32 v83, v21, v27, s[56:57]
    s_add_u32 s53, s25, 2
    s_and_b32 s53, s53, 3
    s_cmp_eq_u32 s53, 3
    s_cselect_b64 s[56:57], -1, 0
    v_cndmask_b32 v84, v20, v26, s[56:57]
    v_cndmask_b32 v85, v21, v27, s[56:57]
    s_add_u32 s53, s25, 3
    s_and_b32 s53, s53, 3
    s_cmp_eq_u32 s53, 3
    s_cselect_b64 s[56:57], -1, 0
    v_cndmask_b32 v86, v20, v26, s[56:57]
    v_cndmask_b32 v87, v21, v27, s[56:57]
    v_lshlrev_b32 v88, 16, v22
    v_and_b32 v89, 0xffff0000, v22
    v_lshlrev_b32 v90, 16, v23
    v_and_b32 v91, 0xffff0000, v23
    v_lshlrev_b32 v92, 16, v24
    v_and_b32 v93, 0xffff0000, v24
    v_lshlrev_b32 v94, 16, v25
    v_and_b32 v95, 0xffff0000, v25
    v_mul_f32 v64, v64, v80
    v_fma_f32 v64, v112, v82, v64
    v_fma_f32 v64, v128, v84, v64
    v_fma_f32 v64, v144, v86, v64
    v_fma_f32 v64, v88, v26, v64
    v_mul_f32 v65, v65, v80
    v_fma_f32 v65, v113, v82, v65
    v_fma_f32 v65, v129, v84, v65
    v_fma_f32 v65, v145, v86, v65
    v_fma_f32 v65, v89, v26, v65
    v_mul_f32 v66, v66, v80
    v_fma_f32 v66, v114, v82, v66
    v_fma_f32 v66, v130, v84, v66
    v_fma_f32 v66, v146, v86, v66
    v_fma_f32 v66, v90, v26, v66
    v_mul_f32 v67, v67, v80
    v_fma_f32 v67, v115, v82, v67
    v_fma_f32 v67, v131, v84, v67
    v_fma_f32 v67, v147, v86, v67
    v_fma_f32 v67, v91, v26, v67
    v_cvt_pk_bf16_f32 v64, v64, v65
    v_cvt_pk_bf16_f32 v65, v66, v67
    v_mul_f32 v68, v68, v80
    v_fma_f32 v68, v116, v82, v68
    v_fma_f32 v68, v132, v84, v68
    v_fma_f32 v68, v148, v86, v68
    v_fma_f32 v68, v92, v26, v68
    v_mul_f32 v69, v69, v80
    v_fma_f32 v69, v117, v82, v69
    v_fma_f32 v69, v133, v84, v69
    v_fma_f32 v69, v149, v86, v69
    v_fma_f32 v69, v93, v26, v69
    v_mul_f32 v70, v70, v80
    v_fma_f32 v70, v118, v82, v70
    v_fma_f32 v70, v134, v84, v70
    v_fma_f32 v70, v150, v86, v70
    v_fma_f32 v70, v94, v26, v70
    v_mul_f32 v71, v71, v80
    v_fma_f32 v71, v119, v82, v71
    v_fma_f32 v71, v135, v84, v71
    v_fma_f32 v71, v151, v86, v71
    v_fma_f32 v71, v95, v26, v71
    v_cvt_pk_bf16_f32 v68, v68, v69
    v_cvt_pk_bf16_f32 v69, v70, v71
    buffer_store_dwordx2 v[64:65], v28, s[12:15], s52 offen offset:0
    buffer_store_dwordx2 v[68:69], v28, s[12:15], s52 offen offset:32
    v_mul_f32 v72, v72, v81
    v_fma_f32 v72, v120, v83, v72
    v_fma_f32 v72, v136, v85, v72
    v_fma_f32 v72, v152, v87, v72
    v_fma_f32 v72, v88, v27, v72
    v_mul_f32 v73, v73, v81
    v_fma_f32 v73, v121, v83, v73
    v_fma_f32 v73, v137, v85, v73
    v_fma_f32 v73, v153, v87, v73
    v_fma_f32 v73, v89, v27, v73
    v_mul_f32 v74, v74, v81
    v_fma_f32 v74, v122, v83, v74
    v_fma_f32 v74, v138, v85, v74
    v_fma_f32 v74, v154, v87, v74
    v_fma_f32 v74, v90, v27, v74
    v_mul_f32 v75, v75, v81
    v_fma_f32 v75, v123, v83, v75
    v_fma_f32 v75, v139, v85, v75
    v_fma_f32 v75, v155, v87, v75
    v_fma_f32 v75, v91, v27, v75
    v_cvt_pk_bf16_f32 v72, v72, v73
    v_cvt_pk_bf16_f32 v73, v74, v75
    v_mul_f32 v76, v76, v81
    v_fma_f32 v76, v124, v83, v76
    v_fma_f32 v76, v140, v85, v76
    v_fma_f32 v76, v156, v87, v76
    v_fma_f32 v76, v92, v27, v76
    v_mul_f32 v77, v77, v81
    v_fma_f32 v77, v125, v83, v77
    v_fma_f32 v77, v141, v85, v77
    v_fma_f32 v77, v157, v87, v77
    v_fma_f32 v77, v93, v27, v77
    v_mul_f32 v78, v78, v81
    v_fma_f32 v78, v126, v83, v78
    v_fma_f32 v78, v142, v85, v78
    v_fma_f32 v78, v158, v87, v78
    v_fma_f32 v78, v94, v27, v78
    v_mul_f32 v79, v79, v81
    v_fma_f32 v79, v127, v83, v79
    v_fma_f32 v79, v143, v85, v79
    v_fma_f32 v79, v159, v87, v79
    v_fma_f32 v79, v95, v27, v79
    v_cvt_pk_bf16_f32 v76, v76, v77
    v_cvt_pk_bf16_f32 v77, v78, v79
    s_add_u32 s52, s52, 16384
    buffer_store_dwordx2 v[72:73], v28, s[12:15], s52 offen offset:0
    buffer_store_dwordx2 v[76:77], v28, s[12:15], s52 offen offset:32
p2_kernel_p3_fin:
    s_waitcnt vmcnt(0)
p2_kernel_end:
    s_endpgm
p2_kernel_hisafe_l_sA:
    s_nop 15
    v_mov_b32 v12, v8
    s_nop 1
    v_permlane32_swap_b32 v8, v12
    s_nop 1
    v_max_f32 v8, v8, v12
    v_mov_b32 v12, v8
    s_nop 1
    v_permlane16_swap_b32 v8, v12
    s_nop 1
    v_max_f32 v8, v8, v12
    v_max_f32 v8, 0, v8
    v_sub_f32 v10, 0, v8
    v_exp_f32 v10, v10
    s_nop 1
    v_mov_b32 v12, v9
    s_nop 1
    v_permlane32_swap_b32 v9, v12
    s_nop 1
    v_max_f32 v9, v9, v12
    v_mov_b32 v12, v9
    s_nop 1
    v_permlane16_swap_b32 v9, v12
    s_nop 1
    v_max_f32 v9, v9, v12
    v_max_f32 v9, 0, v9
    v_sub_f32 v11, 0, v9
    v_exp_f32 v11, v11
    s_nop 1
    v_mul_f32 v64, v64, v10
    v_mul_f32 v65, v65, v10
    v_mul_f32 v66, v66, v10
    v_mul_f32 v67, v67, v10
    v_mul_f32 v68, v68, v11
    v_mul_f32 v69, v69, v11
    v_mul_f32 v70, v70, v11
    v_mul_f32 v71, v71, v11
    v_mul_f32 v72, v72, v10
    v_mul_f32 v73, v73, v10
    v_mul_f32 v74, v74, v10
    v_mul_f32 v75, v75, v10
    v_mul_f32 v76, v76, v11
    v_mul_f32 v77, v77, v11
    v_mul_f32 v78, v78, v11
    v_mul_f32 v79, v79, v11
    v_mul_f32 v80, v80, v10
    v_mul_f32 v81, v81, v10
    v_mul_f32 v82, v82, v10
    v_mul_f32 v83, v83, v10
    v_mul_f32 v84, v84, v11
    v_mul_f32 v85, v85, v11
    v_mul_f32 v86, v86, v11
    v_mul_f32 v87, v87, v11
    v_mul_f32 v88, v88, v10
    v_mul_f32 v89, v89, v10
    v_mul_f32 v90, v90, v10
    v_mul_f32 v91, v91, v10
    v_mul_f32 v92, v92, v11
    v_mul_f32 v93, v93, v11
    v_mul_f32 v94, v94, v11
    v_mul_f32 v95, v95, v11
    v_mul_f32 v96, v96, v10
    v_mul_f32 v97, v97, v10
    v_mul_f32 v98, v98, v10
    v_mul_f32 v99, v99, v10
    v_mul_f32 v100, v100, v11
    v_mul_f32 v101, v101, v11
    v_mul_f32 v102, v102, v11
    v_mul_f32 v103, v103, v11
    v_mul_f32 v104, v104, v10
    v_mul_f32 v105, v105, v10
    v_mul_f32 v106, v106, v10
    v_mul_f32 v107, v107, v10
    v_mul_f32 v108, v108, v11
    v_mul_f32 v109, v109, v11
    v_mul_f32 v110, v110, v11
    v_mul_f32 v111, v111, v11
    v_mul_f32 v112, v112, v10
    v_mul_f32 v113, v113, v10
    v_mul_f32 v114, v114, v10
    v_mul_f32 v115, v115, v10
    v_mul_f32 v116, v116, v11
    v_mul_f32 v117, v117, v11
    v_mul_f32 v118, v118, v11
    v_mul_f32 v119, v119, v11
    v_mul_f32 v120, v120, v10
    v_mul_f32 v121, v121, v10
    v_mul_f32 v122, v122, v10
    v_mul_f32 v123, v123, v10
    v_mul_f32 v124, v124, v11
    v_mul_f32 v125, v125, v11
    v_mul_f32 v126, v126, v11
    v_mul_f32 v127, v127, v11
    v_mul_f32 v240, v240, v10
    v_mul_f32 v241, v241, v10
    v_mul_f32 v242, v242, v10
    v_mul_f32 v243, v243, v10
    v_mul_f32 v244, v244, v11
    v_mul_f32 v245, v245, v11
    v_mul_f32 v246, v246, v11
    v_mul_f32 v247, v247, v11
    v_sub_f32 v144, v144, v8
    v_sub_f32 v160, v160, v8
    v_sub_f32 v176, v176, v8
    v_sub_f32 v145, v145, v8
    v_sub_f32 v161, v161, v8
    v_sub_f32 v177, v177, v8
    v_sub_f32 v146, v146, v8
    v_sub_f32 v162, v162, v8
    v_sub_f32 v178, v178, v8
    v_sub_f32 v147, v147, v8
    v_sub_f32 v163, v163, v8
    v_sub_f32 v179, v179, v8
    v_sub_f32 v148, v148, v9
    v_sub_f32 v164, v164, v9
    v_sub_f32 v180, v180, v9
    v_sub_f32 v149, v149, v9
    v_sub_f32 v165, v165, v9
    v_sub_f32 v181, v181, v9
    v_sub_f32 v150, v150, v9
    v_sub_f32 v166, v166, v9
    v_sub_f32 v182, v182, v9
    v_sub_f32 v151, v151, v9
    v_sub_f32 v167, v167, v9
    v_sub_f32 v183, v183, v9
    v_sub_f32 v152, v152, v8
    v_sub_f32 v168, v168, v8
    v_sub_f32 v184, v184, v8
    v_sub_f32 v153, v153, v8
    v_sub_f32 v169, v169, v8
    v_sub_f32 v185, v185, v8
    v_sub_f32 v154, v154, v8
    v_sub_f32 v170, v170, v8
    v_sub_f32 v186, v186, v8
    v_sub_f32 v155, v155, v8
    v_sub_f32 v171, v171, v8
    v_sub_f32 v187, v187, v8
    v_sub_f32 v156, v156, v9
    v_sub_f32 v172, v172, v9
    v_sub_f32 v188, v188, v9
    v_sub_f32 v157, v157, v9
    v_sub_f32 v173, v173, v9
    v_sub_f32 v189, v189, v9
    v_sub_f32 v158, v158, v9
    v_sub_f32 v174, v174, v9
    v_sub_f32 v190, v190, v9
    v_sub_f32 v159, v159, v9
    v_sub_f32 v175, v175, v9
    v_sub_f32 v191, v191, v9
    s_nop 1
    s_branch p2_kernel_hisafe_l_sA_ret
p2_kernel_hisafe_l_sB:
    s_nop 15
    v_mov_b32 v12, v8
    s_nop 1
    v_permlane32_swap_b32 v8, v12
    s_nop 1
    v_max_f32 v8, v8, v12
    v_mov_b32 v12, v8
    s_nop 1
    v_permlane16_swap_b32 v8, v12
    s_nop 1
    v_max_f32 v8, v8, v12
    v_max_f32 v8, 0, v8
    v_sub_f32 v10, 0, v8
    v_exp_f32 v10, v10
    s_nop 1
    v_mov_b32 v12, v9
    s_nop 1
    v_permlane32_swap_b32 v9, v12
    s_nop 1
    v_max_f32 v9, v9, v12
    v_mov_b32 v12, v9
    s_nop 1
    v_permlane16_swap_b32 v9, v12
    s_nop 1
    v_max_f32 v9, v9, v12
    v_max_f32 v9, 0, v9
    v_sub_f32 v11, 0, v9
    v_exp_f32 v11, v11
    s_nop 1
    v_mul_f32 v64, v64, v10
    v_mul_f32 v65, v65, v10
    v_mul_f32 v66, v66, v10
    v_mul_f32 v67, v67, v10
    v_mul_f32 v68, v68, v11
    v_mul_f32 v69, v69, v11
    v_mul_f32 v70, v70, v11
    v_mul_f32 v71, v71, v11
    v_mul_f32 v72, v72, v10
    v_mul_f32 v73, v73, v10
    v_mul_f32 v74, v74, v10
    v_mul_f32 v75, v75, v10
    v_mul_f32 v76, v76, v11
    v_mul_f32 v77, v77, v11
    v_mul_f32 v78, v78, v11
    v_mul_f32 v79, v79, v11
    v_mul_f32 v80, v80, v10
    v_mul_f32 v81, v81, v10
    v_mul_f32 v82, v82, v10
    v_mul_f32 v83, v83, v10
    v_mul_f32 v84, v84, v11
    v_mul_f32 v85, v85, v11
    v_mul_f32 v86, v86, v11
    v_mul_f32 v87, v87, v11
    v_mul_f32 v88, v88, v10
    v_mul_f32 v89, v89, v10
    v_mul_f32 v90, v90, v10
    v_mul_f32 v91, v91, v10
    v_mul_f32 v92, v92, v11
    v_mul_f32 v93, v93, v11
    v_mul_f32 v94, v94, v11
    v_mul_f32 v95, v95, v11
    v_mul_f32 v96, v96, v10
    v_mul_f32 v97, v97, v10
    v_mul_f32 v98, v98, v10
    v_mul_f32 v99, v99, v10
    v_mul_f32 v100, v100, v11
    v_mul_f32 v101, v101, v11
    v_mul_f32 v102, v102, v11
    v_mul_f32 v103, v103, v11
    v_mul_f32 v104, v104, v10
    v_mul_f32 v105, v105, v10
    v_mul_f32 v106, v106, v10
    v_mul_f32 v107, v107, v10
    v_mul_f32 v108, v108, v11
    v_mul_f32 v109, v109, v11
    v_mul_f32 v110, v110, v11
    v_mul_f32 v111, v111, v11
    v_mul_f32 v112, v112, v10
    v_mul_f32 v113, v113, v10
    v_mul_f32 v114, v114, v10
    v_mul_f32 v115, v115, v10
    v_mul_f32 v116, v116, v11
    v_mul_f32 v117, v117, v11
    v_mul_f32 v118, v118, v11
    v_mul_f32 v119, v119, v11
    v_mul_f32 v120, v120, v10
    v_mul_f32 v121, v121, v10
    v_mul_f32 v122, v122, v10
    v_mul_f32 v123, v123, v10
    v_mul_f32 v124, v124, v11
    v_mul_f32 v125, v125, v11
    v_mul_f32 v126, v126, v11
    v_mul_f32 v127, v127, v11
    v_mul_f32 v240, v240, v10
    v_mul_f32 v241, v241, v10
    v_mul_f32 v242, v242, v10
    v_mul_f32 v243, v243, v10
    v_mul_f32 v244, v244, v11
    v_mul_f32 v245, v245, v11
    v_mul_f32 v246, v246, v11
    v_mul_f32 v247, v247, v11
    v_sub_f32 v128, v128, v8
    v_sub_f32 v160, v160, v8
    v_sub_f32 v176, v176, v8
    v_sub_f32 v129, v129, v8
    v_sub_f32 v161, v161, v8
    v_sub_f32 v177, v177, v8
    v_sub_f32 v130, v130, v8
    v_sub_f32 v162, v162, v8
    v_sub_f32 v178, v178, v8
    v_sub_f32 v131, v131, v8
    v_sub_f32 v163, v163, v8
    v_sub_f32 v179, v179, v8
    v_sub_f32 v132, v132, v9
    v_sub_f32 v164, v164, v9
    v_sub_f32 v180, v180, v9
    v_sub_f32 v133, v133, v9
    v_sub_f32 v165, v165, v9
    v_sub_f32 v181, v181, v9
    v_sub_f32 v134, v134, v9
    v_sub_f32 v166, v166, v9
    v_sub_f32 v182, v182, v9
    v_sub_f32 v135, v135, v9
    v_sub_f32 v167, v167, v9
    v_sub_f32 v183, v183, v9
    v_sub_f32 v136, v136, v8
    v_sub_f32 v168, v168, v8
    v_sub_f32 v184, v184, v8
    v_sub_f32 v137, v137, v8
    v_sub_f32 v169, v169, v8
    v_sub_f32 v185, v185, v8
    v_sub_f32 v138, v138, v8
    v_sub_f32 v170, v170, v8
    v_sub_f32 v186, v186, v8
    v_sub_f32 v139, v139, v8
    v_sub_f32 v171, v171, v8
    v_sub_f32 v187, v187, v8
    v_sub_f32 v140, v140, v9
    v_sub_f32 v172, v172, v9
    v_sub_f32 v188, v188, v9
    v_sub_f32 v141, v141, v9
    v_sub_f32 v173, v173, v9
    v_sub_f32 v189, v189, v9
    v_sub_f32 v142, v142, v9
    v_sub_f32 v174, v174, v9
    v_sub_f32 v190, v190, v9
    v_sub_f32 v143, v143, v9
    v_sub_f32 v175, v175, v9
    v_sub_f32 v191, v191, v9
    s_nop 1
    s_branch p2_kernel_hisafe_l_sB_ret
p2_kernel_hisafe_p_sA:
    s_nop 15
    v_mov_b32 v12, v8
    s_nop 1
    v_permlane32_swap_b32 v8, v12
    s_nop 1
    v_max_f32 v8, v8, v12
    v_mov_b32 v12, v8
    s_nop 1
    v_permlane16_swap_b32 v8, v12
    s_nop 1
    v_max_f32 v8, v8, v12
    v_max_f32 v8, 0, v8
    v_sub_f32 v10, 0, v8
    v_exp_f32 v10, v10
    s_nop 1
    v_mov_b32 v12, v9
    s_nop 1
    v_permlane32_swap_b32 v9, v12
    s_nop 1
    v_max_f32 v9, v9, v12
    v_mov_b32 v12, v9
    s_nop 1
    v_permlane16_swap_b32 v9, v12
    s_nop 1
    v_max_f32 v9, v9, v12
    v_max_f32 v9, 0, v9
    v_sub_f32 v11, 0, v9
    v_exp_f32 v11, v11
    s_nop 1
    v_mul_f32 v64, v64, v10
    v_mul_f32 v65, v65, v10
    v_mul_f32 v66, v66, v10
    v_mul_f32 v67, v67, v10
    v_mul_f32 v68, v68, v11
    v_mul_f32 v69, v69, v11
    v_mul_f32 v70, v70, v11
    v_mul_f32 v71, v71, v11
    v_mul_f32 v72, v72, v10
    v_mul_f32 v73, v73, v10
    v_mul_f32 v74, v74, v10
    v_mul_f32 v75, v75, v10
    v_mul_f32 v76, v76, v11
    v_mul_f32 v77, v77, v11
    v_mul_f32 v78, v78, v11
    v_mul_f32 v79, v79, v11
    v_mul_f32 v80, v80, v10
    v_mul_f32 v81, v81, v10
    v_mul_f32 v82, v82, v10
    v_mul_f32 v83, v83, v10
    v_mul_f32 v84, v84, v11
    v_mul_f32 v85, v85, v11
    v_mul_f32 v86, v86, v11
    v_mul_f32 v87, v87, v11
    v_mul_f32 v88, v88, v10
    v_mul_f32 v89, v89, v10
    v_mul_f32 v90, v90, v10
    v_mul_f32 v91, v91, v10
    v_mul_f32 v92, v92, v11
    v_mul_f32 v93, v93, v11
    v_mul_f32 v94, v94, v11
    v_mul_f32 v95, v95, v11
    v_mul_f32 v96, v96, v10
    v_mul_f32 v97, v97, v10
    v_mul_f32 v98, v98, v10
    v_mul_f32 v99, v99, v10
    v_mul_f32 v100, v100, v11
    v_mul_f32 v101, v101, v11
    v_mul_f32 v102, v102, v11
    v_mul_f32 v103, v103, v11
    v_mul_f32 v104, v104, v10
    v_mul_f32 v105, v105, v10
    v_mul_f32 v106, v106, v10
    v_mul_f32 v107, v107, v10
    v_mul_f32 v108, v108, v11
    v_mul_f32 v109, v109, v11
    v_mul_f32 v110, v110, v11
    v_mul_f32 v111, v111, v11
    v_mul_f32 v112, v112, v10
    v_mul_f32 v113, v113, v10
    v_mul_f32 v114, v114, v10
    v_mul_f32 v115, v115, v10
    v_mul_f32 v116, v116, v11
    v_mul_f32 v117, v117, v11
    v_mul_f32 v118, v118, v11
    v_mul_f32 v119, v119, v11
    v_mul_f32 v120, v120, v10
    v_mul_f32 v121, v121, v10
    v_mul_f32 v122, v122, v10
    v_mul_f32 v123, v123, v10
    v_mul_f32 v124, v124, v11
    v_mul_f32 v125, v125, v11
    v_mul_f32 v126, v126, v11
    v_mul_f32 v127, v127, v11
    v_mul_f32 v240, v240, v10
    v_mul_f32 v241, v241, v10
    v_mul_f32 v242, v242, v10
    v_mul_f32 v243, v243, v10
    v_mul_f32 v244, v244, v11
    v_mul_f32 v245, v245, v11
    v_mul_f32 v246, v246, v11
    v_mul_f32 v247, v247, v11
    v_sub_f32 v144, v144, v8
    v_sub_f32 v160, v160, v8
    v_sub_f32 v176, v176, v8
    v_sub_f32 v145, v145, v8
    v_sub_f32 v161, v161, v8
    v_sub_f32 v177, v177, v8
    v_sub_f32 v146, v146, v8
    v_sub_f32 v162, v162, v8
    v_sub_f32 v178, v178, v8
    v_sub_f32 v147, v147, v8
    v_sub_f32 v163, v163, v8
    v_sub_f32 v179, v179, v8
    v_sub_f32 v148, v148, v9
    v_sub_f32 v164, v164, v9
    v_sub_f32 v180, v180, v9
    v_sub_f32 v149, v149, v9
    v_sub_f32 v165, v165, v9
    v_sub_f32 v181, v181, v9
    v_sub_f32 v150, v150, v9
    v_sub_f32 v166, v166, v9
    v_sub_f32 v182, v182, v9
    v_sub_f32 v151, v151, v9
    v_sub_f32 v167, v167, v9
    v_sub_f32 v183, v183, v9
    v_sub_f32 v152, v152, v8
    v_sub_f32 v168, v168, v8
    v_sub_f32 v184, v184, v8
    v_sub_f32 v153, v153, v8
    v_sub_f32 v169, v169, v8
    v_sub_f32 v185, v185, v8
    v_sub_f32 v154, v154, v8
    v_sub_f32 v170, v170, v8
    v_sub_f32 v186, v186, v8
    v_sub_f32 v155, v155, v8
    v_sub_f32 v171, v171, v8
    v_sub_f32 v187, v187, v8
    v_sub_f32 v156, v156, v9
    v_sub_f32 v172, v172, v9
    v_sub_f32 v188, v188, v9
    v_sub_f32 v157, v157, v9
    v_sub_f32 v173, v173, v9
    v_sub_f32 v189, v189, v9
    v_sub_f32 v158, v158, v9
    v_sub_f32 v174, v174, v9
    v_sub_f32 v190, v190, v9
    v_sub_f32 v159, v159, v9
    v_sub_f32 v175, v175, v9
    v_sub_f32 v191, v191, v9
    s_nop 1
    s_branch p2_kernel_hisafe_p_sA_ret
p2_kernel_hisafe_p_sB:
    s_nop 15
    v_mov_b32 v12, v8
    s_nop 1
    v_permlane32_swap_b32 v8, v12
    s_nop 1
    v_max_f32 v8, v8, v12
    v_mov_b32 v12, v8
    s_nop 1
    v_permlane16_swap_b32 v8, v12
    s_nop 1
    v_max_f32 v8, v8, v12
    v_max_f32 v8, 0, v8
    v_sub_f32 v10, 0, v8
    v_exp_f32 v10, v10
    s_nop 1
    v_mov_b32 v12, v9
    s_nop 1
    v_permlane32_swap_b32 v9, v12
    s_nop 1
    v_max_f32 v9, v9, v12
    v_mov_b32 v12, v9
    s_nop 1
    v_permlane16_swap_b32 v9, v12
    s_nop 1
    v_max_f32 v9, v9, v12
    v_max_f32 v9, 0, v9
    v_sub_f32 v11, 0, v9
    v_exp_f32 v11, v11
    s_nop 1
    v_mul_f32 v64, v64, v10
    v_mul_f32 v65, v65, v10
    v_mul_f32 v66, v66, v10
    v_mul_f32 v67, v67, v10
    v_mul_f32 v68, v68, v11
    v_mul_f32 v69, v69, v11
    v_mul_f32 v70, v70, v11
    v_mul_f32 v71, v71, v11
    v_mul_f32 v72, v72, v10
    v_mul_f32 v73, v73, v10
    v_mul_f32 v74, v74, v10
    v_mul_f32 v75, v75, v10
    v_mul_f32 v76, v76, v11
    v_mul_f32 v77, v77, v11
    v_mul_f32 v78, v78, v11
    v_mul_f32 v79, v79, v11
    v_mul_f32 v80, v80, v10
    v_mul_f32 v81, v81, v10
    v_mul_f32 v82, v82, v10
    v_mul_f32 v83, v83, v10
    v_mul_f32 v84, v84, v11
    v_mul_f32 v85, v85, v11
    v_mul_f32 v86, v86, v11
    v_mul_f32 v87, v87, v11
    v_mul_f32 v88, v88, v10
    v_mul_f32 v89, v89, v10
    v_mul_f32 v90, v90, v10
    v_mul_f32 v91, v91, v10
    v_mul_f32 v92, v92, v11
    v_mul_f32 v93, v93, v11
    v_mul_f32 v94, v94, v11
    v_mul_f32 v95, v95, v11
    v_mul_f32 v96, v96, v10
    v_mul_f32 v97, v97, v10
    v_mul_f32 v98, v98, v10
    v_mul_f32 v99, v99, v10
    v_mul_f32 v100, v100, v11
    v_mul_f32 v101, v101, v11
    v_mul_f32 v102, v102, v11
    v_mul_f32 v103, v103, v11
    v_mul_f32 v104, v104, v10
    v_mul_f32 v105, v105, v10
    v_mul_f32 v106, v106, v10
    v_mul_f32 v107, v107, v10
    v_mul_f32 v108, v108, v11
    v_mul_f32 v109, v109, v11
    v_mul_f32 v110, v110, v11
    v_mul_f32 v111, v111, v11
    v_mul_f32 v112, v112, v10
    v_mul_f32 v113, v113, v10
    v_mul_f32 v114, v114, v10
    v_mul_f32 v115, v115, v10
    v_mul_f32 v116, v116, v11
    v_mul_f32 v117, v117, v11
    v_mul_f32 v118, v118, v11
    v_mul_f32 v119, v119, v11
    v_mul_f32 v120, v120, v10
    v_mul_f32 v121, v121, v10
    v_mul_f32 v122, v122, v10
    v_mul_f32 v123, v123, v10
    v_mul_f32 v124, v124, v11
    v_mul_f32 v125, v125, v11
    v_mul_f32 v126, v126, v11
    v_mul_f32 v127, v127, v11
    v_mul_f32 v240, v240, v10
    v_mul_f32 v241, v241, v10
    v_mul_f32 v242, v242, v10
    v_mul_f32 v243, v243, v10
    v_mul_f32 v244, v244, v11
    v_mul_f32 v245, v245, v11
    v_mul_f32 v246, v246, v11
    v_mul_f32 v247, v247, v11
    v_sub_f32 v128, v128, v8
    v_sub_f32 v160, v160, v8
    v_sub_f32 v176, v176, v8
    v_sub_f32 v129, v129, v8
    v_sub_f32 v161, v161, v8
    v_sub_f32 v177, v177, v8
    v_sub_f32 v130, v130, v8
    v_sub_f32 v162, v162, v8
    v_sub_f32 v178, v178, v8
    v_sub_f32 v131, v131, v8
    v_sub_f32 v163, v163, v8
    v_sub_f32 v179, v179, v8
    v_sub_f32 v132, v132, v9
    v_sub_f32 v164, v164, v9
    v_sub_f32 v180, v180, v9
    v_sub_f32 v133, v133, v9
    v_sub_f32 v165, v165, v9
    v_sub_f32 v181, v181, v9
    v_sub_f32 v134, v134, v9
    v_sub_f32 v166, v166, v9
    v_sub_f32 v182, v182, v9
    v_sub_f32 v135, v135, v9
    v_sub_f32 v167, v167, v9
    v_sub_f32 v183, v183, v9
    v_sub_f32 v136, v136, v8
    v_sub_f32 v168, v168, v8
    v_sub_f32 v184, v184, v8
    v_sub_f32 v137, v137, v8
    v_sub_f32 v169, v169, v8
    v_sub_f32 v185, v185, v8
    v_sub_f32 v138, v138, v8
    v_sub_f32 v170, v170, v8
    v_sub_f32 v186, v186, v8
    v_sub_f32 v139, v139, v8
    v_sub_f32 v171, v171, v8
    v_sub_f32 v187, v187, v8
    v_sub_f32 v140, v140, v9
    v_sub_f32 v172, v172, v9
    v_sub_f32 v188, v188, v9
    v_sub_f32 v141, v141, v9
    v_sub_f32 v173, v173, v9
    v_sub_f32 v189, v189, v9
    v_sub_f32 v142, v142, v9
    v_sub_f32 v174, v174, v9
    v_sub_f32 v190, v190, v9
    v_sub_f32 v143, v143, v9
    v_sub_f32 v175, v175, v9
    v_sub_f32 v191, v191, v9
    s_nop 1
    s_branch p2_kernel_hisafe_p_sB_ret
p2_kernel_hisafe_f_sA:
    s_nop 15
    v_mov_b32 v12, v8
    s_nop 1
    v_permlane32_swap_b32 v8, v12
    s_nop 1
    v_max_f32 v8, v8, v12
    v_mov_b32 v12, v8
    s_nop 1
    v_permlane16_swap_b32 v8, v12
    s_nop 1
    v_max_f32 v8, v8, v12
    v_max_f32 v8, 0, v8
    v_sub_f32 v10, 0, v8
    v_exp_f32 v10, v10
    s_nop 1
    v_mov_b32 v12, v9
    s_nop 1
    v_permlane32_swap_b32 v9, v12
    s_nop 1
    v_max_f32 v9, v9, v12
    v_mov_b32 v12, v9
    s_nop 1
    v_permlane16_swap_b32 v9, v12
    s_nop 1
    v_max_f32 v9, v9, v12
    v_max_f32 v9, 0, v9
    v_sub_f32 v11, 0, v9
    v_exp_f32 v11, v11
    s_nop 1
    v_mul_f32 v64, v64, v10
    v_mul_f32 v65, v65, v10
    v_mul_f32 v66, v66, v10
    v_mul_f32 v67, v67, v10
    v_mul_f32 v68, v68, v11
    v_mul_f32 v69, v69, v11
    v_mul_f32 v70, v70, v11
    v_mul_f32 v71, v71, v11
    v_mul_f32 v72, v72, v10
    v_mul_f32 v73, v73, v10
    v_mul_f32 v74, v74, v10
    v_mul_f32 v75, v75, v10
    v_mul_f32 v76, v76, v11
    v_mul_f32 v77, v77, v11
    v_mul_f32 v78, v78, v11
    v_mul_f32 v79, v79, v11
    v_mul_f32 v80, v80, v10
    v_mul_f32 v81, v81, v10
    v_mul_f32 v82, v82, v10
    v_mul_f32 v83, v83, v10
    v_mul_f32 v84, v84, v11
    v_mul_f32 v85, v85, v11
    v_mul_f32 v86, v86, v11
    v_mul_f32 v87, v87, v11
    v_mul_f32 v88, v88, v10
    v_mul_f32 v89, v89, v10
    v_mul_f32 v90, v90, v10
    v_mul_f32 v91, v91, v10
    v_mul_f32 v92, v92, v11
    v_mul_f32 v93, v93, v11
    v_mul_f32 v94, v94, v11
    v_mul_f32 v95, v95, v11
    v_mul_f32 v96, v96, v10
    v_mul_f32 v97, v97, v10
    v_mul_f32 v98, v98, v10
    v_mul_f32 v99, v99, v10
    v_mul_f32 v100, v100, v11
    v_mul_f32 v101, v101, v11
    v_mul_f32 v102, v102, v11
    v_mul_f32 v103, v103, v11
    v_mul_f32 v104, v104, v10
    v_mul_f32 v105, v105, v10
    v_mul_f32 v106, v106, v10
    v_mul_f32 v107, v107, v10
    v_mul_f32 v108, v108, v11
    v_mul_f32 v109, v109, v11
    v_mul_f32 v110, v110, v11
    v_mul_f32 v111, v111, v11
    v_mul_f32 v112, v112, v10
    v_mul_f32 v113, v113, v10
    v_mul_f32 v114, v114, v10
    v_mul_f32 v115, v115, v10
    v_mul_f32 v116, v116, v11
    v_mul_f32 v117, v117, v11
    v_mul_f32 v118, v118, v11
    v_mul_f32 v119, v119, v11
    v_mul_f32 v120, v120, v10
    v_mul_f32 v121, v121, v10
    v_mul_f32 v122, v122, v10
    v_mul_f32 v123, v123, v10
    v_mul_f32 v124, v124, v11
    v_mul_f32 v125, v125, v11
    v_mul_f32 v126, v126, v11
    v_mul_f32 v127, v127, v11
    v_mul_f32 v240, v240, v10
    v_mul_f32 v241, v241, v10
    v_mul_f32 v242, v242, v10
    v_mul_f32 v243, v243, v10
    v_mul_f32 v244, v244, v11
    v_mul_f32 v245, v245, v11
    v_mul_f32 v246, v246, v11
    v_mul_f32 v247, v247, v11
    v_sub_f32 v144, v144, v8
    v_sub_f32 v160, v160, v8
    v_sub_f32 v176, v176, v8
    v_sub_f32 v145, v145, v8
    v_sub_f32 v161, v161, v8
    v_sub_f32 v177, v177, v8
    v_sub_f32 v146, v146, v8
    v_sub_f32 v162, v162, v8
    v_sub_f32 v178, v178, v8
    v_sub_f32 v147, v147, v8
    v_sub_f32 v163, v163, v8
    v_sub_f32 v179, v179, v8
    v_sub_f32 v148, v148, v9
    v_sub_f32 v164, v164, v9
    v_sub_f32 v180, v180, v9
    v_sub_f32 v149, v149, v9
    v_sub_f32 v165, v165, v9
    v_sub_f32 v181, v181, v9
    v_sub_f32 v150, v150, v9
    v_sub_f32 v166, v166, v9
    v_sub_f32 v182, v182, v9
    v_sub_f32 v151, v151, v9
    v_sub_f32 v167, v167, v9
    v_sub_f32 v183, v183, v9
    v_sub_f32 v152, v152, v8
    v_sub_f32 v168, v168, v8
    v_sub_f32 v184, v184, v8
    v_sub_f32 v153, v153, v8
    v_sub_f32 v169, v169, v8
    v_sub_f32 v185, v185, v8
    v_sub_f32 v154, v154, v8
    v_sub_f32 v170, v170, v8
    v_sub_f32 v186, v186, v8
    v_sub_f32 v155, v155, v8
    v_sub_f32 v171, v171, v8
    v_sub_f32 v187, v187, v8
    v_sub_f32 v156, v156, v9
    v_sub_f32 v172, v172, v9
    v_sub_f32 v188, v188, v9
    v_sub_f32 v157, v157, v9
    v_sub_f32 v173, v173, v9
    v_sub_f32 v189, v189, v9
    v_sub_f32 v158, v158, v9
    v_sub_f32 v174, v174, v9
    v_sub_f32 v190, v190, v9
    v_sub_f32 v159, v159, v9
    v_sub_f32 v175, v175, v9
    v_sub_f32 v191, v191, v9
    s_nop 1
    s_branch p2_kernel_hisafe_f_sA_ret
p2_kernel_losafe_l_sA:
    s_nop 15
    v_mov_b32 v12, v8
    s_nop 1
    v_permlane32_swap_b32 v8, v12
    s_nop 1
    v_max_f32 v8, v8, v12
    v_mov_b32 v12, v8
    s_nop 1
    v_permlane16_swap_b32 v8, v12
    s_nop 1
    v_max_f32 v8, v8, v12
    v_max_f32 v8, 0, v8
    v_sub_f32 v10, 0, v8
    v_exp_f32 v10, v10
    s_nop 1
    v_mov_b32 v12, v9
    s_nop 1
    v_permlane32_swap_b32 v9, v12
    s_nop 1
    v_max_f32 v9, v9, v12
    v_mov_b32 v12, v9
    s_nop 1
    v_permlane16_swap_b32 v9, v12
    s_nop 1
    v_max_f32 v9, v9, v12
    v_max_f32 v9, 0, v9
    v_sub_f32 v11, 0, v9
    v_exp_f32 v11, v11
    s_nop 1
    v_mul_f32 v64, v64, v10
    v_mul_f32 v65, v65, v10
    v_mul_f32 v66, v66, v10
    v_mul_f32 v67, v67, v10
    v_mul_f32 v68, v68, v11
    v_mul_f32 v69, v69, v11
    v_mul_f32 v70, v70, v11
    v_mul_f32 v71, v71, v11
    v_mul_f32 v72, v72, v10
    v_mul_f32 v73, v73, v10
    v_mul_f32 v74, v74, v10
    v_mul_f32 v75, v75, v10
    v_mul_f32 v76, v76, v11
    v_mul_f32 v77, v77, v11
    v_mul_f32 v78, v78, v11
    v_mul_f32 v79, v79, v11
    v_mul_f32 v80, v80, v10
    v_mul_f32 v81, v81, v10
    v_mul_f32 v82, v82, v10
    v_mul_f32 v83, v83, v10
    v_mul_f32 v84, v84, v11
    v_mul_f32 v85, v85, v11
    v_mul_f32 v86, v86, v11
    v_mul_f32 v87, v87, v11
    v_mul_f32 v88, v88, v10
    v_mul_f32 v89, v89, v10
    v_mul_f32 v90, v90, v10
    v_mul_f32 v91, v91, v10
    v_mul_f32 v92, v92, v11
    v_mul_f32 v93, v93, v11
    v_mul_f32 v94, v94, v11
    v_mul_f32 v95, v95, v11
    v_mul_f32 v96, v96, v10
    v_mul_f32 v97, v97, v10
    v_mul_f32 v98, v98, v10
    v_mul_f32 v99, v99, v10
    v_mul_f32 v100, v100, v11
    v_mul_f32 v101, v101, v11
    v_mul_f32 v102, v102, v11
    v_mul_f32 v103, v103, v11
    v_mul_f32 v104, v104, v10
    v_mul_f32 v105, v105, v10
    v_mul_f32 v106, v106, v10
    v_mul_f32 v107, v107, v10
    v_mul_f32 v108, v108, v11
    v_mul_f32 v109, v109, v11
    v_mul_f32 v110, v110, v11
    v_mul_f32 v111, v111, v11
    v_mul_f32 v112, v112, v10
    v_mul_f32 v113, v113, v10
    v_mul_f32 v114, v114, v10
    v_mul_f32 v115, v115, v10
    v_mul_f32 v116, v116, v11
    v_mul_f32 v117, v117, v11
    v_mul_f32 v118, v118, v11
    v_mul_f32 v119, v119, v11
    v_mul_f32 v120, v120, v10
    v_mul_f32 v121, v121, v10
    v_mul_f32 v122, v122, v10
    v_mul_f32 v123, v123, v10
    v_mul_f32 v124, v124, v11
    v_mul_f32 v125, v125, v11
    v_mul_f32 v126, v126, v11
    v_mul_f32 v127, v127, v11
    v_mul_f32 v240, v240, v10
    v_mul_f32 v241, v241, v10
    v_mul_f32 v242, v242, v10
    v_mul_f32 v243, v243, v10
    v_mul_f32 v244, v244, v11
    v_mul_f32 v245, v245, v11
    v_mul_f32 v246, v246, v11
    v_mul_f32 v247, v247, v11
    v_sub_f32 v144, v144, v8
    v_sub_f32 v160, v160, v8
    v_sub_f32 v176, v176, v8
    v_sub_f32 v145, v145, v8
    v_sub_f32 v161, v161, v8
    v_sub_f32 v177, v177, v8
    v_sub_f32 v146, v146, v8
    v_sub_f32 v162, v162, v8
    v_sub_f32 v178, v178, v8
    v_sub_f32 v147, v147, v8
    v_sub_f32 v163, v163, v8
    v_sub_f32 v179, v179, v8
    v_sub_f32 v148, v148, v9
    v_sub_f32 v164, v164, v9
    v_sub_f32 v180, v180, v9
    v_sub_f32 v149, v149, v9
    v_sub_f32 v165, v165, v9
    v_sub_f32 v181, v181, v9
    v_sub_f32 v150, v150, v9
    v_sub_f32 v166, v166, v9
    v_sub_f32 v182, v182, v9
    v_sub_f32 v151, v151, v9
    v_sub_f32 v167, v167, v9
    v_sub_f32 v183, v183, v9
    v_sub_f32 v152, v152, v8
    v_sub_f32 v168, v168, v8
    v_sub_f32 v184, v184, v8
    v_sub_f32 v153, v153, v8
    v_sub_f32 v169, v169, v8
    v_sub_f32 v185, v185, v8
    v_sub_f32 v154, v154, v8
    v_sub_f32 v170, v170, v8
    v_sub_f32 v186, v186, v8
    v_sub_f32 v155, v155, v8
    v_sub_f32 v171, v171, v8
    v_sub_f32 v187, v187, v8
    v_sub_f32 v156, v156, v9
    v_sub_f32 v172, v172, v9
    v_sub_f32 v188, v188, v9
    v_sub_f32 v157, v157, v9
    v_sub_f32 v173, v173, v9
    v_sub_f32 v189, v189, v9
    v_sub_f32 v158, v158, v9
    v_sub_f32 v174, v174, v9
    v_sub_f32 v190, v190, v9
    v_sub_f32 v159, v159, v9
    v_sub_f32 v175, v175, v9
    v_sub_f32 v191, v191, v9
    s_nop 1
    s_branch p2_kernel_losafe_l_sA_ret
p2_kernel_losafe_l_sB:
    s_nop 15
    v_mov_b32 v12, v8
    s_nop 1
    v_permlane32_swap_b32 v8, v12
    s_nop 1
    v_max_f32 v8, v8, v12
    v_mov_b32 v12, v8
    s_nop 1
    v_permlane16_swap_b32 v8, v12
    s_nop 1
    v_max_f32 v8, v8, v12
    v_max_f32 v8, 0, v8
    v_sub_f32 v10, 0, v8
    v_exp_f32 v10, v10
    s_nop 1
    v_mov_b32 v12, v9
    s_nop 1
    v_permlane32_swap_b32 v9, v12
    s_nop 1
    v_max_f32 v9, v9, v12
    v_mov_b32 v12, v9
    s_nop 1
    v_permlane16_swap_b32 v9, v12
    s_nop 1
    v_max_f32 v9, v9, v12
    v_max_f32 v9, 0, v9
    v_sub_f32 v11, 0, v9
    v_exp_f32 v11, v11
    s_nop 1
    v_mul_f32 v64, v64, v10
    v_mul_f32 v65, v65, v10
    v_mul_f32 v66, v66, v10
    v_mul_f32 v67, v67, v10
    v_mul_f32 v68, v68, v11
    v_mul_f32 v69, v69, v11
    v_mul_f32 v70, v70, v11
    v_mul_f32 v71, v71, v11
    v_mul_f32 v72, v72, v10
    v_mul_f32 v73, v73, v10
    v_mul_f32 v74, v74, v10
    v_mul_f32 v75, v75, v10
    v_mul_f32 v76, v76, v11
    v_mul_f32 v77, v77, v11
    v_mul_f32 v78, v78, v11
    v_mul_f32 v79, v79, v11
    v_mul_f32 v80, v80, v10
    v_mul_f32 v81, v81, v10
    v_mul_f32 v82, v82, v10
    v_mul_f32 v83, v83, v10
    v_mul_f32 v84, v84, v11
    v_mul_f32 v85, v85, v11
    v_mul_f32 v86, v86, v11
    v_mul_f32 v87, v87, v11
    v_mul_f32 v88, v88, v10
    v_mul_f32 v89, v89, v10
    v_mul_f32 v90, v90, v10
    v_mul_f32 v91, v91, v10
    v_mul_f32 v92, v92, v11
    v_mul_f32 v93, v93, v11
    v_mul_f32 v94, v94, v11
    v_mul_f32 v95, v95, v11
    v_mul_f32 v96, v96, v10
    v_mul_f32 v97, v97, v10
    v_mul_f32 v98, v98, v10
    v_mul_f32 v99, v99, v10
    v_mul_f32 v100, v100, v11
    v_mul_f32 v101, v101, v11
    v_mul_f32 v102, v102, v11
    v_mul_f32 v103, v103, v11
    v_mul_f32 v104, v104, v10
    v_mul_f32 v105, v105, v10
    v_mul_f32 v106, v106, v10
    v_mul_f32 v107, v107, v10
    v_mul_f32 v108, v108, v11
    v_mul_f32 v109, v109, v11
    v_mul_f32 v110, v110, v11
    v_mul_f32 v111, v111, v11
    v_mul_f32 v112, v112, v10
    v_mul_f32 v113, v113, v10
    v_mul_f32 v114, v114, v10
    v_mul_f32 v115, v115, v10
    v_mul_f32 v116, v116, v11
    v_mul_f32 v117, v117, v11
    v_mul_f32 v118, v118, v11
    v_mul_f32 v119, v119, v11
    v_mul_f32 v120, v120, v10
    v_mul_f32 v121, v121, v10
    v_mul_f32 v122, v122, v10
    v_mul_f32 v123, v123, v10
    v_mul_f32 v124, v124, v11
    v_mul_f32 v125, v125, v11
    v_mul_f32 v126, v126, v11
    v_mul_f32 v127, v127, v11
    v_mul_f32 v240, v240, v10
    v_mul_f32 v241, v241, v10
    v_mul_f32 v242, v242, v10
    v_mul_f32 v243, v243, v10
    v_mul_f32 v244, v244, v11
    v_mul_f32 v245, v245, v11
    v_mul_f32 v246, v246, v11
    v_mul_f32 v247, v247, v11
    v_sub_f32 v128, v128, v8
    v_sub_f32 v160, v160, v8
    v_sub_f32 v176, v176, v8
    v_sub_f32 v129, v129, v8
    v_sub_f32 v161, v161, v8
    v_sub_f32 v177, v177, v8
    v_sub_f32 v130, v130, v8
    v_sub_f32 v162, v162, v8
    v_sub_f32 v178, v178, v8
    v_sub_f32 v131, v131, v8
    v_sub_f32 v163, v163, v8
    v_sub_f32 v179, v179, v8
    v_sub_f32 v132, v132, v9
    v_sub_f32 v164, v164, v9
    v_sub_f32 v180, v180, v9
    v_sub_f32 v133, v133, v9
    v_sub_f32 v165, v165, v9
    v_sub_f32 v181, v181, v9
    v_sub_f32 v134, v134, v9
    v_sub_f32 v166, v166, v9
    v_sub_f32 v182, v182, v9
    v_sub_f32 v135, v135, v9
    v_sub_f32 v167, v167, v9
    v_sub_f32 v183, v183, v9
    v_sub_f32 v136, v136, v8
    v_sub_f32 v168, v168, v8
    v_sub_f32 v184, v184, v8
    v_sub_f32 v137, v137, v8
    v_sub_f32 v169, v169, v8
    v_sub_f32 v185, v185, v8
    v_sub_f32 v138, v138, v8
    v_sub_f32 v170, v170, v8
    v_sub_f32 v186, v186, v8
    v_sub_f32 v139, v139, v8
    v_sub_f32 v171, v171, v8
    v_sub_f32 v187, v187, v8
    v_sub_f32 v140, v140, v9
    v_sub_f32 v172, v172, v9
    v_sub_f32 v188, v188, v9
    v_sub_f32 v141, v141, v9
    v_sub_f32 v173, v173, v9
    v_sub_f32 v189, v189, v9
    v_sub_f32 v142, v142, v9
    v_sub_f32 v174, v174, v9
    v_sub_f32 v190, v190, v9
    v_sub_f32 v143, v143, v9
    v_sub_f32 v175, v175, v9
    v_sub_f32 v191, v191, v9
    s_nop 1
    s_branch p2_kernel_losafe_l_sB_ret
p2_kernel_losafe_p_sA:
    s_nop 15
    v_mov_b32 v12, v8
    s_nop 1
    v_permlane32_swap_b32 v8, v12
    s_nop 1
    v_max_f32 v8, v8, v12
    v_mov_b32 v12, v8
    s_nop 1
    v_permlane16_swap_b32 v8, v12
    s_nop 1
    v_max_f32 v8, v8, v12
    v_max_f32 v8, 0, v8
    v_sub_f32 v10, 0, v8
    v_exp_f32 v10, v10
    s_nop 1
    v_mov_b32 v12, v9
    s_nop 1
    v_permlane32_swap_b32 v9, v12
    s_nop 1
    v_max_f32 v9, v9, v12
    v_mov_b32 v12, v9
    s_nop 1
    v_permlane16_swap_b32 v9, v12
    s_nop 1
    v_max_f32 v9, v9, v12
    v_max_f32 v9, 0, v9
    v_sub_f32 v11, 0, v9
    v_exp_f32 v11, v11
    s_nop 1
    v_mul_f32 v64, v64, v10
    v_mul_f32 v65, v65, v10
    v_mul_f32 v66, v66, v10
    v_mul_f32 v67, v67, v10
    v_mul_f32 v68, v68, v11
    v_mul_f32 v69, v69, v11
    v_mul_f32 v70, v70, v11
    v_mul_f32 v71, v71, v11
    v_mul_f32 v72, v72, v10
    v_mul_f32 v73, v73, v10
    v_mul_f32 v74, v74, v10
    v_mul_f32 v75, v75, v10
    v_mul_f32 v76, v76, v11
    v_mul_f32 v77, v77, v11
    v_mul_f32 v78, v78, v11
    v_mul_f32 v79, v79, v11
    v_mul_f32 v80, v80, v10
    v_mul_f32 v81, v81, v10
    v_mul_f32 v82, v82, v10
    v_mul_f32 v83, v83, v10
    v_mul_f32 v84, v84, v11
    v_mul_f32 v85, v85, v11
    v_mul_f32 v86, v86, v11
    v_mul_f32 v87, v87, v11
    v_mul_f32 v88, v88, v10
    v_mul_f32 v89, v89, v10
    v_mul_f32 v90, v90, v10
    v_mul_f32 v91, v91, v10
    v_mul_f32 v92, v92, v11
    v_mul_f32 v93, v93, v11
    v_mul_f32 v94, v94, v11
    v_mul_f32 v95, v95, v11
    v_mul_f32 v96, v96, v10
    v_mul_f32 v97, v97, v10
    v_mul_f32 v98, v98, v10
    v_mul_f32 v99, v99, v10
    v_mul_f32 v100, v100, v11
    v_mul_f32 v101, v101, v11
    v_mul_f32 v102, v102, v11
    v_mul_f32 v103, v103, v11
    v_mul_f32 v104, v104, v10
    v_mul_f32 v105, v105, v10
    v_mul_f32 v106, v106, v10
    v_mul_f32 v107, v107, v10
    v_mul_f32 v108, v108, v11
    v_mul_f32 v109, v109, v11
    v_mul_f32 v110, v110, v11
    v_mul_f32 v111, v111, v11
    v_mul_f32 v112, v112, v10
    v_mul_f32 v113, v113, v10
    v_mul_f32 v114, v114, v10
    v_mul_f32 v115, v115, v10
    v_mul_f32 v116, v116, v11
    v_mul_f32 v117, v117, v11
    v_mul_f32 v118, v118, v11
    v_mul_f32 v119, v119, v11
    v_mul_f32 v120, v120, v10
    v_mul_f32 v121, v121, v10
    v_mul_f32 v122, v122, v10
    v_mul_f32 v123, v123, v10
    v_mul_f32 v124, v124, v11
    v_mul_f32 v125, v125, v11
    v_mul_f32 v126, v126, v11
    v_mul_f32 v127, v127, v11
    v_mul_f32 v240, v240, v10
    v_mul_f32 v241, v241, v10
    v_mul_f32 v242, v242, v10
    v_mul_f32 v243, v243, v10
    v_mul_f32 v244, v244, v11
    v_mul_f32 v245, v245, v11
    v_mul_f32 v246, v246, v11
    v_mul_f32 v247, v247, v11
    v_sub_f32 v144, v144, v8
    v_sub_f32 v160, v160, v8
    v_sub_f32 v176, v176, v8
    v_sub_f32 v145, v145, v8
    v_sub_f32 v161, v161, v8
    v_sub_f32 v177, v177, v8
    v_sub_f32 v146, v146, v8
    v_sub_f32 v162, v162, v8
    v_sub_f32 v178, v178, v8
    v_sub_f32 v147, v147, v8
    v_sub_f32 v163, v163, v8
    v_sub_f32 v179, v179, v8
    v_sub_f32 v148, v148, v9
    v_sub_f32 v164, v164, v9
    v_sub_f32 v180, v180, v9
    v_sub_f32 v149, v149, v9
    v_sub_f32 v165, v165, v9
    v_sub_f32 v181, v181, v9
    v_sub_f32 v150, v150, v9
    v_sub_f32 v166, v166, v9
    v_sub_f32 v182, v182, v9
    v_sub_f32 v151, v151, v9
    v_sub_f32 v167, v167, v9
    v_sub_f32 v183, v183, v9
    v_sub_f32 v152, v152, v8
    v_sub_f32 v168, v168, v8
    v_sub_f32 v184, v184, v8
    v_sub_f32 v153, v153, v8
    v_sub_f32 v169, v169, v8
    v_sub_f32 v185, v185, v8
    v_sub_f32 v154, v154, v8
    v_sub_f32 v170, v170, v8
    v_sub_f32 v186, v186, v8
    v_sub_f32 v155, v155, v8
    v_sub_f32 v171, v171, v8
    v_sub_f32 v187, v187, v8
    v_sub_f32 v156, v156, v9
    v_sub_f32 v172, v172, v9
    v_sub_f32 v188, v188, v9
    v_sub_f32 v157, v157, v9
    v_sub_f32 v173, v173, v9
    v_sub_f32 v189, v189, v9
    v_sub_f32 v158, v158, v9
    v_sub_f32 v174, v174, v9
    v_sub_f32 v190, v190, v9
    v_sub_f32 v159, v159, v9
    v_sub_f32 v175, v175, v9
    v_sub_f32 v191, v191, v9
    s_nop 1
    s_branch p2_kernel_losafe_p_sA_ret
p2_kernel_losafe_p_sB:
    s_nop 15
    v_mov_b32 v12, v8
    s_nop 1
    v_permlane32_swap_b32 v8, v12
    s_nop 1
    v_max_f32 v8, v8, v12
    v_mov_b32 v12, v8
    s_nop 1
    v_permlane16_swap_b32 v8, v12
    s_nop 1
    v_max_f32 v8, v8, v12
    v_max_f32 v8, 0, v8
    v_sub_f32 v10, 0, v8
    v_exp_f32 v10, v10
    s_nop 1
    v_mov_b32 v12, v9
    s_nop 1
    v_permlane32_swap_b32 v9, v12
    s_nop 1
    v_max_f32 v9, v9, v12
    v_mov_b32 v12, v9
    s_nop 1
    v_permlane16_swap_b32 v9, v12
    s_nop 1
    v_max_f32 v9, v9, v12
    v_max_f32 v9, 0, v9
    v_sub_f32 v11, 0, v9
    v_exp_f32 v11, v11
    s_nop 1
    v_mul_f32 v64, v64, v10
    v_mul_f32 v65, v65, v10
    v_mul_f32 v66, v66, v10
    v_mul_f32 v67, v67, v10
    v_mul_f32 v68, v68, v11
    v_mul_f32 v69, v69, v11
    v_mul_f32 v70, v70, v11
    v_mul_f32 v71, v71, v11
    v_mul_f32 v72, v72, v10
    v_mul_f32 v73, v73, v10
    v_mul_f32 v74, v74, v10
    v_mul_f32 v75, v75, v10
    v_mul_f32 v76, v76, v11
    v_mul_f32 v77, v77, v11
    v_mul_f32 v78, v78, v11
    v_mul_f32 v79, v79, v11
    v_mul_f32 v80, v80, v10
    v_mul_f32 v81, v81, v10
    v_mul_f32 v82, v82, v10
    v_mul_f32 v83, v83, v10
    v_mul_f32 v84, v84, v11
    v_mul_f32 v85, v85, v11
    v_mul_f32 v86, v86, v11
    v_mul_f32 v87, v87, v11
    v_mul_f32 v88, v88, v10
    v_mul_f32 v89, v89, v10
    v_mul_f32 v90, v90, v10
    v_mul_f32 v91, v91, v10
    v_mul_f32 v92, v92, v11
    v_mul_f32 v93, v93, v11
    v_mul_f32 v94, v94, v11
    v_mul_f32 v95, v95, v11
    v_mul_f32 v96, v96, v10
    v_mul_f32 v97, v97, v10
    v_mul_f32 v98, v98, v10
    v_mul_f32 v99, v99, v10
    v_mul_f32 v100, v100, v11
    v_mul_f32 v101, v101, v11
    v_mul_f32 v102, v102, v11
    v_mul_f32 v103, v103, v11
    v_mul_f32 v104, v104, v10
    v_mul_f32 v105, v105, v10
    v_mul_f32 v106, v106, v10
    v_mul_f32 v107, v107, v10
    v_mul_f32 v108, v108, v11
    v_mul_f32 v109, v109, v11
    v_mul_f32 v110, v110, v11
    v_mul_f32 v111, v111, v11
    v_mul_f32 v112, v112, v10
    v_mul_f32 v113, v113, v10
    v_mul_f32 v114, v114, v10
    v_mul_f32 v115, v115, v10
    v_mul_f32 v116, v116, v11
    v_mul_f32 v117, v117, v11
    v_mul_f32 v118, v118, v11
    v_mul_f32 v119, v119, v11
    v_mul_f32 v120, v120, v10
    v_mul_f32 v121, v121, v10
    v_mul_f32 v122, v122, v10
    v_mul_f32 v123, v123, v10
    v_mul_f32 v124, v124, v11
    v_mul_f32 v125, v125, v11
    v_mul_f32 v126, v126, v11
    v_mul_f32 v127, v127, v11
    v_mul_f32 v240, v240, v10
    v_mul_f32 v241, v241, v10
    v_mul_f32 v242, v242, v10
    v_mul_f32 v243, v243, v10
    v_mul_f32 v244, v244, v11
    v_mul_f32 v245, v245, v11
    v_mul_f32 v246, v246, v11
    v_mul_f32 v247, v247, v11
    v_sub_f32 v128, v128, v8
    v_sub_f32 v160, v160, v8
    v_sub_f32 v176, v176, v8
    v_sub_f32 v129, v129, v8
    v_sub_f32 v161, v161, v8
    v_sub_f32 v177, v177, v8
    v_sub_f32 v130, v130, v8
    v_sub_f32 v162, v162, v8
    v_sub_f32 v178, v178, v8
    v_sub_f32 v131, v131, v8
    v_sub_f32 v163, v163, v8
    v_sub_f32 v179, v179, v8
    v_sub_f32 v132, v132, v9
    v_sub_f32 v164, v164, v9
    v_sub_f32 v180, v180, v9
    v_sub_f32 v133, v133, v9
    v_sub_f32 v165, v165, v9
    v_sub_f32 v181, v181, v9
    v_sub_f32 v134, v134, v9
    v_sub_f32 v166, v166, v9
    v_sub_f32 v182, v182, v9
    v_sub_f32 v135, v135, v9
    v_sub_f32 v167, v167, v9
    v_sub_f32 v183, v183, v9
    v_sub_f32 v136, v136, v8
    v_sub_f32 v168, v168, v8
    v_sub_f32 v184, v184, v8
    v_sub_f32 v137, v137, v8
    v_sub_f32 v169, v169, v8
    v_sub_f32 v185, v185, v8
    v_sub_f32 v138, v138, v8
    v_sub_f32 v170, v170, v8
    v_sub_f32 v186, v186, v8
    v_sub_f32 v139, v139, v8
    v_sub_f32 v171, v171, v8
    v_sub_f32 v187, v187, v8
    v_sub_f32 v140, v140, v9
    v_sub_f32 v172, v172, v9
    v_sub_f32 v188, v188, v9
    v_sub_f32 v141, v141, v9
    v_sub_f32 v173, v173, v9
    v_sub_f32 v189, v189, v9
    v_sub_f32 v142, v142, v9
    v_sub_f32 v174, v174, v9
    v_sub_f32 v190, v190, v9
    v_sub_f32 v143, v143, v9
    v_sub_f32 v175, v175, v9
    v_sub_f32 v191, v191, v9
    s_nop 1
    s_branch p2_kernel_losafe_p_sB_ret
p2_kernel_losafe_f_sA:
    s_nop 15
    v_mov_b32 v12, v8
    s_nop 1
    v_permlane32_swap_b32 v8, v12
    s_nop 1
    v_max_f32 v8, v8, v12
    v_mov_b32 v12, v8
    s_nop 1
    v_permlane16_swap_b32 v8, v12
    s_nop 1
    v_max_f32 v8, v8, v12
    v_max_f32 v8, 0, v8
    v_sub_f32 v10, 0, v8
    v_exp_f32 v10, v10
    s_nop 1
    v_mov_b32 v12, v9
    s_nop 1
    v_permlane32_swap_b32 v9, v12
    s_nop 1
    v_max_f32 v9, v9, v12
    v_mov_b32 v12, v9
    s_nop 1
    v_permlane16_swap_b32 v9, v12
    s_nop 1
    v_max_f32 v9, v9, v12
    v_max_f32 v9, 0, v9
    v_sub_f32 v11, 0, v9
    v_exp_f32 v11, v11
    s_nop 1
    v_mul_f32 v64, v64, v10
    v_mul_f32 v65, v65, v10
    v_mul_f32 v66, v66, v10
    v_mul_f32 v67, v67, v10
    v_mul_f32 v68, v68, v11
    v_mul_f32 v69, v69, v11
    v_mul_f32 v70, v70, v11
    v_mul_f32 v71, v71, v11
    v_mul_f32 v72, v72, v10
    v_mul_f32 v73, v73, v10
    v_mul_f32 v74, v74, v10
    v_mul_f32 v75, v75, v10
    v_mul_f32 v76, v76, v11
    v_mul_f32 v77, v77, v11
    v_mul_f32 v78, v78, v11
    v_mul_f32 v79, v79, v11
    v_mul_f32 v80, v80, v10
    v_mul_f32 v81, v81, v10
    v_mul_f32 v82, v82, v10
    v_mul_f32 v83, v83, v10
    v_mul_f32 v84, v84, v11
    v_mul_f32 v85, v85, v11
    v_mul_f32 v86, v86, v11
    v_mul_f32 v87, v87, v11
    v_mul_f32 v88, v88, v10
    v_mul_f32 v89, v89, v10
    v_mul_f32 v90, v90, v10
    v_mul_f32 v91, v91, v10
    v_mul_f32 v92, v92, v11
    v_mul_f32 v93, v93, v11
    v_mul_f32 v94, v94, v11
    v_mul_f32 v95, v95, v11
    v_mul_f32 v96, v96, v10
    v_mul_f32 v97, v97, v10
    v_mul_f32 v98, v98, v10
    v_mul_f32 v99, v99, v10
    v_mul_f32 v100, v100, v11
    v_mul_f32 v101, v101, v11
    v_mul_f32 v102, v102, v11
    v_mul_f32 v103, v103, v11
    v_mul_f32 v104, v104, v10
    v_mul_f32 v105, v105, v10
    v_mul_f32 v106, v106, v10
    v_mul_f32 v107, v107, v10
    v_mul_f32 v108, v108, v11
    v_mul_f32 v109, v109, v11
    v_mul_f32 v110, v110, v11
    v_mul_f32 v111, v111, v11
    v_mul_f32 v112, v112, v10
    v_mul_f32 v113, v113, v10
    v_mul_f32 v114, v114, v10
    v_mul_f32 v115, v115, v10
    v_mul_f32 v116, v116, v11
    v_mul_f32 v117, v117, v11
    v_mul_f32 v118, v118, v11
    v_mul_f32 v119, v119, v11
    v_mul_f32 v120, v120, v10
    v_mul_f32 v121, v121, v10
    v_mul_f32 v122, v122, v10
    v_mul_f32 v123, v123, v10
    v_mul_f32 v124, v124, v11
    v_mul_f32 v125, v125, v11
    v_mul_f32 v126, v126, v11
    v_mul_f32 v127, v127, v11
    v_mul_f32 v240, v240, v10
    v_mul_f32 v241, v241, v10
    v_mul_f32 v242, v242, v10
    v_mul_f32 v243, v243, v10
    v_mul_f32 v244, v244, v11
    v_mul_f32 v245, v245, v11
    v_mul_f32 v246, v246, v11
    v_mul_f32 v247, v247, v11
    v_sub_f32 v144, v144, v8
    v_sub_f32 v160, v160, v8
    v_sub_f32 v176, v176, v8
    v_sub_f32 v145, v145, v8
    v_sub_f32 v161, v161, v8
    v_sub_f32 v177, v177, v8
    v_sub_f32 v146, v146, v8
    v_sub_f32 v162, v162, v8
    v_sub_f32 v178, v178, v8
    v_sub_f32 v147, v147, v8
    v_sub_f32 v163, v163, v8
    v_sub_f32 v179, v179, v8
    v_sub_f32 v148, v148, v9
    v_sub_f32 v164, v164, v9
    v_sub_f32 v180, v180, v9
    v_sub_f32 v149, v149, v9
    v_sub_f32 v165, v165, v9
    v_sub_f32 v181, v181, v9
    v_sub_f32 v150, v150, v9
    v_sub_f32 v166, v166, v9
    v_sub_f32 v182, v182, v9
    v_sub_f32 v151, v151, v9
    v_sub_f32 v167, v167, v9
    v_sub_f32 v183, v183, v9
    v_sub_f32 v152, v152, v8
    v_sub_f32 v168, v168, v8
    v_sub_f32 v184, v184, v8
    v_sub_f32 v153, v153, v8
    v_sub_f32 v169, v169, v8
    v_sub_f32 v185, v185, v8
    v_sub_f32 v154, v154, v8
    v_sub_f32 v170, v170, v8
    v_sub_f32 v186, v186, v8
    v_sub_f32 v155, v155, v8
    v_sub_f32 v171, v171, v8
    v_sub_f32 v187, v187, v8
    v_sub_f32 v156, v156, v9
    v_sub_f32 v172, v172, v9
    v_sub_f32 v188, v188, v9
    v_sub_f32 v157, v157, v9
    v_sub_f32 v173, v173, v9
    v_sub_f32 v189, v189, v9
    v_sub_f32 v158, v158, v9
    v_sub_f32 v174, v174, v9
    v_sub_f32 v190, v190, v9
    v_sub_f32 v159, v159, v9
    v_sub_f32 v175, v175, v9
    v_sub_f32 v191, v191, v9
    s_nop 1
    s_branch p2_kernel_losafe_f_sA_ret
.section .rodata,"a"
.p2align 6
.amdhsa_kernel p1_kernel
  .amdhsa_next_free_vgpr 512
  .amdhsa_next_free_sgpr 100
  .amdhsa_accum_offset 256
  .amdhsa_group_segment_fixed_size 0
  .amdhsa_kernarg_size 120
  .amdhsa_user_sgpr_count 2
  .amdhsa_user_sgpr_kernarg_segment_ptr 1
  .amdhsa_system_sgpr_workgroup_id_x 1
  .amdhsa_float_denorm_mode_32 3
  .amdhsa_float_denorm_mode_16_64 3
.end_amdhsa_kernel
.p2align 6
.amdhsa_kernel p2_kernel
  .amdhsa_next_free_vgpr 252
  .amdhsa_next_free_sgpr 102
  .amdhsa_accum_offset 252
  .amdhsa_group_segment_fixed_size 0
  .amdhsa_kernarg_size 120
  .amdhsa_user_sgpr_count 2
  .amdhsa_user_sgpr_kernarg_segment_ptr 1
  .amdhsa_system_sgpr_workgroup_id_x 1
  .amdhsa_float_denorm_mode_32 3
  .amdhsa_float_denorm_mode_16_64 3
.end_amdhsa_kernel
```
